```python
import torch

def _softmax(x, axis=-1):
    return torch.softmax(x, dim=axis)
def _gelu(x):
    return torch.nn.functional.gelu(x, approximate="tanh")
def _silu(x):
    return torch.nn.functional.silu(x)
def _sigmoid(x):
    return torch.sigmoid(x)
def _layernorm(x, axis=-1, eps=1e-5):
    m = x.mean(dim=axis, keepdim=True)
    v = x.var(dim=axis, keepdim=True, unbiased=False)
    return (x - m) / torch.sqrt(v + eps)
def _scatter_add(tgt, idx, src, axis=0):
    return tgt.clone().index_add_(axis, idx, src)
def _segment_sum(src, seg, n):
    out = torch.zeros((n,) + src.shape[1:], dtype=src.dtype)
    return out.index_add_(0, seg, src)
def _pad(x, pw):
    flat = tuple(v for pair in reversed(pw) for v in pair)
    return torch.nn.functional.pad(x, flat)

kernel_name = 'recurrent_scan__softmax_full_mha__glu_gated_glu__prompt'

def setup_inputs():

    _w = (lambda a: (lambda t: t.to(torch.bfloat16) if t.is_floating_point() else t)(torch.as_tensor(a)))
    def _A_setup():
        B, S, D = 1, 2048, 640
        return {
            "x": _w((lambda *s: torch.randn(*s, dtype=torch.bfloat16) * 0.05)(B, S, D)),
            "wqkv": _w((lambda *s: torch.randn(*s, dtype=torch.bfloat16) * 0.05)(D, 3 * D)),
            "wo": _w((lambda *s: torch.randn(*s, dtype=torch.bfloat16) * 0.05)(D, D)),
        }
    _A_in = _A_setup()

    def _B_setup():
        B, S, D, F = 1, 2048, 640, 1728
        return {
            "x": _w((lambda *s: torch.randn(*s, dtype=torch.bfloat16) * 0.05)(B, S, D)),
            "w_gate": _w((lambda *s: torch.randn(*s, dtype=torch.bfloat16) * 0.05)(D, F)),
            "w_up": _w((lambda *s: torch.randn(*s, dtype=torch.bfloat16) * 0.05)(D, F)),
            "w_down": _w((lambda *s: torch.randn(*s, dtype=torch.bfloat16) * 0.05)(F, D)),
        }
    _B_in = _B_setup()

    return {
        "A_x": _A_in["x"],
        "A_wqkv": _A_in["wqkv"],
        "A_wo": _A_in["wo"],
        "B_x": _B_in["x"],
        "B_w_gate": _B_in["w_gate"],
        "B_w_up": _B_in["w_up"],
        "B_w_down": _B_in["w_down"],
    }

def reference(A_x, A_wqkv, A_wo, B_x, B_w_gate, B_w_up, B_w_down):
    def _A_ref(x, wqkv, wo):
        B, S, D = x.shape
        H = 32; Dh = D // H
        qkv = (lambda x, *d: x.permute(*d))((x @ wqkv).reshape(B, S, 3, H, Dh), 2, 0, 3, 1, 4)
        q, k, v = qkv[0], qkv[1], qkv[2]
        scale = Dh ** -0.5
        scores = torch.einsum("bhqd,bhkd->bhqk", q, k) * scale
        p = _softmax(scores, axis=-1)
        o = torch.einsum("bhqk,bhkd->bhqd", p, v)
        return (lambda x, *d: x.permute(*d))(o, 0, 2, 1, 3).reshape(B, S, D) @ wo

    def _B_ref(x, w_gate, w_up, w_down):
        g = torch.einsum("bsd,df->bsf", x, w_gate)
        u = torch.einsum("bsd,df->bsf", x, w_up)
        h = _sigmoid(g) * u
        return torch.einsum("bsf,fd->bsd", h, w_down)

    x = A_x
    xn = _layernorm(x, axis=-1)
    s = _A_ref(xn, A_wqkv, A_wo)
    g = _silu(_B_ref(xn, B_w_gate, B_w_up, B_w_down))
    return x + s * g
```

```asm
; @launch grid=(512,1,1) block=(256,1,1) lds=81920
.amdgcn_target "amdgcn-amd-amdhsa--gfx950"
.text
.globl recurrent_scan__softmax_full_mha__glu_gated_glu__prompt_kernel
.p2align 8
.type recurrent_scan__softmax_full_mha__glu_gated_glu__prompt_kernel,@function
recurrent_scan__softmax_full_mha__glu_gated_glu__prompt_kernel:
    s_cmp_ge_u32 s2, 512
    s_cbranch_scc1 L_exit
    s_load_dwordx4 s[60:63], s[0:1], 0
    s_load_dwordx2 s[64:65], s[0:1], 16
    s_load_dwordx4 s[68:71], s[0:1], 40
    s_load_dwordx2 s[66:67], s[0:1], 32
    s_load_dwordx4 s[72:75], s[0:1], 56
    s_load_dwordx2 s[76:77], s[0:1], 72
    v_lshrrev_b32 v1, 6, v0
    s_nop 0
    v_readfirstlane_b32 s26, v1
    v_and_b32 v1, 63, v0
    s_lshr_b32 s27, s26, 1
    s_and_b32 s28, s26, 1
    s_lshl_b32 s23, s26, 10
    s_mov_b32 s78, 0
    s_cmp_ge_u32 s2, 256
    s_cbranch_scc1 L_roleB
    s_mov_b32 s3, s2
    s_setprio 1
    s_mov_b32 s79, 0x100000
    s_and_b32 s40, s3, 7
    s_lshr_b32 s41, s3, 3
    s_lshr_b32 s42, s40, 2
    s_and_b32 s43, s40, 3
    s_lshl_b32 s44, s42, 3
    s_and_b32 s45, s41, 7
    s_add_u32 s44, s44, s45
    s_lshr_b32 s46, s41, 3
    s_lshl_b32 s45, s43, 2
    s_add_u32 s45, s45, s46
    s_mul_i32 s47, s43, 7
    s_add_u32 s47, s47, s46
    s_mul_i32 s20, s44, 163840
    s_lshl_b32 s21, s45, 8
    s_lshl_b32 s22, s47, 7
    s_lshr_b32 s46, s41, 3
    s_mul_i32 s46, s46, 5
    s_and_b32 s25, s41, 7
    s_mul_i32 s25, s25, 5
    s_add_u32 s46, s46, s25
    s_mul_i32 s25, s46, 6554
    s_lshr_b32 s25, s25, 16
    s_mul_i32 s25, s25, 10
    s_sub_u32 s46, s46, s25
    s_mov_b32 s36, s20
    s_add_u32 s37, s20, 1280
    s_mul_i32 s25, s46, 128
    s_add_u32 s20, s20, s25
    s_mov_b32 s38, s21
    s_add_u32 s39, s21, 2457600
    s_mul_i32 s25, s46, 245760
    s_add_u32 s21, s21, s25
    s_mov_b32 s52, s22
    s_add_u32 s53, s22, 2211840
    s_mul_i32 s25, s46, 221184
    s_add_u32 s22, s22, s25
    v_lshrrev_b32 v14, 3, v1
    s_lshl_b32 s25, s26, 3
    v_add_u32 v14, s25, v14
    v_lshrrev_b32 v15, 4, v1
    s_lshl_b32 s25, s28, 2
    v_add_u32 v16, s25, v15
    v_and_b32 v17, 7, v1
    v_xor_b32 v16, v16, v17
    v_lshlrev_b32 v16, 4, v16
    s_mov_b32 s25, 1280
    v_mad_u32_u24 v2, v14, s25, v16
    v_and_b32 v15, 1, v15
    v_lshlrev_b32 v15, 2, v15
    v_xor_b32 v16, v15, v17
    v_lshlrev_b32 v16, 4, v16
    s_mov_b32 s25, 3456
    v_mad_u32_u24 v3, v14, s25, v16
    v_mov_b32 v13, v3
    v_lshrrev_b32 v14, 3, v1
    s_lshl_b32 s25, s26, 3
    v_add_u32 v14, s25, v14
    v_lshrrev_b32 v15, 4, v1
    s_lshl_b32 s25, s28, 2
    v_add_u32 v16, s25, v15
    v_and_b32 v17, 7, v1
    v_xor_b32 v16, v16, v17
    v_lshlrev_b32 v16, 4, v16
    s_mov_b32 s25, 1280
    v_mad_u32_u24 v2, v14, s25, v16
    v_and_b32 v15, 1, v15
    v_lshlrev_b32 v15, 2, v15
    v_xor_b32 v16, v15, v17
    v_lshlrev_b32 v16, 4, v16
    s_mov_b32 s25, 3840
    v_mad_u32_u24 v3, v14, s25, v16
    s_waitcnt lgkmcnt(0)
    s_add_u32 s56, s76, 65536
    s_addc_u32 s57, s77, 0
    s_and_b32 s57, s57, 0xffff
    s_mov_b32 s58, 57344
    s_mov_b32 s59, 0x00020000
    s_mov_b32 s4, s60
    s_mov_b32 s5, s61
    s_and_b32 s5, s5, 0xffff
    s_mov_b32 s6, 2621440
    s_mov_b32 s7, 0x00020000
    s_mov_b32 s8, s62
    s_mov_b32 s9, s63
    s_and_b32 s9, s9, 0xffff
    s_mov_b32 s10, 2457600
    s_mov_b32 s11, 0x00020000
    s_add_u32 m0, s23, 0
    s_add_u32 s25, s20, 0
    buffer_load_dwordx4 v2, s[4:7], s25 offen lds
    s_add_u32 m0, s23, 4096
    s_add_u32 s25, s20, 40960
    buffer_load_dwordx4 v2, s[4:7], s25 offen lds
    s_add_u32 m0, s23, 8192
    s_add_u32 s25, s20, 81920
    buffer_load_dwordx4 v2, s[4:7], s25 offen lds
    s_add_u32 m0, s23, 12288
    s_add_u32 s25, s20, 122880
    buffer_load_dwordx4 v2, s[4:7], s25 offen lds
    s_add_u32 s20, s20, 128
    s_cmp_eq_u32 s20, s37
    s_cselect_b32 s20, s36, s20
    s_add_u32 m0, s23, 16384
    s_add_u32 s25, s21, 0
    buffer_load_dwordx4 v3, s[8:11], s25 offen lds
    s_add_u32 m0, s23, 20480
    s_add_u32 s25, s21, 122880
    buffer_load_dwordx4 v3, s[8:11], s25 offen lds
    s_add_u32 m0, s23, 24576
    s_add_u32 s25, s21, 128
    buffer_load_dwordx4 v3, s[8:11], s25 offen lds
    s_add_u32 m0, s23, 28672
    s_add_u32 s25, s21, 123008
    buffer_load_dwordx4 v3, s[8:11], s25 offen lds
    s_add_u32 s21, s21, 245760
    s_cmp_eq_u32 s21, s39
    s_cselect_b32 s21, s38, s21
    s_mov_b32 s12, s66
    s_mov_b32 s13, s67
    s_and_b32 s13, s13, 0xffff
    s_mov_b32 s14, 2211840
    s_mov_b32 s15, 0x00020000
    s_mov_b32 s16, s68
    s_mov_b32 s17, s69
    s_and_b32 s17, s17, 0xffff
    s_mov_b32 s18, 2211840
    s_mov_b32 s19, 0x00020000
    s_mov_b32 s48, s76
    s_mov_b32 s49, s77
    s_and_b32 s49, s49, 0xffff
    s_mov_b32 s50, 65536
    s_mov_b32 s51, 0x00020000
    s_add_u32 m0, s23, 32768
    s_add_u32 s25, s22, 0
    buffer_load_dwordx4 v13, s[12:15], s25 offen lds
    s_add_u32 m0, s23, 36864
    s_add_u32 s25, s22, 110592
    buffer_load_dwordx4 v13, s[12:15], s25 offen lds
    s_add_u32 m0, s23, 40960
    s_add_u32 s25, s22, 0
    buffer_load_dwordx4 v13, s[16:19], s25 offen lds
    s_add_u32 m0, s23, 45056
    s_add_u32 s25, s22, 110592
    buffer_load_dwordx4 v13, s[16:19], s25 offen lds
    s_add_u32 s22, s22, 221184
    s_cmp_eq_u32 s22, s53
    s_cselect_b32 s22, s52, s22
    v_and_b32 v14, 31, v1
    v_lshrrev_b32 v15, 5, v1
    v_bfe_u32 v16, v14, 1, 3
    v_xor_b32 v16, v16, v15
    s_mul_i32 s25, s27, 64
    v_add_u32 v17, s25, v14
    v_lshlrev_b32 v17, 7, v17
    v_xor_b32 v18, 0, v16
    v_lshl_add_u32 v4, v18, 4, v17
    v_add_u32 v8, 0x10000, v4
    v_xor_b32 v18, 2, v16
    v_lshl_add_u32 v5, v18, 4, v17
    v_add_u32 v9, 0x10000, v5
    v_xor_b32 v18, 4, v16
    v_lshl_add_u32 v6, v18, 4, v17
    v_add_u32 v10, 0x10000, v6
    v_xor_b32 v18, 6, v16
    v_lshl_add_u32 v7, v18, 4, v17
    v_add_u32 v11, 0x10000, v7
    v_lshrrev_b32 v14, 4, v1
    v_and_b32 v15, 1, v14
    v_lshrrev_b32 v14, 1, v14
    v_and_b32 v16, 15, v1
    v_lshrrev_b32 v17, 2, v16
    v_lshl_add_u32 v17, v14, 3, v17
    v_lshlrev_b32 v17, 7, v17
    v_bfe_u32 v18, v16, 1, 1
    v_lshl_add_u32 v18, v15, 1, v18
    s_lshl_b32 s25, s28, 2
    v_add_u32 v18, s25, v18
    v_bfe_u32 v19, v16, 3, 1
    v_lshlrev_b32 v19, 2, v19
    v_xor_b32 v18, v18, v19
    v_lshl_add_u32 v17, v18, 4, v17
    v_and_b32 v19, 1, v16
    v_lshl_add_u32 v12, v19, 3, v17
    s_lshl_b32 s25, s27, 13
    v_add_u32 v228, s25, v12
    s_xor_b32 s25, s25, 0x2000
    v_add_u32 v230, s25, v12
    v_add_u32 v229, 0x10000, v228
    v_add_u32 v231, 0x10000, v230
    v_and_b32 v14, 15, v1
    v_bfe_u32 v15, v1, 4, 1
    v_cmp_eq_u32 vcc, v14, v15
    v_mov_b32 v16, 0x3f803f80
    s_nop 0
    v_cndmask_b32 v224, 0, v16, vcc
    v_mov_b32 v225, v224
    v_mov_b32 v226, v224
    v_mov_b32 v227, v224
    s_lshl_b32 s46, s44, 7
    s_cmp_eq_u32 s45, 15
    s_cbranch_scc1 L_af_v_2_qk
    s_cmp_ge_u32 s45, 10
    s_cbranch_scc1 L_af_v_2
L_af_v_2_qk:
    s_waitcnt vmcnt(4)
    s_barrier
    ds_read_b128 v[192:195], v4 offset:0
    ds_read_b128 v[196:199], v4 offset:4096
    ds_read_b64_tr_b16 v[32:33], v228 offset:16384
    ds_read_b64_tr_b16 v[34:35], v228 offset:16896
    ds_read_b64_tr_b16 v[36:37], v230 offset:16384
    ds_read_b64_tr_b16 v[38:39], v230 offset:16896
    ds_read_b128 v[200:203], v5 offset:0
    ds_read_b128 v[204:207], v5 offset:4096
    ds_read_b64_tr_b16 v[40:41], v228 offset:18432
    ds_read_b64_tr_b16 v[42:43], v228 offset:18944
    ds_read_b64_tr_b16 v[44:45], v230 offset:18432
    ds_read_b64_tr_b16 v[46:47], v230 offset:18944
    s_waitcnt lgkmcnt(6)
    v_mfma_f32_32x32x16_bf16 v[64:79], v[32:35], v[192:195], 0
    ds_read_b128 v[208:211], v6 offset:0
    ds_read_b128 v[212:215], v6 offset:4096
    v_mfma_f32_32x32x16_bf16 v[80:95], v[36:39], v[192:195], 0
    ds_read_b64_tr_b16 v[48:49], v228 offset:20480
    s_add_u32 m0, s23, 49152
    s_add_u32 s25, s20, 0
    buffer_load_dwordx4 v2, s[4:7], s25 offen lds
    v_mfma_f32_16x16x32_bf16 v[56:59], v[32:35], v[224:227], 0
    ds_read_b64_tr_b16 v[50:51], v228 offset:20992
    s_add_u32 m0, s23, 53248
    s_add_u32 s25, s20, 40960
    buffer_load_dwordx4 v2, s[4:7], s25 offen lds
    v_mfma_f32_32x32x16_bf16 v[96:111], v[32:35], v[196:199], 0
    ds_read_b64_tr_b16 v[52:53], v230 offset:20480
    s_add_u32 m0, s23, 57344
    s_add_u32 s25, s20, 81920
    buffer_load_dwordx4 v2, s[4:7], s25 offen lds
    v_mfma_f32_32x32x16_bf16 v[112:127], v[36:39], v[196:199], 0
    ds_read_b64_tr_b16 v[54:55], v230 offset:20992
    s_add_u32 m0, s23, 61440
    s_add_u32 s25, s20, 122880
    buffer_load_dwordx4 v2, s[4:7], s25 offen lds
    s_add_u32 s20, s20, 128
    s_cmp_eq_u32 s20, s37
    s_cselect_b32 s20, s36, s20
    s_waitcnt lgkmcnt(6)
    v_mfma_f32_32x32x16_bf16 v[64:79], v[40:43], v[200:203], v[64:79]
    ds_read_b128 v[216:219], v7 offset:0
    ds_read_b128 v[220:223], v7 offset:4096
    v_mfma_f32_32x32x16_bf16 v[80:95], v[44:47], v[200:203], v[80:95]
    ds_read_b64_tr_b16 v[32:33], v228 offset:22528
    s_add_u32 m0, s23, 65536
    s_add_u32 s25, s21, 0
    buffer_load_dwordx4 v3, s[8:11], s25 offen lds
    v_mfma_f32_16x16x32_bf16 v[56:59], v[40:43], v[224:227], v[56:59]
    ds_read_b64_tr_b16 v[34:35], v228 offset:23040
    s_add_u32 m0, s23, 69632
    s_add_u32 s25, s21, 122880
    buffer_load_dwordx4 v3, s[8:11], s25 offen lds
    v_mfma_f32_32x32x16_bf16 v[96:111], v[40:43], v[204:207], v[96:111]
    ds_read_b64_tr_b16 v[36:37], v230 offset:22528
    s_add_u32 m0, s23, 73728
    s_add_u32 s25, s21, 128
    buffer_load_dwordx4 v3, s[8:11], s25 offen lds
    v_mfma_f32_32x32x16_bf16 v[112:127], v[44:47], v[204:207], v[112:127]
    ds_read_b64_tr_b16 v[38:39], v230 offset:23040
    s_add_u32 m0, s23, 77824
    s_add_u32 s25, s21, 123008
    buffer_load_dwordx4 v3, s[8:11], s25 offen lds
    s_add_u32 s21, s21, 245760
    s_cmp_eq_u32 s21, s39
    s_cselect_b32 s21, s38, s21
    s_waitcnt lgkmcnt(6)
    v_mfma_f32_32x32x16_bf16 v[64:79], v[48:51], v[208:211], v[64:79]
    v_mfma_f32_32x32x16_bf16 v[80:95], v[52:55], v[208:211], v[80:95]
    s_waitcnt vmcnt(8) lgkmcnt(0)
    s_barrier
    ds_read_b64_tr_b16 v[40:41], v228 offset:32768
    v_mfma_f32_16x16x32_bf16 v[56:59], v[48:51], v[224:227], v[56:59]
    ds_read_b64_tr_b16 v[42:43], v228 offset:33280
    s_add_u32 m0, s23, 0
    s_add_u32 s25, s22, 0
    buffer_load_dwordx4 v13, s[12:15], s25 offen lds
    v_mfma_f32_32x32x16_bf16 v[96:111], v[48:51], v[212:215], v[96:111]
    ds_read_b64_tr_b16 v[44:45], v230 offset:32768
    v_mfma_f32_32x32x16_bf16 v[112:127], v[52:55], v[212:215], v[112:127]
    ds_read_b64_tr_b16 v[46:47], v230 offset:33280
    s_add_u32 m0, s23, 4096
    s_add_u32 s25, s22, 110592
    buffer_load_dwordx4 v13, s[12:15], s25 offen lds
    s_waitcnt lgkmcnt(4)
    v_mfma_f32_32x32x16_bf16 v[64:79], v[32:35], v[216:219], v[64:79]
    ds_read_b64_tr_b16 v[48:49], v228 offset:34816
    v_mfma_f32_32x32x16_bf16 v[80:95], v[36:39], v[216:219], v[80:95]
    ds_read_b64_tr_b16 v[50:51], v228 offset:35328
    v_mfma_f32_16x16x32_bf16 v[56:59], v[32:35], v[224:227], v[56:59]
    ds_read_b64_tr_b16 v[52:53], v230 offset:34816
    s_add_u32 m0, s23, 8192
    s_add_u32 s25, s22, 0
    buffer_load_dwordx4 v13, s[16:19], s25 offen lds
    v_mfma_f32_32x32x16_bf16 v[96:111], v[32:35], v[220:223], v[96:111]
    ds_read_b64_tr_b16 v[54:55], v230 offset:35328
    v_mfma_f32_32x32x16_bf16 v[112:127], v[36:39], v[220:223], v[112:127]
    s_add_u32 m0, s23, 12288
    s_add_u32 s25, s22, 110592
    buffer_load_dwordx4 v13, s[16:19], s25 offen lds
    s_add_u32 s22, s22, 221184
    s_cmp_eq_u32 s22, s53
    s_cselect_b32 s22, s52, s22
    s_waitcnt lgkmcnt(4)
    v_mfma_f32_32x32x16_bf16 v[128:143], v[40:43], v[192:195], 0
    ds_read_b64_tr_b16 v[32:33], v228 offset:36864
    v_mfma_f32_32x32x16_bf16 v[144:159], v[44:47], v[192:195], 0
    ds_read_b64_tr_b16 v[34:35], v228 offset:37376
    v_mfma_f32_16x16x32_bf16 v[60:63], v[40:43], v[224:227], 0
    ds_read_b64_tr_b16 v[36:37], v230 offset:36864
    s_add_u32 m0, s23, 16384
    s_add_u32 s25, s20, 0
    buffer_load_dwordx4 v2, s[4:7], s25 offen lds
    v_mfma_f32_32x32x16_bf16 v[160:175], v[40:43], v[196:199], 0
    ds_read_b64_tr_b16 v[38:39], v230 offset:37376
    v_mfma_f32_32x32x16_bf16 v[176:191], v[44:47], v[196:199], 0
    s_add_u32 m0, s23, 20480
    s_add_u32 s25, s20, 40960
    buffer_load_dwordx4 v2, s[4:7], s25 offen lds
    s_waitcnt lgkmcnt(4)
    v_mfma_f32_32x32x16_bf16 v[128:143], v[48:51], v[200:203], v[128:143]
    ds_read_b64_tr_b16 v[40:41], v228 offset:38912
    v_mfma_f32_32x32x16_bf16 v[144:159], v[52:55], v[200:203], v[144:159]
    ds_read_b64_tr_b16 v[42:43], v228 offset:39424
    v_mfma_f32_16x16x32_bf16 v[60:63], v[48:51], v[224:227], v[60:63]
    ds_read_b64_tr_b16 v[44:45], v230 offset:38912
    s_add_u32 m0, s23, 24576
    s_add_u32 s25, s20, 81920
    buffer_load_dwordx4 v2, s[4:7], s25 offen lds
    v_mfma_f32_32x32x16_bf16 v[160:175], v[48:51], v[204:207], v[160:175]
    ds_read_b64_tr_b16 v[46:47], v230 offset:39424
    v_mfma_f32_32x32x16_bf16 v[176:191], v[52:55], v[204:207], v[176:191]
    s_add_u32 m0, s23, 28672
    s_add_u32 s25, s20, 122880
    buffer_load_dwordx4 v2, s[4:7], s25 offen lds
    s_add_u32 s20, s20, 128
    s_cmp_eq_u32 s20, s37
    s_cselect_b32 s20, s36, s20
    s_waitcnt lgkmcnt(4)
    v_mfma_f32_32x32x16_bf16 v[128:143], v[32:35], v[208:211], v[128:143]
    v_mfma_f32_32x32x16_bf16 v[144:159], v[36:39], v[208:211], v[144:159]
    s_waitcnt vmcnt(8) lgkmcnt(0)
    s_barrier
    ds_read_b128 v[192:195], v4 offset:49152
    ds_read_b128 v[196:199], v4 offset:53248
    v_mfma_f32_16x16x32_bf16 v[60:63], v[32:35], v[224:227], v[60:63]
    ds_read_b64_tr_b16 v[48:49], v229 offset:0
    v_mfma_f32_32x32x16_bf16 v[160:175], v[32:35], v[212:215], v[160:175]
    ds_read_b64_tr_b16 v[50:51], v229 offset:512
    ds_read_b64_tr_b16 v[52:53], v231 offset:0
    v_mfma_f32_32x32x16_bf16 v[176:191], v[36:39], v[212:215], v[176:191]
    ds_read_b64_tr_b16 v[54:55], v231 offset:512
    s_add_u32 m0, s23, 32768
    s_add_u32 s25, s21, 0
    buffer_load_dwordx4 v3, s[8:11], s25 offen lds
    s_waitcnt lgkmcnt(6)
    v_mfma_f32_32x32x16_bf16 v[128:143], v[40:43], v[216:219], v[128:143]
    ds_read_b128 v[200:203], v5 offset:49152
    ds_read_b128 v[204:207], v5 offset:53248
    v_mfma_f32_32x32x16_bf16 v[144:159], v[44:47], v[216:219], v[144:159]
    ds_read_b64_tr_b16 v[32:33], v229 offset:2048
    v_mfma_f32_16x16x32_bf16 v[60:63], v[40:43], v[224:227], v[60:63]
    ds_read_b64_tr_b16 v[34:35], v229 offset:2560
    v_mfma_f32_32x32x16_bf16 v[160:175], v[40:43], v[220:223], v[160:175]
    ds_read_b64_tr_b16 v[36:37], v231 offset:2048
    v_mfma_f32_32x32x16_bf16 v[176:191], v[44:47], v[220:223], v[176:191]
    ds_read_b64_tr_b16 v[38:39], v231 offset:2560
    s_add_u32 m0, s23, 36864
    s_add_u32 s25, s21, 122880
    buffer_load_dwordx4 v3, s[8:11], s25 offen lds
    s_waitcnt lgkmcnt(6)
    v_mfma_f32_32x32x16_bf16 v[64:79], v[48:51], v[192:195], v[64:79]
    ds_read_b128 v[208:211], v6 offset:49152
    ds_read_b128 v[212:215], v6 offset:53248
    v_mfma_f32_32x32x16_bf16 v[80:95], v[52:55], v[192:195], v[80:95]
    ds_read_b64_tr_b16 v[40:41], v229 offset:4096
    v_mfma_f32_16x16x32_bf16 v[56:59], v[48:51], v[224:227], v[56:59]
    ds_read_b64_tr_b16 v[42:43], v229 offset:4608
    v_mfma_f32_32x32x16_bf16 v[96:111], v[48:51], v[196:199], v[96:111]
    ds_read_b64_tr_b16 v[44:45], v231 offset:4096
    v_mfma_f32_32x32x16_bf16 v[112:127], v[52:55], v[196:199], v[112:127]
    ds_read_b64_tr_b16 v[46:47], v231 offset:4608
    s_add_u32 m0, s23, 40960
    s_add_u32 s25, s21, 128
    buffer_load_dwordx4 v3, s[8:11], s25 offen lds
    s_waitcnt lgkmcnt(6)
    v_mfma_f32_32x32x16_bf16 v[64:79], v[32:35], v[200:203], v[64:79]
    ds_read_b128 v[216:219], v7 offset:49152
    ds_read_b128 v[220:223], v7 offset:53248
    v_mfma_f32_32x32x16_bf16 v[80:95], v[36:39], v[200:203], v[80:95]
    ds_read_b64_tr_b16 v[48:49], v229 offset:6144
    v_mfma_f32_16x16x32_bf16 v[56:59], v[32:35], v[224:227], v[56:59]
    ds_read_b64_tr_b16 v[50:51], v229 offset:6656
    v_mfma_f32_32x32x16_bf16 v[96:111], v[32:35], v[204:207], v[96:111]
    ds_read_b64_tr_b16 v[52:53], v231 offset:6144
    v_mfma_f32_32x32x16_bf16 v[112:127], v[36:39], v[204:207], v[112:127]
    ds_read_b64_tr_b16 v[54:55], v231 offset:6656
    s_add_u32 m0, s23, 45056
    s_add_u32 s25, s21, 123008
    buffer_load_dwordx4 v3, s[8:11], s25 offen lds
    s_add_u32 s21, s21, 245760
    s_cmp_eq_u32 s21, s39
    s_cselect_b32 s21, s38, s21
    s_waitcnt lgkmcnt(6)
    v_mfma_f32_32x32x16_bf16 v[64:79], v[40:43], v[208:211], v[64:79]
    v_mfma_f32_32x32x16_bf16 v[80:95], v[44:47], v[208:211], v[80:95]
    s_waitcnt vmcnt(8) lgkmcnt(0)
    s_barrier
    ds_read_b64_tr_b16 v[32:33], v228 offset:0
    v_mfma_f32_16x16x32_bf16 v[56:59], v[40:43], v[224:227], v[56:59]
    ds_read_b64_tr_b16 v[34:35], v228 offset:512
    s_add_u32 m0, s23, 49152
    s_add_u32 s25, s22, 0
    buffer_load_dwordx4 v13, s[12:15], s25 offen lds
    v_mfma_f32_32x32x16_bf16 v[96:111], v[40:43], v[212:215], v[96:111]
    ds_read_b64_tr_b16 v[36:37], v230 offset:0
    v_mfma_f32_32x32x16_bf16 v[112:127], v[44:47], v[212:215], v[112:127]
    ds_read_b64_tr_b16 v[38:39], v230 offset:512
    s_add_u32 m0, s23, 53248
    s_add_u32 s25, s22, 110592
    buffer_load_dwordx4 v13, s[12:15], s25 offen lds
    s_waitcnt lgkmcnt(4)
    v_mfma_f32_32x32x16_bf16 v[64:79], v[48:51], v[216:219], v[64:79]
    ds_read_b64_tr_b16 v[40:41], v228 offset:2048
    v_mfma_f32_32x32x16_bf16 v[80:95], v[52:55], v[216:219], v[80:95]
    ds_read_b64_tr_b16 v[42:43], v228 offset:2560
    v_mfma_f32_16x16x32_bf16 v[56:59], v[48:51], v[224:227], v[56:59]
    ds_read_b64_tr_b16 v[44:45], v230 offset:2048
    s_add_u32 m0, s23, 57344
    s_add_u32 s25, s22, 0
    buffer_load_dwordx4 v13, s[16:19], s25 offen lds
    v_mfma_f32_32x32x16_bf16 v[96:111], v[48:51], v[220:223], v[96:111]
    ds_read_b64_tr_b16 v[46:47], v230 offset:2560
    v_mfma_f32_32x32x16_bf16 v[112:127], v[52:55], v[220:223], v[112:127]
    s_add_u32 m0, s23, 61440
    s_add_u32 s25, s22, 110592
    buffer_load_dwordx4 v13, s[16:19], s25 offen lds
    s_add_u32 s22, s22, 221184
    s_cmp_eq_u32 s22, s53
    s_cselect_b32 s22, s52, s22
    s_waitcnt lgkmcnt(4)
    v_mfma_f32_32x32x16_bf16 v[128:143], v[32:35], v[192:195], v[128:143]
    ds_read_b64_tr_b16 v[48:49], v228 offset:4096
    v_mfma_f32_32x32x16_bf16 v[144:159], v[36:39], v[192:195], v[144:159]
    ds_read_b64_tr_b16 v[50:51], v228 offset:4608
    v_mfma_f32_16x16x32_bf16 v[60:63], v[32:35], v[224:227], v[60:63]
    ds_read_b64_tr_b16 v[52:53], v230 offset:4096
    s_add_u32 m0, s23, 65536
    s_add_u32 s25, s20, 0
    buffer_load_dwordx4 v2, s[4:7], s25 offen lds
    v_mfma_f32_32x32x16_bf16 v[160:175], v[32:35], v[196:199], v[160:175]
    ds_read_b64_tr_b16 v[54:55], v230 offset:4608
    v_mfma_f32_32x32x16_bf16 v[176:191], v[36:39], v[196:199], v[176:191]
    s_add_u32 m0, s23, 69632
    s_add_u32 s25, s20, 40960
    buffer_load_dwordx4 v2, s[4:7], s25 offen lds
    s_waitcnt lgkmcnt(4)
    v_mfma_f32_32x32x16_bf16 v[128:143], v[40:43], v[200:203], v[128:143]
    ds_read_b64_tr_b16 v[32:33], v228 offset:6144
    v_mfma_f32_32x32x16_bf16 v[144:159], v[44:47], v[200:203], v[144:159]
    ds_read_b64_tr_b16 v[34:35], v228 offset:6656
    v_mfma_f32_16x16x32_bf16 v[60:63], v[40:43], v[224:227], v[60:63]
    ds_read_b64_tr_b16 v[36:37], v230 offset:6144
    s_add_u32 m0, s23, 73728
    s_add_u32 s25, s20, 81920
    buffer_load_dwordx4 v2, s[4:7], s25 offen lds
    v_mfma_f32_32x32x16_bf16 v[160:175], v[40:43], v[204:207], v[160:175]
    ds_read_b64_tr_b16 v[38:39], v230 offset:6656
    v_mfma_f32_32x32x16_bf16 v[176:191], v[44:47], v[204:207], v[176:191]
    s_add_u32 m0, s23, 77824
    s_add_u32 s25, s20, 122880
    buffer_load_dwordx4 v2, s[4:7], s25 offen lds
    s_add_u32 s20, s20, 128
    s_cmp_eq_u32 s20, s37
    s_cselect_b32 s20, s36, s20
    s_waitcnt lgkmcnt(4)
    v_mfma_f32_32x32x16_bf16 v[128:143], v[48:51], v[208:211], v[128:143]
    v_mfma_f32_32x32x16_bf16 v[144:159], v[52:55], v[208:211], v[144:159]
    s_waitcnt vmcnt(8) lgkmcnt(0)
    s_barrier
    ds_read_b128 v[192:195], v4 offset:16384
    ds_read_b128 v[196:199], v4 offset:20480
    v_mfma_f32_16x16x32_bf16 v[60:63], v[48:51], v[224:227], v[60:63]
    ds_read_b64_tr_b16 v[40:41], v228 offset:32768
    v_mfma_f32_32x32x16_bf16 v[160:175], v[48:51], v[212:215], v[160:175]
    ds_read_b64_tr_b16 v[42:43], v228 offset:33280
    ds_read_b64_tr_b16 v[44:45], v230 offset:32768
    v_mfma_f32_32x32x16_bf16 v[176:191], v[52:55], v[212:215], v[176:191]
    ds_read_b64_tr_b16 v[46:47], v230 offset:33280
    s_add_u32 m0, s23, 0
    s_add_u32 s25, s21, 0
    buffer_load_dwordx4 v3, s[8:11], s25 offen lds
    s_waitcnt lgkmcnt(6)
    v_mfma_f32_32x32x16_bf16 v[128:143], v[32:35], v[216:219], v[128:143]
    ds_read_b128 v[200:203], v5 offset:16384
    ds_read_b128 v[204:207], v5 offset:20480
    v_mfma_f32_32x32x16_bf16 v[144:159], v[36:39], v[216:219], v[144:159]
    ds_read_b64_tr_b16 v[48:49], v228 offset:34816
    v_mfma_f32_16x16x32_bf16 v[60:63], v[32:35], v[224:227], v[60:63]
    ds_read_b64_tr_b16 v[50:51], v228 offset:35328
    v_mfma_f32_32x32x16_bf16 v[160:175], v[32:35], v[220:223], v[160:175]
    ds_read_b64_tr_b16 v[52:53], v230 offset:34816
    v_mfma_f32_32x32x16_bf16 v[176:191], v[36:39], v[220:223], v[176:191]
    ds_read_b64_tr_b16 v[54:55], v230 offset:35328
    s_add_u32 m0, s23, 4096
    s_add_u32 s25, s21, 122880
    buffer_load_dwordx4 v3, s[8:11], s25 offen lds
    s_waitcnt lgkmcnt(6)
    v_mfma_f32_32x32x16_bf16 v[64:79], v[40:43], v[192:195], v[64:79]
    ds_read_b128 v[208:211], v6 offset:16384
    ds_read_b128 v[212:215], v6 offset:20480
    v_mfma_f32_32x32x16_bf16 v[80:95], v[44:47], v[192:195], v[80:95]
    ds_read_b64_tr_b16 v[32:33], v228 offset:36864
    v_mfma_f32_16x16x32_bf16 v[56:59], v[40:43], v[224:227], v[56:59]
    ds_read_b64_tr_b16 v[34:35], v228 offset:37376
    v_mfma_f32_32x32x16_bf16 v[96:111], v[40:43], v[196:199], v[96:111]
    ds_read_b64_tr_b16 v[36:37], v230 offset:36864
    v_mfma_f32_32x32x16_bf16 v[112:127], v[44:47], v[196:199], v[112:127]
    ds_read_b64_tr_b16 v[38:39], v230 offset:37376
    s_add_u32 m0, s23, 8192
    s_add_u32 s25, s21, 128
    buffer_load_dwordx4 v3, s[8:11], s25 offen lds
    s_waitcnt lgkmcnt(6)
    v_mfma_f32_32x32x16_bf16 v[64:79], v[48:51], v[200:203], v[64:79]
    ds_read_b128 v[216:219], v7 offset:16384
    ds_read_b128 v[220:223], v7 offset:20480
    v_mfma_f32_32x32x16_bf16 v[80:95], v[52:55], v[200:203], v[80:95]
    ds_read_b64_tr_b16 v[40:41], v228 offset:38912
    v_mfma_f32_16x16x32_bf16 v[56:59], v[48:51], v[224:227], v[56:59]
    ds_read_b64_tr_b16 v[42:43], v228 offset:39424
    v_mfma_f32_32x32x16_bf16 v[96:111], v[48:51], v[204:207], v[96:111]
    ds_read_b64_tr_b16 v[44:45], v230 offset:38912
    v_mfma_f32_32x32x16_bf16 v[112:127], v[52:55], v[204:207], v[112:127]
    ds_read_b64_tr_b16 v[46:47], v230 offset:39424
    s_add_u32 m0, s23, 12288
    s_add_u32 s25, s21, 123008
    buffer_load_dwordx4 v3, s[8:11], s25 offen lds
    s_add_u32 s21, s21, 245760
    s_cmp_eq_u32 s21, s39
    s_cselect_b32 s21, s38, s21
    s_waitcnt lgkmcnt(6)
    v_mfma_f32_32x32x16_bf16 v[64:79], v[32:35], v[208:211], v[64:79]
    v_mfma_f32_32x32x16_bf16 v[80:95], v[36:39], v[208:211], v[80:95]
    s_waitcnt vmcnt(8) lgkmcnt(0)
    s_barrier
    ds_read_b64_tr_b16 v[48:49], v228 offset:49152
    v_mfma_f32_16x16x32_bf16 v[56:59], v[32:35], v[224:227], v[56:59]
    ds_read_b64_tr_b16 v[50:51], v228 offset:49664
    s_add_u32 m0, s23, 16384
    s_add_u32 s25, s22, 0
    buffer_load_dwordx4 v13, s[12:15], s25 offen lds
    v_mfma_f32_32x32x16_bf16 v[96:111], v[32:35], v[212:215], v[96:111]
    ds_read_b64_tr_b16 v[52:53], v230 offset:49152
    v_mfma_f32_32x32x16_bf16 v[112:127], v[36:39], v[212:215], v[112:127]
    ds_read_b64_tr_b16 v[54:55], v230 offset:49664
    s_add_u32 m0, s23, 20480
    s_add_u32 s25, s22, 110592
    buffer_load_dwordx4 v13, s[12:15], s25 offen lds
    s_waitcnt lgkmcnt(4)
    v_mfma_f32_32x32x16_bf16 v[64:79], v[40:43], v[216:219], v[64:79]
    ds_read_b64_tr_b16 v[32:33], v228 offset:51200
    v_mfma_f32_32x32x16_bf16 v[80:95], v[44:47], v[216:219], v[80:95]
    ds_read_b64_tr_b16 v[34:35], v228 offset:51712
    v_mfma_f32_16x16x32_bf16 v[56:59], v[40:43], v[224:227], v[56:59]
    ds_read_b64_tr_b16 v[36:37], v230 offset:51200
    s_add_u32 m0, s23, 24576
    s_add_u32 s25, s22, 0
    buffer_load_dwordx4 v13, s[16:19], s25 offen lds
    v_mfma_f32_32x32x16_bf16 v[96:111], v[40:43], v[220:223], v[96:111]
    ds_read_b64_tr_b16 v[38:39], v230 offset:51712
    v_mfma_f32_32x32x16_bf16 v[112:127], v[44:47], v[220:223], v[112:127]
    s_add_u32 m0, s23, 28672
    s_add_u32 s25, s22, 110592
    buffer_load_dwordx4 v13, s[16:19], s25 offen lds
    s_add_u32 s22, s22, 221184
    s_cmp_eq_u32 s22, s53
    s_cselect_b32 s22, s52, s22
    s_waitcnt lgkmcnt(4)
    v_mfma_f32_32x32x16_bf16 v[128:143], v[48:51], v[192:195], v[128:143]
    ds_read_b64_tr_b16 v[40:41], v228 offset:53248
    v_mfma_f32_32x32x16_bf16 v[144:159], v[52:55], v[192:195], v[144:159]
    ds_read_b64_tr_b16 v[42:43], v228 offset:53760
    v_mfma_f32_16x16x32_bf16 v[60:63], v[48:51], v[224:227], v[60:63]
    ds_read_b64_tr_b16 v[44:45], v230 offset:53248
    s_add_u32 m0, s23, 32768
    s_add_u32 s25, s20, 0
    buffer_load_dwordx4 v2, s[4:7], s25 offen lds
    v_mfma_f32_32x32x16_bf16 v[160:175], v[48:51], v[196:199], v[160:175]
    ds_read_b64_tr_b16 v[46:47], v230 offset:53760
    v_mfma_f32_32x32x16_bf16 v[176:191], v[52:55], v[196:199], v[176:191]
    s_add_u32 m0, s23, 36864
    s_add_u32 s25, s20, 40960
    buffer_load_dwordx4 v2, s[4:7], s25 offen lds
    s_waitcnt lgkmcnt(4)
    v_mfma_f32_32x32x16_bf16 v[128:143], v[32:35], v[200:203], v[128:143]
    ds_read_b64_tr_b16 v[48:49], v228 offset:55296
    v_mfma_f32_32x32x16_bf16 v[144:159], v[36:39], v[200:203], v[144:159]
    ds_read_b64_tr_b16 v[50:51], v228 offset:55808
    v_mfma_f32_16x16x32_bf16 v[60:63], v[32:35], v[224:227], v[60:63]
    ds_read_b64_tr_b16 v[52:53], v230 offset:55296
    s_add_u32 m0, s23, 40960
    s_add_u32 s25, s20, 81920
    buffer_load_dwordx4 v2, s[4:7], s25 offen lds
    v_mfma_f32_32x32x16_bf16 v[160:175], v[32:35], v[204:207], v[160:175]
    ds_read_b64_tr_b16 v[54:55], v230 offset:55808
    v_mfma_f32_32x32x16_bf16 v[176:191], v[36:39], v[204:207], v[176:191]
    s_add_u32 m0, s23, 45056
    s_add_u32 s25, s20, 122880
    buffer_load_dwordx4 v2, s[4:7], s25 offen lds
    s_add_u32 s20, s20, 128
    s_cmp_eq_u32 s20, s37
    s_cselect_b32 s20, s36, s20
    s_waitcnt lgkmcnt(4)
    v_mfma_f32_32x32x16_bf16 v[128:143], v[40:43], v[208:211], v[128:143]
    v_mfma_f32_32x32x16_bf16 v[144:159], v[44:47], v[208:211], v[144:159]
    s_waitcnt vmcnt(8) lgkmcnt(0)
    s_barrier
    ds_read_b128 v[192:195], v8 offset:0
    ds_read_b128 v[196:199], v8 offset:4096
    v_mfma_f32_16x16x32_bf16 v[60:63], v[40:43], v[224:227], v[60:63]
    ds_read_b64_tr_b16 v[32:33], v228 offset:0
    v_mfma_f32_32x32x16_bf16 v[160:175], v[40:43], v[212:215], v[160:175]
    ds_read_b64_tr_b16 v[34:35], v228 offset:512
    ds_read_b64_tr_b16 v[36:37], v230 offset:0
    v_mfma_f32_32x32x16_bf16 v[176:191], v[44:47], v[212:215], v[176:191]
    ds_read_b64_tr_b16 v[38:39], v230 offset:512
    s_add_u32 m0, s23, 49152
    s_add_u32 s25, s21, 0
    buffer_load_dwordx4 v3, s[8:11], s25 offen lds
    s_waitcnt lgkmcnt(6)
    v_mfma_f32_32x32x16_bf16 v[128:143], v[48:51], v[216:219], v[128:143]
    ds_read_b128 v[200:203], v9 offset:0
    ds_read_b128 v[204:207], v9 offset:4096
    v_mfma_f32_32x32x16_bf16 v[144:159], v[52:55], v[216:219], v[144:159]
    ds_read_b64_tr_b16 v[40:41], v228 offset:2048
    v_mfma_f32_16x16x32_bf16 v[60:63], v[48:51], v[224:227], v[60:63]
    ds_read_b64_tr_b16 v[42:43], v228 offset:2560
    v_mfma_f32_32x32x16_bf16 v[160:175], v[48:51], v[220:223], v[160:175]
    ds_read_b64_tr_b16 v[44:45], v230 offset:2048
    v_mfma_f32_32x32x16_bf16 v[176:191], v[52:55], v[220:223], v[176:191]
    ds_read_b64_tr_b16 v[46:47], v230 offset:2560
    s_add_u32 m0, s23, 53248
    s_add_u32 s25, s21, 122880
    buffer_load_dwordx4 v3, s[8:11], s25 offen lds
    v_mov_b32 v234, 0
    global_load_dword v232, v234, s[74:75] sc1
    s_waitcnt lgkmcnt(6)
    v_mfma_f32_32x32x16_bf16 v[64:79], v[32:35], v[192:195], v[64:79]
    ds_read_b128 v[208:211], v10 offset:0
    ds_read_b128 v[212:215], v10 offset:4096
    v_mfma_f32_32x32x16_bf16 v[80:95], v[36:39], v[192:195], v[80:95]
    ds_read_b64_tr_b16 v[48:49], v228 offset:4096
    v_mfma_f32_16x16x32_bf16 v[56:59], v[32:35], v[224:227], v[56:59]
    ds_read_b64_tr_b16 v[50:51], v228 offset:4608
    v_mfma_f32_32x32x16_bf16 v[96:111], v[32:35], v[196:199], v[96:111]
    ds_read_b64_tr_b16 v[52:53], v230 offset:4096
    v_mfma_f32_32x32x16_bf16 v[112:127], v[36:39], v[196:199], v[112:127]
    ds_read_b64_tr_b16 v[54:55], v230 offset:4608
    s_add_u32 m0, s23, 57344
    s_add_u32 s25, s21, 128
    buffer_load_dwordx4 v3, s[8:11], s25 offen lds
    s_waitcnt lgkmcnt(6)
    v_mfma_f32_32x32x16_bf16 v[64:79], v[40:43], v[200:203], v[64:79]
    ds_read_b128 v[216:219], v11 offset:0
    ds_read_b128 v[220:223], v11 offset:4096
    v_mfma_f32_32x32x16_bf16 v[80:95], v[44:47], v[200:203], v[80:95]
    ds_read_b64_tr_b16 v[32:33], v228 offset:6144
    v_mfma_f32_16x16x32_bf16 v[56:59], v[40:43], v[224:227], v[56:59]
    ds_read_b64_tr_b16 v[34:35], v228 offset:6656
    v_mfma_f32_32x32x16_bf16 v[96:111], v[40:43], v[204:207], v[96:111]
    ds_read_b64_tr_b16 v[36:37], v230 offset:6144
    v_mfma_f32_32x32x16_bf16 v[112:127], v[44:47], v[204:207], v[112:127]
    ds_read_b64_tr_b16 v[38:39], v230 offset:6656
    s_add_u32 m0, s23, 61440
    s_add_u32 s25, s21, 123008
    buffer_load_dwordx4 v3, s[8:11], s25 offen lds
    s_add_u32 s21, s21, 245760
    s_cmp_eq_u32 s21, s39
    s_cselect_b32 s21, s38, s21
    s_waitcnt lgkmcnt(6)
    v_mfma_f32_32x32x16_bf16 v[64:79], v[48:51], v[208:211], v[64:79]
    v_mfma_f32_32x32x16_bf16 v[80:95], v[52:55], v[208:211], v[80:95]
    s_waitcnt vmcnt(9) lgkmcnt(0)
    s_barrier
    ds_read_b64_tr_b16 v[40:41], v228 offset:16384
    v_mfma_f32_16x16x32_bf16 v[56:59], v[48:51], v[224:227], v[56:59]
    ds_read_b64_tr_b16 v[42:43], v228 offset:16896
    s_add_u32 m0, s23, 65536
    s_add_u32 s25, s22, 0
    buffer_load_dwordx4 v13, s[12:15], s25 offen lds
    v_mfma_f32_32x32x16_bf16 v[96:111], v[48:51], v[212:215], v[96:111]
    ds_read_b64_tr_b16 v[44:45], v230 offset:16384
    v_mfma_f32_32x32x16_bf16 v[112:127], v[52:55], v[212:215], v[112:127]
    ds_read_b64_tr_b16 v[46:47], v230 offset:16896
    s_add_u32 m0, s23, 69632
    s_add_u32 s25, s22, 110592
    buffer_load_dwordx4 v13, s[12:15], s25 offen lds
    s_waitcnt lgkmcnt(4)
    v_mfma_f32_32x32x16_bf16 v[64:79], v[32:35], v[216:219], v[64:79]
    ds_read_b64_tr_b16 v[48:49], v228 offset:18432
    v_mfma_f32_32x32x16_bf16 v[80:95], v[36:39], v[216:219], v[80:95]
    ds_read_b64_tr_b16 v[50:51], v228 offset:18944
    v_mfma_f32_16x16x32_bf16 v[56:59], v[32:35], v[224:227], v[56:59]
    ds_read_b64_tr_b16 v[52:53], v230 offset:18432
    s_add_u32 m0, s23, 73728
    s_add_u32 s25, s22, 0
    buffer_load_dwordx4 v13, s[16:19], s25 offen lds
    v_mfma_f32_32x32x16_bf16 v[96:111], v[32:35], v[220:223], v[96:111]
    ds_read_b64_tr_b16 v[54:55], v230 offset:18944
    v_mfma_f32_32x32x16_bf16 v[112:127], v[36:39], v[220:223], v[112:127]
    s_add_u32 m0, s23, 77824
    s_add_u32 s25, s22, 110592
    buffer_load_dwordx4 v13, s[16:19], s25 offen lds
    s_add_u32 s22, s22, 221184
    s_cmp_eq_u32 s22, s53
    s_cselect_b32 s22, s52, s22
    s_waitcnt lgkmcnt(4)
    v_mfma_f32_32x32x16_bf16 v[128:143], v[40:43], v[192:195], v[128:143]
    ds_read_b64_tr_b16 v[32:33], v228 offset:20480
    v_mfma_f32_32x32x16_bf16 v[144:159], v[44:47], v[192:195], v[144:159]
    ds_read_b64_tr_b16 v[34:35], v228 offset:20992
    v_mfma_f32_16x16x32_bf16 v[60:63], v[40:43], v[224:227], v[60:63]
    ds_read_b64_tr_b16 v[36:37], v230 offset:20480
    s_add_u32 m0, s23, 0
    s_add_u32 s25, s20, 0
    buffer_load_dwordx4 v2, s[4:7], s25 offen lds
    v_mfma_f32_32x32x16_bf16 v[160:175], v[40:43], v[196:199], v[160:175]
    ds_read_b64_tr_b16 v[38:39], v230 offset:20992
    v_mfma_f32_32x32x16_bf16 v[176:191], v[44:47], v[196:199], v[176:191]
    s_add_u32 m0, s23, 4096
    s_add_u32 s25, s20, 40960
    buffer_load_dwordx4 v2, s[4:7], s25 offen lds
    s_waitcnt lgkmcnt(4)
    v_mfma_f32_32x32x16_bf16 v[128:143], v[48:51], v[200:203], v[128:143]
    ds_read_b64_tr_b16 v[40:41], v228 offset:22528
    v_mfma_f32_32x32x16_bf16 v[144:159], v[52:55], v[200:203], v[144:159]
    ds_read_b64_tr_b16 v[42:43], v228 offset:23040
    v_mfma_f32_16x16x32_bf16 v[60:63], v[48:51], v[224:227], v[60:63]
    ds_read_b64_tr_b16 v[44:45], v230 offset:22528
    s_add_u32 m0, s23, 8192
    s_add_u32 s25, s20, 81920
    buffer_load_dwordx4 v2, s[4:7], s25 offen lds
    v_mfma_f32_32x32x16_bf16 v[160:175], v[48:51], v[204:207], v[160:175]
    ds_read_b64_tr_b16 v[46:47], v230 offset:23040
    v_mfma_f32_32x32x16_bf16 v[176:191], v[52:55], v[204:207], v[176:191]
    s_add_u32 m0, s23, 12288
    s_add_u32 s25, s20, 122880
    buffer_load_dwordx4 v2, s[4:7], s25 offen lds
    s_add_u32 s20, s20, 128
    s_cmp_eq_u32 s20, s37
    s_cselect_b32 s20, s36, s20
    s_waitcnt lgkmcnt(4)
    v_mfma_f32_32x32x16_bf16 v[128:143], v[32:35], v[208:211], v[128:143]
    v_mfma_f32_32x32x16_bf16 v[144:159], v[36:39], v[208:211], v[144:159]
    s_waitcnt vmcnt(8) lgkmcnt(0)
    s_barrier
    ds_read_b128 v[192:195], v4 offset:32768
    ds_read_b128 v[196:199], v4 offset:36864
    v_mfma_f32_16x16x32_bf16 v[60:63], v[32:35], v[224:227], v[60:63]
    ds_read_b64_tr_b16 v[48:49], v228 offset:49152
    v_mfma_f32_32x32x16_bf16 v[160:175], v[32:35], v[212:215], v[160:175]
    ds_read_b64_tr_b16 v[50:51], v228 offset:49664
    ds_read_b64_tr_b16 v[52:53], v230 offset:49152
    v_mfma_f32_32x32x16_bf16 v[176:191], v[36:39], v[212:215], v[176:191]
    ds_read_b64_tr_b16 v[54:55], v230 offset:49664
    s_add_u32 m0, s23, 16384
    s_add_u32 s25, s21, 0
    buffer_load_dwordx4 v3, s[8:11], s25 offen lds
    s_waitcnt lgkmcnt(6)
    v_mfma_f32_32x32x16_bf16 v[128:143], v[40:43], v[216:219], v[128:143]
    ds_read_b128 v[200:203], v5 offset:32768
    ds_read_b128 v[204:207], v5 offset:36864
    v_mfma_f32_32x32x16_bf16 v[144:159], v[44:47], v[216:219], v[144:159]
    ds_read_b64_tr_b16 v[32:33], v228 offset:51200
    v_mfma_f32_16x16x32_bf16 v[60:63], v[40:43], v[224:227], v[60:63]
    ds_read_b64_tr_b16 v[34:35], v228 offset:51712
    v_mfma_f32_32x32x16_bf16 v[160:175], v[40:43], v[220:223], v[160:175]
    ds_read_b64_tr_b16 v[36:37], v230 offset:51200
    v_mfma_f32_32x32x16_bf16 v[176:191], v[44:47], v[220:223], v[176:191]
    ds_read_b64_tr_b16 v[38:39], v230 offset:51712
    s_add_u32 m0, s23, 20480
    s_add_u32 s25, s21, 122880
    buffer_load_dwordx4 v3, s[8:11], s25 offen lds
    s_waitcnt lgkmcnt(6)
    v_mfma_f32_32x32x16_bf16 v[64:79], v[48:51], v[192:195], v[64:79]
    ds_read_b128 v[208:211], v6 offset:32768
    ds_read_b128 v[212:215], v6 offset:36864
    v_mfma_f32_32x32x16_bf16 v[80:95], v[52:55], v[192:195], v[80:95]
    ds_read_b64_tr_b16 v[40:41], v228 offset:53248
    v_mfma_f32_16x16x32_bf16 v[56:59], v[48:51], v[224:227], v[56:59]
    ds_read_b64_tr_b16 v[42:43], v228 offset:53760
    v_mfma_f32_32x32x16_bf16 v[96:111], v[48:51], v[196:199], v[96:111]
    ds_read_b64_tr_b16 v[44:45], v230 offset:53248
    v_mfma_f32_32x32x16_bf16 v[112:127], v[52:55], v[196:199], v[112:127]
    ds_read_b64_tr_b16 v[46:47], v230 offset:53760
    s_add_u32 m0, s23, 24576
    s_add_u32 s25, s21, 128
    buffer_load_dwordx4 v3, s[8:11], s25 offen lds
    s_waitcnt lgkmcnt(6)
    v_mfma_f32_32x32x16_bf16 v[64:79], v[32:35], v[200:203], v[64:79]
    ds_read_b128 v[216:219], v7 offset:32768
    ds_read_b128 v[220:223], v7 offset:36864
    v_mfma_f32_32x32x16_bf16 v[80:95], v[36:39], v[200:203], v[80:95]
    ds_read_b64_tr_b16 v[48:49], v228 offset:55296
    v_mfma_f32_16x16x32_bf16 v[56:59], v[32:35], v[224:227], v[56:59]
    ds_read_b64_tr_b16 v[50:51], v228 offset:55808
    v_mfma_f32_32x32x16_bf16 v[96:111], v[32:35], v[204:207], v[96:111]
    ds_read_b64_tr_b16 v[52:53], v230 offset:55296
    v_mfma_f32_32x32x16_bf16 v[112:127], v[36:39], v[204:207], v[112:127]
    ds_read_b64_tr_b16 v[54:55], v230 offset:55808
    s_add_u32 m0, s23, 28672
    s_add_u32 s25, s21, 123008
    buffer_load_dwordx4 v3, s[8:11], s25 offen lds
    s_add_u32 s21, s21, 245760
    s_cmp_eq_u32 s21, s39
    s_cselect_b32 s21, s38, s21
    s_waitcnt lgkmcnt(6)
    v_mfma_f32_32x32x16_bf16 v[64:79], v[40:43], v[208:211], v[64:79]
    v_mfma_f32_32x32x16_bf16 v[80:95], v[44:47], v[208:211], v[80:95]
    s_waitcnt vmcnt(8) lgkmcnt(0)
    s_barrier
    ds_read_b64_tr_b16 v[32:33], v229 offset:0
    v_mfma_f32_16x16x32_bf16 v[56:59], v[40:43], v[224:227], v[56:59]
    ds_read_b64_tr_b16 v[34:35], v229 offset:512
    s_add_u32 m0, s23, 32768
    s_add_u32 s25, s22, 0
    buffer_load_dwordx4 v13, s[12:15], s25 offen lds
    v_mfma_f32_32x32x16_bf16 v[96:111], v[40:43], v[212:215], v[96:111]
    ds_read_b64_tr_b16 v[36:37], v231 offset:0
    v_mfma_f32_32x32x16_bf16 v[112:127], v[44:47], v[212:215], v[112:127]
    ds_read_b64_tr_b16 v[38:39], v231 offset:512
    s_add_u32 m0, s23, 36864
    s_add_u32 s25, s22, 110592
    buffer_load_dwordx4 v13, s[12:15], s25 offen lds
    s_waitcnt lgkmcnt(4)
    v_mfma_f32_32x32x16_bf16 v[64:79], v[48:51], v[216:219], v[64:79]
    ds_read_b64_tr_b16 v[40:41], v229 offset:2048
    v_mfma_f32_32x32x16_bf16 v[80:95], v[52:55], v[216:219], v[80:95]
    ds_read_b64_tr_b16 v[42:43], v229 offset:2560
    v_mfma_f32_16x16x32_bf16 v[56:59], v[48:51], v[224:227], v[56:59]
    ds_read_b64_tr_b16 v[44:45], v231 offset:2048
    s_add_u32 m0, s23, 40960
    s_add_u32 s25, s22, 0
    buffer_load_dwordx4 v13, s[16:19], s25 offen lds
    v_mfma_f32_32x32x16_bf16 v[96:111], v[48:51], v[220:223], v[96:111]
    ds_read_b64_tr_b16 v[46:47], v231 offset:2560
    v_mfma_f32_32x32x16_bf16 v[112:127], v[52:55], v[220:223], v[112:127]
    s_add_u32 m0, s23, 45056
    s_add_u32 s25, s22, 110592
    buffer_load_dwordx4 v13, s[16:19], s25 offen lds
    s_add_u32 s22, s22, 221184
    s_cmp_eq_u32 s22, s53
    s_cselect_b32 s22, s52, s22
    s_waitcnt lgkmcnt(4)
    v_mfma_f32_32x32x16_bf16 v[128:143], v[32:35], v[192:195], v[128:143]
    ds_read_b64_tr_b16 v[48:49], v229 offset:4096
    v_mfma_f32_32x32x16_bf16 v[144:159], v[36:39], v[192:195], v[144:159]
    ds_read_b64_tr_b16 v[50:51], v229 offset:4608
    v_mfma_f32_16x16x32_bf16 v[60:63], v[32:35], v[224:227], v[60:63]
    ds_read_b64_tr_b16 v[52:53], v231 offset:4096
    s_add_u32 m0, s23, 49152
    s_add_u32 s25, s20, 0
    buffer_load_dwordx4 v2, s[4:7], s25 offen lds
    v_mfma_f32_32x32x16_bf16 v[160:175], v[32:35], v[196:199], v[160:175]
    ds_read_b64_tr_b16 v[54:55], v231 offset:4608
    v_mfma_f32_32x32x16_bf16 v[176:191], v[36:39], v[196:199], v[176:191]
    s_add_u32 m0, s23, 53248
    s_add_u32 s25, s20, 40960
    buffer_load_dwordx4 v2, s[4:7], s25 offen lds
    s_waitcnt lgkmcnt(4)
    v_mfma_f32_32x32x16_bf16 v[128:143], v[40:43], v[200:203], v[128:143]
    ds_read_b64_tr_b16 v[32:33], v229 offset:6144
    v_mfma_f32_32x32x16_bf16 v[144:159], v[44:47], v[200:203], v[144:159]
    ds_read_b64_tr_b16 v[34:35], v229 offset:6656
    v_mfma_f32_16x16x32_bf16 v[60:63], v[40:43], v[224:227], v[60:63]
    ds_read_b64_tr_b16 v[36:37], v231 offset:6144
    s_add_u32 m0, s23, 57344
    s_add_u32 s25, s20, 81920
    buffer_load_dwordx4 v2, s[4:7], s25 offen lds
    v_mfma_f32_32x32x16_bf16 v[160:175], v[40:43], v[204:207], v[160:175]
    ds_read_b64_tr_b16 v[38:39], v231 offset:6656
    v_mfma_f32_32x32x16_bf16 v[176:191], v[44:47], v[204:207], v[176:191]
    s_add_u32 m0, s23, 61440
    s_add_u32 s25, s20, 122880
    buffer_load_dwordx4 v2, s[4:7], s25 offen lds
    s_add_u32 s20, s20, 128
    s_cmp_eq_u32 s20, s37
    s_cselect_b32 s20, s36, s20
    s_waitcnt lgkmcnt(4)
    v_mfma_f32_32x32x16_bf16 v[128:143], v[48:51], v[208:211], v[128:143]
    v_mfma_f32_32x32x16_bf16 v[144:159], v[52:55], v[208:211], v[144:159]
    s_waitcnt vmcnt(8) lgkmcnt(0)
    s_barrier
    ds_read_b128 v[192:195], v4 offset:0
    ds_read_b128 v[196:199], v4 offset:4096
    v_mfma_f32_16x16x32_bf16 v[60:63], v[48:51], v[224:227], v[60:63]
    ds_read_b64_tr_b16 v[40:41], v228 offset:16384
    v_mfma_f32_32x32x16_bf16 v[160:175], v[48:51], v[212:215], v[160:175]
    ds_read_b64_tr_b16 v[42:43], v228 offset:16896
    ds_read_b64_tr_b16 v[44:45], v230 offset:16384
    v_mfma_f32_32x32x16_bf16 v[176:191], v[52:55], v[212:215], v[176:191]
    ds_read_b64_tr_b16 v[46:47], v230 offset:16896
    s_add_u32 m0, s23, 65536
    s_add_u32 s25, s21, 0
    buffer_load_dwordx4 v3, s[8:11], s25 offen lds
    s_waitcnt lgkmcnt(6)
    v_mfma_f32_32x32x16_bf16 v[128:143], v[32:35], v[216:219], v[128:143]
    ds_read_b128 v[200:203], v5 offset:0
    ds_read_b128 v[204:207], v5 offset:4096
    v_mfma_f32_32x32x16_bf16 v[144:159], v[36:39], v[216:219], v[144:159]
    ds_read_b64_tr_b16 v[48:49], v228 offset:18432
    v_mfma_f32_16x16x32_bf16 v[60:63], v[32:35], v[224:227], v[60:63]
    ds_read_b64_tr_b16 v[50:51], v228 offset:18944
    v_mfma_f32_32x32x16_bf16 v[160:175], v[32:35], v[220:223], v[160:175]
    ds_read_b64_tr_b16 v[52:53], v230 offset:18432
    v_mfma_f32_32x32x16_bf16 v[176:191], v[36:39], v[220:223], v[176:191]
    ds_read_b64_tr_b16 v[54:55], v230 offset:18944
    s_add_u32 m0, s23, 69632
    s_add_u32 s25, s21, 122880
    buffer_load_dwordx4 v3, s[8:11], s25 offen lds
    s_waitcnt lgkmcnt(6)
    v_mfma_f32_32x32x16_bf16 v[64:79], v[40:43], v[192:195], v[64:79]
    ds_read_b128 v[208:211], v6 offset:0
    ds_read_b128 v[212:215], v6 offset:4096
    v_mfma_f32_32x32x16_bf16 v[80:95], v[44:47], v[192:195], v[80:95]
    ds_read_b64_tr_b16 v[32:33], v228 offset:20480
    v_mfma_f32_16x16x32_bf16 v[56:59], v[40:43], v[224:227], v[56:59]
    ds_read_b64_tr_b16 v[34:35], v228 offset:20992
    v_mfma_f32_32x32x16_bf16 v[96:111], v[40:43], v[196:199], v[96:111]
    ds_read_b64_tr_b16 v[36:37], v230 offset:20480
    v_mfma_f32_32x32x16_bf16 v[112:127], v[44:47], v[196:199], v[112:127]
    ds_read_b64_tr_b16 v[38:39], v230 offset:20992
    s_add_u32 m0, s23, 73728
    s_add_u32 s25, s21, 128
    buffer_load_dwordx4 v3, s[8:11], s25 offen lds
    s_waitcnt lgkmcnt(6)
    v_mfma_f32_32x32x16_bf16 v[64:79], v[48:51], v[200:203], v[64:79]
    ds_read_b128 v[216:219], v7 offset:0
    ds_read_b128 v[220:223], v7 offset:4096
    v_mfma_f32_32x32x16_bf16 v[80:95], v[52:55], v[200:203], v[80:95]
    ds_read_b64_tr_b16 v[40:41], v228 offset:22528
    v_mfma_f32_16x16x32_bf16 v[56:59], v[48:51], v[224:227], v[56:59]
    ds_read_b64_tr_b16 v[42:43], v228 offset:23040
    v_mfma_f32_32x32x16_bf16 v[96:111], v[48:51], v[204:207], v[96:111]
    ds_read_b64_tr_b16 v[44:45], v230 offset:22528
    v_mfma_f32_32x32x16_bf16 v[112:127], v[52:55], v[204:207], v[112:127]
    ds_read_b64_tr_b16 v[46:47], v230 offset:23040
    s_add_u32 m0, s23, 77824
    s_add_u32 s25, s21, 123008
    buffer_load_dwordx4 v3, s[8:11], s25 offen lds
    s_add_u32 s21, s21, 245760
    s_cmp_eq_u32 s21, s39
    s_cselect_b32 s21, s38, s21
    s_waitcnt lgkmcnt(6)
    v_mfma_f32_32x32x16_bf16 v[64:79], v[32:35], v[208:211], v[64:79]
    v_mfma_f32_32x32x16_bf16 v[80:95], v[36:39], v[208:211], v[80:95]
    s_waitcnt vmcnt(8) lgkmcnt(0)
    s_barrier
    ds_read_b64_tr_b16 v[48:49], v228 offset:32768
    v_mfma_f32_16x16x32_bf16 v[56:59], v[32:35], v[224:227], v[56:59]
    ds_read_b64_tr_b16 v[50:51], v228 offset:33280
    s_add_u32 m0, s23, 0
    s_add_u32 s25, s22, 0
    buffer_load_dwordx4 v13, s[12:15], s25 offen lds
    v_mfma_f32_32x32x16_bf16 v[96:111], v[32:35], v[212:215], v[96:111]
    ds_read_b64_tr_b16 v[52:53], v230 offset:32768
    v_mfma_f32_32x32x16_bf16 v[112:127], v[36:39], v[212:215], v[112:127]
    ds_read_b64_tr_b16 v[54:55], v230 offset:33280
    s_add_u32 m0, s23, 4096
    s_add_u32 s25, s22, 110592
    buffer_load_dwordx4 v13, s[12:15], s25 offen lds
    s_waitcnt lgkmcnt(4)
    v_mfma_f32_32x32x16_bf16 v[64:79], v[40:43], v[216:219], v[64:79]
    ds_read_b64_tr_b16 v[32:33], v228 offset:34816
    v_mfma_f32_32x32x16_bf16 v[80:95], v[44:47], v[216:219], v[80:95]
    ds_read_b64_tr_b16 v[34:35], v228 offset:35328
    v_mfma_f32_16x16x32_bf16 v[56:59], v[40:43], v[224:227], v[56:59]
    ds_read_b64_tr_b16 v[36:37], v230 offset:34816
    s_add_u32 m0, s23, 8192
    s_add_u32 s25, s22, 0
    buffer_load_dwordx4 v13, s[16:19], s25 offen lds
    v_mfma_f32_32x32x16_bf16 v[96:111], v[40:43], v[220:223], v[96:111]
    ds_read_b64_tr_b16 v[38:39], v230 offset:35328
    v_mfma_f32_32x32x16_bf16 v[112:127], v[44:47], v[220:223], v[112:127]
    s_add_u32 m0, s23, 12288
    s_add_u32 s25, s22, 110592
    buffer_load_dwordx4 v13, s[16:19], s25 offen lds
    s_add_u32 s22, s22, 221184
    s_cmp_eq_u32 s22, s53
    s_cselect_b32 s22, s52, s22
    v_readfirstlane_b32 s29, v232
    s_or_b32 s78, s78, s29
    s_and_b32 s54, s2, 7
    s_lshl_b32 s29, s44, 3
    s_add_u32 s54, s54, s29
    s_add_u32 s54, s54, 40
    s_lshl_b32 s29, s54, 7
    v_mov_b32 v234, s29
    buffer_load_dword v233, v234, s[56:59], 0 offen sc1
    s_waitcnt lgkmcnt(4)
    v_mfma_f32_32x32x16_bf16 v[128:143], v[48:51], v[192:195], v[128:143]
    ds_read_b64_tr_b16 v[40:41], v228 offset:36864
    v_mfma_f32_32x32x16_bf16 v[144:159], v[52:55], v[192:195], v[144:159]
    ds_read_b64_tr_b16 v[42:43], v228 offset:37376
    v_mfma_f32_16x16x32_bf16 v[60:63], v[48:51], v[224:227], v[60:63]
    ds_read_b64_tr_b16 v[44:45], v230 offset:36864
    s_add_u32 m0, s23, 16384
    s_add_u32 s25, s20, 0
    buffer_load_dwordx4 v2, s[4:7], s25 offen lds
    v_mfma_f32_32x32x16_bf16 v[160:175], v[48:51], v[196:199], v[160:175]
    ds_read_b64_tr_b16 v[46:47], v230 offset:37376
    v_mfma_f32_32x32x16_bf16 v[176:191], v[52:55], v[196:199], v[176:191]
    s_add_u32 m0, s23, 20480
    s_add_u32 s25, s20, 40960
    buffer_load_dwordx4 v2, s[4:7], s25 offen lds
    s_waitcnt lgkmcnt(4)
    v_mfma_f32_32x32x16_bf16 v[128:143], v[32:35], v[200:203], v[128:143]
    ds_read_b64_tr_b16 v[48:49], v228 offset:38912
    v_mfma_f32_32x32x16_bf16 v[144:159], v[36:39], v[200:203], v[144:159]
    ds_read_b64_tr_b16 v[50:51], v228 offset:39424
    v_mfma_f32_16x16x32_bf16 v[60:63], v[32:35], v[224:227], v[60:63]
    ds_read_b64_tr_b16 v[52:53], v230 offset:38912
    s_add_u32 m0, s23, 24576
    s_add_u32 s25, s20, 81920
    buffer_load_dwordx4 v2, s[4:7], s25 offen lds
    v_mfma_f32_32x32x16_bf16 v[160:175], v[32:35], v[204:207], v[160:175]
    ds_read_b64_tr_b16 v[54:55], v230 offset:39424
    v_mfma_f32_32x32x16_bf16 v[176:191], v[36:39], v[204:207], v[176:191]
    s_add_u32 m0, s23, 28672
    s_add_u32 s25, s20, 122880
    buffer_load_dwordx4 v2, s[4:7], s25 offen lds
    s_add_u32 s20, s20, 128
    s_cmp_eq_u32 s20, s37
    s_cselect_b32 s20, s36, s20
    s_waitcnt lgkmcnt(4)
    v_mfma_f32_32x32x16_bf16 v[128:143], v[40:43], v[208:211], v[128:143]
    v_mfma_f32_32x32x16_bf16 v[144:159], v[44:47], v[208:211], v[144:159]
    s_waitcnt vmcnt(9) lgkmcnt(0)
    s_barrier
    ds_read_b128 v[192:195], v4 offset:49152
    ds_read_b128 v[196:199], v4 offset:53248
    v_mfma_f32_16x16x32_bf16 v[60:63], v[40:43], v[224:227], v[60:63]
    ds_read_b64_tr_b16 v[32:33], v229 offset:0
    v_mfma_f32_32x32x16_bf16 v[160:175], v[40:43], v[212:215], v[160:175]
    ds_read_b64_tr_b16 v[34:35], v229 offset:512
    ds_read_b64_tr_b16 v[36:37], v231 offset:0
    v_mfma_f32_32x32x16_bf16 v[176:191], v[44:47], v[212:215], v[176:191]
    ds_read_b64_tr_b16 v[38:39], v231 offset:512
    s_add_u32 m0, s23, 32768
    s_add_u32 s25, s21, 0
    buffer_load_dwordx4 v3, s[8:11], s25 offen lds
    s_waitcnt lgkmcnt(6)
    v_mfma_f32_32x32x16_bf16 v[128:143], v[48:51], v[216:219], v[128:143]
    ds_read_b128 v[200:203], v5 offset:49152
    ds_read_b128 v[204:207], v5 offset:53248
    v_mfma_f32_32x32x16_bf16 v[144:159], v[52:55], v[216:219], v[144:159]
    ds_read_b64_tr_b16 v[40:41], v229 offset:2048
    v_mfma_f32_16x16x32_bf16 v[60:63], v[48:51], v[224:227], v[60:63]
    ds_read_b64_tr_b16 v[42:43], v229 offset:2560
    v_mfma_f32_32x32x16_bf16 v[160:175], v[48:51], v[220:223], v[160:175]
    ds_read_b64_tr_b16 v[44:45], v231 offset:2048
    v_mfma_f32_32x32x16_bf16 v[176:191], v[52:55], v[220:223], v[176:191]
    ds_read_b64_tr_b16 v[46:47], v231 offset:2560
    s_add_u32 m0, s23, 36864
    s_add_u32 s25, s21, 122880
    buffer_load_dwordx4 v3, s[8:11], s25 offen lds
    s_waitcnt lgkmcnt(6)
    v_mfma_f32_32x32x16_bf16 v[64:79], v[32:35], v[192:195], v[64:79]
    ds_read_b128 v[208:211], v6 offset:49152
    ds_read_b128 v[212:215], v6 offset:53248
    v_mfma_f32_32x32x16_bf16 v[80:95], v[36:39], v[192:195], v[80:95]
    ds_read_b64_tr_b16 v[48:49], v229 offset:4096
    v_mfma_f32_16x16x32_bf16 v[56:59], v[32:35], v[224:227], v[56:59]
    ds_read_b64_tr_b16 v[50:51], v229 offset:4608
    v_mfma_f32_32x32x16_bf16 v[96:111], v[32:35], v[196:199], v[96:111]
    ds_read_b64_tr_b16 v[52:53], v231 offset:4096
    v_mfma_f32_32x32x16_bf16 v[112:127], v[36:39], v[196:199], v[112:127]
    ds_read_b64_tr_b16 v[54:55], v231 offset:4608
    s_add_u32 m0, s23, 40960
    s_add_u32 s25, s21, 128
    buffer_load_dwordx4 v3, s[8:11], s25 offen lds
    s_waitcnt lgkmcnt(6)
    v_mfma_f32_32x32x16_bf16 v[64:79], v[40:43], v[200:203], v[64:79]
    ds_read_b128 v[216:219], v7 offset:49152
    ds_read_b128 v[220:223], v7 offset:53248
    v_mfma_f32_32x32x16_bf16 v[80:95], v[44:47], v[200:203], v[80:95]
    ds_read_b64_tr_b16 v[32:33], v229 offset:6144
    v_mfma_f32_16x16x32_bf16 v[56:59], v[40:43], v[224:227], v[56:59]
    ds_read_b64_tr_b16 v[34:35], v229 offset:6656
    v_mfma_f32_32x32x16_bf16 v[96:111], v[40:43], v[204:207], v[96:111]
    ds_read_b64_tr_b16 v[36:37], v231 offset:6144
    v_mfma_f32_32x32x16_bf16 v[112:127], v[44:47], v[204:207], v[112:127]
    ds_read_b64_tr_b16 v[38:39], v231 offset:6656
    s_add_u32 m0, s23, 45056
    s_add_u32 s25, s21, 123008
    buffer_load_dwordx4 v3, s[8:11], s25 offen lds
    s_add_u32 s21, s21, 245760
    s_cmp_eq_u32 s21, s39
    s_cselect_b32 s21, s38, s21
    s_waitcnt lgkmcnt(6)
    v_mfma_f32_32x32x16_bf16 v[64:79], v[48:51], v[208:211], v[64:79]
    v_mfma_f32_32x32x16_bf16 v[80:95], v[52:55], v[208:211], v[80:95]
    s_waitcnt vmcnt(9) lgkmcnt(0)
    s_barrier
    ds_read_b64_tr_b16 v[40:41], v228 offset:0
    v_mfma_f32_16x16x32_bf16 v[56:59], v[48:51], v[224:227], v[56:59]
    ds_read_b64_tr_b16 v[42:43], v228 offset:512
    s_add_u32 m0, s23, 49152
    s_add_u32 s25, s22, 0
    buffer_load_dwordx4 v13, s[12:15], s25 offen lds
    v_mfma_f32_32x32x16_bf16 v[96:111], v[48:51], v[212:215], v[96:111]
    ds_read_b64_tr_b16 v[44:45], v230 offset:0
    v_mfma_f32_32x32x16_bf16 v[112:127], v[52:55], v[212:215], v[112:127]
    ds_read_b64_tr_b16 v[46:47], v230 offset:512
    s_add_u32 m0, s23, 53248
    s_add_u32 s25, s22, 110592
    buffer_load_dwordx4 v13, s[12:15], s25 offen lds
    s_waitcnt lgkmcnt(4)
    v_mfma_f32_32x32x16_bf16 v[64:79], v[32:35], v[216:219], v[64:79]
    ds_read_b64_tr_b16 v[48:49], v228 offset:2048
    v_mfma_f32_32x32x16_bf16 v[80:95], v[36:39], v[216:219], v[80:95]
    ds_read_b64_tr_b16 v[50:51], v228 offset:2560
    v_mfma_f32_16x16x32_bf16 v[56:59], v[32:35], v[224:227], v[56:59]
    ds_read_b64_tr_b16 v[52:53], v230 offset:2048
    s_add_u32 m0, s23, 57344
    s_add_u32 s25, s22, 0
    buffer_load_dwordx4 v13, s[16:19], s25 offen lds
    v_mfma_f32_32x32x16_bf16 v[96:111], v[32:35], v[220:223], v[96:111]
    ds_read_b64_tr_b16 v[54:55], v230 offset:2560
    v_mfma_f32_32x32x16_bf16 v[112:127], v[36:39], v[220:223], v[112:127]
    s_add_u32 m0, s23, 61440
    s_add_u32 s25, s22, 110592
    buffer_load_dwordx4 v13, s[16:19], s25 offen lds
    s_add_u32 s22, s22, 221184
    s_cmp_eq_u32 s22, s53
    s_cselect_b32 s22, s52, s22
    s_waitcnt lgkmcnt(4)
    v_mfma_f32_32x32x16_bf16 v[128:143], v[40:43], v[192:195], v[128:143]
    ds_read_b64_tr_b16 v[32:33], v228 offset:4096
    v_mfma_f32_32x32x16_bf16 v[144:159], v[44:47], v[192:195], v[144:159]
    ds_read_b64_tr_b16 v[34:35], v228 offset:4608
    v_mfma_f32_16x16x32_bf16 v[60:63], v[40:43], v[224:227], v[60:63]
    ds_read_b64_tr_b16 v[36:37], v230 offset:4096
    s_add_u32 m0, s23, 65536
    s_add_u32 s25, s20, 0
    buffer_load_dwordx4 v2, s[4:7], s25 offen lds
    v_mfma_f32_32x32x16_bf16 v[160:175], v[40:43], v[196:199], v[160:175]
    ds_read_b64_tr_b16 v[38:39], v230 offset:4608
    v_mfma_f32_32x32x16_bf16 v[176:191], v[44:47], v[196:199], v[176:191]
    s_add_u32 m0, s23, 69632
    s_add_u32 s25, s20, 40960
    buffer_load_dwordx4 v2, s[4:7], s25 offen lds
    s_waitcnt lgkmcnt(4)
    v_mfma_f32_32x32x16_bf16 v[128:143], v[48:51], v[200:203], v[128:143]
    ds_read_b64_tr_b16 v[40:41], v228 offset:6144
    v_mfma_f32_32x32x16_bf16 v[144:159], v[52:55], v[200:203], v[144:159]
    ds_read_b64_tr_b16 v[42:43], v228 offset:6656
    v_mfma_f32_16x16x32_bf16 v[60:63], v[48:51], v[224:227], v[60:63]
    ds_read_b64_tr_b16 v[44:45], v230 offset:6144
    s_add_u32 m0, s23, 73728
    s_add_u32 s25, s20, 81920
    buffer_load_dwordx4 v2, s[4:7], s25 offen lds
    v_mfma_f32_32x32x16_bf16 v[160:175], v[48:51], v[204:207], v[160:175]
    ds_read_b64_tr_b16 v[46:47], v230 offset:6656
    v_mfma_f32_32x32x16_bf16 v[176:191], v[52:55], v[204:207], v[176:191]
    s_add_u32 m0, s23, 77824
    s_add_u32 s25, s20, 122880
    buffer_load_dwordx4 v2, s[4:7], s25 offen lds
    s_add_u32 s20, s20, 128
    s_cmp_eq_u32 s20, s37
    s_cselect_b32 s20, s36, s20
    s_waitcnt lgkmcnt(4)
    v_mfma_f32_32x32x16_bf16 v[128:143], v[32:35], v[208:211], v[128:143]
    v_mfma_f32_32x32x16_bf16 v[144:159], v[36:39], v[208:211], v[144:159]
    s_waitcnt vmcnt(8) lgkmcnt(0)
    s_barrier
    ds_read_b128 v[192:195], v4 offset:16384
    ds_read_b128 v[196:199], v4 offset:20480
    v_mfma_f32_16x16x32_bf16 v[60:63], v[32:35], v[224:227], v[60:63]
    ds_read_b64_tr_b16 v[48:49], v228 offset:32768
    v_mfma_f32_32x32x16_bf16 v[160:175], v[32:35], v[212:215], v[160:175]
    ds_read_b64_tr_b16 v[50:51], v228 offset:33280
    ds_read_b64_tr_b16 v[52:53], v230 offset:32768
    v_mfma_f32_32x32x16_bf16 v[176:191], v[36:39], v[212:215], v[176:191]
    ds_read_b64_tr_b16 v[54:55], v230 offset:33280
    s_add_u32 m0, s23, 0
    s_add_u32 s25, s21, 0
    buffer_load_dwordx4 v3, s[8:11], s25 offen lds
    s_waitcnt lgkmcnt(6)
    v_mfma_f32_32x32x16_bf16 v[128:143], v[40:43], v[216:219], v[128:143]
    ds_read_b128 v[200:203], v5 offset:16384
    ds_read_b128 v[204:207], v5 offset:20480
    v_mfma_f32_32x32x16_bf16 v[144:159], v[44:47], v[216:219], v[144:159]
    ds_read_b64_tr_b16 v[32:33], v228 offset:34816
    v_mfma_f32_16x16x32_bf16 v[60:63], v[40:43], v[224:227], v[60:63]
    ds_read_b64_tr_b16 v[34:35], v228 offset:35328
    v_mfma_f32_32x32x16_bf16 v[160:175], v[40:43], v[220:223], v[160:175]
    ds_read_b64_tr_b16 v[36:37], v230 offset:34816
    v_mfma_f32_32x32x16_bf16 v[176:191], v[44:47], v[220:223], v[176:191]
    ds_read_b64_tr_b16 v[38:39], v230 offset:35328
    s_add_u32 m0, s23, 4096
    s_add_u32 s25, s21, 122880
    buffer_load_dwordx4 v3, s[8:11], s25 offen lds
    s_waitcnt lgkmcnt(6)
    v_mfma_f32_32x32x16_bf16 v[64:79], v[48:51], v[192:195], v[64:79]
    ds_read_b128 v[208:211], v6 offset:16384
    ds_read_b128 v[212:215], v6 offset:20480
    v_mfma_f32_32x32x16_bf16 v[80:95], v[52:55], v[192:195], v[80:95]
    ds_read_b64_tr_b16 v[40:41], v228 offset:36864
    v_mfma_f32_16x16x32_bf16 v[56:59], v[48:51], v[224:227], v[56:59]
    ds_read_b64_tr_b16 v[42:43], v228 offset:37376
    v_mfma_f32_32x32x16_bf16 v[96:111], v[48:51], v[196:199], v[96:111]
    ds_read_b64_tr_b16 v[44:45], v230 offset:36864
    v_mfma_f32_32x32x16_bf16 v[112:127], v[52:55], v[196:199], v[112:127]
    ds_read_b64_tr_b16 v[46:47], v230 offset:37376
    s_add_u32 m0, s23, 8192
    s_add_u32 s25, s21, 128
    buffer_load_dwordx4 v3, s[8:11], s25 offen lds
    s_waitcnt lgkmcnt(6)
    v_mfma_f32_32x32x16_bf16 v[64:79], v[32:35], v[200:203], v[64:79]
    ds_read_b128 v[216:219], v7 offset:16384
    ds_read_b128 v[220:223], v7 offset:20480
    v_mfma_f32_32x32x16_bf16 v[80:95], v[36:39], v[200:203], v[80:95]
    ds_read_b64_tr_b16 v[48:49], v228 offset:38912
    v_mfma_f32_16x16x32_bf16 v[56:59], v[32:35], v[224:227], v[56:59]
    ds_read_b64_tr_b16 v[50:51], v228 offset:39424
    v_mfma_f32_32x32x16_bf16 v[96:111], v[32:35], v[204:207], v[96:111]
    ds_read_b64_tr_b16 v[52:53], v230 offset:38912
    v_mfma_f32_32x32x16_bf16 v[112:127], v[36:39], v[204:207], v[112:127]
    ds_read_b64_tr_b16 v[54:55], v230 offset:39424
    s_add_u32 m0, s23, 12288
    s_add_u32 s25, s21, 123008
    buffer_load_dwordx4 v3, s[8:11], s25 offen lds
    s_add_u32 s21, s21, 245760
    s_cmp_eq_u32 s21, s39
    s_cselect_b32 s21, s38, s21
    s_waitcnt lgkmcnt(6)
    v_mfma_f32_32x32x16_bf16 v[64:79], v[40:43], v[208:211], v[64:79]
    v_mfma_f32_32x32x16_bf16 v[80:95], v[44:47], v[208:211], v[80:95]
    s_waitcnt vmcnt(8) lgkmcnt(0)
    s_barrier
    ds_read_b64_tr_b16 v[32:33], v228 offset:49152
    v_mfma_f32_16x16x32_bf16 v[56:59], v[40:43], v[224:227], v[56:59]
    ds_read_b64_tr_b16 v[34:35], v228 offset:49664
    s_add_u32 m0, s23, 16384
    s_add_u32 s25, s22, 0
    buffer_load_dwordx4 v13, s[12:15], s25 offen lds
    v_mfma_f32_32x32x16_bf16 v[96:111], v[40:43], v[212:215], v[96:111]
    ds_read_b64_tr_b16 v[36:37], v230 offset:49152
    v_mfma_f32_32x32x16_bf16 v[112:127], v[44:47], v[212:215], v[112:127]
    ds_read_b64_tr_b16 v[38:39], v230 offset:49664
    s_add_u32 m0, s23, 20480
    s_add_u32 s25, s22, 110592
    buffer_load_dwordx4 v13, s[12:15], s25 offen lds
    s_waitcnt lgkmcnt(4)
    v_mfma_f32_32x32x16_bf16 v[64:79], v[48:51], v[216:219], v[64:79]
    ds_read_b64_tr_b16 v[40:41], v228 offset:51200
    v_mfma_f32_32x32x16_bf16 v[80:95], v[52:55], v[216:219], v[80:95]
    ds_read_b64_tr_b16 v[42:43], v228 offset:51712
    v_mfma_f32_16x16x32_bf16 v[56:59], v[48:51], v[224:227], v[56:59]
    ds_read_b64_tr_b16 v[44:45], v230 offset:51200
    s_add_u32 m0, s23, 24576
    s_add_u32 s25, s22, 0
    buffer_load_dwordx4 v13, s[16:19], s25 offen lds
    v_mfma_f32_32x32x16_bf16 v[96:111], v[48:51], v[220:223], v[96:111]
    ds_read_b64_tr_b16 v[46:47], v230 offset:51712
    v_mfma_f32_32x32x16_bf16 v[112:127], v[52:55], v[220:223], v[112:127]
    s_add_u32 m0, s23, 28672
    s_add_u32 s25, s22, 110592
    buffer_load_dwordx4 v13, s[16:19], s25 offen lds
    s_add_u32 s22, s22, 221184
    s_cmp_eq_u32 s22, s53
    s_cselect_b32 s22, s52, s22
    s_waitcnt lgkmcnt(4)
    v_mfma_f32_32x32x16_bf16 v[128:143], v[32:35], v[192:195], v[128:143]
    ds_read_b64_tr_b16 v[48:49], v228 offset:53248
    v_mfma_f32_32x32x16_bf16 v[144:159], v[36:39], v[192:195], v[144:159]
    ds_read_b64_tr_b16 v[50:51], v228 offset:53760
    v_mfma_f32_16x16x32_bf16 v[60:63], v[32:35], v[224:227], v[60:63]
    ds_read_b64_tr_b16 v[52:53], v230 offset:53248
    s_add_u32 m0, s23, 32768
    s_add_u32 s25, s20, 0
    buffer_load_dwordx4 v2, s[4:7], s25 offen lds
    v_mfma_f32_32x32x16_bf16 v[160:175], v[32:35], v[196:199], v[160:175]
    ds_read_b64_tr_b16 v[54:55], v230 offset:53760
    v_mfma_f32_32x32x16_bf16 v[176:191], v[36:39], v[196:199], v[176:191]
    s_add_u32 m0, s23, 36864
    s_add_u32 s25, s20, 40960
    buffer_load_dwordx4 v2, s[4:7], s25 offen lds
    s_waitcnt lgkmcnt(4)
    v_mfma_f32_32x32x16_bf16 v[128:143], v[40:43], v[200:203], v[128:143]
    ds_read_b64_tr_b16 v[32:33], v228 offset:55296
    v_mfma_f32_32x32x16_bf16 v[144:159], v[44:47], v[200:203], v[144:159]
    ds_read_b64_tr_b16 v[34:35], v228 offset:55808
    v_mfma_f32_16x16x32_bf16 v[60:63], v[40:43], v[224:227], v[60:63]
    ds_read_b64_tr_b16 v[36:37], v230 offset:55296
    s_add_u32 m0, s23, 40960
    s_add_u32 s25, s20, 81920
    buffer_load_dwordx4 v2, s[4:7], s25 offen lds
    v_mfma_f32_32x32x16_bf16 v[160:175], v[40:43], v[204:207], v[160:175]
    ds_read_b64_tr_b16 v[38:39], v230 offset:55808
    v_mfma_f32_32x32x16_bf16 v[176:191], v[44:47], v[204:207], v[176:191]
    s_add_u32 m0, s23, 45056
    s_add_u32 s25, s20, 122880
    buffer_load_dwordx4 v2, s[4:7], s25 offen lds
    s_add_u32 s20, s20, 128
    s_cmp_eq_u32 s20, s37
    s_cselect_b32 s20, s36, s20
    s_waitcnt lgkmcnt(4)
    v_mfma_f32_32x32x16_bf16 v[128:143], v[48:51], v[208:211], v[128:143]
    v_mfma_f32_32x32x16_bf16 v[144:159], v[52:55], v[208:211], v[144:159]
    s_waitcnt vmcnt(8) lgkmcnt(0)
    s_barrier
    ds_read_b128 v[192:195], v8 offset:0
    ds_read_b128 v[196:199], v8 offset:4096
    v_mfma_f32_16x16x32_bf16 v[60:63], v[48:51], v[224:227], v[60:63]
    ds_read_b64_tr_b16 v[40:41], v228 offset:0
    v_mfma_f32_32x32x16_bf16 v[160:175], v[48:51], v[212:215], v[160:175]
    ds_read_b64_tr_b16 v[42:43], v228 offset:512
    ds_read_b64_tr_b16 v[44:45], v230 offset:0
    v_mfma_f32_32x32x16_bf16 v[176:191], v[52:55], v[212:215], v[176:191]
    ds_read_b64_tr_b16 v[46:47], v230 offset:512
    s_add_u32 m0, s23, 49152
    s_add_u32 s25, s21, 0
    buffer_load_dwordx4 v3, s[8:11], s25 offen lds
    s_waitcnt lgkmcnt(6)
    v_mfma_f32_32x32x16_bf16 v[128:143], v[32:35], v[216:219], v[128:143]
    ds_read_b128 v[200:203], v9 offset:0
    ds_read_b128 v[204:207], v9 offset:4096
    v_mfma_f32_32x32x16_bf16 v[144:159], v[36:39], v[216:219], v[144:159]
    ds_read_b64_tr_b16 v[48:49], v228 offset:2048
    v_mfma_f32_16x16x32_bf16 v[60:63], v[32:35], v[224:227], v[60:63]
    ds_read_b64_tr_b16 v[50:51], v228 offset:2560
    v_mfma_f32_32x32x16_bf16 v[160:175], v[32:35], v[220:223], v[160:175]
    ds_read_b64_tr_b16 v[52:53], v230 offset:2048
    v_mfma_f32_32x32x16_bf16 v[176:191], v[36:39], v[220:223], v[176:191]
    ds_read_b64_tr_b16 v[54:55], v230 offset:2560
    s_add_u32 m0, s23, 53248
    s_add_u32 s25, s21, 122880
    buffer_load_dwordx4 v3, s[8:11], s25 offen lds
    v_and_b32 v14, 31, v1
    s_lshl_b32 s30, s27, 6
    s_add_u32 s30, s30, s46
    v_add_u32 v14, s30, v14
    v_lshlrev_b32 v14, 3, v14
    buffer_load_dwordx2 v[240:241], v14, s[48:51], 0 offen sc1
    buffer_load_dwordx2 v[242:243], v14, s[48:51], 0 offen offset:256 sc1
    s_waitcnt lgkmcnt(6)
    v_mfma_f32_32x32x16_bf16 v[64:79], v[40:43], v[192:195], v[64:79]
    ds_read_b128 v[208:211], v10 offset:0
    ds_read_b128 v[212:215], v10 offset:4096
    v_mfma_f32_32x32x16_bf16 v[80:95], v[44:47], v[192:195], v[80:95]
    ds_read_b64_tr_b16 v[32:33], v228 offset:4096
    v_mfma_f32_16x16x32_bf16 v[56:59], v[40:43], v[224:227], v[56:59]
    ds_read_b64_tr_b16 v[34:35], v228 offset:4608
    v_mfma_f32_32x32x16_bf16 v[96:111], v[40:43], v[196:199], v[96:111]
    ds_read_b64_tr_b16 v[36:37], v230 offset:4096
    v_mfma_f32_32x32x16_bf16 v[112:127], v[44:47], v[196:199], v[112:127]
    ds_read_b64_tr_b16 v[38:39], v230 offset:4608
    s_add_u32 m0, s23, 57344
    s_add_u32 s25, s21, 128
    buffer_load_dwordx4 v3, s[8:11], s25 offen lds
    s_waitcnt lgkmcnt(6)
    v_mfma_f32_32x32x16_bf16 v[64:79], v[48:51], v[200:203], v[64:79]
    ds_read_b128 v[216:219], v11 offset:0
    ds_read_b128 v[220:223], v11 offset:4096
    v_mfma_f32_32x32x16_bf16 v[80:95], v[52:55], v[200:203], v[80:95]
    ds_read_b64_tr_b16 v[40:41], v228 offset:6144
    v_mfma_f32_16x16x32_bf16 v[56:59], v[48:51], v[224:227], v[56:59]
    ds_read_b64_tr_b16 v[42:43], v228 offset:6656
    v_mfma_f32_32x32x16_bf16 v[96:111], v[48:51], v[204:207], v[96:111]
    ds_read_b64_tr_b16 v[44:45], v230 offset:6144
    v_mfma_f32_32x32x16_bf16 v[112:127], v[52:55], v[204:207], v[112:127]
    ds_read_b64_tr_b16 v[46:47], v230 offset:6656
    s_add_u32 m0, s23, 61440
    s_add_u32 s25, s21, 123008
    buffer_load_dwordx4 v3, s[8:11], s25 offen lds
    s_add_u32 s21, s21, 245760
    s_cmp_eq_u32 s21, s39
    s_cselect_b32 s21, s38, s21
    s_waitcnt lgkmcnt(6)
    v_mfma_f32_32x32x16_bf16 v[64:79], v[32:35], v[208:211], v[64:79]
    v_mfma_f32_32x32x16_bf16 v[80:95], v[36:39], v[208:211], v[80:95]
    s_waitcnt vmcnt(10) lgkmcnt(0)
    s_barrier
    ds_read_b64_tr_b16 v[48:49], v228 offset:16384
    v_mfma_f32_16x16x32_bf16 v[56:59], v[32:35], v[224:227], v[56:59]
    ds_read_b64_tr_b16 v[50:51], v228 offset:16896
    v_mfma_f32_32x32x16_bf16 v[96:111], v[32:35], v[212:215], v[96:111]
    ds_read_b64_tr_b16 v[52:53], v230 offset:16384
    v_mfma_f32_32x32x16_bf16 v[112:127], v[36:39], v[212:215], v[112:127]
    ds_read_b64_tr_b16 v[54:55], v230 offset:16896
    s_add_u32 m0, s23, 65536
    s_add_u32 s25, s22, 0
    buffer_load_dwordx4 v13, s[12:15], s25 offen lds
    s_waitcnt lgkmcnt(4)
    v_mfma_f32_32x32x16_bf16 v[64:79], v[40:43], v[216:219], v[64:79]
    ds_read_b64_tr_b16 v[32:33], v228 offset:18432
    v_mfma_f32_32x32x16_bf16 v[80:95], v[44:47], v[216:219], v[80:95]
    ds_read_b64_tr_b16 v[34:35], v228 offset:18944
    v_mfma_f32_16x16x32_bf16 v[56:59], v[40:43], v[224:227], v[56:59]
    ds_read_b64_tr_b16 v[36:37], v230 offset:18432
    v_mfma_f32_32x32x16_bf16 v[96:111], v[40:43], v[220:223], v[96:111]
    ds_read_b64_tr_b16 v[38:39], v230 offset:18944
    v_mfma_f32_32x32x16_bf16 v[112:127], v[44:47], v[220:223], v[112:127]
    s_add_u32 m0, s23, 69632
    s_add_u32 s25, s22, 110592
    buffer_load_dwordx4 v13, s[12:15], s25 offen lds
    s_waitcnt lgkmcnt(4)
    v_mfma_f32_32x32x16_bf16 v[128:143], v[48:51], v[192:195], v[128:143]
    ds_read_b64_tr_b16 v[40:41], v228 offset:20480
    v_mfma_f32_32x32x16_bf16 v[144:159], v[52:55], v[192:195], v[144:159]
    ds_read_b64_tr_b16 v[42:43], v228 offset:20992
    v_mfma_f32_16x16x32_bf16 v[60:63], v[48:51], v[224:227], v[60:63]
    ds_read_b64_tr_b16 v[44:45], v230 offset:20480
    v_mfma_f32_32x32x16_bf16 v[160:175], v[48:51], v[196:199], v[160:175]
    ds_read_b64_tr_b16 v[46:47], v230 offset:20992
    v_mfma_f32_32x32x16_bf16 v[176:191], v[52:55], v[196:199], v[176:191]
    s_add_u32 m0, s23, 73728
    s_add_u32 s25, s22, 0
    buffer_load_dwordx4 v13, s[16:19], s25 offen lds
    s_waitcnt lgkmcnt(4)
    v_mfma_f32_32x32x16_bf16 v[128:143], v[32:35], v[200:203], v[128:143]
    ds_read_b64_tr_b16 v[48:49], v228 offset:22528
    v_mfma_f32_32x32x16_bf16 v[144:159], v[36:39], v[200:203], v[144:159]
    ds_read_b64_tr_b16 v[50:51], v228 offset:23040
    v_mfma_f32_16x16x32_bf16 v[60:63], v[32:35], v[224:227], v[60:63]
    ds_read_b64_tr_b16 v[52:53], v230 offset:22528
    v_mfma_f32_32x32x16_bf16 v[160:175], v[32:35], v[204:207], v[160:175]
    ds_read_b64_tr_b16 v[54:55], v230 offset:23040
    v_mfma_f32_32x32x16_bf16 v[176:191], v[36:39], v[204:207], v[176:191]
    s_add_u32 m0, s23, 77824
    s_add_u32 s25, s22, 110592
    buffer_load_dwordx4 v13, s[16:19], s25 offen lds
    s_add_u32 s22, s22, 221184
    s_cmp_eq_u32 s22, s53
    s_cselect_b32 s22, s52, s22
    s_waitcnt lgkmcnt(4)
    v_mfma_f32_32x32x16_bf16 v[128:143], v[40:43], v[208:211], v[128:143]
    v_mfma_f32_32x32x16_bf16 v[144:159], v[44:47], v[208:211], v[144:159]
    s_waitcnt vmcnt(4) lgkmcnt(0)
    s_barrier
    ds_read_b128 v[192:195], v4 offset:32768
    ds_read_b128 v[196:199], v4 offset:36864
    v_mfma_f32_16x16x32_bf16 v[60:63], v[40:43], v[224:227], v[60:63]
    ds_read_b64_tr_b16 v[32:33], v228 offset:49152
    v_mfma_f32_32x32x16_bf16 v[160:175], v[40:43], v[212:215], v[160:175]
    ds_read_b64_tr_b16 v[34:35], v228 offset:49664
    ds_read_b64_tr_b16 v[36:37], v230 offset:49152
    v_mfma_f32_32x32x16_bf16 v[176:191], v[44:47], v[212:215], v[176:191]
    ds_read_b64_tr_b16 v[38:39], v230 offset:49664
    s_waitcnt lgkmcnt(6)
    v_mfma_f32_32x32x16_bf16 v[128:143], v[48:51], v[216:219], v[128:143]
    ds_read_b128 v[200:203], v5 offset:32768
    ds_read_b128 v[204:207], v5 offset:36864
    v_mfma_f32_32x32x16_bf16 v[144:159], v[52:55], v[216:219], v[144:159]
    ds_read_b64_tr_b16 v[40:41], v228 offset:51200
    v_mfma_f32_16x16x32_bf16 v[60:63], v[48:51], v[224:227], v[60:63]
    ds_read_b64_tr_b16 v[42:43], v228 offset:51712
    v_mfma_f32_32x32x16_bf16 v[160:175], v[48:51], v[220:223], v[160:175]
    ds_read_b64_tr_b16 v[44:45], v230 offset:51200
    v_mfma_f32_32x32x16_bf16 v[176:191], v[52:55], v[220:223], v[176:191]
    ds_read_b64_tr_b16 v[46:47], v230 offset:51712
    s_waitcnt lgkmcnt(6)
    v_mfma_f32_32x32x16_bf16 v[64:79], v[32:35], v[192:195], v[64:79]
    ds_read_b128 v[208:211], v6 offset:32768
    ds_read_b128 v[212:215], v6 offset:36864
    v_mfma_f32_32x32x16_bf16 v[80:95], v[36:39], v[192:195], v[80:95]
    ds_read_b64_tr_b16 v[48:49], v228 offset:53248
    v_mfma_f32_16x16x32_bf16 v[56:59], v[32:35], v[224:227], v[56:59]
    ds_read_b64_tr_b16 v[50:51], v228 offset:53760
    v_mfma_f32_32x32x16_bf16 v[96:111], v[32:35], v[196:199], v[96:111]
    ds_read_b64_tr_b16 v[52:53], v230 offset:53248
    v_mfma_f32_32x32x16_bf16 v[112:127], v[36:39], v[196:199], v[112:127]
    ds_read_b64_tr_b16 v[54:55], v230 offset:53760
    s_waitcnt lgkmcnt(6)
    v_mfma_f32_32x32x16_bf16 v[64:79], v[40:43], v[200:203], v[64:79]
    ds_read_b128 v[216:219], v7 offset:32768
    ds_read_b128 v[220:223], v7 offset:36864
    v_mfma_f32_32x32x16_bf16 v[80:95], v[44:47], v[200:203], v[80:95]
    ds_read_b64_tr_b16 v[32:33], v228 offset:55296
    v_mfma_f32_16x16x32_bf16 v[56:59], v[40:43], v[224:227], v[56:59]
    ds_read_b64_tr_b16 v[34:35], v228 offset:55808
    v_mfma_f32_32x32x16_bf16 v[96:111], v[40:43], v[204:207], v[96:111]
    ds_read_b64_tr_b16 v[36:37], v230 offset:55296
    v_mfma_f32_32x32x16_bf16 v[112:127], v[44:47], v[204:207], v[112:127]
    ds_read_b64_tr_b16 v[38:39], v230 offset:55808
    s_waitcnt lgkmcnt(6)
    v_mfma_f32_32x32x16_bf16 v[64:79], v[48:51], v[208:211], v[64:79]
    v_mfma_f32_32x32x16_bf16 v[80:95], v[52:55], v[208:211], v[80:95]
    s_waitcnt vmcnt(0) lgkmcnt(0)
    s_barrier
    ds_read_b64_tr_b16 v[40:41], v229 offset:0
    v_mfma_f32_16x16x32_bf16 v[56:59], v[48:51], v[224:227], v[56:59]
    ds_read_b64_tr_b16 v[42:43], v229 offset:512
    v_mfma_f32_32x32x16_bf16 v[96:111], v[48:51], v[212:215], v[96:111]
    ds_read_b64_tr_b16 v[44:45], v231 offset:0
    v_mfma_f32_32x32x16_bf16 v[112:127], v[52:55], v[212:215], v[112:127]
    ds_read_b64_tr_b16 v[46:47], v231 offset:512
    s_waitcnt lgkmcnt(4)
    v_mfma_f32_32x32x16_bf16 v[64:79], v[32:35], v[216:219], v[64:79]
    ds_read_b64_tr_b16 v[48:49], v229 offset:2048
    v_mfma_f32_32x32x16_bf16 v[80:95], v[36:39], v[216:219], v[80:95]
    ds_read_b64_tr_b16 v[50:51], v229 offset:2560
    v_mfma_f32_16x16x32_bf16 v[56:59], v[32:35], v[224:227], v[56:59]
    ds_read_b64_tr_b16 v[52:53], v231 offset:2048
    v_mfma_f32_32x32x16_bf16 v[96:111], v[32:35], v[220:223], v[96:111]
    ds_read_b64_tr_b16 v[54:55], v231 offset:2560
    v_mfma_f32_32x32x16_bf16 v[112:127], v[36:39], v[220:223], v[112:127]
    s_waitcnt lgkmcnt(4)
    v_mfma_f32_32x32x16_bf16 v[128:143], v[40:43], v[192:195], v[128:143]
    ds_read_b64_tr_b16 v[32:33], v229 offset:4096
    v_mfma_f32_32x32x16_bf16 v[144:159], v[44:47], v[192:195], v[144:159]
    ds_read_b64_tr_b16 v[34:35], v229 offset:4608
    v_mfma_f32_16x16x32_bf16 v[60:63], v[40:43], v[224:227], v[60:63]
    ds_read_b64_tr_b16 v[36:37], v231 offset:4096
    v_mfma_f32_32x32x16_bf16 v[160:175], v[40:43], v[196:199], v[160:175]
    ds_read_b64_tr_b16 v[38:39], v231 offset:4608
    v_mfma_f32_32x32x16_bf16 v[176:191], v[44:47], v[196:199], v[176:191]
    s_waitcnt lgkmcnt(4)
    v_mfma_f32_32x32x16_bf16 v[128:143], v[48:51], v[200:203], v[128:143]
    ds_read_b64_tr_b16 v[40:41], v229 offset:6144
    v_mfma_f32_32x32x16_bf16 v[144:159], v[52:55], v[200:203], v[144:159]
    ds_read_b64_tr_b16 v[42:43], v229 offset:6656
    v_mfma_f32_16x16x32_bf16 v[60:63], v[48:51], v[224:227], v[60:63]
    ds_read_b64_tr_b16 v[44:45], v231 offset:6144
    v_mfma_f32_32x32x16_bf16 v[160:175], v[48:51], v[204:207], v[160:175]
    ds_read_b64_tr_b16 v[46:47], v231 offset:6656
    v_mfma_f32_32x32x16_bf16 v[176:191], v[52:55], v[204:207], v[176:191]
    s_waitcnt lgkmcnt(4)
    v_mfma_f32_32x32x16_bf16 v[128:143], v[32:35], v[208:211], v[128:143]
    v_mfma_f32_32x32x16_bf16 v[144:159], v[36:39], v[208:211], v[144:159]
    v_mfma_f32_16x16x32_bf16 v[60:63], v[32:35], v[224:227], v[60:63]
    v_mfma_f32_32x32x16_bf16 v[160:175], v[32:35], v[212:215], v[160:175]
    v_mfma_f32_32x32x16_bf16 v[176:191], v[36:39], v[212:215], v[176:191]
    s_waitcnt lgkmcnt(0)
    v_mfma_f32_32x32x16_bf16 v[128:143], v[40:43], v[216:219], v[128:143]
    v_mfma_f32_32x32x16_bf16 v[144:159], v[44:47], v[216:219], v[144:159]
    v_mfma_f32_16x16x32_bf16 v[60:63], v[40:43], v[224:227], v[60:63]
    v_mfma_f32_32x32x16_bf16 v[160:175], v[40:43], v[220:223], v[160:175]
    v_mfma_f32_32x32x16_bf16 v[176:191], v[44:47], v[220:223], v[176:191]
    s_nop 15
    v_and_b32 v14, 15, v1
    v_lshrrev_b32 v15, 4, v1
    v_lshlrev_b32 v15, 4, v15
    v_lshl_add_u32 v15, v14, 6, v15
    s_lshl_b32 s30, s28, 8
    s_lshl_b32 s31, s27, 7
    s_add_u32 s31, s31, s30
    v_add_u32 v15, s31, v15
    v_cmp_gt_u32 vcc, 2, v14
    s_and_saveexec_b64 s[32:33], vcc
    ds_write_b128 v15, v[56:59] offset:0
    ds_write_b128 v15, v[60:63] offset:512
    s_mov_b64 exec, s[32:33]
    s_waitcnt vmcnt(0) lgkmcnt(0)
    s_barrier
    v_readfirstlane_b32 s34, v233
    s_cmp_eq_u32 s78, 0
    s_cbranch_scc1 L_fst_4_slow
    s_cmp_ge_u32 s34, 32
    s_cbranch_scc1 L_fst_4
L_fst_4_slow:
    s_cmp_lg_u32 s78, 0
    s_cbranch_scc1 L_rdyd_6
    v_mov_b32 v238, 0
    s_mov_b32 s30, 0x40000
L_rdy_5:
    global_load_dword v239, v238, s[74:75] sc1
    s_waitcnt vmcnt(0)
    v_readfirstlane_b32 s78, v239
    s_cmp_lg_u32 s78, 0
    s_cbranch_scc1 L_rdyd_6
    s_sleep 4
    s_sub_u32 s30, s30, 1
    s_cmp_lg_u32 s30, 0
    s_cbranch_scc1 L_rdy_5
L_rdyd_6:
    s_lshl_b32 s31, s54, 7
    v_mov_b32 v238, s31
    s_mov_b32 exec_lo, 1
    s_mov_b32 exec_hi, 0
    s_mov_b32 s30, 0x40000
L_wc_7:
    buffer_load_dword v239, v238, s[56:59], 0 offen sc1
    s_waitcnt vmcnt(0)
    v_cmp_gt_u32 vcc, 32, v239
    s_nop 4
    s_cbranch_vccz L_wcd_8_x
    s_sleep 1
    s_sub_u32 s30, s30, 1
    s_cmp_lg_u32 s30, 0
    s_cbranch_scc1 L_wc_7
L_wcd_8_x:
    s_mov_b64 exec, -1
L_wcd_8:
    v_and_b32 v14, 31, v1
    s_lshl_b32 s30, s27, 6
    s_add_u32 s30, s30, s46
    v_add_u32 v14, s30, v14
    v_lshlrev_b32 v14, 3, v14
    buffer_load_dwordx2 v[240:241], v14, s[48:51], 0 offen sc1
    buffer_load_dwordx2 v[242:243], v14, s[48:51], 0 offen offset:256 sc1
    s_waitcnt vmcnt(0)
L_fst_4:
    v_lshrrev_b32 v14, 5, v1
    v_lshlrev_b32 v14, 4, v14
    s_lshl_b32 s30, s28, 8
    v_add_u32 v14, s30, v14
    ds_read_b128 v[196:199], v14 offset:0
    ds_read_b128 v[200:203], v14 offset:32
    ds_read_b128 v[204:207], v14 offset:64
    ds_read_b128 v[208:211], v14 offset:96
    ds_read_b128 v[212:215], v14 offset:128
    ds_read_b128 v[216:219], v14 offset:160
    ds_read_b128 v[220:223], v14 offset:192
    ds_read_b128 v[224:227], v14 offset:224
    s_cmp_ge_u32 s45, 5
    s_cselect_b32 s42, 1, 0
    s_mul_i32 s43, s42, 5
    s_sub_u32 s43, s45, s43
    s_mov_b32 s30, 1048576
    s_mov_b32 s31, 3670016
    s_cmp_eq_u32 s42, 1
    s_cselect_b32 s30, s31, s30
    s_add_u32 s8, s76, s30
    s_addc_u32 s9, s77, 0
    s_and_b32 s9, s9, 0xffff
    s_mov_b32 s10, 2621440
    s_cmp_eq_u32 s45, 15
    s_cselect_b32 s10, 0, s10
    s_mov_b32 s11, 0x00020000
    s_cmp_eq_u32 s42, 1
    s_mov_b32 s53, 0x3ea52b5c
    s_cselect_b32 s53, 1.0, s53
    s_lshl_b32 s30, s43, 4
    s_lshl_b32 s31, s28, 2
    s_add_u32 s30, s30, s31
    s_lshl_b32 s30, s30, 15
    s_lshl_b32 s31, s27, 6
    s_add_u32 s31, s31, s46
    s_lshl_b32 s31, s31, 4
    s_add_u32 s51, s30, s31
    s_lshl_b32 s30, s27, 18
    s_add_u32 s52, s51, s30
    s_xor_b32 s30, s30, 262144
    s_add_u32 s51, s51, s30
    v_lshrrev_b32 v16, 5, v1
    v_lshlrev_b32 v16, 15, v16
    v_and_b32 v15, 31, v1
    v_lshl_add_u32 v16, v15, 4, v16
    v_mul_f32 v192, s53, v240
    v_mul_f32 v193, s53, v241
    v_mul_f32 v194, s53, v242
    v_mul_f32 v195, s53, v243
    s_waitcnt lgkmcnt(0)
    s_cmp_eq_u32 s27, 0
    s_cbranch_scc1 L_af_end_1_ns
    v_swap_b32 v196, v212
    v_swap_b32 v197, v213
    v_swap_b32 v198, v214
    v_swap_b32 v199, v215
    v_swap_b32 v200, v216
    v_swap_b32 v201, v217
    v_swap_b32 v202, v218
    v_swap_b32 v203, v219
    v_swap_b32 v204, v220
    v_swap_b32 v205, v221
    v_swap_b32 v206, v222
    v_swap_b32 v207, v223
    v_swap_b32 v208, v224
    v_swap_b32 v209, v225
    v_swap_b32 v210, v226
    v_swap_b32 v211, v227
L_af_end_1_ns:
    v_mul_f32 v32, v192, v196
    v_mul_f32 v33, v192, v197
    v_mul_f32 v34, v192, v198
    v_mul_f32 v35, v192, v199
    v_fma_f32 v32, v64, v193, -v32
    v_fma_f32 v33, v65, v193, -v33
    v_fma_f32 v34, v66, v193, -v34
    v_fma_f32 v35, v67, v193, -v35
    v_mul_f32 v36, v192, v200
    v_mul_f32 v37, v192, v201
    v_mul_f32 v38, v192, v202
    v_mul_f32 v39, v192, v203
    v_fma_f32 v36, v68, v193, -v36
    v_fma_f32 v37, v69, v193, -v37
    v_fma_f32 v38, v70, v193, -v38
    v_fma_f32 v39, v71, v193, -v39
    v_cvt_pk_bf16_f32 v40, v32, v33
    v_cvt_pk_bf16_f32 v41, v34, v35
    v_cvt_pk_bf16_f32 v42, v36, v37
    v_cvt_pk_bf16_f32 v43, v38, v39
    s_add_u32 s30, s52, 0
    s_nop 0
    v_permlane32_swap_b32 v40, v42
    v_permlane32_swap_b32 v41, v43
    buffer_store_dwordx4 v[40:43], v16, s[8:11], s30 offen sc1
    v_mul_f32 v44, v194, v196
    v_mul_f32 v45, v194, v197
    v_mul_f32 v46, v194, v198
    v_mul_f32 v47, v194, v199
    v_fma_f32 v44, v96, v195, -v44
    v_fma_f32 v45, v97, v195, -v45
    v_fma_f32 v46, v98, v195, -v46
    v_fma_f32 v47, v99, v195, -v47
    v_mul_f32 v48, v194, v200
    v_mul_f32 v49, v194, v201
    v_mul_f32 v50, v194, v202
    v_mul_f32 v51, v194, v203
    v_fma_f32 v48, v100, v195, -v48
    v_fma_f32 v49, v101, v195, -v49
    v_fma_f32 v50, v102, v195, -v50
    v_fma_f32 v51, v103, v195, -v51
    v_cvt_pk_bf16_f32 v52, v44, v45
    v_cvt_pk_bf16_f32 v53, v46, v47
    v_cvt_pk_bf16_f32 v54, v48, v49
    v_cvt_pk_bf16_f32 v55, v50, v51
    s_add_u32 s30, s52, 512
    s_nop 0
    v_permlane32_swap_b32 v52, v54
    v_permlane32_swap_b32 v53, v55
    buffer_store_dwordx4 v[52:55], v16, s[8:11], s30 offen sc1
    v_mul_f32 v32, v192, v204
    v_mul_f32 v33, v192, v205
    v_mul_f32 v34, v192, v206
    v_mul_f32 v35, v192, v207
    v_fma_f32 v32, v72, v193, -v32
    v_fma_f32 v33, v73, v193, -v33
    v_fma_f32 v34, v74, v193, -v34
    v_fma_f32 v35, v75, v193, -v35
    v_mul_f32 v36, v192, v208
    v_mul_f32 v37, v192, v209
    v_mul_f32 v38, v192, v210
    v_mul_f32 v39, v192, v211
    v_fma_f32 v36, v76, v193, -v36
    v_fma_f32 v37, v77, v193, -v37
    v_fma_f32 v38, v78, v193, -v38
    v_fma_f32 v39, v79, v193, -v39
    v_cvt_pk_bf16_f32 v40, v32, v33
    v_cvt_pk_bf16_f32 v41, v34, v35
    v_cvt_pk_bf16_f32 v42, v36, v37
    v_cvt_pk_bf16_f32 v43, v38, v39
    s_add_u32 s30, s52, 65536
    s_nop 0
    v_permlane32_swap_b32 v40, v42
    v_permlane32_swap_b32 v41, v43
    buffer_store_dwordx4 v[40:43], v16, s[8:11], s30 offen sc1
    v_mul_f32 v44, v194, v204
    v_mul_f32 v45, v194, v205
    v_mul_f32 v46, v194, v206
    v_mul_f32 v47, v194, v207
    v_fma_f32 v44, v104, v195, -v44
    v_fma_f32 v45, v105, v195, -v45
    v_fma_f32 v46, v106, v195, -v46
    v_fma_f32 v47, v107, v195, -v47
    v_mul_f32 v48, v194, v208
    v_mul_f32 v49, v194, v209
    v_mul_f32 v50, v194, v210
    v_mul_f32 v51, v194, v211
    v_fma_f32 v48, v108, v195, -v48
    v_fma_f32 v49, v109, v195, -v49
    v_fma_f32 v50, v110, v195, -v50
    v_fma_f32 v51, v111, v195, -v51
    v_cvt_pk_bf16_f32 v52, v44, v45
    v_cvt_pk_bf16_f32 v53, v46, v47
    v_cvt_pk_bf16_f32 v54, v48, v49
    v_cvt_pk_bf16_f32 v55, v50, v51
    s_add_u32 s30, s52, 66048
    s_nop 0
    v_permlane32_swap_b32 v52, v54
    v_permlane32_swap_b32 v53, v55
    buffer_store_dwordx4 v[52:55], v16, s[8:11], s30 offen sc1
    v_mul_f32 v32, v192, v212
    v_mul_f32 v33, v192, v213
    v_mul_f32 v34, v192, v214
    v_mul_f32 v35, v192, v215
    v_fma_f32 v32, v80, v193, -v32
    v_fma_f32 v33, v81, v193, -v33
    v_fma_f32 v34, v82, v193, -v34
    v_fma_f32 v35, v83, v193, -v35
    v_mul_f32 v36, v192, v216
    v_mul_f32 v37, v192, v217
    v_mul_f32 v38, v192, v218
    v_mul_f32 v39, v192, v219
    v_fma_f32 v36, v84, v193, -v36
    v_fma_f32 v37, v85, v193, -v37
    v_fma_f32 v38, v86, v193, -v38
    v_fma_f32 v39, v87, v193, -v39
    v_cvt_pk_bf16_f32 v40, v32, v33
    v_cvt_pk_bf16_f32 v41, v34, v35
    v_cvt_pk_bf16_f32 v42, v36, v37
    v_cvt_pk_bf16_f32 v43, v38, v39
    s_add_u32 s30, s51, 0
    s_nop 0
    v_permlane32_swap_b32 v40, v42
    v_permlane32_swap_b32 v41, v43
    buffer_store_dwordx4 v[40:43], v16, s[8:11], s30 offen sc1
    v_mul_f32 v44, v194, v212
    v_mul_f32 v45, v194, v213
    v_mul_f32 v46, v194, v214
    v_mul_f32 v47, v194, v215
    v_fma_f32 v44, v112, v195, -v44
    v_fma_f32 v45, v113, v195, -v45
    v_fma_f32 v46, v114, v195, -v46
    v_fma_f32 v47, v115, v195, -v47
    v_mul_f32 v48, v194, v216
    v_mul_f32 v49, v194, v217
    v_mul_f32 v50, v194, v218
    v_mul_f32 v51, v194, v219
    v_fma_f32 v48, v116, v195, -v48
    v_fma_f32 v49, v117, v195, -v49
    v_fma_f32 v50, v118, v195, -v50
    v_fma_f32 v51, v119, v195, -v51
    v_cvt_pk_bf16_f32 v52, v44, v45
    v_cvt_pk_bf16_f32 v53, v46, v47
    v_cvt_pk_bf16_f32 v54, v48, v49
    v_cvt_pk_bf16_f32 v55, v50, v51
    s_add_u32 s30, s51, 512
    s_nop 0
    v_permlane32_swap_b32 v52, v54
    v_permlane32_swap_b32 v53, v55
    buffer_store_dwordx4 v[52:55], v16, s[8:11], s30 offen sc1
    v_mul_f32 v32, v192, v220
    v_mul_f32 v33, v192, v221
    v_mul_f32 v34, v192, v222
    v_mul_f32 v35, v192, v223
    v_fma_f32 v32, v88, v193, -v32
    v_fma_f32 v33, v89, v193, -v33
    v_fma_f32 v34, v90, v193, -v34
    v_fma_f32 v35, v91, v193, -v35
    v_mul_f32 v36, v192, v224
    v_mul_f32 v37, v192, v225
    v_mul_f32 v38, v192, v226
    v_mul_f32 v39, v192, v227
    v_fma_f32 v36, v92, v193, -v36
    v_fma_f32 v37, v93, v193, -v37
    v_fma_f32 v38, v94, v193, -v38
    v_fma_f32 v39, v95, v193, -v39
    v_cvt_pk_bf16_f32 v40, v32, v33
    v_cvt_pk_bf16_f32 v41, v34, v35
    v_cvt_pk_bf16_f32 v42, v36, v37
    v_cvt_pk_bf16_f32 v43, v38, v39
    s_add_u32 s30, s51, 65536
    s_nop 0
    v_permlane32_swap_b32 v40, v42
    v_permlane32_swap_b32 v41, v43
    buffer_store_dwordx4 v[40:43], v16, s[8:11], s30 offen sc1
    v_mul_f32 v44, v194, v220
    v_mul_f32 v45, v194, v221
    v_mul_f32 v46, v194, v222
    v_mul_f32 v47, v194, v223
    v_fma_f32 v44, v120, v195, -v44
    v_fma_f32 v45, v121, v195, -v45
    v_fma_f32 v46, v122, v195, -v46
    v_fma_f32 v47, v123, v195, -v47
    v_mul_f32 v48, v194, v224
    v_mul_f32 v49, v194, v225
    v_mul_f32 v50, v194, v226
    v_mul_f32 v51, v194, v227
    v_fma_f32 v48, v124, v195, -v48
    v_fma_f32 v49, v125, v195, -v49
    v_fma_f32 v50, v126, v195, -v50
    v_fma_f32 v51, v127, v195, -v51
    v_cvt_pk_bf16_f32 v52, v44, v45
    v_cvt_pk_bf16_f32 v53, v46, v47
    v_cvt_pk_bf16_f32 v54, v48, v49
    v_cvt_pk_bf16_f32 v55, v50, v51
    s_add_u32 s30, s51, 66048
    s_nop 0
    v_permlane32_swap_b32 v52, v54
    v_permlane32_swap_b32 v53, v55
    buffer_store_dwordx4 v[52:55], v16, s[8:11], s30 offen sc1
    s_branch L_af_h_3
L_af_v_2:
    s_waitcnt vmcnt(4)
    s_barrier
    ds_read_b128 v[192:195], v4 offset:0
    ds_read_b128 v[196:199], v4 offset:4096
    ds_read_b64_tr_b16 v[32:33], v228 offset:16384
    ds_read_b64_tr_b16 v[34:35], v228 offset:16896
    ds_read_b64_tr_b16 v[36:37], v230 offset:16384
    ds_read_b64_tr_b16 v[38:39], v230 offset:16896
    ds_read_b128 v[200:203], v5 offset:0
    ds_read_b128 v[204:207], v5 offset:4096
    ds_read_b64_tr_b16 v[40:41], v228 offset:18432
    ds_read_b64_tr_b16 v[42:43], v228 offset:18944
    ds_read_b64_tr_b16 v[44:45], v230 offset:18432
    ds_read_b64_tr_b16 v[46:47], v230 offset:18944
    s_waitcnt lgkmcnt(6)
    v_mfma_f32_32x32x16_bf16 v[64:79], v[192:195], v[32:35], 0
    ds_read_b128 v[208:211], v6 offset:0
    ds_read_b128 v[212:215], v6 offset:4096
    v_mfma_f32_32x32x16_bf16 v[80:95], v[192:195], v[36:39], 0
    ds_read_b64_tr_b16 v[48:49], v228 offset:20480
    s_add_u32 m0, s23, 49152
    s_add_u32 s25, s20, 0
    buffer_load_dwordx4 v2, s[4:7], s25 offen lds
    v_mfma_f32_16x16x32_bf16 v[56:59], v[32:35], v[224:227], 0
    ds_read_b64_tr_b16 v[50:51], v228 offset:20992
    s_add_u32 m0, s23, 53248
    s_add_u32 s25, s20, 40960
    buffer_load_dwordx4 v2, s[4:7], s25 offen lds
    v_mfma_f32_32x32x16_bf16 v[96:111], v[196:199], v[32:35], 0
    ds_read_b64_tr_b16 v[52:53], v230 offset:20480
    s_add_u32 m0, s23, 57344
    s_add_u32 s25, s20, 81920
    buffer_load_dwordx4 v2, s[4:7], s25 offen lds
    v_mfma_f32_32x32x16_bf16 v[112:127], v[196:199], v[36:39], 0
    ds_read_b64_tr_b16 v[54:55], v230 offset:20992
    s_add_u32 m0, s23, 61440
    s_add_u32 s25, s20, 122880
    buffer_load_dwordx4 v2, s[4:7], s25 offen lds
    s_add_u32 s20, s20, 128
    s_cmp_eq_u32 s20, s37
    s_cselect_b32 s20, s36, s20
    s_waitcnt lgkmcnt(6)
    v_mfma_f32_32x32x16_bf16 v[64:79], v[200:203], v[40:43], v[64:79]
    ds_read_b128 v[216:219], v7 offset:0
    ds_read_b128 v[220:223], v7 offset:4096
    v_mfma_f32_32x32x16_bf16 v[80:95], v[200:203], v[44:47], v[80:95]
    ds_read_b64_tr_b16 v[32:33], v228 offset:22528
    s_add_u32 m0, s23, 65536
    s_add_u32 s25, s21, 0
    buffer_load_dwordx4 v3, s[8:11], s25 offen lds
    v_mfma_f32_16x16x32_bf16 v[56:59], v[40:43], v[224:227], v[56:59]
    ds_read_b64_tr_b16 v[34:35], v228 offset:23040
    s_add_u32 m0, s23, 69632
    s_add_u32 s25, s21, 122880
    buffer_load_dwordx4 v3, s[8:11], s25 offen lds
    v_mfma_f32_32x32x16_bf16 v[96:111], v[204:207], v[40:43], v[96:111]
    ds_read_b64_tr_b16 v[36:37], v230 offset:22528
    s_add_u32 m0, s23, 73728
    s_add_u32 s25, s21, 128
    buffer_load_dwordx4 v3, s[8:11], s25 offen lds
    v_mfma_f32_32x32x16_bf16 v[112:127], v[204:207], v[44:47], v[112:127]
    ds_read_b64_tr_b16 v[38:39], v230 offset:23040
    s_add_u32 m0, s23, 77824
    s_add_u32 s25, s21, 123008
    buffer_load_dwordx4 v3, s[8:11], s25 offen lds
    s_add_u32 s21, s21, 245760
    s_cmp_eq_u32 s21, s39
    s_cselect_b32 s21, s38, s21
    s_waitcnt lgkmcnt(6)
    v_mfma_f32_32x32x16_bf16 v[64:79], v[208:211], v[48:51], v[64:79]
    v_mfma_f32_32x32x16_bf16 v[80:95], v[208:211], v[52:55], v[80:95]
    s_waitcnt vmcnt(8) lgkmcnt(0)
    s_barrier
    ds_read_b64_tr_b16 v[40:41], v228 offset:32768
    v_mfma_f32_16x16x32_bf16 v[56:59], v[48:51], v[224:227], v[56:59]
    ds_read_b64_tr_b16 v[42:43], v228 offset:33280
    s_add_u32 m0, s23, 0
    s_add_u32 s25, s22, 0
    buffer_load_dwordx4 v13, s[12:15], s25 offen lds
    v_mfma_f32_32x32x16_bf16 v[96:111], v[212:215], v[48:51], v[96:111]
    ds_read_b64_tr_b16 v[44:45], v230 offset:32768
    v_mfma_f32_32x32x16_bf16 v[112:127], v[212:215], v[52:55], v[112:127]
    ds_read_b64_tr_b16 v[46:47], v230 offset:33280
    s_add_u32 m0, s23, 4096
    s_add_u32 s25, s22, 110592
    buffer_load_dwordx4 v13, s[12:15], s25 offen lds
    s_waitcnt lgkmcnt(4)
    v_mfma_f32_32x32x16_bf16 v[64:79], v[216:219], v[32:35], v[64:79]
    ds_read_b64_tr_b16 v[48:49], v228 offset:34816
    v_mfma_f32_32x32x16_bf16 v[80:95], v[216:219], v[36:39], v[80:95]
    ds_read_b64_tr_b16 v[50:51], v228 offset:35328
    v_mfma_f32_16x16x32_bf16 v[56:59], v[32:35], v[224:227], v[56:59]
    ds_read_b64_tr_b16 v[52:53], v230 offset:34816
    s_add_u32 m0, s23, 8192
    s_add_u32 s25, s22, 0
    buffer_load_dwordx4 v13, s[16:19], s25 offen lds
    v_mfma_f32_32x32x16_bf16 v[96:111], v[220:223], v[32:35], v[96:111]
    ds_read_b64_tr_b16 v[54:55], v230 offset:35328
    v_mfma_f32_32x32x16_bf16 v[112:127], v[220:223], v[36:39], v[112:127]
    s_add_u32 m0, s23, 12288
    s_add_u32 s25, s22, 110592
    buffer_load_dwordx4 v13, s[16:19], s25 offen lds
    s_add_u32 s22, s22, 221184
    s_cmp_eq_u32 s22, s53
    s_cselect_b32 s22, s52, s22
    s_waitcnt lgkmcnt(4)
    v_mfma_f32_32x32x16_bf16 v[128:143], v[40:43], v[192:195], 0
    ds_read_b64_tr_b16 v[32:33], v228 offset:36864
    v_mfma_f32_32x32x16_bf16 v[144:159], v[44:47], v[192:195], 0
    ds_read_b64_tr_b16 v[34:35], v228 offset:37376
    v_mfma_f32_16x16x32_bf16 v[60:63], v[40:43], v[224:227], 0
    ds_read_b64_tr_b16 v[36:37], v230 offset:36864
    s_add_u32 m0, s23, 16384
    s_add_u32 s25, s20, 0
    buffer_load_dwordx4 v2, s[4:7], s25 offen lds
    v_mfma_f32_32x32x16_bf16 v[160:175], v[40:43], v[196:199], 0
    ds_read_b64_tr_b16 v[38:39], v230 offset:37376
    v_mfma_f32_32x32x16_bf16 v[176:191], v[44:47], v[196:199], 0
    s_add_u32 m0, s23, 20480
    s_add_u32 s25, s20, 40960
    buffer_load_dwordx4 v2, s[4:7], s25 offen lds
    s_waitcnt lgkmcnt(4)
    v_mfma_f32_32x32x16_bf16 v[128:143], v[48:51], v[200:203], v[128:143]
    ds_read_b64_tr_b16 v[40:41], v228 offset:38912
    v_mfma_f32_32x32x16_bf16 v[144:159], v[52:55], v[200:203], v[144:159]
    ds_read_b64_tr_b16 v[42:43], v228 offset:39424
    v_mfma_f32_16x16x32_bf16 v[60:63], v[48:51], v[224:227], v[60:63]
    ds_read_b64_tr_b16 v[44:45], v230 offset:38912
    s_add_u32 m0, s23, 24576
    s_add_u32 s25, s20, 81920
    buffer_load_dwordx4 v2, s[4:7], s25 offen lds
    v_mfma_f32_32x32x16_bf16 v[160:175], v[48:51], v[204:207], v[160:175]
    ds_read_b64_tr_b16 v[46:47], v230 offset:39424
    v_mfma_f32_32x32x16_bf16 v[176:191], v[52:55], v[204:207], v[176:191]
    s_add_u32 m0, s23, 28672
    s_add_u32 s25, s20, 122880
    buffer_load_dwordx4 v2, s[4:7], s25 offen lds
    s_add_u32 s20, s20, 128
    s_cmp_eq_u32 s20, s37
    s_cselect_b32 s20, s36, s20
    s_waitcnt lgkmcnt(4)
    v_mfma_f32_32x32x16_bf16 v[128:143], v[32:35], v[208:211], v[128:143]
    v_mfma_f32_32x32x16_bf16 v[144:159], v[36:39], v[208:211], v[144:159]
    s_waitcnt vmcnt(8) lgkmcnt(0)
    s_barrier
    ds_read_b128 v[192:195], v4 offset:49152
    ds_read_b128 v[196:199], v4 offset:53248
    v_mfma_f32_16x16x32_bf16 v[60:63], v[32:35], v[224:227], v[60:63]
    ds_read_b64_tr_b16 v[48:49], v229 offset:0
    v_mfma_f32_32x32x16_bf16 v[160:175], v[32:35], v[212:215], v[160:175]
    ds_read_b64_tr_b16 v[50:51], v229 offset:512
    ds_read_b64_tr_b16 v[52:53], v231 offset:0
    v_mfma_f32_32x32x16_bf16 v[176:191], v[36:39], v[212:215], v[176:191]
    ds_read_b64_tr_b16 v[54:55], v231 offset:512
    s_add_u32 m0, s23, 32768
    s_add_u32 s25, s21, 0
    buffer_load_dwordx4 v3, s[8:11], s25 offen lds
    s_waitcnt lgkmcnt(6)
    v_mfma_f32_32x32x16_bf16 v[128:143], v[40:43], v[216:219], v[128:143]
    ds_read_b128 v[200:203], v5 offset:49152
    ds_read_b128 v[204:207], v5 offset:53248
    v_mfma_f32_32x32x16_bf16 v[144:159], v[44:47], v[216:219], v[144:159]
    ds_read_b64_tr_b16 v[32:33], v229 offset:2048
    v_mfma_f32_16x16x32_bf16 v[60:63], v[40:43], v[224:227], v[60:63]
    ds_read_b64_tr_b16 v[34:35], v229 offset:2560
    v_mfma_f32_32x32x16_bf16 v[160:175], v[40:43], v[220:223], v[160:175]
    ds_read_b64_tr_b16 v[36:37], v231 offset:2048
    v_mfma_f32_32x32x16_bf16 v[176:191], v[44:47], v[220:223], v[176:191]
    ds_read_b64_tr_b16 v[38:39], v231 offset:2560
    s_add_u32 m0, s23, 36864
    s_add_u32 s25, s21, 122880
    buffer_load_dwordx4 v3, s[8:11], s25 offen lds
    s_waitcnt lgkmcnt(6)
    v_mfma_f32_32x32x16_bf16 v[64:79], v[192:195], v[48:51], v[64:79]
    ds_read_b128 v[208:211], v6 offset:49152
    ds_read_b128 v[212:215], v6 offset:53248
    v_mfma_f32_32x32x16_bf16 v[80:95], v[192:195], v[52:55], v[80:95]
    ds_read_b64_tr_b16 v[40:41], v229 offset:4096
    v_mfma_f32_16x16x32_bf16 v[56:59], v[48:51], v[224:227], v[56:59]
    ds_read_b64_tr_b16 v[42:43], v229 offset:4608
    v_mfma_f32_32x32x16_bf16 v[96:111], v[196:199], v[48:51], v[96:111]
    ds_read_b64_tr_b16 v[44:45], v231 offset:4096
    v_mfma_f32_32x32x16_bf16 v[112:127], v[196:199], v[52:55], v[112:127]
    ds_read_b64_tr_b16 v[46:47], v231 offset:4608
    s_add_u32 m0, s23, 40960
    s_add_u32 s25, s21, 128
    buffer_load_dwordx4 v3, s[8:11], s25 offen lds
    s_waitcnt lgkmcnt(6)
    v_mfma_f32_32x32x16_bf16 v[64:79], v[200:203], v[32:35], v[64:79]
    ds_read_b128 v[216:219], v7 offset:49152
    ds_read_b128 v[220:223], v7 offset:53248
    v_mfma_f32_32x32x16_bf16 v[80:95], v[200:203], v[36:39], v[80:95]
    ds_read_b64_tr_b16 v[48:49], v229 offset:6144
    v_mfma_f32_16x16x32_bf16 v[56:59], v[32:35], v[224:227], v[56:59]
    ds_read_b64_tr_b16 v[50:51], v229 offset:6656
    v_mfma_f32_32x32x16_bf16 v[96:111], v[204:207], v[32:35], v[96:111]
    ds_read_b64_tr_b16 v[52:53], v231 offset:6144
    v_mfma_f32_32x32x16_bf16 v[112:127], v[204:207], v[36:39], v[112:127]
    ds_read_b64_tr_b16 v[54:55], v231 offset:6656
    s_add_u32 m0, s23, 45056
    s_add_u32 s25, s21, 123008
    buffer_load_dwordx4 v3, s[8:11], s25 offen lds
    s_add_u32 s21, s21, 245760
    s_cmp_eq_u32 s21, s39
    s_cselect_b32 s21, s38, s21
    s_waitcnt lgkmcnt(6)
    v_mfma_f32_32x32x16_bf16 v[64:79], v[208:211], v[40:43], v[64:79]
    v_mfma_f32_32x32x16_bf16 v[80:95], v[208:211], v[44:47], v[80:95]
    s_waitcnt vmcnt(8) lgkmcnt(0)
    s_barrier
    ds_read_b64_tr_b16 v[32:33], v228 offset:0
    v_mfma_f32_16x16x32_bf16 v[56:59], v[40:43], v[224:227], v[56:59]
    ds_read_b64_tr_b16 v[34:35], v228 offset:512
    s_add_u32 m0, s23, 49152
    s_add_u32 s25, s22, 0
    buffer_load_dwordx4 v13, s[12:15], s25 offen lds
    v_mfma_f32_32x32x16_bf16 v[96:111], v[212:215], v[40:43], v[96:111]
    ds_read_b64_tr_b16 v[36:37], v230 offset:0
    v_mfma_f32_32x32x16_bf16 v[112:127], v[212:215], v[44:47], v[112:127]
    ds_read_b64_tr_b16 v[38:39], v230 offset:512
    s_add_u32 m0, s23, 53248
    s_add_u32 s25, s22, 110592
    buffer_load_dwordx4 v13, s[12:15], s25 offen lds
    s_waitcnt lgkmcnt(4)
    v_mfma_f32_32x32x16_bf16 v[64:79], v[216:219], v[48:51], v[64:79]
    ds_read_b64_tr_b16 v[40:41], v228 offset:2048
    v_mfma_f32_32x32x16_bf16 v[80:95], v[216:219], v[52:55], v[80:95]
    ds_read_b64_tr_b16 v[42:43], v228 offset:2560
    v_mfma_f32_16x16x32_bf16 v[56:59], v[48:51], v[224:227], v[56:59]
    ds_read_b64_tr_b16 v[44:45], v230 offset:2048
    s_add_u32 m0, s23, 57344
    s_add_u32 s25, s22, 0
    buffer_load_dwordx4 v13, s[16:19], s25 offen lds
    v_mfma_f32_32x32x16_bf16 v[96:111], v[220:223], v[48:51], v[96:111]
    ds_read_b64_tr_b16 v[46:47], v230 offset:2560
    v_mfma_f32_32x32x16_bf16 v[112:127], v[220:223], v[52:55], v[112:127]
    s_add_u32 m0, s23, 61440
    s_add_u32 s25, s22, 110592
    buffer_load_dwordx4 v13, s[16:19], s25 offen lds
    s_add_u32 s22, s22, 221184
    s_cmp_eq_u32 s22, s53
    s_cselect_b32 s22, s52, s22
    s_waitcnt lgkmcnt(4)
    v_mfma_f32_32x32x16_bf16 v[128:143], v[32:35], v[192:195], v[128:143]
    ds_read_b64_tr_b16 v[48:49], v228 offset:4096
    v_mfma_f32_32x32x16_bf16 v[144:159], v[36:39], v[192:195], v[144:159]
    ds_read_b64_tr_b16 v[50:51], v228 offset:4608
    v_mfma_f32_16x16x32_bf16 v[60:63], v[32:35], v[224:227], v[60:63]
    ds_read_b64_tr_b16 v[52:53], v230 offset:4096
    s_add_u32 m0, s23, 65536
    s_add_u32 s25, s20, 0
    buffer_load_dwordx4 v2, s[4:7], s25 offen lds
    v_mfma_f32_32x32x16_bf16 v[160:175], v[32:35], v[196:199], v[160:175]
    ds_read_b64_tr_b16 v[54:55], v230 offset:4608
    v_mfma_f32_32x32x16_bf16 v[176:191], v[36:39], v[196:199], v[176:191]
    s_add_u32 m0, s23, 69632
    s_add_u32 s25, s20, 40960
    buffer_load_dwordx4 v2, s[4:7], s25 offen lds
    s_waitcnt lgkmcnt(4)
    v_mfma_f32_32x32x16_bf16 v[128:143], v[40:43], v[200:203], v[128:143]
    ds_read_b64_tr_b16 v[32:33], v228 offset:6144
    v_mfma_f32_32x32x16_bf16 v[144:159], v[44:47], v[200:203], v[144:159]
    ds_read_b64_tr_b16 v[34:35], v228 offset:6656
    v_mfma_f32_16x16x32_bf16 v[60:63], v[40:43], v[224:227], v[60:63]
    ds_read_b64_tr_b16 v[36:37], v230 offset:6144
    s_add_u32 m0, s23, 73728
    s_add_u32 s25, s20, 81920
    buffer_load_dwordx4 v2, s[4:7], s25 offen lds
    v_mfma_f32_32x32x16_bf16 v[160:175], v[40:43], v[204:207], v[160:175]
    ds_read_b64_tr_b16 v[38:39], v230 offset:6656
    v_mfma_f32_32x32x16_bf16 v[176:191], v[44:47], v[204:207], v[176:191]
    s_add_u32 m0, s23, 77824
    s_add_u32 s25, s20, 122880
    buffer_load_dwordx4 v2, s[4:7], s25 offen lds
    s_add_u32 s20, s20, 128
    s_cmp_eq_u32 s20, s37
    s_cselect_b32 s20, s36, s20
    s_waitcnt lgkmcnt(4)
    v_mfma_f32_32x32x16_bf16 v[128:143], v[48:51], v[208:211], v[128:143]
    v_mfma_f32_32x32x16_bf16 v[144:159], v[52:55], v[208:211], v[144:159]
    s_waitcnt vmcnt(8) lgkmcnt(0)
    s_barrier
    ds_read_b128 v[192:195], v4 offset:16384
    ds_read_b128 v[196:199], v4 offset:20480
    v_mfma_f32_16x16x32_bf16 v[60:63], v[48:51], v[224:227], v[60:63]
    ds_read_b64_tr_b16 v[40:41], v228 offset:32768
    v_mfma_f32_32x32x16_bf16 v[160:175], v[48:51], v[212:215], v[160:175]
    ds_read_b64_tr_b16 v[42:43], v228 offset:33280
    ds_read_b64_tr_b16 v[44:45], v230 offset:32768
    v_mfma_f32_32x32x16_bf16 v[176:191], v[52:55], v[212:215], v[176:191]
    ds_read_b64_tr_b16 v[46:47], v230 offset:33280
    s_add_u32 m0, s23, 0
    s_add_u32 s25, s21, 0
    buffer_load_dwordx4 v3, s[8:11], s25 offen lds
    s_waitcnt lgkmcnt(6)
    v_mfma_f32_32x32x16_bf16 v[128:143], v[32:35], v[216:219], v[128:143]
    ds_read_b128 v[200:203], v5 offset:16384
    ds_read_b128 v[204:207], v5 offset:20480
    v_mfma_f32_32x32x16_bf16 v[144:159], v[36:39], v[216:219], v[144:159]
    ds_read_b64_tr_b16 v[48:49], v228 offset:34816
    v_mfma_f32_16x16x32_bf16 v[60:63], v[32:35], v[224:227], v[60:63]
    ds_read_b64_tr_b16 v[50:51], v228 offset:35328
    v_mfma_f32_32x32x16_bf16 v[160:175], v[32:35], v[220:223], v[160:175]
    ds_read_b64_tr_b16 v[52:53], v230 offset:34816
    v_mfma_f32_32x32x16_bf16 v[176:191], v[36:39], v[220:223], v[176:191]
    ds_read_b64_tr_b16 v[54:55], v230 offset:35328
    s_add_u32 m0, s23, 4096
    s_add_u32 s25, s21, 122880
    buffer_load_dwordx4 v3, s[8:11], s25 offen lds
    s_waitcnt lgkmcnt(6)
    v_mfma_f32_32x32x16_bf16 v[64:79], v[192:195], v[40:43], v[64:79]
    ds_read_b128 v[208:211], v6 offset:16384
    ds_read_b128 v[212:215], v6 offset:20480
    v_mfma_f32_32x32x16_bf16 v[80:95], v[192:195], v[44:47], v[80:95]
    ds_read_b64_tr_b16 v[32:33], v228 offset:36864
    v_mfma_f32_16x16x32_bf16 v[56:59], v[40:43], v[224:227], v[56:59]
    ds_read_b64_tr_b16 v[34:35], v228 offset:37376
    v_mfma_f32_32x32x16_bf16 v[96:111], v[196:199], v[40:43], v[96:111]
    ds_read_b64_tr_b16 v[36:37], v230 offset:36864
    v_mfma_f32_32x32x16_bf16 v[112:127], v[196:199], v[44:47], v[112:127]
    ds_read_b64_tr_b16 v[38:39], v230 offset:37376
    s_add_u32 m0, s23, 8192
    s_add_u32 s25, s21, 128
    buffer_load_dwordx4 v3, s[8:11], s25 offen lds
    s_waitcnt lgkmcnt(6)
    v_mfma_f32_32x32x16_bf16 v[64:79], v[200:203], v[48:51], v[64:79]
    ds_read_b128 v[216:219], v7 offset:16384
    ds_read_b128 v[220:223], v7 offset:20480
    v_mfma_f32_32x32x16_bf16 v[80:95], v[200:203], v[52:55], v[80:95]
    ds_read_b64_tr_b16 v[40:41], v228 offset:38912
    v_mfma_f32_16x16x32_bf16 v[56:59], v[48:51], v[224:227], v[56:59]
    ds_read_b64_tr_b16 v[42:43], v228 offset:39424
    v_mfma_f32_32x32x16_bf16 v[96:111], v[204:207], v[48:51], v[96:111]
    ds_read_b64_tr_b16 v[44:45], v230 offset:38912
    v_mfma_f32_32x32x16_bf16 v[112:127], v[204:207], v[52:55], v[112:127]
    ds_read_b64_tr_b16 v[46:47], v230 offset:39424
    s_add_u32 m0, s23, 12288
    s_add_u32 s25, s21, 123008
    buffer_load_dwordx4 v3, s[8:11], s25 offen lds
    s_add_u32 s21, s21, 245760
    s_cmp_eq_u32 s21, s39
    s_cselect_b32 s21, s38, s21
    s_waitcnt lgkmcnt(6)
    v_mfma_f32_32x32x16_bf16 v[64:79], v[208:211], v[32:35], v[64:79]
    v_mfma_f32_32x32x16_bf16 v[80:95], v[208:211], v[36:39], v[80:95]
    s_waitcnt vmcnt(8) lgkmcnt(0)
    s_barrier
    ds_read_b64_tr_b16 v[48:49], v228 offset:49152
    v_mfma_f32_16x16x32_bf16 v[56:59], v[32:35], v[224:227], v[56:59]
    ds_read_b64_tr_b16 v[50:51], v228 offset:49664
    s_add_u32 m0, s23, 16384
    s_add_u32 s25, s22, 0
    buffer_load_dwordx4 v13, s[12:15], s25 offen lds
    v_mfma_f32_32x32x16_bf16 v[96:111], v[212:215], v[32:35], v[96:111]
    ds_read_b64_tr_b16 v[52:53], v230 offset:49152
    v_mfma_f32_32x32x16_bf16 v[112:127], v[212:215], v[36:39], v[112:127]
    ds_read_b64_tr_b16 v[54:55], v230 offset:49664
    s_add_u32 m0, s23, 20480
    s_add_u32 s25, s22, 110592
    buffer_load_dwordx4 v13, s[12:15], s25 offen lds
    s_waitcnt lgkmcnt(4)
    v_mfma_f32_32x32x16_bf16 v[64:79], v[216:219], v[40:43], v[64:79]
    ds_read_b64_tr_b16 v[32:33], v228 offset:51200
    v_mfma_f32_32x32x16_bf16 v[80:95], v[216:219], v[44:47], v[80:95]
    ds_read_b64_tr_b16 v[34:35], v228 offset:51712
    v_mfma_f32_16x16x32_bf16 v[56:59], v[40:43], v[224:227], v[56:59]
    ds_read_b64_tr_b16 v[36:37], v230 offset:51200
    s_add_u32 m0, s23, 24576
    s_add_u32 s25, s22, 0
    buffer_load_dwordx4 v13, s[16:19], s25 offen lds
    v_mfma_f32_32x32x16_bf16 v[96:111], v[220:223], v[40:43], v[96:111]
    ds_read_b64_tr_b16 v[38:39], v230 offset:51712
    v_mfma_f32_32x32x16_bf16 v[112:127], v[220:223], v[44:47], v[112:127]
    s_add_u32 m0, s23, 28672
    s_add_u32 s25, s22, 110592
    buffer_load_dwordx4 v13, s[16:19], s25 offen lds
    s_add_u32 s22, s22, 221184
    s_cmp_eq_u32 s22, s53
    s_cselect_b32 s22, s52, s22
    s_waitcnt lgkmcnt(4)
    v_mfma_f32_32x32x16_bf16 v[128:143], v[48:51], v[192:195], v[128:143]
    ds_read_b64_tr_b16 v[40:41], v228 offset:53248
    v_mfma_f32_32x32x16_bf16 v[144:159], v[52:55], v[192:195], v[144:159]
    ds_read_b64_tr_b16 v[42:43], v228 offset:53760
    v_mfma_f32_16x16x32_bf16 v[60:63], v[48:51], v[224:227], v[60:63]
    ds_read_b64_tr_b16 v[44:45], v230 offset:53248
    s_add_u32 m0, s23, 32768
    s_add_u32 s25, s20, 0
    buffer_load_dwordx4 v2, s[4:7], s25 offen lds
    v_mfma_f32_32x32x16_bf16 v[160:175], v[48:51], v[196:199], v[160:175]
    ds_read_b64_tr_b16 v[46:47], v230 offset:53760
    v_mfma_f32_32x32x16_bf16 v[176:191], v[52:55], v[196:199], v[176:191]
    s_add_u32 m0, s23, 36864
    s_add_u32 s25, s20, 40960
    buffer_load_dwordx4 v2, s[4:7], s25 offen lds
    s_waitcnt lgkmcnt(4)
    v_mfma_f32_32x32x16_bf16 v[128:143], v[32:35], v[200:203], v[128:143]
    ds_read_b64_tr_b16 v[48:49], v228 offset:55296
    v_mfma_f32_32x32x16_bf16 v[144:159], v[36:39], v[200:203], v[144:159]
    ds_read_b64_tr_b16 v[50:51], v228 offset:55808
    v_mfma_f32_16x16x32_bf16 v[60:63], v[32:35], v[224:227], v[60:63]
    ds_read_b64_tr_b16 v[52:53], v230 offset:55296
    s_add_u32 m0, s23, 40960
    s_add_u32 s25, s20, 81920
    buffer_load_dwordx4 v2, s[4:7], s25 offen lds
    v_mfma_f32_32x32x16_bf16 v[160:175], v[32:35], v[204:207], v[160:175]
    ds_read_b64_tr_b16 v[54:55], v230 offset:55808
    v_mfma_f32_32x32x16_bf16 v[176:191], v[36:39], v[204:207], v[176:191]
    s_add_u32 m0, s23, 45056
    s_add_u32 s25, s20, 122880
    buffer_load_dwordx4 v2, s[4:7], s25 offen lds
    s_add_u32 s20, s20, 128
    s_cmp_eq_u32 s20, s37
    s_cselect_b32 s20, s36, s20
    s_waitcnt lgkmcnt(4)
    v_mfma_f32_32x32x16_bf16 v[128:143], v[40:43], v[208:211], v[128:143]
    v_mfma_f32_32x32x16_bf16 v[144:159], v[44:47], v[208:211], v[144:159]
    s_waitcnt vmcnt(8) lgkmcnt(0)
    s_barrier
    ds_read_b128 v[192:195], v8 offset:0
    ds_read_b128 v[196:199], v8 offset:4096
    v_mfma_f32_16x16x32_bf16 v[60:63], v[40:43], v[224:227], v[60:63]
    ds_read_b64_tr_b16 v[32:33], v228 offset:0
    v_mfma_f32_32x32x16_bf16 v[160:175], v[40:43], v[212:215], v[160:175]
    ds_read_b64_tr_b16 v[34:35], v228 offset:512
    ds_read_b64_tr_b16 v[36:37], v230 offset:0
    v_mfma_f32_32x32x16_bf16 v[176:191], v[44:47], v[212:215], v[176:191]
    ds_read_b64_tr_b16 v[38:39], v230 offset:512
    s_add_u32 m0, s23, 49152
    s_add_u32 s25, s21, 0
    buffer_load_dwordx4 v3, s[8:11], s25 offen lds
    s_waitcnt lgkmcnt(6)
    v_mfma_f32_32x32x16_bf16 v[128:143], v[48:51], v[216:219], v[128:143]
    ds_read_b128 v[200:203], v9 offset:0
    ds_read_b128 v[204:207], v9 offset:4096
    v_mfma_f32_32x32x16_bf16 v[144:159], v[52:55], v[216:219], v[144:159]
    ds_read_b64_tr_b16 v[40:41], v228 offset:2048
    v_mfma_f32_16x16x32_bf16 v[60:63], v[48:51], v[224:227], v[60:63]
    ds_read_b64_tr_b16 v[42:43], v228 offset:2560
    v_mfma_f32_32x32x16_bf16 v[160:175], v[48:51], v[220:223], v[160:175]
    ds_read_b64_tr_b16 v[44:45], v230 offset:2048
    v_mfma_f32_32x32x16_bf16 v[176:191], v[52:55], v[220:223], v[176:191]
    ds_read_b64_tr_b16 v[46:47], v230 offset:2560
    s_add_u32 m0, s23, 53248
    s_add_u32 s25, s21, 122880
    buffer_load_dwordx4 v3, s[8:11], s25 offen lds
    v_mov_b32 v234, 0
    global_load_dword v232, v234, s[74:75] sc1
    s_waitcnt lgkmcnt(6)
    v_mfma_f32_32x32x16_bf16 v[64:79], v[192:195], v[32:35], v[64:79]
    ds_read_b128 v[208:211], v10 offset:0
    ds_read_b128 v[212:215], v10 offset:4096
    v_mfma_f32_32x32x16_bf16 v[80:95], v[192:195], v[36:39], v[80:95]
    ds_read_b64_tr_b16 v[48:49], v228 offset:4096
    v_mfma_f32_16x16x32_bf16 v[56:59], v[32:35], v[224:227], v[56:59]
    ds_read_b64_tr_b16 v[50:51], v228 offset:4608
    v_mfma_f32_32x32x16_bf16 v[96:111], v[196:199], v[32:35], v[96:111]
    ds_read_b64_tr_b16 v[52:53], v230 offset:4096
    v_mfma_f32_32x32x16_bf16 v[112:127], v[196:199], v[36:39], v[112:127]
    ds_read_b64_tr_b16 v[54:55], v230 offset:4608
    s_add_u32 m0, s23, 57344
    s_add_u32 s25, s21, 128
    buffer_load_dwordx4 v3, s[8:11], s25 offen lds
    s_waitcnt lgkmcnt(6)
    v_mfma_f32_32x32x16_bf16 v[64:79], v[200:203], v[40:43], v[64:79]
    ds_read_b128 v[216:219], v11 offset:0
    ds_read_b128 v[220:223], v11 offset:4096
    v_mfma_f32_32x32x16_bf16 v[80:95], v[200:203], v[44:47], v[80:95]
    ds_read_b64_tr_b16 v[32:33], v228 offset:6144
    v_mfma_f32_16x16x32_bf16 v[56:59], v[40:43], v[224:227], v[56:59]
    ds_read_b64_tr_b16 v[34:35], v228 offset:6656
    v_mfma_f32_32x32x16_bf16 v[96:111], v[204:207], v[40:43], v[96:111]
    ds_read_b64_tr_b16 v[36:37], v230 offset:6144
    v_mfma_f32_32x32x16_bf16 v[112:127], v[204:207], v[44:47], v[112:127]
    ds_read_b64_tr_b16 v[38:39], v230 offset:6656
    s_add_u32 m0, s23, 61440
    s_add_u32 s25, s21, 123008
    buffer_load_dwordx4 v3, s[8:11], s25 offen lds
    s_add_u32 s21, s21, 245760
    s_cmp_eq_u32 s21, s39
    s_cselect_b32 s21, s38, s21
    s_waitcnt lgkmcnt(6)
    v_mfma_f32_32x32x16_bf16 v[64:79], v[208:211], v[48:51], v[64:79]
    v_mfma_f32_32x32x16_bf16 v[80:95], v[208:211], v[52:55], v[80:95]
    s_waitcnt vmcnt(9) lgkmcnt(0)
    s_barrier
    ds_read_b64_tr_b16 v[40:41], v228 offset:16384
    v_mfma_f32_16x16x32_bf16 v[56:59], v[48:51], v[224:227], v[56:59]
    ds_read_b64_tr_b16 v[42:43], v228 offset:16896
    s_add_u32 m0, s23, 65536
    s_add_u32 s25, s22, 0
    buffer_load_dwordx4 v13, s[12:15], s25 offen lds
    v_mfma_f32_32x32x16_bf16 v[96:111], v[212:215], v[48:51], v[96:111]
    ds_read_b64_tr_b16 v[44:45], v230 offset:16384
    v_mfma_f32_32x32x16_bf16 v[112:127], v[212:215], v[52:55], v[112:127]
    ds_read_b64_tr_b16 v[46:47], v230 offset:16896
    s_add_u32 m0, s23, 69632
    s_add_u32 s25, s22, 110592
    buffer_load_dwordx4 v13, s[12:15], s25 offen lds
    s_waitcnt lgkmcnt(4)
    v_mfma_f32_32x32x16_bf16 v[64:79], v[216:219], v[32:35], v[64:79]
    ds_read_b64_tr_b16 v[48:49], v228 offset:18432
    v_mfma_f32_32x32x16_bf16 v[80:95], v[216:219], v[36:39], v[80:95]
    ds_read_b64_tr_b16 v[50:51], v228 offset:18944
    v_mfma_f32_16x16x32_bf16 v[56:59], v[32:35], v[224:227], v[56:59]
    ds_read_b64_tr_b16 v[52:53], v230 offset:18432
    s_add_u32 m0, s23, 73728
    s_add_u32 s25, s22, 0
    buffer_load_dwordx4 v13, s[16:19], s25 offen lds
    v_mfma_f32_32x32x16_bf16 v[96:111], v[220:223], v[32:35], v[96:111]
    ds_read_b64_tr_b16 v[54:55], v230 offset:18944
    v_mfma_f32_32x32x16_bf16 v[112:127], v[220:223], v[36:39], v[112:127]
    s_add_u32 m0, s23, 77824
    s_add_u32 s25, s22, 110592
    buffer_load_dwordx4 v13, s[16:19], s25 offen lds
    s_add_u32 s22, s22, 221184
    s_cmp_eq_u32 s22, s53
    s_cselect_b32 s22, s52, s22
    s_waitcnt lgkmcnt(4)
    v_mfma_f32_32x32x16_bf16 v[128:143], v[40:43], v[192:195], v[128:143]
    ds_read_b64_tr_b16 v[32:33], v228 offset:20480
    v_mfma_f32_32x32x16_bf16 v[144:159], v[44:47], v[192:195], v[144:159]
    ds_read_b64_tr_b16 v[34:35], v228 offset:20992
    v_mfma_f32_16x16x32_bf16 v[60:63], v[40:43], v[224:227], v[60:63]
    ds_read_b64_tr_b16 v[36:37], v230 offset:20480
    s_add_u32 m0, s23, 0
    s_add_u32 s25, s20, 0
    buffer_load_dwordx4 v2, s[4:7], s25 offen lds
    v_mfma_f32_32x32x16_bf16 v[160:175], v[40:43], v[196:199], v[160:175]
    ds_read_b64_tr_b16 v[38:39], v230 offset:20992
    v_mfma_f32_32x32x16_bf16 v[176:191], v[44:47], v[196:199], v[176:191]
    s_add_u32 m0, s23, 4096
    s_add_u32 s25, s20, 40960
    buffer_load_dwordx4 v2, s[4:7], s25 offen lds
    s_waitcnt lgkmcnt(4)
    v_mfma_f32_32x32x16_bf16 v[128:143], v[48:51], v[200:203], v[128:143]
    ds_read_b64_tr_b16 v[40:41], v228 offset:22528
    v_mfma_f32_32x32x16_bf16 v[144:159], v[52:55], v[200:203], v[144:159]
    ds_read_b64_tr_b16 v[42:43], v228 offset:23040
    v_mfma_f32_16x16x32_bf16 v[60:63], v[48:51], v[224:227], v[60:63]
    ds_read_b64_tr_b16 v[44:45], v230 offset:22528
    s_add_u32 m0, s23, 8192
    s_add_u32 s25, s20, 81920
    buffer_load_dwordx4 v2, s[4:7], s25 offen lds
    v_mfma_f32_32x32x16_bf16 v[160:175], v[48:51], v[204:207], v[160:175]
    ds_read_b64_tr_b16 v[46:47], v230 offset:23040
    v_mfma_f32_32x32x16_bf16 v[176:191], v[52:55], v[204:207], v[176:191]
    s_add_u32 m0, s23, 12288
    s_add_u32 s25, s20, 122880
    buffer_load_dwordx4 v2, s[4:7], s25 offen lds
    s_add_u32 s20, s20, 128
    s_cmp_eq_u32 s20, s37
    s_cselect_b32 s20, s36, s20
    s_waitcnt lgkmcnt(4)
    v_mfma_f32_32x32x16_bf16 v[128:143], v[32:35], v[208:211], v[128:143]
    v_mfma_f32_32x32x16_bf16 v[144:159], v[36:39], v[208:211], v[144:159]
    s_waitcnt vmcnt(8) lgkmcnt(0)
    s_barrier
    ds_read_b128 v[192:195], v4 offset:32768
    ds_read_b128 v[196:199], v4 offset:36864
    v_mfma_f32_16x16x32_bf16 v[60:63], v[32:35], v[224:227], v[60:63]
    ds_read_b64_tr_b16 v[48:49], v228 offset:49152
    v_mfma_f32_32x32x16_bf16 v[160:175], v[32:35], v[212:215], v[160:175]
    ds_read_b64_tr_b16 v[50:51], v228 offset:49664
    ds_read_b64_tr_b16 v[52:53], v230 offset:49152
    v_mfma_f32_32x32x16_bf16 v[176:191], v[36:39], v[212:215], v[176:191]
    ds_read_b64_tr_b16 v[54:55], v230 offset:49664
    s_add_u32 m0, s23, 16384
    s_add_u32 s25, s21, 0
    buffer_load_dwordx4 v3, s[8:11], s25 offen lds
    s_waitcnt lgkmcnt(6)
    v_mfma_f32_32x32x16_bf16 v[128:143], v[40:43], v[216:219], v[128:143]
    ds_read_b128 v[200:203], v5 offset:32768
    ds_read_b128 v[204:207], v5 offset:36864
    v_mfma_f32_32x32x16_bf16 v[144:159], v[44:47], v[216:219], v[144:159]
    ds_read_b64_tr_b16 v[32:33], v228 offset:51200
    v_mfma_f32_16x16x32_bf16 v[60:63], v[40:43], v[224:227], v[60:63]
    ds_read_b64_tr_b16 v[34:35], v228 offset:51712
    v_mfma_f32_32x32x16_bf16 v[160:175], v[40:43], v[220:223], v[160:175]
    ds_read_b64_tr_b16 v[36:37], v230 offset:51200
    v_mfma_f32_32x32x16_bf16 v[176:191], v[44:47], v[220:223], v[176:191]
    ds_read_b64_tr_b16 v[38:39], v230 offset:51712
    s_add_u32 m0, s23, 20480
    s_add_u32 s25, s21, 122880
    buffer_load_dwordx4 v3, s[8:11], s25 offen lds
    s_waitcnt lgkmcnt(6)
    v_mfma_f32_32x32x16_bf16 v[64:79], v[192:195], v[48:51], v[64:79]
    ds_read_b128 v[208:211], v6 offset:32768
    ds_read_b128 v[212:215], v6 offset:36864
    v_mfma_f32_32x32x16_bf16 v[80:95], v[192:195], v[52:55], v[80:95]
    ds_read_b64_tr_b16 v[40:41], v228 offset:53248
    v_mfma_f32_16x16x32_bf16 v[56:59], v[48:51], v[224:227], v[56:59]
    ds_read_b64_tr_b16 v[42:43], v228 offset:53760
    v_mfma_f32_32x32x16_bf16 v[96:111], v[196:199], v[48:51], v[96:111]
    ds_read_b64_tr_b16 v[44:45], v230 offset:53248
    v_mfma_f32_32x32x16_bf16 v[112:127], v[196:199], v[52:55], v[112:127]
    ds_read_b64_tr_b16 v[46:47], v230 offset:53760
    s_add_u32 m0, s23, 24576
    s_add_u32 s25, s21, 128
    buffer_load_dwordx4 v3, s[8:11], s25 offen lds
    s_waitcnt lgkmcnt(6)
    v_mfma_f32_32x32x16_bf16 v[64:79], v[200:203], v[32:35], v[64:79]
    ds_read_b128 v[216:219], v7 offset:32768
    ds_read_b128 v[220:223], v7 offset:36864
    v_mfma_f32_32x32x16_bf16 v[80:95], v[200:203], v[36:39], v[80:95]
    ds_read_b64_tr_b16 v[48:49], v228 offset:55296
    v_mfma_f32_16x16x32_bf16 v[56:59], v[32:35], v[224:227], v[56:59]
    ds_read_b64_tr_b16 v[50:51], v228 offset:55808
    v_mfma_f32_32x32x16_bf16 v[96:111], v[204:207], v[32:35], v[96:111]
    ds_read_b64_tr_b16 v[52:53], v230 offset:55296
    v_mfma_f32_32x32x16_bf16 v[112:127], v[204:207], v[36:39], v[112:127]
    ds_read_b64_tr_b16 v[54:55], v230 offset:55808
    s_add_u32 m0, s23, 28672
    s_add_u32 s25, s21, 123008
    buffer_load_dwordx4 v3, s[8:11], s25 offen lds
    s_add_u32 s21, s21, 245760
    s_cmp_eq_u32 s21, s39
    s_cselect_b32 s21, s38, s21
    s_waitcnt lgkmcnt(6)
    v_mfma_f32_32x32x16_bf16 v[64:79], v[208:211], v[40:43], v[64:79]
    v_mfma_f32_32x32x16_bf16 v[80:95], v[208:211], v[44:47], v[80:95]
    s_waitcnt vmcnt(8) lgkmcnt(0)
    s_barrier
    ds_read_b64_tr_b16 v[32:33], v229 offset:0
    v_mfma_f32_16x16x32_bf16 v[56:59], v[40:43], v[224:227], v[56:59]
    ds_read_b64_tr_b16 v[34:35], v229 offset:512
    s_add_u32 m0, s23, 32768
    s_add_u32 s25, s22, 0
    buffer_load_dwordx4 v13, s[12:15], s25 offen lds
    v_mfma_f32_32x32x16_bf16 v[96:111], v[212:215], v[40:43], v[96:111]
    ds_read_b64_tr_b16 v[36:37], v231 offset:0
    v_mfma_f32_32x32x16_bf16 v[112:127], v[212:215], v[44:47], v[112:127]
    ds_read_b64_tr_b16 v[38:39], v231 offset:512
    s_add_u32 m0, s23, 36864
    s_add_u32 s25, s22, 110592
    buffer_load_dwordx4 v13, s[12:15], s25 offen lds
    s_waitcnt lgkmcnt(4)
    v_mfma_f32_32x32x16_bf16 v[64:79], v[216:219], v[48:51], v[64:79]
    ds_read_b64_tr_b16 v[40:41], v229 offset:2048
    v_mfma_f32_32x32x16_bf16 v[80:95], v[216:219], v[52:55], v[80:95]
    ds_read_b64_tr_b16 v[42:43], v229 offset:2560
    v_mfma_f32_16x16x32_bf16 v[56:59], v[48:51], v[224:227], v[56:59]
    ds_read_b64_tr_b16 v[44:45], v231 offset:2048
    s_add_u32 m0, s23, 40960
    s_add_u32 s25, s22, 0
    buffer_load_dwordx4 v13, s[16:19], s25 offen lds
    v_mfma_f32_32x32x16_bf16 v[96:111], v[220:223], v[48:51], v[96:111]
    ds_read_b64_tr_b16 v[46:47], v231 offset:2560
    v_mfma_f32_32x32x16_bf16 v[112:127], v[220:223], v[52:55], v[112:127]
    s_add_u32 m0, s23, 45056
    s_add_u32 s25, s22, 110592
    buffer_load_dwordx4 v13, s[16:19], s25 offen lds
    s_add_u32 s22, s22, 221184
    s_cmp_eq_u32 s22, s53
    s_cselect_b32 s22, s52, s22
    s_waitcnt lgkmcnt(4)
    v_mfma_f32_32x32x16_bf16 v[128:143], v[32:35], v[192:195], v[128:143]
    ds_read_b64_tr_b16 v[48:49], v229 offset:4096
    v_mfma_f32_32x32x16_bf16 v[144:159], v[36:39], v[192:195], v[144:159]
    ds_read_b64_tr_b16 v[50:51], v229 offset:4608
    v_mfma_f32_16x16x32_bf16 v[60:63], v[32:35], v[224:227], v[60:63]
    ds_read_b64_tr_b16 v[52:53], v231 offset:4096
    s_add_u32 m0, s23, 49152
    s_add_u32 s25, s20, 0
    buffer_load_dwordx4 v2, s[4:7], s25 offen lds
    v_mfma_f32_32x32x16_bf16 v[160:175], v[32:35], v[196:199], v[160:175]
    ds_read_b64_tr_b16 v[54:55], v231 offset:4608
    v_mfma_f32_32x32x16_bf16 v[176:191], v[36:39], v[196:199], v[176:191]
    s_add_u32 m0, s23, 53248
    s_add_u32 s25, s20, 40960
    buffer_load_dwordx4 v2, s[4:7], s25 offen lds
    s_waitcnt lgkmcnt(4)
    v_mfma_f32_32x32x16_bf16 v[128:143], v[40:43], v[200:203], v[128:143]
    ds_read_b64_tr_b16 v[32:33], v229 offset:6144
    v_mfma_f32_32x32x16_bf16 v[144:159], v[44:47], v[200:203], v[144:159]
    ds_read_b64_tr_b16 v[34:35], v229 offset:6656
    v_mfma_f32_16x16x32_bf16 v[60:63], v[40:43], v[224:227], v[60:63]
    ds_read_b64_tr_b16 v[36:37], v231 offset:6144
    s_add_u32 m0, s23, 57344
    s_add_u32 s25, s20, 81920
    buffer_load_dwordx4 v2, s[4:7], s25 offen lds
    v_mfma_f32_32x32x16_bf16 v[160:175], v[40:43], v[204:207], v[160:175]
    ds_read_b64_tr_b16 v[38:39], v231 offset:6656
    v_mfma_f32_32x32x16_bf16 v[176:191], v[44:47], v[204:207], v[176:191]
    s_add_u32 m0, s23, 61440
    s_add_u32 s25, s20, 122880
    buffer_load_dwordx4 v2, s[4:7], s25 offen lds
    s_add_u32 s20, s20, 128
    s_cmp_eq_u32 s20, s37
    s_cselect_b32 s20, s36, s20
    s_waitcnt lgkmcnt(4)
    v_mfma_f32_32x32x16_bf16 v[128:143], v[48:51], v[208:211], v[128:143]
    v_mfma_f32_32x32x16_bf16 v[144:159], v[52:55], v[208:211], v[144:159]
    s_waitcnt vmcnt(8) lgkmcnt(0)
    s_barrier
    ds_read_b128 v[192:195], v4 offset:0
    ds_read_b128 v[196:199], v4 offset:4096
    v_mfma_f32_16x16x32_bf16 v[60:63], v[48:51], v[224:227], v[60:63]
    ds_read_b64_tr_b16 v[40:41], v228 offset:16384
    v_mfma_f32_32x32x16_bf16 v[160:175], v[48:51], v[212:215], v[160:175]
    ds_read_b64_tr_b16 v[42:43], v228 offset:16896
    ds_read_b64_tr_b16 v[44:45], v230 offset:16384
    v_mfma_f32_32x32x16_bf16 v[176:191], v[52:55], v[212:215], v[176:191]
    ds_read_b64_tr_b16 v[46:47], v230 offset:16896
    s_add_u32 m0, s23, 65536
    s_add_u32 s25, s21, 0
    buffer_load_dwordx4 v3, s[8:11], s25 offen lds
    s_waitcnt lgkmcnt(6)
    v_mfma_f32_32x32x16_bf16 v[128:143], v[32:35], v[216:219], v[128:143]
    ds_read_b128 v[200:203], v5 offset:0
    ds_read_b128 v[204:207], v5 offset:4096
    v_mfma_f32_32x32x16_bf16 v[144:159], v[36:39], v[216:219], v[144:159]
    ds_read_b64_tr_b16 v[48:49], v228 offset:18432
    v_mfma_f32_16x16x32_bf16 v[60:63], v[32:35], v[224:227], v[60:63]
    ds_read_b64_tr_b16 v[50:51], v228 offset:18944
    v_mfma_f32_32x32x16_bf16 v[160:175], v[32:35], v[220:223], v[160:175]
    ds_read_b64_tr_b16 v[52:53], v230 offset:18432
    v_mfma_f32_32x32x16_bf16 v[176:191], v[36:39], v[220:223], v[176:191]
    ds_read_b64_tr_b16 v[54:55], v230 offset:18944
    s_add_u32 m0, s23, 69632
    s_add_u32 s25, s21, 122880
    buffer_load_dwordx4 v3, s[8:11], s25 offen lds
    s_waitcnt lgkmcnt(6)
    v_mfma_f32_32x32x16_bf16 v[64:79], v[192:195], v[40:43], v[64:79]
    ds_read_b128 v[208:211], v6 offset:0
    ds_read_b128 v[212:215], v6 offset:4096
    v_mfma_f32_32x32x16_bf16 v[80:95], v[192:195], v[44:47], v[80:95]
    ds_read_b64_tr_b16 v[32:33], v228 offset:20480
    v_mfma_f32_16x16x32_bf16 v[56:59], v[40:43], v[224:227], v[56:59]
    ds_read_b64_tr_b16 v[34:35], v228 offset:20992
    v_mfma_f32_32x32x16_bf16 v[96:111], v[196:199], v[40:43], v[96:111]
    ds_read_b64_tr_b16 v[36:37], v230 offset:20480
    v_mfma_f32_32x32x16_bf16 v[112:127], v[196:199], v[44:47], v[112:127]
    ds_read_b64_tr_b16 v[38:39], v230 offset:20992
    s_add_u32 m0, s23, 73728
    s_add_u32 s25, s21, 128
    buffer_load_dwordx4 v3, s[8:11], s25 offen lds
    s_waitcnt lgkmcnt(6)
    v_mfma_f32_32x32x16_bf16 v[64:79], v[200:203], v[48:51], v[64:79]
    ds_read_b128 v[216:219], v7 offset:0
    ds_read_b128 v[220:223], v7 offset:4096
    v_mfma_f32_32x32x16_bf16 v[80:95], v[200:203], v[52:55], v[80:95]
    ds_read_b64_tr_b16 v[40:41], v228 offset:22528
    v_mfma_f32_16x16x32_bf16 v[56:59], v[48:51], v[224:227], v[56:59]
    ds_read_b64_tr_b16 v[42:43], v228 offset:23040
    v_mfma_f32_32x32x16_bf16 v[96:111], v[204:207], v[48:51], v[96:111]
    ds_read_b64_tr_b16 v[44:45], v230 offset:22528
    v_mfma_f32_32x32x16_bf16 v[112:127], v[204:207], v[52:55], v[112:127]
    ds_read_b64_tr_b16 v[46:47], v230 offset:23040
    s_add_u32 m0, s23, 77824
    s_add_u32 s25, s21, 123008
    buffer_load_dwordx4 v3, s[8:11], s25 offen lds
    s_add_u32 s21, s21, 245760
    s_cmp_eq_u32 s21, s39
    s_cselect_b32 s21, s38, s21
    s_waitcnt lgkmcnt(6)
    v_mfma_f32_32x32x16_bf16 v[64:79], v[208:211], v[32:35], v[64:79]
    v_mfma_f32_32x32x16_bf16 v[80:95], v[208:211], v[36:39], v[80:95]
    s_waitcnt vmcnt(8) lgkmcnt(0)
    s_barrier
    ds_read_b64_tr_b16 v[48:49], v228 offset:32768
    v_mfma_f32_16x16x32_bf16 v[56:59], v[32:35], v[224:227], v[56:59]
    ds_read_b64_tr_b16 v[50:51], v228 offset:33280
    s_add_u32 m0, s23, 0
    s_add_u32 s25, s22, 0
    buffer_load_dwordx4 v13, s[12:15], s25 offen lds
    v_mfma_f32_32x32x16_bf16 v[96:111], v[212:215], v[32:35], v[96:111]
    ds_read_b64_tr_b16 v[52:53], v230 offset:32768
    v_mfma_f32_32x32x16_bf16 v[112:127], v[212:215], v[36:39], v[112:127]
    ds_read_b64_tr_b16 v[54:55], v230 offset:33280
    s_add_u32 m0, s23, 4096
    s_add_u32 s25, s22, 110592
    buffer_load_dwordx4 v13, s[12:15], s25 offen lds
    s_waitcnt lgkmcnt(4)
    v_mfma_f32_32x32x16_bf16 v[64:79], v[216:219], v[40:43], v[64:79]
    ds_read_b64_tr_b16 v[32:33], v228 offset:34816
    v_mfma_f32_32x32x16_bf16 v[80:95], v[216:219], v[44:47], v[80:95]
    ds_read_b64_tr_b16 v[34:35], v228 offset:35328
    v_mfma_f32_16x16x32_bf16 v[56:59], v[40:43], v[224:227], v[56:59]
    ds_read_b64_tr_b16 v[36:37], v230 offset:34816
    s_add_u32 m0, s23, 8192
    s_add_u32 s25, s22, 0
    buffer_load_dwordx4 v13, s[16:19], s25 offen lds
    v_mfma_f32_32x32x16_bf16 v[96:111], v[220:223], v[40:43], v[96:111]
    ds_read_b64_tr_b16 v[38:39], v230 offset:35328
    v_mfma_f32_32x32x16_bf16 v[112:127], v[220:223], v[44:47], v[112:127]
    s_add_u32 m0, s23, 12288
    s_add_u32 s25, s22, 110592
    buffer_load_dwordx4 v13, s[16:19], s25 offen lds
    s_add_u32 s22, s22, 221184
    s_cmp_eq_u32 s22, s53
    s_cselect_b32 s22, s52, s22
    v_readfirstlane_b32 s29, v232
    s_or_b32 s78, s78, s29
    s_and_b32 s54, s2, 7
    s_lshl_b32 s29, s44, 3
    s_add_u32 s54, s54, s29
    s_add_u32 s54, s54, 40
    s_lshl_b32 s29, s54, 7
    v_mov_b32 v234, s29
    buffer_load_dword v233, v234, s[56:59], 0 offen sc1
    s_waitcnt lgkmcnt(4)
    v_mfma_f32_32x32x16_bf16 v[128:143], v[48:51], v[192:195], v[128:143]
    ds_read_b64_tr_b16 v[40:41], v228 offset:36864
    v_mfma_f32_32x32x16_bf16 v[144:159], v[52:55], v[192:195], v[144:159]
    ds_read_b64_tr_b16 v[42:43], v228 offset:37376
    v_mfma_f32_16x16x32_bf16 v[60:63], v[48:51], v[224:227], v[60:63]
    ds_read_b64_tr_b16 v[44:45], v230 offset:36864
    s_add_u32 m0, s23, 16384
    s_add_u32 s25, s20, 0
    buffer_load_dwordx4 v2, s[4:7], s25 offen lds
    v_mfma_f32_32x32x16_bf16 v[160:175], v[48:51], v[196:199], v[160:175]
    ds_read_b64_tr_b16 v[46:47], v230 offset:37376
    v_mfma_f32_32x32x16_bf16 v[176:191], v[52:55], v[196:199], v[176:191]
    s_add_u32 m0, s23, 20480
    s_add_u32 s25, s20, 40960
    buffer_load_dwordx4 v2, s[4:7], s25 offen lds
    s_waitcnt lgkmcnt(4)
    v_mfma_f32_32x32x16_bf16 v[128:143], v[32:35], v[200:203], v[128:143]
    ds_read_b64_tr_b16 v[48:49], v228 offset:38912
    v_mfma_f32_32x32x16_bf16 v[144:159], v[36:39], v[200:203], v[144:159]
    ds_read_b64_tr_b16 v[50:51], v228 offset:39424
    v_mfma_f32_16x16x32_bf16 v[60:63], v[32:35], v[224:227], v[60:63]
    ds_read_b64_tr_b16 v[52:53], v230 offset:38912
    s_add_u32 m0, s23, 24576
    s_add_u32 s25, s20, 81920
    buffer_load_dwordx4 v2, s[4:7], s25 offen lds
    v_mfma_f32_32x32x16_bf16 v[160:175], v[32:35], v[204:207], v[160:175]
    ds_read_b64_tr_b16 v[54:55], v230 offset:39424
    v_mfma_f32_32x32x16_bf16 v[176:191], v[36:39], v[204:207], v[176:191]
    s_add_u32 m0, s23, 28672
    s_add_u32 s25, s20, 122880
    buffer_load_dwordx4 v2, s[4:7], s25 offen lds
    s_add_u32 s20, s20, 128
    s_cmp_eq_u32 s20, s37
    s_cselect_b32 s20, s36, s20
    s_waitcnt lgkmcnt(4)
    v_mfma_f32_32x32x16_bf16 v[128:143], v[40:43], v[208:211], v[128:143]
    v_mfma_f32_32x32x16_bf16 v[144:159], v[44:47], v[208:211], v[144:159]
    s_waitcnt vmcnt(9) lgkmcnt(0)
    s_barrier
    ds_read_b128 v[192:195], v4 offset:49152
    ds_read_b128 v[196:199], v4 offset:53248
    v_mfma_f32_16x16x32_bf16 v[60:63], v[40:43], v[224:227], v[60:63]
    ds_read_b64_tr_b16 v[32:33], v229 offset:0
    v_mfma_f32_32x32x16_bf16 v[160:175], v[40:43], v[212:215], v[160:175]
    ds_read_b64_tr_b16 v[34:35], v229 offset:512
    ds_read_b64_tr_b16 v[36:37], v231 offset:0
    v_mfma_f32_32x32x16_bf16 v[176:191], v[44:47], v[212:215], v[176:191]
    ds_read_b64_tr_b16 v[38:39], v231 offset:512
    s_add_u32 m0, s23, 32768
    s_add_u32 s25, s21, 0
    buffer_load_dwordx4 v3, s[8:11], s25 offen lds
    s_waitcnt lgkmcnt(6)
    v_mfma_f32_32x32x16_bf16 v[128:143], v[48:51], v[216:219], v[128:143]
    ds_read_b128 v[200:203], v5 offset:49152
    ds_read_b128 v[204:207], v5 offset:53248
    v_mfma_f32_32x32x16_bf16 v[144:159], v[52:55], v[216:219], v[144:159]
    ds_read_b64_tr_b16 v[40:41], v229 offset:2048
    v_mfma_f32_16x16x32_bf16 v[60:63], v[48:51], v[224:227], v[60:63]
    ds_read_b64_tr_b16 v[42:43], v229 offset:2560
    v_mfma_f32_32x32x16_bf16 v[160:175], v[48:51], v[220:223], v[160:175]
    ds_read_b64_tr_b16 v[44:45], v231 offset:2048
    v_mfma_f32_32x32x16_bf16 v[176:191], v[52:55], v[220:223], v[176:191]
    ds_read_b64_tr_b16 v[46:47], v231 offset:2560
    s_add_u32 m0, s23, 36864
    s_add_u32 s25, s21, 122880
    buffer_load_dwordx4 v3, s[8:11], s25 offen lds
    s_waitcnt lgkmcnt(6)
    v_mfma_f32_32x32x16_bf16 v[64:79], v[192:195], v[32:35], v[64:79]
    ds_read_b128 v[208:211], v6 offset:49152
    ds_read_b128 v[212:215], v6 offset:53248
    v_mfma_f32_32x32x16_bf16 v[80:95], v[192:195], v[36:39], v[80:95]
    ds_read_b64_tr_b16 v[48:49], v229 offset:4096
    v_mfma_f32_16x16x32_bf16 v[56:59], v[32:35], v[224:227], v[56:59]
    ds_read_b64_tr_b16 v[50:51], v229 offset:4608
    v_mfma_f32_32x32x16_bf16 v[96:111], v[196:199], v[32:35], v[96:111]
    ds_read_b64_tr_b16 v[52:53], v231 offset:4096
    v_mfma_f32_32x32x16_bf16 v[112:127], v[196:199], v[36:39], v[112:127]
    ds_read_b64_tr_b16 v[54:55], v231 offset:4608
    s_add_u32 m0, s23, 40960
    s_add_u32 s25, s21, 128
    buffer_load_dwordx4 v3, s[8:11], s25 offen lds
    s_waitcnt lgkmcnt(6)
    v_mfma_f32_32x32x16_bf16 v[64:79], v[200:203], v[40:43], v[64:79]
    ds_read_b128 v[216:219], v7 offset:49152
    ds_read_b128 v[220:223], v7 offset:53248
    v_mfma_f32_32x32x16_bf16 v[80:95], v[200:203], v[44:47], v[80:95]
    ds_read_b64_tr_b16 v[32:33], v229 offset:6144
    v_mfma_f32_16x16x32_bf16 v[56:59], v[40:43], v[224:227], v[56:59]
    ds_read_b64_tr_b16 v[34:35], v229 offset:6656
    v_mfma_f32_32x32x16_bf16 v[96:111], v[204:207], v[40:43], v[96:111]
    ds_read_b64_tr_b16 v[36:37], v231 offset:6144
    v_mfma_f32_32x32x16_bf16 v[112:127], v[204:207], v[44:47], v[112:127]
    ds_read_b64_tr_b16 v[38:39], v231 offset:6656
    s_add_u32 m0, s23, 45056
    s_add_u32 s25, s21, 123008
    buffer_load_dwordx4 v3, s[8:11], s25 offen lds
    s_add_u32 s21, s21, 245760
    s_cmp_eq_u32 s21, s39
    s_cselect_b32 s21, s38, s21
    s_waitcnt lgkmcnt(6)
    v_mfma_f32_32x32x16_bf16 v[64:79], v[208:211], v[48:51], v[64:79]
    v_mfma_f32_32x32x16_bf16 v[80:95], v[208:211], v[52:55], v[80:95]
    s_waitcnt vmcnt(9) lgkmcnt(0)
    s_barrier
    ds_read_b64_tr_b16 v[40:41], v228 offset:0
    v_mfma_f32_16x16x32_bf16 v[56:59], v[48:51], v[224:227], v[56:59]
    ds_read_b64_tr_b16 v[42:43], v228 offset:512
    s_add_u32 m0, s23, 49152
    s_add_u32 s25, s22, 0
    buffer_load_dwordx4 v13, s[12:15], s25 offen lds
    v_mfma_f32_32x32x16_bf16 v[96:111], v[212:215], v[48:51], v[96:111]
    ds_read_b64_tr_b16 v[44:45], v230 offset:0
    v_mfma_f32_32x32x16_bf16 v[112:127], v[212:215], v[52:55], v[112:127]
    ds_read_b64_tr_b16 v[46:47], v230 offset:512
    s_add_u32 m0, s23, 53248
    s_add_u32 s25, s22, 110592
    buffer_load_dwordx4 v13, s[12:15], s25 offen lds
    s_waitcnt lgkmcnt(4)
    v_mfma_f32_32x32x16_bf16 v[64:79], v[216:219], v[32:35], v[64:79]
    ds_read_b64_tr_b16 v[48:49], v228 offset:2048
    v_mfma_f32_32x32x16_bf16 v[80:95], v[216:219], v[36:39], v[80:95]
    ds_read_b64_tr_b16 v[50:51], v228 offset:2560
    v_mfma_f32_16x16x32_bf16 v[56:59], v[32:35], v[224:227], v[56:59]
    ds_read_b64_tr_b16 v[52:53], v230 offset:2048
    s_add_u32 m0, s23, 57344
    s_add_u32 s25, s22, 0
    buffer_load_dwordx4 v13, s[16:19], s25 offen lds
    v_mfma_f32_32x32x16_bf16 v[96:111], v[220:223], v[32:35], v[96:111]
    ds_read_b64_tr_b16 v[54:55], v230 offset:2560
    v_mfma_f32_32x32x16_bf16 v[112:127], v[220:223], v[36:39], v[112:127]
    s_add_u32 m0, s23, 61440
    s_add_u32 s25, s22, 110592
    buffer_load_dwordx4 v13, s[16:19], s25 offen lds
    s_add_u32 s22, s22, 221184
    s_cmp_eq_u32 s22, s53
    s_cselect_b32 s22, s52, s22
    s_waitcnt lgkmcnt(4)
    v_mfma_f32_32x32x16_bf16 v[128:143], v[40:43], v[192:195], v[128:143]
    ds_read_b64_tr_b16 v[32:33], v228 offset:4096
    v_mfma_f32_32x32x16_bf16 v[144:159], v[44:47], v[192:195], v[144:159]
    ds_read_b64_tr_b16 v[34:35], v228 offset:4608
    v_mfma_f32_16x16x32_bf16 v[60:63], v[40:43], v[224:227], v[60:63]
    ds_read_b64_tr_b16 v[36:37], v230 offset:4096
    s_add_u32 m0, s23, 65536
    s_add_u32 s25, s20, 0
    buffer_load_dwordx4 v2, s[4:7], s25 offen lds
    v_mfma_f32_32x32x16_bf16 v[160:175], v[40:43], v[196:199], v[160:175]
    ds_read_b64_tr_b16 v[38:39], v230 offset:4608
    v_mfma_f32_32x32x16_bf16 v[176:191], v[44:47], v[196:199], v[176:191]
    s_add_u32 m0, s23, 69632
    s_add_u32 s25, s20, 40960
    buffer_load_dwordx4 v2, s[4:7], s25 offen lds
    s_waitcnt lgkmcnt(4)
    v_mfma_f32_32x32x16_bf16 v[128:143], v[48:51], v[200:203], v[128:143]
    ds_read_b64_tr_b16 v[40:41], v228 offset:6144
    v_mfma_f32_32x32x16_bf16 v[144:159], v[52:55], v[200:203], v[144:159]
    ds_read_b64_tr_b16 v[42:43], v228 offset:6656
    v_mfma_f32_16x16x32_bf16 v[60:63], v[48:51], v[224:227], v[60:63]
    ds_read_b64_tr_b16 v[44:45], v230 offset:6144
    s_add_u32 m0, s23, 73728
    s_add_u32 s25, s20, 81920
    buffer_load_dwordx4 v2, s[4:7], s25 offen lds
    v_mfma_f32_32x32x16_bf16 v[160:175], v[48:51], v[204:207], v[160:175]
    ds_read_b64_tr_b16 v[46:47], v230 offset:6656
    v_mfma_f32_32x32x16_bf16 v[176:191], v[52:55], v[204:207], v[176:191]
    s_add_u32 m0, s23, 77824
    s_add_u32 s25, s20, 122880
    buffer_load_dwordx4 v2, s[4:7], s25 offen lds
    s_add_u32 s20, s20, 128
    s_cmp_eq_u32 s20, s37
    s_cselect_b32 s20, s36, s20
    s_waitcnt lgkmcnt(4)
    v_mfma_f32_32x32x16_bf16 v[128:143], v[32:35], v[208:211], v[128:143]
    v_mfma_f32_32x32x16_bf16 v[144:159], v[36:39], v[208:211], v[144:159]
    s_waitcnt vmcnt(8) lgkmcnt(0)
    s_barrier
    ds_read_b128 v[192:195], v4 offset:16384
    ds_read_b128 v[196:199], v4 offset:20480
    v_mfma_f32_16x16x32_bf16 v[60:63], v[32:35], v[224:227], v[60:63]
    ds_read_b64_tr_b16 v[48:49], v228 offset:32768
    v_mfma_f32_32x32x16_bf16 v[160:175], v[32:35], v[212:215], v[160:175]
    ds_read_b64_tr_b16 v[50:51], v228 offset:33280
    ds_read_b64_tr_b16 v[52:53], v230 offset:32768
    v_mfma_f32_32x32x16_bf16 v[176:191], v[36:39], v[212:215], v[176:191]
    ds_read_b64_tr_b16 v[54:55], v230 offset:33280
    s_add_u32 m0, s23, 0
    s_add_u32 s25, s21, 0
    buffer_load_dwordx4 v3, s[8:11], s25 offen lds
    s_waitcnt lgkmcnt(6)
    v_mfma_f32_32x32x16_bf16 v[128:143], v[40:43], v[216:219], v[128:143]
    ds_read_b128 v[200:203], v5 offset:16384
    ds_read_b128 v[204:207], v5 offset:20480
    v_mfma_f32_32x32x16_bf16 v[144:159], v[44:47], v[216:219], v[144:159]
    ds_read_b64_tr_b16 v[32:33], v228 offset:34816
    v_mfma_f32_16x16x32_bf16 v[60:63], v[40:43], v[224:227], v[60:63]
    ds_read_b64_tr_b16 v[34:35], v228 offset:35328
    v_mfma_f32_32x32x16_bf16 v[160:175], v[40:43], v[220:223], v[160:175]
    ds_read_b64_tr_b16 v[36:37], v230 offset:34816
    v_mfma_f32_32x32x16_bf16 v[176:191], v[44:47], v[220:223], v[176:191]
    ds_read_b64_tr_b16 v[38:39], v230 offset:35328
    s_add_u32 m0, s23, 4096
    s_add_u32 s25, s21, 122880
    buffer_load_dwordx4 v3, s[8:11], s25 offen lds
    s_waitcnt lgkmcnt(6)
    v_mfma_f32_32x32x16_bf16 v[64:79], v[192:195], v[48:51], v[64:79]
    ds_read_b128 v[208:211], v6 offset:16384
    ds_read_b128 v[212:215], v6 offset:20480
    v_mfma_f32_32x32x16_bf16 v[80:95], v[192:195], v[52:55], v[80:95]
    ds_read_b64_tr_b16 v[40:41], v228 offset:36864
    v_mfma_f32_16x16x32_bf16 v[56:59], v[48:51], v[224:227], v[56:59]
    ds_read_b64_tr_b16 v[42:43], v228 offset:37376
    v_mfma_f32_32x32x16_bf16 v[96:111], v[196:199], v[48:51], v[96:111]
    ds_read_b64_tr_b16 v[44:45], v230 offset:36864
    v_mfma_f32_32x32x16_bf16 v[112:127], v[196:199], v[52:55], v[112:127]
    ds_read_b64_tr_b16 v[46:47], v230 offset:37376
    s_add_u32 m0, s23, 8192
    s_add_u32 s25, s21, 128
    buffer_load_dwordx4 v3, s[8:11], s25 offen lds
    s_waitcnt lgkmcnt(6)
    v_mfma_f32_32x32x16_bf16 v[64:79], v[200:203], v[32:35], v[64:79]
    ds_read_b128 v[216:219], v7 offset:16384
    ds_read_b128 v[220:223], v7 offset:20480
    v_mfma_f32_32x32x16_bf16 v[80:95], v[200:203], v[36:39], v[80:95]
    ds_read_b64_tr_b16 v[48:49], v228 offset:38912
    v_mfma_f32_16x16x32_bf16 v[56:59], v[32:35], v[224:227], v[56:59]
    ds_read_b64_tr_b16 v[50:51], v228 offset:39424
    v_mfma_f32_32x32x16_bf16 v[96:111], v[204:207], v[32:35], v[96:111]
    ds_read_b64_tr_b16 v[52:53], v230 offset:38912
    v_mfma_f32_32x32x16_bf16 v[112:127], v[204:207], v[36:39], v[112:127]
    ds_read_b64_tr_b16 v[54:55], v230 offset:39424
    s_add_u32 m0, s23, 12288
    s_add_u32 s25, s21, 123008
    buffer_load_dwordx4 v3, s[8:11], s25 offen lds
    s_add_u32 s21, s21, 245760
    s_cmp_eq_u32 s21, s39
    s_cselect_b32 s21, s38, s21
    s_waitcnt lgkmcnt(6)
    v_mfma_f32_32x32x16_bf16 v[64:79], v[208:211], v[40:43], v[64:79]
    v_mfma_f32_32x32x16_bf16 v[80:95], v[208:211], v[44:47], v[80:95]
    s_waitcnt vmcnt(8) lgkmcnt(0)
    s_barrier
    ds_read_b64_tr_b16 v[32:33], v228 offset:49152
    v_mfma_f32_16x16x32_bf16 v[56:59], v[40:43], v[224:227], v[56:59]
    ds_read_b64_tr_b16 v[34:35], v228 offset:49664
    s_add_u32 m0, s23, 16384
    s_add_u32 s25, s22, 0
    buffer_load_dwordx4 v13, s[12:15], s25 offen lds
    v_mfma_f32_32x32x16_bf16 v[96:111], v[212:215], v[40:43], v[96:111]
    ds_read_b64_tr_b16 v[36:37], v230 offset:49152
    v_mfma_f32_32x32x16_bf16 v[112:127], v[212:215], v[44:47], v[112:127]
    ds_read_b64_tr_b16 v[38:39], v230 offset:49664
    s_add_u32 m0, s23, 20480
    s_add_u32 s25, s22, 110592
    buffer_load_dwordx4 v13, s[12:15], s25 offen lds
    s_waitcnt lgkmcnt(4)
    v_mfma_f32_32x32x16_bf16 v[64:79], v[216:219], v[48:51], v[64:79]
    ds_read_b64_tr_b16 v[40:41], v228 offset:51200
    v_mfma_f32_32x32x16_bf16 v[80:95], v[216:219], v[52:55], v[80:95]
    ds_read_b64_tr_b16 v[42:43], v228 offset:51712
    v_mfma_f32_16x16x32_bf16 v[56:59], v[48:51], v[224:227], v[56:59]
    ds_read_b64_tr_b16 v[44:45], v230 offset:51200
    s_add_u32 m0, s23, 24576
    s_add_u32 s25, s22, 0
    buffer_load_dwordx4 v13, s[16:19], s25 offen lds
    v_mfma_f32_32x32x16_bf16 v[96:111], v[220:223], v[48:51], v[96:111]
    ds_read_b64_tr_b16 v[46:47], v230 offset:51712
    v_mfma_f32_32x32x16_bf16 v[112:127], v[220:223], v[52:55], v[112:127]
    s_add_u32 m0, s23, 28672
    s_add_u32 s25, s22, 110592
    buffer_load_dwordx4 v13, s[16:19], s25 offen lds
    s_add_u32 s22, s22, 221184
    s_cmp_eq_u32 s22, s53
    s_cselect_b32 s22, s52, s22
    s_waitcnt lgkmcnt(4)
    v_mfma_f32_32x32x16_bf16 v[128:143], v[32:35], v[192:195], v[128:143]
    ds_read_b64_tr_b16 v[48:49], v228 offset:53248
    v_mfma_f32_32x32x16_bf16 v[144:159], v[36:39], v[192:195], v[144:159]
    ds_read_b64_tr_b16 v[50:51], v228 offset:53760
    v_mfma_f32_16x16x32_bf16 v[60:63], v[32:35], v[224:227], v[60:63]
    ds_read_b64_tr_b16 v[52:53], v230 offset:53248
    s_add_u32 m0, s23, 32768
    s_add_u32 s25, s20, 0
    buffer_load_dwordx4 v2, s[4:7], s25 offen lds
    v_mfma_f32_32x32x16_bf16 v[160:175], v[32:35], v[196:199], v[160:175]
    ds_read_b64_tr_b16 v[54:55], v230 offset:53760
    v_mfma_f32_32x32x16_bf16 v[176:191], v[36:39], v[196:199], v[176:191]
    s_add_u32 m0, s23, 36864
    s_add_u32 s25, s20, 40960
    buffer_load_dwordx4 v2, s[4:7], s25 offen lds
    s_waitcnt lgkmcnt(4)
    v_mfma_f32_32x32x16_bf16 v[128:143], v[40:43], v[200:203], v[128:143]
    ds_read_b64_tr_b16 v[32:33], v228 offset:55296
    v_mfma_f32_32x32x16_bf16 v[144:159], v[44:47], v[200:203], v[144:159]
    ds_read_b64_tr_b16 v[34:35], v228 offset:55808
    v_mfma_f32_16x16x32_bf16 v[60:63], v[40:43], v[224:227], v[60:63]
    ds_read_b64_tr_b16 v[36:37], v230 offset:55296
    s_add_u32 m0, s23, 40960
    s_add_u32 s25, s20, 81920
    buffer_load_dwordx4 v2, s[4:7], s25 offen lds
    v_mfma_f32_32x32x16_bf16 v[160:175], v[40:43], v[204:207], v[160:175]
    ds_read_b64_tr_b16 v[38:39], v230 offset:55808
    v_mfma_f32_32x32x16_bf16 v[176:191], v[44:47], v[204:207], v[176:191]
    s_add_u32 m0, s23, 45056
    s_add_u32 s25, s20, 122880
    buffer_load_dwordx4 v2, s[4:7], s25 offen lds
    s_add_u32 s20, s20, 128
    s_cmp_eq_u32 s20, s37
    s_cselect_b32 s20, s36, s20
    s_waitcnt lgkmcnt(4)
    v_mfma_f32_32x32x16_bf16 v[128:143], v[48:51], v[208:211], v[128:143]
    v_mfma_f32_32x32x16_bf16 v[144:159], v[52:55], v[208:211], v[144:159]
    s_waitcnt vmcnt(8) lgkmcnt(0)
    s_barrier
    ds_read_b128 v[192:195], v8 offset:0
    ds_read_b128 v[196:199], v8 offset:4096
    v_mfma_f32_16x16x32_bf16 v[60:63], v[48:51], v[224:227], v[60:63]
    ds_read_b64_tr_b16 v[40:41], v228 offset:0
    v_mfma_f32_32x32x16_bf16 v[160:175], v[48:51], v[212:215], v[160:175]
    ds_read_b64_tr_b16 v[42:43], v228 offset:512
    ds_read_b64_tr_b16 v[44:45], v230 offset:0
    v_mfma_f32_32x32x16_bf16 v[176:191], v[52:55], v[212:215], v[176:191]
    ds_read_b64_tr_b16 v[46:47], v230 offset:512
    s_add_u32 m0, s23, 49152
    s_add_u32 s25, s21, 0
    buffer_load_dwordx4 v3, s[8:11], s25 offen lds
    s_waitcnt lgkmcnt(6)
    v_mfma_f32_32x32x16_bf16 v[128:143], v[32:35], v[216:219], v[128:143]
    ds_read_b128 v[200:203], v9 offset:0
    ds_read_b128 v[204:207], v9 offset:4096
    v_mfma_f32_32x32x16_bf16 v[144:159], v[36:39], v[216:219], v[144:159]
    ds_read_b64_tr_b16 v[48:49], v228 offset:2048
    v_mfma_f32_16x16x32_bf16 v[60:63], v[32:35], v[224:227], v[60:63]
    ds_read_b64_tr_b16 v[50:51], v228 offset:2560
    v_mfma_f32_32x32x16_bf16 v[160:175], v[32:35], v[220:223], v[160:175]
    ds_read_b64_tr_b16 v[52:53], v230 offset:2048
    v_mfma_f32_32x32x16_bf16 v[176:191], v[36:39], v[220:223], v[176:191]
    ds_read_b64_tr_b16 v[54:55], v230 offset:2560
    s_add_u32 m0, s23, 53248
    s_add_u32 s25, s21, 122880
    buffer_load_dwordx4 v3, s[8:11], s25 offen lds
    v_and_b32 v14, 31, v1
    s_lshl_b32 s30, s27, 6
    s_add_u32 s30, s30, s46
    v_add_u32 v14, s30, v14
    v_lshlrev_b32 v14, 3, v14
    buffer_load_dwordx2 v[240:241], v14, s[48:51], 0 offen sc1
    buffer_load_dwordx2 v[242:243], v14, s[48:51], 0 offen offset:256 sc1
    s_waitcnt lgkmcnt(6)
    v_mfma_f32_32x32x16_bf16 v[64:79], v[192:195], v[40:43], v[64:79]
    ds_read_b128 v[208:211], v10 offset:0
    ds_read_b128 v[212:215], v10 offset:4096
    v_mfma_f32_32x32x16_bf16 v[80:95], v[192:195], v[44:47], v[80:95]
    ds_read_b64_tr_b16 v[32:33], v228 offset:4096
    v_mfma_f32_16x16x32_bf16 v[56:59], v[40:43], v[224:227], v[56:59]
    ds_read_b64_tr_b16 v[34:35], v228 offset:4608
    v_mfma_f32_32x32x16_bf16 v[96:111], v[196:199], v[40:43], v[96:111]
    ds_read_b64_tr_b16 v[36:37], v230 offset:4096
    v_mfma_f32_32x32x16_bf16 v[112:127], v[196:199], v[44:47], v[112:127]
    ds_read_b64_tr_b16 v[38:39], v230 offset:4608
    s_add_u32 m0, s23, 57344
    s_add_u32 s25, s21, 128
    buffer_load_dwordx4 v3, s[8:11], s25 offen lds
    s_waitcnt lgkmcnt(6)
    v_mfma_f32_32x32x16_bf16 v[64:79], v[200:203], v[48:51], v[64:79]
    ds_read_b128 v[216:219], v11 offset:0
    ds_read_b128 v[220:223], v11 offset:4096
    v_mfma_f32_32x32x16_bf16 v[80:95], v[200:203], v[52:55], v[80:95]
    ds_read_b64_tr_b16 v[40:41], v228 offset:6144
    v_mfma_f32_16x16x32_bf16 v[56:59], v[48:51], v[224:227], v[56:59]
    ds_read_b64_tr_b16 v[42:43], v228 offset:6656
    v_mfma_f32_32x32x16_bf16 v[96:111], v[204:207], v[48:51], v[96:111]
    ds_read_b64_tr_b16 v[44:45], v230 offset:6144
    v_mfma_f32_32x32x16_bf16 v[112:127], v[204:207], v[52:55], v[112:127]
    ds_read_b64_tr_b16 v[46:47], v230 offset:6656
    s_add_u32 m0, s23, 61440
    s_add_u32 s25, s21, 123008
    buffer_load_dwordx4 v3, s[8:11], s25 offen lds
    s_add_u32 s21, s21, 245760
    s_cmp_eq_u32 s21, s39
    s_cselect_b32 s21, s38, s21
    s_waitcnt lgkmcnt(6)
    v_mfma_f32_32x32x16_bf16 v[64:79], v[208:211], v[32:35], v[64:79]
    v_mfma_f32_32x32x16_bf16 v[80:95], v[208:211], v[36:39], v[80:95]
    s_waitcnt vmcnt(10) lgkmcnt(0)
    s_barrier
    ds_read_b64_tr_b16 v[48:49], v228 offset:16384
    v_mfma_f32_16x16x32_bf16 v[56:59], v[32:35], v[224:227], v[56:59]
    ds_read_b64_tr_b16 v[50:51], v228 offset:16896
    v_mfma_f32_32x32x16_bf16 v[96:111], v[212:215], v[32:35], v[96:111]
    ds_read_b64_tr_b16 v[52:53], v230 offset:16384
    v_mfma_f32_32x32x16_bf16 v[112:127], v[212:215], v[36:39], v[112:127]
    ds_read_b64_tr_b16 v[54:55], v230 offset:16896
    s_add_u32 m0, s23, 65536
    s_add_u32 s25, s22, 0
    buffer_load_dwordx4 v13, s[12:15], s25 offen lds
    s_waitcnt lgkmcnt(4)
    v_mfma_f32_32x32x16_bf16 v[64:79], v[216:219], v[40:43], v[64:79]
    ds_read_b64_tr_b16 v[32:33], v228 offset:18432
    v_mfma_f32_32x32x16_bf16 v[80:95], v[216:219], v[44:47], v[80:95]
    ds_read_b64_tr_b16 v[34:35], v228 offset:18944
    v_mfma_f32_16x16x32_bf16 v[56:59], v[40:43], v[224:227], v[56:59]
    ds_read_b64_tr_b16 v[36:37], v230 offset:18432
    v_mfma_f32_32x32x16_bf16 v[96:111], v[220:223], v[40:43], v[96:111]
    ds_read_b64_tr_b16 v[38:39], v230 offset:18944
    v_mfma_f32_32x32x16_bf16 v[112:127], v[220:223], v[44:47], v[112:127]
    s_add_u32 m0, s23, 69632
    s_add_u32 s25, s22, 110592
    buffer_load_dwordx4 v13, s[12:15], s25 offen lds
    s_waitcnt lgkmcnt(4)
    v_mfma_f32_32x32x16_bf16 v[128:143], v[48:51], v[192:195], v[128:143]
    ds_read_b64_tr_b16 v[40:41], v228 offset:20480
    v_mfma_f32_32x32x16_bf16 v[144:159], v[52:55], v[192:195], v[144:159]
    ds_read_b64_tr_b16 v[42:43], v228 offset:20992
    v_mfma_f32_16x16x32_bf16 v[60:63], v[48:51], v[224:227], v[60:63]
    ds_read_b64_tr_b16 v[44:45], v230 offset:20480
    v_mfma_f32_32x32x16_bf16 v[160:175], v[48:51], v[196:199], v[160:175]
    ds_read_b64_tr_b16 v[46:47], v230 offset:20992
    v_mfma_f32_32x32x16_bf16 v[176:191], v[52:55], v[196:199], v[176:191]
    s_add_u32 m0, s23, 73728
    s_add_u32 s25, s22, 0
    buffer_load_dwordx4 v13, s[16:19], s25 offen lds
    s_waitcnt lgkmcnt(4)
    v_mfma_f32_32x32x16_bf16 v[128:143], v[32:35], v[200:203], v[128:143]
    ds_read_b64_tr_b16 v[48:49], v228 offset:22528
    v_mfma_f32_32x32x16_bf16 v[144:159], v[36:39], v[200:203], v[144:159]
    ds_read_b64_tr_b16 v[50:51], v228 offset:23040
    v_mfma_f32_16x16x32_bf16 v[60:63], v[32:35], v[224:227], v[60:63]
    ds_read_b64_tr_b16 v[52:53], v230 offset:22528
    v_mfma_f32_32x32x16_bf16 v[160:175], v[32:35], v[204:207], v[160:175]
    ds_read_b64_tr_b16 v[54:55], v230 offset:23040
    v_mfma_f32_32x32x16_bf16 v[176:191], v[36:39], v[204:207], v[176:191]
    s_add_u32 m0, s23, 77824
    s_add_u32 s25, s22, 110592
    buffer_load_dwordx4 v13, s[16:19], s25 offen lds
    s_add_u32 s22, s22, 221184
    s_cmp_eq_u32 s22, s53
    s_cselect_b32 s22, s52, s22
    s_waitcnt lgkmcnt(4)
    v_mfma_f32_32x32x16_bf16 v[128:143], v[40:43], v[208:211], v[128:143]
    v_mfma_f32_32x32x16_bf16 v[144:159], v[44:47], v[208:211], v[144:159]
    s_waitcnt vmcnt(4) lgkmcnt(0)
    s_barrier
    ds_read_b128 v[192:195], v4 offset:32768
    ds_read_b128 v[196:199], v4 offset:36864
    v_mfma_f32_16x16x32_bf16 v[60:63], v[40:43], v[224:227], v[60:63]
    ds_read_b64_tr_b16 v[32:33], v228 offset:49152
    v_mfma_f32_32x32x16_bf16 v[160:175], v[40:43], v[212:215], v[160:175]
    ds_read_b64_tr_b16 v[34:35], v228 offset:49664
    ds_read_b64_tr_b16 v[36:37], v230 offset:49152
    v_mfma_f32_32x32x16_bf16 v[176:191], v[44:47], v[212:215], v[176:191]
    ds_read_b64_tr_b16 v[38:39], v230 offset:49664
    s_waitcnt lgkmcnt(6)
    v_mfma_f32_32x32x16_bf16 v[128:143], v[48:51], v[216:219], v[128:143]
    ds_read_b128 v[200:203], v5 offset:32768
    ds_read_b128 v[204:207], v5 offset:36864
    v_mfma_f32_32x32x16_bf16 v[144:159], v[52:55], v[216:219], v[144:159]
    ds_read_b64_tr_b16 v[40:41], v228 offset:51200
    v_mfma_f32_16x16x32_bf16 v[60:63], v[48:51], v[224:227], v[60:63]
    ds_read_b64_tr_b16 v[42:43], v228 offset:51712
    v_mfma_f32_32x32x16_bf16 v[160:175], v[48:51], v[220:223], v[160:175]
    ds_read_b64_tr_b16 v[44:45], v230 offset:51200
    v_mfma_f32_32x32x16_bf16 v[176:191], v[52:55], v[220:223], v[176:191]
    ds_read_b64_tr_b16 v[46:47], v230 offset:51712
    s_waitcnt lgkmcnt(6)
    v_mfma_f32_32x32x16_bf16 v[64:79], v[192:195], v[32:35], v[64:79]
    ds_read_b128 v[208:211], v6 offset:32768
    ds_read_b128 v[212:215], v6 offset:36864
    v_mfma_f32_32x32x16_bf16 v[80:95], v[192:195], v[36:39], v[80:95]
    ds_read_b64_tr_b16 v[48:49], v228 offset:53248
    v_mfma_f32_16x16x32_bf16 v[56:59], v[32:35], v[224:227], v[56:59]
    ds_read_b64_tr_b16 v[50:51], v228 offset:53760
    v_mfma_f32_32x32x16_bf16 v[96:111], v[196:199], v[32:35], v[96:111]
    ds_read_b64_tr_b16 v[52:53], v230 offset:53248
    v_mfma_f32_32x32x16_bf16 v[112:127], v[196:199], v[36:39], v[112:127]
    ds_read_b64_tr_b16 v[54:55], v230 offset:53760
    s_waitcnt lgkmcnt(6)
    v_mfma_f32_32x32x16_bf16 v[64:79], v[200:203], v[40:43], v[64:79]
    ds_read_b128 v[216:219], v7 offset:32768
    ds_read_b128 v[220:223], v7 offset:36864
    v_mfma_f32_32x32x16_bf16 v[80:95], v[200:203], v[44:47], v[80:95]
    ds_read_b64_tr_b16 v[32:33], v228 offset:55296
    v_mfma_f32_16x16x32_bf16 v[56:59], v[40:43], v[224:227], v[56:59]
    ds_read_b64_tr_b16 v[34:35], v228 offset:55808
    v_mfma_f32_32x32x16_bf16 v[96:111], v[204:207], v[40:43], v[96:111]
    ds_read_b64_tr_b16 v[36:37], v230 offset:55296
    v_mfma_f32_32x32x16_bf16 v[112:127], v[204:207], v[44:47], v[112:127]
    ds_read_b64_tr_b16 v[38:39], v230 offset:55808
    s_waitcnt lgkmcnt(6)
    v_mfma_f32_32x32x16_bf16 v[64:79], v[208:211], v[48:51], v[64:79]
    v_mfma_f32_32x32x16_bf16 v[80:95], v[208:211], v[52:55], v[80:95]
    s_waitcnt vmcnt(0) lgkmcnt(0)
    s_barrier
    ds_read_b64_tr_b16 v[40:41], v229 offset:0
    v_mfma_f32_16x16x32_bf16 v[56:59], v[48:51], v[224:227], v[56:59]
    ds_read_b64_tr_b16 v[42:43], v229 offset:512
    v_mfma_f32_32x32x16_bf16 v[96:111], v[212:215], v[48:51], v[96:111]
    ds_read_b64_tr_b16 v[44:45], v231 offset:0
    v_mfma_f32_32x32x16_bf16 v[112:127], v[212:215], v[52:55], v[112:127]
    ds_read_b64_tr_b16 v[46:47], v231 offset:512
    s_waitcnt lgkmcnt(4)
    v_mfma_f32_32x32x16_bf16 v[64:79], v[216:219], v[32:35], v[64:79]
    ds_read_b64_tr_b16 v[48:49], v229 offset:2048
    v_mfma_f32_32x32x16_bf16 v[80:95], v[216:219], v[36:39], v[80:95]
    ds_read_b64_tr_b16 v[50:51], v229 offset:2560
    v_mfma_f32_16x16x32_bf16 v[56:59], v[32:35], v[224:227], v[56:59]
    ds_read_b64_tr_b16 v[52:53], v231 offset:2048
    v_mfma_f32_32x32x16_bf16 v[96:111], v[220:223], v[32:35], v[96:111]
    ds_read_b64_tr_b16 v[54:55], v231 offset:2560
    v_mfma_f32_32x32x16_bf16 v[112:127], v[220:223], v[36:39], v[112:127]
    s_waitcnt lgkmcnt(4)
    v_mfma_f32_32x32x16_bf16 v[128:143], v[40:43], v[192:195], v[128:143]
    ds_read_b64_tr_b16 v[32:33], v229 offset:4096
    v_mfma_f32_32x32x16_bf16 v[144:159], v[44:47], v[192:195], v[144:159]
    ds_read_b64_tr_b16 v[34:35], v229 offset:4608
    v_mfma_f32_16x16x32_bf16 v[60:63], v[40:43], v[224:227], v[60:63]
    ds_read_b64_tr_b16 v[36:37], v231 offset:4096
    v_mfma_f32_32x32x16_bf16 v[160:175], v[40:43], v[196:199], v[160:175]
    ds_read_b64_tr_b16 v[38:39], v231 offset:4608
    v_mfma_f32_32x32x16_bf16 v[176:191], v[44:47], v[196:199], v[176:191]
    s_waitcnt lgkmcnt(4)
    v_mfma_f32_32x32x16_bf16 v[128:143], v[48:51], v[200:203], v[128:143]
    ds_read_b64_tr_b16 v[40:41], v229 offset:6144
    v_mfma_f32_32x32x16_bf16 v[144:159], v[52:55], v[200:203], v[144:159]
    ds_read_b64_tr_b16 v[42:43], v229 offset:6656
    v_mfma_f32_16x16x32_bf16 v[60:63], v[48:51], v[224:227], v[60:63]
    ds_read_b64_tr_b16 v[44:45], v231 offset:6144
    v_mfma_f32_32x32x16_bf16 v[160:175], v[48:51], v[204:207], v[160:175]
    ds_read_b64_tr_b16 v[46:47], v231 offset:6656
    v_mfma_f32_32x32x16_bf16 v[176:191], v[52:55], v[204:207], v[176:191]
    s_waitcnt lgkmcnt(4)
    v_mfma_f32_32x32x16_bf16 v[128:143], v[32:35], v[208:211], v[128:143]
    v_mfma_f32_32x32x16_bf16 v[144:159], v[36:39], v[208:211], v[144:159]
    v_mfma_f32_16x16x32_bf16 v[60:63], v[32:35], v[224:227], v[60:63]
    v_mfma_f32_32x32x16_bf16 v[160:175], v[32:35], v[212:215], v[160:175]
    v_mfma_f32_32x32x16_bf16 v[176:191], v[36:39], v[212:215], v[176:191]
    s_waitcnt lgkmcnt(0)
    v_mfma_f32_32x32x16_bf16 v[128:143], v[40:43], v[216:219], v[128:143]
    v_mfma_f32_32x32x16_bf16 v[144:159], v[44:47], v[216:219], v[144:159]
    v_mfma_f32_16x16x32_bf16 v[60:63], v[40:43], v[224:227], v[60:63]
    v_mfma_f32_32x32x16_bf16 v[160:175], v[40:43], v[220:223], v[160:175]
    v_mfma_f32_32x32x16_bf16 v[176:191], v[44:47], v[220:223], v[176:191]
    s_nop 15
    v_and_b32 v14, 15, v1
    v_lshrrev_b32 v15, 4, v1
    v_lshlrev_b32 v15, 4, v15
    v_lshl_add_u32 v15, v14, 6, v15
    s_lshl_b32 s30, s28, 8
    s_lshl_b32 s31, s27, 7
    s_add_u32 s31, s31, s30
    v_add_u32 v15, s31, v15
    v_cmp_gt_u32 vcc, 2, v14
    s_and_saveexec_b64 s[32:33], vcc
    ds_write_b128 v15, v[56:59] offset:0
    ds_write_b128 v15, v[60:63] offset:512
    s_mov_b64 exec, s[32:33]
    s_waitcnt vmcnt(0) lgkmcnt(0)
    s_barrier
    v_readfirstlane_b32 s34, v233
    s_cmp_eq_u32 s78, 0
    s_cbranch_scc1 L_fst_9_slow
    s_cmp_ge_u32 s34, 32
    s_cbranch_scc1 L_fst_9
L_fst_9_slow:
    s_cmp_lg_u32 s78, 0
    s_cbranch_scc1 L_rdyd_11
    v_mov_b32 v238, 0
    s_mov_b32 s30, 0x40000
L_rdy_10:
    global_load_dword v239, v238, s[74:75] sc1
    s_waitcnt vmcnt(0)
    v_readfirstlane_b32 s78, v239
    s_cmp_lg_u32 s78, 0
    s_cbranch_scc1 L_rdyd_11
    s_sleep 4
    s_sub_u32 s30, s30, 1
    s_cmp_lg_u32 s30, 0
    s_cbranch_scc1 L_rdy_10
L_rdyd_11:
    s_lshl_b32 s31, s54, 7
    v_mov_b32 v238, s31
    s_mov_b32 exec_lo, 1
    s_mov_b32 exec_hi, 0
    s_mov_b32 s30, 0x40000
L_wc_12:
    buffer_load_dword v239, v238, s[56:59], 0 offen sc1
    s_waitcnt vmcnt(0)
    v_cmp_gt_u32 vcc, 32, v239
    s_nop 4
    s_cbranch_vccz L_wcd_13_x
    s_sleep 1
    s_sub_u32 s30, s30, 1
    s_cmp_lg_u32 s30, 0
    s_cbranch_scc1 L_wc_12
L_wcd_13_x:
    s_mov_b64 exec, -1
L_wcd_13:
    v_and_b32 v14, 31, v1
    s_lshl_b32 s30, s27, 6
    s_add_u32 s30, s30, s46
    v_add_u32 v14, s30, v14
    v_lshlrev_b32 v14, 3, v14
    buffer_load_dwordx2 v[240:241], v14, s[48:51], 0 offen sc1
    buffer_load_dwordx2 v[242:243], v14, s[48:51], 0 offen offset:256 sc1
    s_waitcnt vmcnt(0)
L_fst_9:
    v_and_b32 v15, 31, v1
    v_lshlrev_b32 v15, 3, v15
    s_lshl_b32 s30, s26, 9
    s_add_u32 s30, s30, 2048
    v_add_u32 v15, s30, v15
    ds_write_b64 v15, v[240:241]
    ds_write_b64 v15, v[242:243] offset:256
    v_lshrrev_b32 v15, 5, v1
    v_lshlrev_b32 v15, 5, v15
    v_add_u32 v15, s30, v15
    s_waitcnt lgkmcnt(0)
    ds_read_b128 v[196:199], v15 offset:0
    ds_read_b128 v[200:203], v15 offset:16
    ds_read_b128 v[204:207], v15 offset:64
    ds_read_b128 v[208:211], v15 offset:80
    ds_read_b128 v[212:215], v15 offset:128
    ds_read_b128 v[216:219], v15 offset:144
    ds_read_b128 v[220:223], v15 offset:192
    ds_read_b128 v[224:227], v15 offset:208
    s_waitcnt lgkmcnt(4)
    ds_read_b128 v[32:35], v15 offset:256
    ds_read_b128 v[36:39], v15 offset:272
    ds_read_b128 v[40:43], v15 offset:320
    ds_read_b128 v[44:47], v15 offset:336
    ds_read_b128 v[48:51], v15 offset:384
    ds_read_b128 v[52:55], v15 offset:400
    ds_read_b128 v[56:59], v15 offset:448
    ds_read_b128 v[60:63], v15 offset:464
    s_waitcnt lgkmcnt(4)
    v_and_b32 v14, 31, v1
    v_lshlrev_b32 v14, 2, v14
    s_lshl_b32 s30, s28, 8
    v_add_u32 v14, s30, v14
    ds_read_b32 v192, v14 offset:0
    ds_read_b32 v193, v14 offset:128
    s_sub_u32 s43, s45, 10
    s_add_u32 s8, s76, 6291456
    s_addc_u32 s9, s77, 0
    s_and_b32 s9, s9, 0xffff
    s_mov_b32 s10, 2621440
    s_mov_b32 s11, 0x00020000
    s_lshl_b32 s30, s44, 2
    s_lshl_b32 s31, s27, 1
    s_add_u32 s30, s30, s31
    s_mul_i32 s52, s30, 1280
    s_lshl_b32 s31, s43, 7
    s_lshl_b32 s32, s28, 5
    s_add_u32 s31, s31, s32
    v_and_b32 v20, 31, v1
    v_add_u32 v20, s31, v20
    v_lshrrev_b32 v21, 5, v1
    v_mul_u32_u24 v21, 320, v21
    s_mov_b32 s51, 81920
    s_lshl_b32 s54, s27, 6
    s_xor_b32 s55, s54, 64
    s_waitcnt vmcnt(0) lgkmcnt(0)
    s_cmp_eq_u32 s27, 0
    s_cbranch_scc1 L_af_end_1_nv
    v_swap_b32 v192, v193
L_af_end_1_nv:
    v_add_u32 v22, s54, v20
    v_mul_u32_u24 v23, 3277, v22
    v_lshrrev_b32 v23, 16, v23
    v_mul_u32_u24 v24, 20, v23
    v_sub_u32 v24, v22, v24
    v_mul_lo_u32 v25, v23, s51
    v_add_u32 v25, v25, v21
    v_lshl_add_u32 v25, v24, 4, v25
    v_mul_f32 v228, v196, v192
    v_fma_f32 v228, v64, v197, -v228
    v_mul_f32 v229, v198, v192
    v_fma_f32 v229, v65, v199, -v229
    v_mul_f32 v230, v200, v192
    v_fma_f32 v230, v66, v201, -v230
    v_mul_f32 v231, v202, v192
    v_fma_f32 v231, v67, v203, -v231
    v_mul_f32 v232, v204, v192
    v_fma_f32 v232, v68, v205, -v232
    v_mul_f32 v233, v206, v192
    v_fma_f32 v233, v69, v207, -v233
    v_mul_f32 v234, v208, v192
    v_fma_f32 v234, v70, v209, -v234
    v_mul_f32 v235, v210, v192
    v_fma_f32 v235, v71, v211, -v235
    v_cvt_pk_bf16_f32 v236, v228, v229
    v_cvt_pk_bf16_f32 v237, v230, v231
    v_cvt_pk_bf16_f32 v238, v232, v233
    v_cvt_pk_bf16_f32 v239, v234, v235
    s_add_u32 s30, s52, 0
    buffer_store_dwordx4 v[236:239], v25, s[8:11], s30 offen sc1
    v_mul_f32 v244, v212, v192
    v_fma_f32 v244, v72, v213, -v244
    v_mul_f32 v245, v214, v192
    v_fma_f32 v245, v73, v215, -v245
    v_mul_f32 v246, v216, v192
    v_fma_f32 v246, v74, v217, -v246
    v_mul_f32 v247, v218, v192
    v_fma_f32 v247, v75, v219, -v247
    v_mul_f32 v248, v220, v192
    v_fma_f32 v248, v76, v221, -v248
    v_mul_f32 v249, v222, v192
    v_fma_f32 v249, v77, v223, -v249
    v_mul_f32 v250, v224, v192
    v_fma_f32 v250, v78, v225, -v250
    v_mul_f32 v251, v226, v192
    v_fma_f32 v251, v79, v227, -v251
    v_cvt_pk_bf16_f32 v252, v244, v245
    v_cvt_pk_bf16_f32 v253, v246, v247
    v_cvt_pk_bf16_f32 v254, v248, v249
    v_cvt_pk_bf16_f32 v255, v250, v251
    s_add_u32 s30, s52, 640
    buffer_store_dwordx4 v[252:255], v25, s[8:11], s30 offen sc1
    v_mul_f32 v228, v32, v192
    v_fma_f32 v228, v96, v33, -v228
    v_mul_f32 v229, v34, v192
    v_fma_f32 v229, v97, v35, -v229
    v_mul_f32 v230, v36, v192
    v_fma_f32 v230, v98, v37, -v230
    v_mul_f32 v231, v38, v192
    v_fma_f32 v231, v99, v39, -v231
    v_mul_f32 v232, v40, v192
    v_fma_f32 v232, v100, v41, -v232
    v_mul_f32 v233, v42, v192
    v_fma_f32 v233, v101, v43, -v233
    v_mul_f32 v234, v44, v192
    v_fma_f32 v234, v102, v45, -v234
    v_mul_f32 v235, v46, v192
    v_fma_f32 v235, v103, v47, -v235
    v_cvt_pk_bf16_f32 v236, v228, v229
    v_cvt_pk_bf16_f32 v237, v230, v231
    v_cvt_pk_bf16_f32 v238, v232, v233
    v_cvt_pk_bf16_f32 v239, v234, v235
    s_add_u32 s30, s52, 1280
    buffer_store_dwordx4 v[236:239], v25, s[8:11], s30 offen sc1
    v_mul_f32 v244, v48, v192
    v_fma_f32 v244, v104, v49, -v244
    v_mul_f32 v245, v50, v192
    v_fma_f32 v245, v105, v51, -v245
    v_mul_f32 v246, v52, v192
    v_fma_f32 v246, v106, v53, -v246
    v_mul_f32 v247, v54, v192
    v_fma_f32 v247, v107, v55, -v247
    v_mul_f32 v248, v56, v192
    v_fma_f32 v248, v108, v57, -v248
    v_mul_f32 v249, v58, v192
    v_fma_f32 v249, v109, v59, -v249
    v_mul_f32 v250, v60, v192
    v_fma_f32 v250, v110, v61, -v250
    v_mul_f32 v251, v62, v192
    v_fma_f32 v251, v111, v63, -v251
    v_cvt_pk_bf16_f32 v252, v244, v245
    v_cvt_pk_bf16_f32 v253, v246, v247
    v_cvt_pk_bf16_f32 v254, v248, v249
    v_cvt_pk_bf16_f32 v255, v250, v251
    s_add_u32 s30, s52, 1920
    buffer_store_dwordx4 v[252:255], v25, s[8:11], s30 offen sc1
    v_add_u32 v22, s55, v20
    v_mul_u32_u24 v23, 3277, v22
    v_lshrrev_b32 v23, 16, v23
    v_mul_u32_u24 v24, 20, v23
    v_sub_u32 v24, v22, v24
    v_mul_lo_u32 v25, v23, s51
    v_add_u32 v25, v25, v21
    v_lshl_add_u32 v25, v24, 4, v25
    v_mul_f32 v228, v196, v193
    v_fma_f32 v228, v80, v197, -v228
    v_mul_f32 v229, v198, v193
    v_fma_f32 v229, v81, v199, -v229
    v_mul_f32 v230, v200, v193
    v_fma_f32 v230, v82, v201, -v230
    v_mul_f32 v231, v202, v193
    v_fma_f32 v231, v83, v203, -v231
    v_mul_f32 v232, v204, v193
    v_fma_f32 v232, v84, v205, -v232
    v_mul_f32 v233, v206, v193
    v_fma_f32 v233, v85, v207, -v233
    v_mul_f32 v234, v208, v193
    v_fma_f32 v234, v86, v209, -v234
    v_mul_f32 v235, v210, v193
    v_fma_f32 v235, v87, v211, -v235
    v_cvt_pk_bf16_f32 v236, v228, v229
    v_cvt_pk_bf16_f32 v237, v230, v231
    v_cvt_pk_bf16_f32 v238, v232, v233
    v_cvt_pk_bf16_f32 v239, v234, v235
    s_add_u32 s30, s52, 0
    buffer_store_dwordx4 v[236:239], v25, s[8:11], s30 offen sc1
    v_mul_f32 v244, v212, v193
    v_fma_f32 v244, v88, v213, -v244
    v_mul_f32 v245, v214, v193
    v_fma_f32 v245, v89, v215, -v245
    v_mul_f32 v246, v216, v193
    v_fma_f32 v246, v90, v217, -v246
    v_mul_f32 v247, v218, v193
    v_fma_f32 v247, v91, v219, -v247
    v_mul_f32 v248, v220, v193
    v_fma_f32 v248, v92, v221, -v248
    v_mul_f32 v249, v222, v193
    v_fma_f32 v249, v93, v223, -v249
    v_mul_f32 v250, v224, v193
    v_fma_f32 v250, v94, v225, -v250
    v_mul_f32 v251, v226, v193
    v_fma_f32 v251, v95, v227, -v251
    v_cvt_pk_bf16_f32 v252, v244, v245
    v_cvt_pk_bf16_f32 v253, v246, v247
    v_cvt_pk_bf16_f32 v254, v248, v249
    v_cvt_pk_bf16_f32 v255, v250, v251
    s_add_u32 s30, s52, 640
    buffer_store_dwordx4 v[252:255], v25, s[8:11], s30 offen sc1
    v_mul_f32 v228, v32, v193
    v_fma_f32 v228, v112, v33, -v228
    v_mul_f32 v229, v34, v193
    v_fma_f32 v229, v113, v35, -v229
    v_mul_f32 v230, v36, v193
    v_fma_f32 v230, v114, v37, -v230
    v_mul_f32 v231, v38, v193
    v_fma_f32 v231, v115, v39, -v231
    v_mul_f32 v232, v40, v193
    v_fma_f32 v232, v116, v41, -v232
    v_mul_f32 v233, v42, v193
    v_fma_f32 v233, v117, v43, -v233
    v_mul_f32 v234, v44, v193
    v_fma_f32 v234, v118, v45, -v234
    v_mul_f32 v235, v46, v193
    v_fma_f32 v235, v119, v47, -v235
    v_cvt_pk_bf16_f32 v236, v228, v229
    v_cvt_pk_bf16_f32 v237, v230, v231
    v_cvt_pk_bf16_f32 v238, v232, v233
    v_cvt_pk_bf16_f32 v239, v234, v235
    s_add_u32 s30, s52, 1280
    buffer_store_dwordx4 v[236:239], v25, s[8:11], s30 offen sc1
    v_mul_f32 v244, v48, v193
    v_fma_f32 v244, v120, v49, -v244
    v_mul_f32 v245, v50, v193
    v_fma_f32 v245, v121, v51, -v245
    v_mul_f32 v246, v52, v193
    v_fma_f32 v246, v122, v53, -v246
    v_mul_f32 v247, v54, v193
    v_fma_f32 v247, v123, v55, -v247
    v_mul_f32 v248, v56, v193
    v_fma_f32 v248, v124, v57, -v248
    v_mul_f32 v249, v58, v193
    v_fma_f32 v249, v125, v59, -v249
    v_mul_f32 v250, v60, v193
    v_fma_f32 v250, v126, v61, -v250
    v_mul_f32 v251, v62, v193
    v_fma_f32 v251, v127, v63, -v251
    v_cvt_pk_bf16_f32 v252, v244, v245
    v_cvt_pk_bf16_f32 v253, v246, v247
    v_cvt_pk_bf16_f32 v254, v248, v249
    v_cvt_pk_bf16_f32 v255, v250, v251
    s_add_u32 s30, s52, 1920
    buffer_store_dwordx4 v[252:255], v25, s[8:11], s30 offen sc1
L_af_h_3:
    s_lshl_b32 s79, s43, 3
    s_add_u32 s79, s79, 0
    s_cmp_eq_u32 s45, 15
    s_cselect_b32 s79, 0x100000, s79
    s_add_u32 s55, s3, 192
    s_cmp_lg_u32 s26, 0
    s_cbranch_scc1 L_ls_14
    v_add_u32 v234, s55, v1
    v_lshlrev_b32 v234, 7, v234
    s_mov_b32 exec_lo, 1
    s_mov_b32 exec_hi, 0
    v_mov_b32 v235, 1
    buffer_atomic_add v235, v234, s[56:59], 0 offen sc1
    s_mov_b64 exec, -1
    s_branch L_ls_14_e
L_ls_14:
    v_mov_b32 v234, 0x7ffffff0
    buffer_store_dword v234, v234, s[56:59], 0 offen
L_ls_14_e:
    v_lshrrev_b32 v14, 5, v1
    v_lshlrev_b32 v14, 4, v14
    s_lshl_b32 s30, s28, 8
    v_add_u32 v14, s30, v14
    ds_read_b128 v[196:199], v14 offset:512
    ds_read_b128 v[200:203], v14 offset:544
    ds_read_b128 v[204:207], v14 offset:576
    ds_read_b128 v[208:211], v14 offset:608
    ds_read_b128 v[212:215], v14 offset:640
    ds_read_b128 v[216:219], v14 offset:672
    ds_read_b128 v[220:223], v14 offset:704
    ds_read_b128 v[224:227], v14 offset:736
    s_add_u32 s8, s76, 8912896
    s_addc_u32 s9, s77, 0
    s_and_b32 s9, s9, 0xffff
    s_mov_b32 s10, 7077888
    s_mov_b32 s11, 0x00020000
    s_lshl_b32 s30, s47, 3
    s_lshl_b32 s31, s28, 2
    s_add_u32 s30, s30, s31
    s_lshl_b32 s30, s30, 15
    s_lshl_b32 s31, s27, 6
    s_add_u32 s31, s31, s46
    s_lshl_b32 s31, s31, 4
    s_add_u32 s51, s30, s31
    v_lshrrev_b32 v14, 5, v1
    v_lshlrev_b32 v14, 15, v14
    v_and_b32 v15, 31, v1
    v_lshl_add_u32 v14, v15, 4, v14
    s_waitcnt lgkmcnt(0)
    v_mov_b32 v28, v240
    v_mov_b32 v29, v241
    v_mov_b32 v30, v242
    v_mov_b32 v31, v243
    s_cmp_eq_u32 s27, 0
    s_cbranch_scc1 L_af_h_3_w0
    v_swap_b32 v128, v144
    v_swap_b32 v129, v145
    v_swap_b32 v130, v146
    v_swap_b32 v131, v147
    v_swap_b32 v132, v148
    v_swap_b32 v133, v149
    v_swap_b32 v134, v150
    v_swap_b32 v135, v151
    v_swap_b32 v136, v152
    v_swap_b32 v137, v153
    v_swap_b32 v138, v154
    v_swap_b32 v139, v155
    v_swap_b32 v140, v156
    v_swap_b32 v141, v157
    v_swap_b32 v142, v158
    v_swap_b32 v143, v159
    v_swap_b32 v160, v176
    v_swap_b32 v161, v177
    v_swap_b32 v162, v178
    v_swap_b32 v163, v179
    v_swap_b32 v164, v180
    v_swap_b32 v165, v181
    v_swap_b32 v166, v182
    v_swap_b32 v167, v183
    v_swap_b32 v168, v184
    v_swap_b32 v169, v185
    v_swap_b32 v170, v186
    v_swap_b32 v171, v187
    v_swap_b32 v172, v188
    v_swap_b32 v173, v189
    v_swap_b32 v174, v190
    v_swap_b32 v175, v191
L_af_h_3_w0:
    v_mul_f32 v16, 0xbfb8aa3b, v28
    v_mul_f32 v17, 0xbfb8aa3b, v29
    v_mul_f32 v32, v16, v196
    v_mul_f32 v36, v28, v212
    v_mul_f32 v33, v16, v197
    v_mul_f32 v37, v28, v213
    v_mul_f32 v34, v16, v198
    v_mul_f32 v38, v28, v214
    v_mul_f32 v35, v16, v199
    v_mul_f32 v39, v28, v215
    v_fma_f32 v32, v128, v17, -v32
    v_fma_f32 v36, v144, v29, -v36
    v_fma_f32 v33, v129, v17, -v33
    v_fma_f32 v37, v145, v29, -v37
    v_fma_f32 v34, v130, v17, -v34
    v_fma_f32 v38, v146, v29, -v38
    v_fma_f32 v35, v131, v17, -v35
    v_fma_f32 v39, v147, v29, -v39
    v_exp_f32 v32, v32
    v_exp_f32 v33, v33
    v_exp_f32 v34, v34
    v_exp_f32 v35, v35
    v_add_f32 v32, 1.0, v32
    v_add_f32 v33, 1.0, v33
    v_add_f32 v34, 1.0, v34
    v_add_f32 v35, 1.0, v35
    v_rcp_f32 v32, v32
    v_rcp_f32 v33, v33
    v_rcp_f32 v34, v34
    v_rcp_f32 v35, v35
    s_nop 0
    v_mul_f32 v32, v32, v36
    v_mul_f32 v33, v33, v37
    v_mul_f32 v34, v34, v38
    v_mul_f32 v35, v35, v39
    v_cvt_pk_bf16_f32 v240, v32, v33
    v_cvt_pk_bf16_f32 v241, v34, v35
    v_mul_f32 v40, v16, v200
    v_mul_f32 v44, v28, v216
    v_mul_f32 v41, v16, v201
    v_mul_f32 v45, v28, v217
    v_mul_f32 v42, v16, v202
    v_mul_f32 v46, v28, v218
    v_mul_f32 v43, v16, v203
    v_mul_f32 v47, v28, v219
    v_fma_f32 v40, v132, v17, -v40
    v_fma_f32 v44, v148, v29, -v44
    v_fma_f32 v41, v133, v17, -v41
    v_fma_f32 v45, v149, v29, -v45
    v_fma_f32 v42, v134, v17, -v42
    v_fma_f32 v46, v150, v29, -v46
    v_fma_f32 v43, v135, v17, -v43
    v_fma_f32 v47, v151, v29, -v47
    v_exp_f32 v40, v40
    v_exp_f32 v41, v41
    v_exp_f32 v42, v42
    v_exp_f32 v43, v43
    v_add_f32 v40, 1.0, v40
    v_add_f32 v41, 1.0, v41
    v_add_f32 v42, 1.0, v42
    v_add_f32 v43, 1.0, v43
    v_rcp_f32 v40, v40
    v_rcp_f32 v41, v41
    v_rcp_f32 v42, v42
    v_rcp_f32 v43, v43
    s_nop 0
    v_mul_f32 v40, v40, v44
    v_mul_f32 v41, v41, v45
    v_mul_f32 v42, v42, v46
    v_mul_f32 v43, v43, v47
    v_cvt_pk_bf16_f32 v242, v40, v41
    v_cvt_pk_bf16_f32 v243, v42, v43
    s_nop 1
    v_permlane32_swap_b32 v240, v242
    v_permlane32_swap_b32 v241, v243
    v_mul_f32 v32, v16, v204
    v_mul_f32 v36, v28, v220
    v_mul_f32 v33, v16, v205
    v_mul_f32 v37, v28, v221
    v_mul_f32 v34, v16, v206
    v_mul_f32 v38, v28, v222
    v_mul_f32 v35, v16, v207
    v_mul_f32 v39, v28, v223
    v_fma_f32 v32, v136, v17, -v32
    v_fma_f32 v36, v152, v29, -v36
    v_fma_f32 v33, v137, v17, -v33
    v_fma_f32 v37, v153, v29, -v37
    v_fma_f32 v34, v138, v17, -v34
    v_fma_f32 v38, v154, v29, -v38
    v_fma_f32 v35, v139, v17, -v35
    v_fma_f32 v39, v155, v29, -v39
    v_exp_f32 v32, v32
    v_exp_f32 v33, v33
    v_exp_f32 v34, v34
    v_exp_f32 v35, v35
    v_add_f32 v32, 1.0, v32
    v_add_f32 v33, 1.0, v33
    v_add_f32 v34, 1.0, v34
    v_add_f32 v35, 1.0, v35
    v_rcp_f32 v32, v32
    v_rcp_f32 v33, v33
    v_rcp_f32 v34, v34
    v_rcp_f32 v35, v35
    s_nop 0
    v_mul_f32 v32, v32, v36
    v_mul_f32 v33, v33, v37
    v_mul_f32 v34, v34, v38
    v_mul_f32 v35, v35, v39
    v_cvt_pk_bf16_f32 v244, v32, v33
    v_cvt_pk_bf16_f32 v245, v34, v35
    v_mul_f32 v40, v16, v208
    v_mul_f32 v44, v28, v224
    v_mul_f32 v41, v16, v209
    v_mul_f32 v45, v28, v225
    v_mul_f32 v42, v16, v210
    v_mul_f32 v46, v28, v226
    v_mul_f32 v43, v16, v211
    v_mul_f32 v47, v28, v227
    v_fma_f32 v40, v140, v17, -v40
    v_fma_f32 v44, v156, v29, -v44
    v_fma_f32 v41, v141, v17, -v41
    v_fma_f32 v45, v157, v29, -v45
    v_fma_f32 v42, v142, v17, -v42
    v_fma_f32 v46, v158, v29, -v46
    v_fma_f32 v43, v143, v17, -v43
    v_fma_f32 v47, v159, v29, -v47
    v_exp_f32 v40, v40
    v_exp_f32 v41, v41
    v_exp_f32 v42, v42
    v_exp_f32 v43, v43
    v_add_f32 v40, 1.0, v40
    v_add_f32 v41, 1.0, v41
    v_add_f32 v42, 1.0, v42
    v_add_f32 v43, 1.0, v43
    v_rcp_f32 v40, v40
    v_rcp_f32 v41, v41
    v_rcp_f32 v42, v42
    v_rcp_f32 v43, v43
    s_nop 0
    v_mul_f32 v40, v40, v44
    v_mul_f32 v41, v41, v45
    v_mul_f32 v42, v42, v46
    v_mul_f32 v43, v43, v47
    v_cvt_pk_bf16_f32 v246, v40, v41
    v_cvt_pk_bf16_f32 v247, v42, v43
    s_nop 1
    v_permlane32_swap_b32 v244, v246
    v_permlane32_swap_b32 v245, v247
    v_mul_f32 v16, 0xbfb8aa3b, v30
    v_mul_f32 v17, 0xbfb8aa3b, v31
    v_mul_f32 v32, v16, v196
    v_mul_f32 v36, v30, v212
    v_mul_f32 v33, v16, v197
    v_mul_f32 v37, v30, v213
    v_mul_f32 v34, v16, v198
    v_mul_f32 v38, v30, v214
    v_mul_f32 v35, v16, v199
    v_mul_f32 v39, v30, v215
    v_fma_f32 v32, v160, v17, -v32
    v_fma_f32 v36, v176, v31, -v36
    v_fma_f32 v33, v161, v17, -v33
    v_fma_f32 v37, v177, v31, -v37
    v_fma_f32 v34, v162, v17, -v34
    v_fma_f32 v38, v178, v31, -v38
    v_fma_f32 v35, v163, v17, -v35
    v_fma_f32 v39, v179, v31, -v39
    v_exp_f32 v32, v32
    v_exp_f32 v33, v33
    v_exp_f32 v34, v34
    v_exp_f32 v35, v35
    v_add_f32 v32, 1.0, v32
    v_add_f32 v33, 1.0, v33
    v_add_f32 v34, 1.0, v34
    v_add_f32 v35, 1.0, v35
    v_rcp_f32 v32, v32
    v_rcp_f32 v33, v33
    v_rcp_f32 v34, v34
    v_rcp_f32 v35, v35
    s_nop 0
    v_mul_f32 v32, v32, v36
    v_mul_f32 v33, v33, v37
    v_mul_f32 v34, v34, v38
    v_mul_f32 v35, v35, v39
    v_cvt_pk_bf16_f32 v248, v32, v33
    v_cvt_pk_bf16_f32 v249, v34, v35
    v_mul_f32 v40, v16, v200
    v_mul_f32 v44, v30, v216
    v_mul_f32 v41, v16, v201
    v_mul_f32 v45, v30, v217
    v_mul_f32 v42, v16, v202
    v_mul_f32 v46, v30, v218
    v_mul_f32 v43, v16, v203
    v_mul_f32 v47, v30, v219
    v_fma_f32 v40, v164, v17, -v40
    v_fma_f32 v44, v180, v31, -v44
    v_fma_f32 v41, v165, v17, -v41
    v_fma_f32 v45, v181, v31, -v45
    v_fma_f32 v42, v166, v17, -v42
    v_fma_f32 v46, v182, v31, -v46
    v_fma_f32 v43, v167, v17, -v43
    v_fma_f32 v47, v183, v31, -v47
    v_exp_f32 v40, v40
    v_exp_f32 v41, v41
    v_exp_f32 v42, v42
    v_exp_f32 v43, v43
    v_add_f32 v40, 1.0, v40
    v_add_f32 v41, 1.0, v41
    v_add_f32 v42, 1.0, v42
    v_add_f32 v43, 1.0, v43
    v_rcp_f32 v40, v40
    v_rcp_f32 v41, v41
    v_rcp_f32 v42, v42
    v_rcp_f32 v43, v43
    s_nop 0
    v_mul_f32 v40, v40, v44
    v_mul_f32 v41, v41, v45
    v_mul_f32 v42, v42, v46
    v_mul_f32 v43, v43, v47
    v_cvt_pk_bf16_f32 v250, v40, v41
    v_cvt_pk_bf16_f32 v251, v42, v43
    s_nop 1
    v_permlane32_swap_b32 v248, v250
    v_permlane32_swap_b32 v249, v251
    v_mul_f32 v32, v16, v204
    v_mul_f32 v36, v30, v220
    v_mul_f32 v33, v16, v205
    v_mul_f32 v37, v30, v221
    v_mul_f32 v34, v16, v206
    v_mul_f32 v38, v30, v222
    v_mul_f32 v35, v16, v207
    v_mul_f32 v39, v30, v223
    v_fma_f32 v32, v168, v17, -v32
    v_fma_f32 v36, v184, v31, -v36
    v_fma_f32 v33, v169, v17, -v33
    v_fma_f32 v37, v185, v31, -v37
    v_fma_f32 v34, v170, v17, -v34
    v_fma_f32 v38, v186, v31, -v38
    v_fma_f32 v35, v171, v17, -v35
    v_fma_f32 v39, v187, v31, -v39
    v_exp_f32 v32, v32
    v_exp_f32 v33, v33
    v_exp_f32 v34, v34
    v_exp_f32 v35, v35
    v_add_f32 v32, 1.0, v32
    v_add_f32 v33, 1.0, v33
    v_add_f32 v34, 1.0, v34
    v_add_f32 v35, 1.0, v35
    v_rcp_f32 v32, v32
    v_rcp_f32 v33, v33
    v_rcp_f32 v34, v34
    v_rcp_f32 v35, v35
    s_nop 0
    v_mul_f32 v32, v32, v36
    v_mul_f32 v33, v33, v37
    v_mul_f32 v34, v34, v38
    v_mul_f32 v35, v35, v39
    v_cvt_pk_bf16_f32 v252, v32, v33
    v_cvt_pk_bf16_f32 v253, v34, v35
    v_mul_f32 v40, v16, v208
    v_mul_f32 v44, v30, v224
    v_mul_f32 v41, v16, v209
    v_mul_f32 v45, v30, v225
    v_mul_f32 v42, v16, v210
    v_mul_f32 v46, v30, v226
    v_mul_f32 v43, v16, v211
    v_mul_f32 v47, v30, v227
    v_fma_f32 v40, v172, v17, -v40
    v_fma_f32 v44, v188, v31, -v44
    v_fma_f32 v41, v173, v17, -v41
    v_fma_f32 v45, v189, v31, -v45
    v_fma_f32 v42, v174, v17, -v42
    v_fma_f32 v46, v190, v31, -v46
    v_fma_f32 v43, v175, v17, -v43
    v_fma_f32 v47, v191, v31, -v47
    v_exp_f32 v40, v40
    v_exp_f32 v41, v41
    v_exp_f32 v42, v42
    v_exp_f32 v43, v43
    v_add_f32 v40, 1.0, v40
    v_add_f32 v41, 1.0, v41
    v_add_f32 v42, 1.0, v42
    v_add_f32 v43, 1.0, v43
    v_rcp_f32 v40, v40
    v_rcp_f32 v41, v41
    v_rcp_f32 v42, v42
    v_rcp_f32 v43, v43
    s_nop 0
    v_mul_f32 v40, v40, v44
    v_mul_f32 v41, v41, v45
    v_mul_f32 v42, v42, v46
    v_mul_f32 v43, v43, v47
    v_cvt_pk_bf16_f32 v254, v40, v41
    v_cvt_pk_bf16_f32 v255, v42, v43
    s_nop 1
    v_permlane32_swap_b32 v252, v254
    v_permlane32_swap_b32 v253, v255
    s_add_u32 s22, s51, 8912896
    s_mov_b32 s20, 1
    s_add_u32 s35, s44, 168
    s_waitcnt vmcnt(0)
    s_barrier
    s_cmp_lg_u32 s26, 0
    s_cbranch_scc1 L_ls_15
    v_add_u32 v234, s79, v1
    v_lshlrev_b32 v234, 7, v234
    s_mov_b32 exec_lo, 255
    s_mov_b32 exec_hi, 0
    v_mov_b32 v235, 1
    buffer_atomic_add v235, v234, s[56:59], 0 offen sc1
    s_mov_b64 exec, -1
    s_branch L_ls_15_e
L_ls_15:
    v_mov_b32 v234, 0x7ffffff0
    buffer_store_dword v234, v234, s[56:59], 0 offen
L_ls_15_e:
L_af_end_1:
    s_barrier
    s_and_b32 s27, s26, 1
    s_lshr_b32 s28, s26, 1
    s_and_b32 s40, s3, 7
    s_lshr_b32 s41, s3, 3
    s_and_b32 s42, s41, 3
    s_lshl_b32 s40, s40, 2
    s_add_u32 s40, s40, s42
    s_lshr_b32 s41, s41, 2
    s_add_u32 s4, s76, 1048576
    s_addc_u32 s5, s77, 0
    s_and_b32 s5, s5, 0xffff
    s_mov_b32 s6, 2621440
    s_mov_b32 s7, 0x00020000
    s_add_u32 s8, s76, 3670016
    s_addc_u32 s9, s77, 0
    s_and_b32 s9, s9, 0xffff
    s_mov_b32 s10, 2621440
    s_mov_b32 s11, 0x00020000
    s_add_u32 s12, s76, 15990784
    s_addc_u32 s13, s77, 0
    s_and_b32 s13, s13, 0xffff
    s_mov_b32 s14, 2621440
    s_mov_b32 s15, 0x00020000
    s_mov_b32 s16, s76
    s_mov_b32 s17, s77
    s_and_b32 s17, s17, 0xffff
    s_mov_b32 s18, 18612224
    s_mov_b32 s19, 0x00020000
    v_cmp_eq_u32 vcc, 0, v1
    v_cmp_eq_u32 s[30:31], 40, v1
    s_or_b64 vcc, vcc, s[30:31]
    v_mov_b32 v180, 0x3f803f80
    s_nop 0
    v_cndmask_b32 v176, 0, v180, vcc
    v_mov_b32 v177, v176
    v_mov_b32 v178, v176
    v_mov_b32 v179, v176
    v_lshlrev_b32 v180, 4, v1
    s_lshl_b32 s30, s2, 10
    s_add_u32 s53, s30, 131072
    buffer_store_dwordx4 v[176:179], v180, s[16:19], s53 offen sc1
    v_and_b32 v181, 31, v1
    v_lshrrev_b32 v182, 5, v1
    v_lshlrev_b32 v183, 15, v182
    v_lshl_add_u32 v170, v181, 4, v183
    v_lshlrev_b32 v172, 4, v181
    s_mul_i32 s30, s40, 5
    s_lshr_b32 s30, s30, 1
    s_and_b32 s31, s40, 1
    s_add_u32 s34, s30, s31
    s_xor_b32 s31, s31, 1
    s_lshl_b32 s31, s31, 1
    s_add_u32 s29, s30, s31
    s_lshl_b32 s34, s34, 15
    s_lshl_b32 s29, s29, 15
    s_mul_i32 s30, s40, 81920
    s_mul_i32 s31, s28, 40960
    s_add_u32 s30, s30, s31
    s_add_u32 s54, s30, 6291456
    v_mul_u32_u24 v183, 320, v182
    v_lshl_add_u32 v183, v181, 4, v183
    v_add_u32 v183, s54, v183
    v_cmp_lt_u32 vcc, 20, v181
    v_mov_b32 v184, s53
    v_add_u32 v185, 16, v184
    v_cndmask_b32 v184, v184, v185, vcc
    v_cmp_gt_u32 vcc, 20, v181
    v_mov_b32 v185, 1280
    v_mov_b32 v186, 0
    v_cndmask_b32 v187, v184, v183, vcc
    v_cndmask_b32 v174, v186, v185, vcc
    v_mov_b32 v142, 0x3f803f80
    v_mov_b32 v143, 0x00003f80
    v_mov_b32 v144, 0
    v_mov_b32 v145, 0
    v_mov_b32 v150, 0x3f803f80
    v_mov_b32 v151, 0x00003f80
    v_mov_b32 v152, 0
    v_mov_b32 v153, 0
    v_mov_b32 v158, 0x3f803f80
    v_mov_b32 v159, 0x00003f80
    v_mov_b32 v160, 0
    v_mov_b32 v161, 0
    v_mov_b32 v166, 0x3f803f80
    v_mov_b32 v167, 0x00003f80
    v_mov_b32 v168, 0
    v_mov_b32 v169, 0
    s_mov_b32 s24, s29
    v_mov_b32 v18, 0
    v_mov_b32 v19, 0
    v_mov_b32 v20, 0
    v_mov_b32 v21, 0
    v_mov_b32 v22, 0
    v_mov_b32 v23, 0
    v_mov_b32 v24, 0
    v_mov_b32 v25, 0
    v_mov_b32 v26, 0
    v_mov_b32 v27, 0
    v_mov_b32 v28, 0
    v_mov_b32 v29, 0
    v_mov_b32 v30, 0
    v_mov_b32 v31, 0
    v_mov_b32 v32, 0
    v_mov_b32 v33, 0
    v_mov_b32 v34, 0
    v_mov_b32 v35, 0
    v_mov_b32 v36, 0
    v_mov_b32 v37, 0
    v_mov_b32 v38, 0
    v_mov_b32 v39, 0
    v_mov_b32 v40, 0
    v_mov_b32 v41, 0
    v_mov_b32 v42, 0
    v_mov_b32 v43, 0
    v_mov_b32 v44, 0
    v_mov_b32 v45, 0
    v_mov_b32 v46, 0
    v_mov_b32 v47, 0
    v_mov_b32 v48, 0
    v_mov_b32 v49, 0
    v_mov_b32 v50, 0
    v_mov_b32 v51, 0
    v_mov_b32 v52, 0
    v_mov_b32 v53, 0
    v_mov_b32 v54, 0
    v_mov_b32 v55, 0
    v_mov_b32 v56, 0
    v_mov_b32 v57, 0
    v_mov_b32 v58, 0
    v_mov_b32 v59, 0
    v_mov_b32 v60, 0
    v_mov_b32 v61, 0
    v_mov_b32 v62, 0
    v_mov_b32 v63, 0
    v_mov_b32 v64, 0
    v_mov_b32 v65, 0
    v_mov_b32 v66, 0
    v_mov_b32 v67, 0
    v_mov_b32 v68, 0
    v_mov_b32 v69, 0
    v_mov_b32 v70, 0
    v_mov_b32 v71, 0
    v_mov_b32 v72, 0
    v_mov_b32 v73, 0
    v_mov_b32 v74, 0
    v_mov_b32 v75, 0
    v_mov_b32 v76, 0
    v_mov_b32 v77, 0
    v_mov_b32 v78, 0
    v_mov_b32 v79, 0
    v_mov_b32 v80, 0
    v_mov_b32 v81, 0
    v_mov_b32 v82, 0
    v_mov_b32 v83, 0
    v_mov_b32 v84, 0
    v_mov_b32 v85, 0
    v_mov_b32 v86, 0
    v_mov_b32 v87, 0
    v_mov_b32 v88, 0
    v_mov_b32 v89, 0
    v_mov_b32 v90, 0
    v_mov_b32 v91, 0
    v_mov_b32 v92, 0
    v_mov_b32 v93, 0
    v_mov_b32 v94, 0
    v_mov_b32 v95, 0
    v_mov_b32 v96, 0
    v_mov_b32 v97, 0
    v_mov_b32 v188, 0
    v_mov_b32 v220, 0
    v_mov_b32 v189, 0
    v_mov_b32 v221, 0
    v_mov_b32 v190, 0
    v_mov_b32 v222, 0
    v_mov_b32 v191, 0
    v_mov_b32 v223, 0
    v_mov_b32 v192, 0
    v_mov_b32 v224, 0
    v_mov_b32 v193, 0
    v_mov_b32 v225, 0
    v_mov_b32 v194, 0
    v_mov_b32 v226, 0
    v_mov_b32 v195, 0
    v_mov_b32 v227, 0
    s_waitcnt vmcnt(0)
    s_mul_i32 s50, s40, 20
    s_add_u32 s51, s50, 19
    s_lshr_b32 s50, s50, 7
    s_lshr_b32 s51, s51, 7
    s_and_b32 s32, s2, 7
    s_lshl_b32 s50, s50, 3
    s_lshl_b32 s51, s51, 3
    s_add_u32 s50, s50, s32
    s_add_u32 s51, s51, s32
    s_cmp_lg_u32 s26, 0
    s_cbranch_scc1 L_wcd_17
    s_lshl_b32 s31, s50, 7
    v_mov_b32 v238, s31
    s_lshl_b32 s31, s51, 7
    v_writelane_b32 v238, s31, 1
    s_mov_b32 exec_lo, 3
    s_mov_b32 exec_hi, 0
    s_mov_b32 s30, 0x40000
L_wc_16:
    buffer_load_dword v239, v238, s[56:59], 0 offen sc1
    s_waitcnt vmcnt(0)
    v_cmp_gt_u32 vcc, 48, v239
    s_nop 4
    s_cbranch_vccz L_wcd_17_x
    s_sleep 2
    s_sub_u32 s30, s30, 1
    s_cmp_lg_u32 s30, 0
    s_cbranch_scc1 L_wc_16
L_wcd_17_x:
    s_mov_b64 exec, -1
L_wcd_17:
    s_barrier
    s_lshl_b32 s43, s41, 3
    s_lshl_b32 s44, s27, 2
    s_add_u32 s43, s43, s44
    s_lshl_b32 s44, s43, 9
    s_add_u32 s30, s44, 0
    s_add_u32 s30, s30, s34
    buffer_load_dwordx4 v[2:5], v170, s[4:7], s30 offen sc1
    s_add_u32 s30, s44, 512
    s_add_u32 s30, s30, s34
    buffer_load_dwordx4 v[6:9], v170, s[4:7], s30 offen sc1
    s_add_u32 s30, s44, 1024
    s_add_u32 s30, s30, s34
    buffer_load_dwordx4 v[10:13], v170, s[4:7], s30 offen sc1
    s_add_u32 s30, s44, 1536
    s_add_u32 s30, s30, s34
    buffer_load_dwordx4 v[14:17], v170, s[4:7], s30 offen sc1
    s_mov_b32 exec_hi, 0
    s_add_u32 s30, s44, 0
    s_add_u32 s30, s30, s24
    buffer_load_dwordx4 v[18:21], v172, s[4:7], s30 offen sc1
    s_add_u32 s30, s44, 512
    s_add_u32 s30, s30, s24
    buffer_load_dwordx4 v[22:25], v172, s[4:7], s30 offen sc1
    s_add_u32 s30, s44, 1024
    s_add_u32 s30, s30, s24
    buffer_load_dwordx4 v[26:29], v172, s[4:7], s30 offen sc1
    s_add_u32 s30, s44, 1536
    s_add_u32 s30, s30, s24
    buffer_load_dwordx4 v[30:33], v172, s[4:7], s30 offen sc1
    s_mov_b64 exec, -1
    s_lshl_b32 s54, s28, 14
    s_add_u32 s53, s54, s24
    s_add_u32 s54, s54, s34
    s_mov_b32 s55, 0
L_att_pass:
    s_mov_b32 s48, s54
    s_mov_b32 s49, s53
    v_mov_b32 v173, v187
    buffer_load_dwordx4 v[138:141], v170, s[8:11], s48 offen sc1
    s_mov_b32 exec_hi, 0
    buffer_load_dwordx4 v[142:145], v172, s[8:11], s49 offen sc1
    s_mov_b32 exec_hi, -1
    s_add_u32 s48, s48, 512
    s_add_u32 s49, s49, 512
    buffer_load_dwordx4 v[196:199], v173, s[16:19], 0 offen sc1
    buffer_load_dwordx4 v[200:203], v173, s[16:19], 0 offen offset:640 sc1
    v_add_u32 v173, v173, v174
    buffer_load_dwordx4 v[146:149], v170, s[8:11], s48 offen sc1
    s_mov_b32 exec_hi, 0
    buffer_load_dwordx4 v[150:153], v172, s[8:11], s49 offen sc1
    s_mov_b32 exec_hi, -1
    s_add_u32 s48, s48, 512
    s_add_u32 s49, s49, 512
    buffer_load_dwordx4 v[204:207], v173, s[16:19], 0 offen sc1
    buffer_load_dwordx4 v[208:211], v173, s[16:19], 0 offen offset:640 sc1
    v_add_u32 v173, v173, v174
    buffer_load_dwordx4 v[154:157], v170, s[8:11], s48 offen sc1
    s_mov_b32 exec_hi, 0
    buffer_load_dwordx4 v[158:161], v172, s[8:11], s49 offen sc1
    s_mov_b32 exec_hi, -1
    s_add_u32 s48, s48, 512
    s_add_u32 s49, s49, 512
    buffer_load_dwordx4 v[212:215], v173, s[16:19], 0 offen sc1
    buffer_load_dwordx4 v[216:219], v173, s[16:19], 0 offen offset:640 sc1
    v_add_u32 v173, v173, v174
    buffer_load_dwordx4 v[162:165], v170, s[8:11], s48 offen sc1
    s_mov_b32 exec_hi, 0
    buffer_load_dwordx4 v[166:169], v172, s[8:11], s49 offen sc1
    s_mov_b32 exec_hi, -1
    s_add_u32 s48, s48, 512
    s_add_u32 s49, s49, 512
    s_cmp_eq_u32 s55, 0
    s_cbranch_scc1 L_at_zeroed
    v_mov_b32 v34, 0
    v_mov_b32 v35, 0
    v_mov_b32 v36, 0
    v_mov_b32 v37, 0
    v_mov_b32 v38, 0
    v_mov_b32 v39, 0
    v_mov_b32 v40, 0
    v_mov_b32 v41, 0
    v_mov_b32 v42, 0
    v_mov_b32 v43, 0
    v_mov_b32 v44, 0
    v_mov_b32 v45, 0
    v_mov_b32 v46, 0
    v_mov_b32 v47, 0
    v_mov_b32 v48, 0
    v_mov_b32 v49, 0
    v_mov_b32 v50, 0
    v_mov_b32 v51, 0
    v_mov_b32 v52, 0
    v_mov_b32 v53, 0
    v_mov_b32 v54, 0
    v_mov_b32 v55, 0
    v_mov_b32 v56, 0
    v_mov_b32 v57, 0
    v_mov_b32 v58, 0
    v_mov_b32 v59, 0
    v_mov_b32 v60, 0
    v_mov_b32 v61, 0
    v_mov_b32 v62, 0
    v_mov_b32 v63, 0
    v_mov_b32 v64, 0
    v_mov_b32 v65, 0
    v_mov_b32 v66, 0
    v_mov_b32 v67, 0
    v_mov_b32 v68, 0
    v_mov_b32 v69, 0
    v_mov_b32 v70, 0
    v_mov_b32 v71, 0
    v_mov_b32 v72, 0
    v_mov_b32 v73, 0
    v_mov_b32 v74, 0
    v_mov_b32 v75, 0
    v_mov_b32 v76, 0
    v_mov_b32 v77, 0
    v_mov_b32 v78, 0
    v_mov_b32 v79, 0
    v_mov_b32 v80, 0
    v_mov_b32 v81, 0
    v_mov_b32 v82, 0
    v_mov_b32 v83, 0
    v_mov_b32 v84, 0
    v_mov_b32 v85, 0
    v_mov_b32 v86, 0
    v_mov_b32 v87, 0
    v_mov_b32 v88, 0
    v_mov_b32 v89, 0
    v_mov_b32 v90, 0
    v_mov_b32 v91, 0
    v_mov_b32 v92, 0
    v_mov_b32 v93, 0
    v_mov_b32 v94, 0
    v_mov_b32 v95, 0
    v_mov_b32 v96, 0
    v_mov_b32 v97, 0
    v_mov_b32 v188, 0
    v_mov_b32 v189, 0
    v_mov_b32 v190, 0
    v_mov_b32 v191, 0
    v_mov_b32 v192, 0
    v_mov_b32 v193, 0
    v_mov_b32 v194, 0
    v_mov_b32 v195, 0
    v_mov_b32 v220, 0
    v_mov_b32 v221, 0
    v_mov_b32 v222, 0
    v_mov_b32 v223, 0
    v_mov_b32 v224, 0
    v_mov_b32 v225, 0
    v_mov_b32 v226, 0
    v_mov_b32 v227, 0
L_at_zeroed:
    s_waitcnt vmcnt(12)
    s_mov_b32 exec_hi, 0
    s_bitcmp1_b32 s40, 0
    s_cbranch_scc1 L_at_qodd
    v_mov_b32 v20, 0
    v_mov_b32 v21, 0
    v_mov_b32 v24, 0
    v_mov_b32 v25, 0
    v_mov_b32 v28, 0
    v_mov_b32 v29, 0
    v_mov_b32 v32, 0
    v_mov_b32 v33, 0
    s_branch L_at_qdone
L_at_qodd:
    v_mov_b32 v18, 0
    v_mov_b32 v19, 0
    v_mov_b32 v22, 0
    v_mov_b32 v23, 0
    v_mov_b32 v26, 0
    v_mov_b32 v27, 0
    v_mov_b32 v30, 0
    v_mov_b32 v31, 0
L_at_qdone:
    s_mov_b64 exec, -1
    s_nop 1
    v_mfma_f32_32x32x16_bf16 v[98:113], v[138:141], v[2:5], 0
    v_mfma_f32_32x32x16_bf16 v[98:113], v[142:145], v[18:21], v[98:113]
    s_nop 15
    s_mov_b32 s50, 8
.p2align 6
L_at_loop:
    s_cmp_eq_u32 s20, 0
    s_cbranch_scc1 L_at_noh
    s_cmp_eq_u32 s20, 1
    s_cbranch_scc0 L_at_hsig
    s_add_u32 s30, s22, 0
    buffer_store_dwordx4 v[240:243], v170, s[16:19], s30 offen sc1
    s_add_u32 s30, s22, 65536
    buffer_store_dwordx4 v[244:247], v170, s[16:19], s30 offen sc1
    s_add_u32 s30, s22, 512
    buffer_store_dwordx4 v[248:251], v170, s[16:19], s30 offen sc1
    s_add_u32 s30, s22, 66048
    buffer_store_dwordx4 v[252:255], v170, s[16:19], s30 offen sc1
    s_mov_b32 s20, 2
    s_branch L_at_noh
L_at_hsig:
    s_waitcnt vmcnt(0)
    s_lshl_b32 s30, s35, 7
    v_mov_b32 v234, s30
    v_mov_b32 v235, 1
    s_mov_b32 exec_lo, 1
    s_mov_b32 exec_hi, 0
    buffer_atomic_add v235, v234, s[56:59], 0 offen sc1
    s_mov_b64 exec, -1
    s_mov_b32 s20, 0
L_at_noh:
    s_cmp_eq_u32 s50, 4
    s_cbranch_scc1 L_at_s2
    s_cmp_lg_u32 s50, 2
    s_cbranch_scc1 L_at_nos2
L_at_s2:
    s_cmp_lg_u32 s55, 0
    s_cbranch_scc1 L_at_nos2
    s_add_u32 s21, s3, 192
    s_cmp_lg_u32 s26, 0
    s_cbranch_scc1 L_ls_18
    v_add_u32 v234, s21, v1
    v_lshlrev_b32 v234, 7, v234
    s_mov_b32 exec_lo, 1
    s_mov_b32 exec_hi, 0
    v_mov_b32 v235, 1
    buffer_atomic_add v235, v234, s[56:59], 0 offen sc1
    s_mov_b64 exec, -1
    s_branch L_ls_18_e
L_ls_18:
    v_mov_b32 v234, 0x7ffffff0
    buffer_store_dword v234, v234, s[56:59], 0 offen
L_ls_18_e:
L_at_nos2:
    v_mfma_f32_32x32x16_bf16 v[114:129], v[138:141], v[6:9], 0
    v_exp_f32 v98, v98
    v_exp_f32 v99, v99
    v_exp_f32 v100, v100
    v_mfma_f32_32x32x16_bf16 v[114:129], v[142:145], v[22:25], v[114:129]
    v_exp_f32 v101, v101
    v_exp_f32 v102, v102
    v_exp_f32 v103, v103
    v_mfma_f32_32x32x16_bf16 v[82:97], v[220:223], v[188:191], v[82:97]
    v_exp_f32 v104, v104
    v_exp_f32 v105, v105
    v_cvt_pk_bf16_f32 v130, v98, v99
    v_cvt_pk_bf16_f32 v131, v100, v101
    v_mfma_f32_32x32x16_bf16 v[82:97], v[224:227], v[192:195], v[82:97]
    buffer_load_dwordx4 v[220:223], v173, s[16:19], 0 offen sc1
    buffer_load_dwordx4 v[224:227], v173, s[16:19], 0 offen offset:640 sc1
    v_add_u32 v173, v173, v174
    v_exp_f32 v106, v106
    v_exp_f32 v107, v107
    v_cvt_pk_bf16_f32 v132, v102, v103
    v_cvt_pk_bf16_f32 v133, v104, v105
    v_exp_f32 v108, v108
    v_exp_f32 v109, v109
    v_exp_f32 v110, v110
    v_exp_f32 v111, v111
    v_cvt_pk_bf16_f32 v134, v106, v107
    v_cvt_pk_bf16_f32 v135, v108, v109
    v_exp_f32 v112, v112
    v_exp_f32 v113, v113
    v_cvt_pk_bf16_f32 v136, v110, v111
    v_cvt_pk_bf16_f32 v137, v112, v113
    v_mfma_f32_32x32x16_bf16 v[98:113], v[138:141], v[10:13], 0
    v_exp_f32 v114, v114
    v_exp_f32 v115, v115
    v_exp_f32 v116, v116
    v_mfma_f32_32x32x16_bf16 v[98:113], v[142:145], v[26:29], v[98:113]
    v_exp_f32 v117, v117
    v_exp_f32 v118, v118
    v_exp_f32 v119, v119
    s_waitcnt vmcnt(12)
    v_mfma_f32_32x32x16_bf16 v[34:49], v[196:199], v[130:133], v[34:49]
    v_exp_f32 v120, v120
    v_exp_f32 v121, v121
    v_cvt_pk_bf16_f32 v188, v114, v115
    v_cvt_pk_bf16_f32 v189, v116, v117
    v_mfma_f32_32x32x16_bf16 v[34:49], v[200:203], v[134:137], v[34:49]
    v_exp_f32 v122, v122
    v_exp_f32 v123, v123
    v_cvt_pk_bf16_f32 v190, v118, v119
    v_cvt_pk_bf16_f32 v191, v120, v121
    v_exp_f32 v124, v124
    v_exp_f32 v125, v125
    v_exp_f32 v126, v126
    v_exp_f32 v127, v127
    v_cvt_pk_bf16_f32 v192, v122, v123
    v_cvt_pk_bf16_f32 v193, v124, v125
    v_exp_f32 v128, v128
    v_exp_f32 v129, v129
    v_cvt_pk_bf16_f32 v194, v126, v127
    v_cvt_pk_bf16_f32 v195, v128, v129
    v_mfma_f32_32x32x16_bf16 v[114:129], v[138:141], v[14:17], 0
    v_exp_f32 v98, v98
    v_exp_f32 v99, v99
    v_exp_f32 v100, v100
    v_mfma_f32_32x32x16_bf16 v[114:129], v[142:145], v[30:33], v[114:129]
    v_exp_f32 v101, v101
    v_exp_f32 v102, v102
    v_exp_f32 v103, v103
    v_mfma_f32_32x32x16_bf16 v[50:65], v[196:199], v[188:191], v[50:65]
    v_exp_f32 v104, v104
    v_exp_f32 v105, v105
    v_cvt_pk_bf16_f32 v130, v98, v99
    v_cvt_pk_bf16_f32 v131, v100, v101
    v_mfma_f32_32x32x16_bf16 v[50:65], v[200:203], v[192:195], v[50:65]
    v_exp_f32 v106, v106
    v_exp_f32 v107, v107
    v_cvt_pk_bf16_f32 v132, v102, v103
    v_cvt_pk_bf16_f32 v133, v104, v105
    v_exp_f32 v108, v108
    v_exp_f32 v109, v109
    v_exp_f32 v110, v110
    v_exp_f32 v111, v111
    v_cvt_pk_bf16_f32 v134, v106, v107
    v_cvt_pk_bf16_f32 v135, v108, v109
    v_exp_f32 v112, v112
    v_exp_f32 v113, v113
    v_cvt_pk_bf16_f32 v136, v110, v111
    v_cvt_pk_bf16_f32 v137, v112, v113
    s_waitcnt vmcnt(10)
    v_mfma_f32_32x32x16_bf16 v[98:113], v[146:149], v[2:5], 0
    v_exp_f32 v114, v114
    v_exp_f32 v115, v115
    v_exp_f32 v116, v116
    v_mfma_f32_32x32x16_bf16 v[98:113], v[150:153], v[18:21], v[98:113]
    buffer_load_dwordx4 v[138:141], v170, s[8:11], s48 offen sc1
    s_mov_b32 exec_hi, 0
    buffer_load_dwordx4 v[142:145], v172, s[8:11], s49 offen sc1
    s_mov_b32 exec_hi, -1
    s_add_u32 s48, s48, 512
    s_add_u32 s49, s49, 512
    v_exp_f32 v117, v117
    v_exp_f32 v118, v118
    v_exp_f32 v119, v119
    v_mfma_f32_32x32x16_bf16 v[66:81], v[196:199], v[130:133], v[66:81]
    v_exp_f32 v120, v120
    v_exp_f32 v121, v121
    v_cvt_pk_bf16_f32 v188, v114, v115
    v_cvt_pk_bf16_f32 v189, v116, v117
    v_mfma_f32_32x32x16_bf16 v[66:81], v[200:203], v[134:137], v[66:81]
    v_exp_f32 v122, v122
    v_exp_f32 v123, v123
    v_cvt_pk_bf16_f32 v190, v118, v119
    v_cvt_pk_bf16_f32 v191, v120, v121
    v_exp_f32 v124, v124
    v_exp_f32 v125, v125
    v_exp_f32 v126, v126
    v_exp_f32 v127, v127
    v_cvt_pk_bf16_f32 v192, v122, v123
    v_cvt_pk_bf16_f32 v193, v124, v125
    v_exp_f32 v128, v128
    v_exp_f32 v129, v129
    v_cvt_pk_bf16_f32 v194, v126, v127
    v_cvt_pk_bf16_f32 v195, v128, v129
    v_mfma_f32_32x32x16_bf16 v[114:129], v[146:149], v[6:9], 0
    v_exp_f32 v98, v98
    v_exp_f32 v99, v99
    v_exp_f32 v100, v100
    v_mfma_f32_32x32x16_bf16 v[114:129], v[150:153], v[22:25], v[114:129]
    v_exp_f32 v101, v101
    v_exp_f32 v102, v102
    v_exp_f32 v103, v103
    v_mfma_f32_32x32x16_bf16 v[82:97], v[196:199], v[188:191], v[82:97]
    v_exp_f32 v104, v104
    v_exp_f32 v105, v105
    v_cvt_pk_bf16_f32 v130, v98, v99
    v_cvt_pk_bf16_f32 v131, v100, v101
    v_mfma_f32_32x32x16_bf16 v[82:97], v[200:203], v[192:195], v[82:97]
    buffer_load_dwordx4 v[196:199], v173, s[16:19], 0 offen sc1
    buffer_load_dwordx4 v[200:203], v173, s[16:19], 0 offen offset:640 sc1
    v_add_u32 v173, v173, v174
    v_exp_f32 v106, v106
    v_exp_f32 v107, v107
    v_cvt_pk_bf16_f32 v132, v102, v103
    v_cvt_pk_bf16_f32 v133, v104, v105
    v_exp_f32 v108, v108
    v_exp_f32 v109, v109
    v_exp_f32 v110, v110
    v_exp_f32 v111, v111
    v_cvt_pk_bf16_f32 v134, v106, v107
    v_cvt_pk_bf16_f32 v135, v108, v109
    v_exp_f32 v112, v112
    v_exp_f32 v113, v113
    v_cvt_pk_bf16_f32 v136, v110, v111
    v_cvt_pk_bf16_f32 v137, v112, v113
    v_mfma_f32_32x32x16_bf16 v[98:113], v[146:149], v[10:13], 0
    v_exp_f32 v114, v114
    v_exp_f32 v115, v115
    v_exp_f32 v116, v116
    v_mfma_f32_32x32x16_bf16 v[98:113], v[150:153], v[26:29], v[98:113]
    v_exp_f32 v117, v117
    v_exp_f32 v118, v118
    v_exp_f32 v119, v119
    s_waitcnt vmcnt(12)
    v_mfma_f32_32x32x16_bf16 v[34:49], v[204:207], v[130:133], v[34:49]
    v_exp_f32 v120, v120
    v_exp_f32 v121, v121
    v_cvt_pk_bf16_f32 v188, v114, v115
    v_cvt_pk_bf16_f32 v189, v116, v117
    v_mfma_f32_32x32x16_bf16 v[34:49], v[208:211], v[134:137], v[34:49]
    v_exp_f32 v122, v122
    v_exp_f32 v123, v123
    v_cvt_pk_bf16_f32 v190, v118, v119
    v_cvt_pk_bf16_f32 v191, v120, v121
    v_exp_f32 v124, v124
    v_exp_f32 v125, v125
    v_exp_f32 v126, v126
    v_exp_f32 v127, v127
    v_cvt_pk_bf16_f32 v192, v122, v123
    v_cvt_pk_bf16_f32 v193, v124, v125
    v_exp_f32 v128, v128
    v_exp_f32 v129, v129
    v_cvt_pk_bf16_f32 v194, v126, v127
    v_cvt_pk_bf16_f32 v195, v128, v129
    v_mfma_f32_32x32x16_bf16 v[114:129], v[146:149], v[14:17], 0
    v_exp_f32 v98, v98
    v_exp_f32 v99, v99
    v_exp_f32 v100, v100
    v_mfma_f32_32x32x16_bf16 v[114:129], v[150:153], v[30:33], v[114:129]
    v_exp_f32 v101, v101
    v_exp_f32 v102, v102
    v_exp_f32 v103, v103
    v_mfma_f32_32x32x16_bf16 v[50:65], v[204:207], v[188:191], v[50:65]
    v_exp_f32 v104, v104
    v_exp_f32 v105, v105
    v_cvt_pk_bf16_f32 v130, v98, v99
    v_cvt_pk_bf16_f32 v131, v100, v101
    v_mfma_f32_32x32x16_bf16 v[50:65], v[208:211], v[192:195], v[50:65]
    v_exp_f32 v106, v106
    v_exp_f32 v107, v107
    v_cvt_pk_bf16_f32 v132, v102, v103
    v_cvt_pk_bf16_f32 v133, v104, v105
    v_exp_f32 v108, v108
    v_exp_f32 v109, v109
    v_exp_f32 v110, v110
    v_exp_f32 v111, v111
    v_cvt_pk_bf16_f32 v134, v106, v107
    v_cvt_pk_bf16_f32 v135, v108, v109
    v_exp_f32 v112, v112
    v_exp_f32 v113, v113
    v_cvt_pk_bf16_f32 v136, v110, v111
    v_cvt_pk_bf16_f32 v137, v112, v113
    s_waitcnt vmcnt(10)
    v_mfma_f32_32x32x16_bf16 v[98:113], v[154:157], v[2:5], 0
    v_exp_f32 v114, v114
    v_exp_f32 v115, v115
    v_exp_f32 v116, v116
    v_mfma_f32_32x32x16_bf16 v[98:113], v[158:161], v[18:21], v[98:113]
    buffer_load_dwordx4 v[146:149], v170, s[8:11], s48 offen sc1
    s_mov_b32 exec_hi, 0
    buffer_load_dwordx4 v[150:153], v172, s[8:11], s49 offen sc1
    s_mov_b32 exec_hi, -1
    s_add_u32 s48, s48, 512
    s_add_u32 s49, s49, 512
    v_exp_f32 v117, v117
    v_exp_f32 v118, v118
    v_exp_f32 v119, v119
    v_mfma_f32_32x32x16_bf16 v[66:81], v[204:207], v[130:133], v[66:81]
    v_exp_f32 v120, v120
    v_exp_f32 v121, v121
    v_cvt_pk_bf16_f32 v188, v114, v115
    v_cvt_pk_bf16_f32 v189, v116, v117
    v_mfma_f32_32x32x16_bf16 v[66:81], v[208:211], v[134:137], v[66:81]
    v_exp_f32 v122, v122
    v_exp_f32 v123, v123
    v_cvt_pk_bf16_f32 v190, v118, v119
    v_cvt_pk_bf16_f32 v191, v120, v121
    v_exp_f32 v124, v124
    v_exp_f32 v125, v125
    v_exp_f32 v126, v126
    v_exp_f32 v127, v127
    v_cvt_pk_bf16_f32 v192, v122, v123
    v_cvt_pk_bf16_f32 v193, v124, v125
    v_exp_f32 v128, v128
    v_exp_f32 v129, v129
    v_cvt_pk_bf16_f32 v194, v126, v127
    v_cvt_pk_bf16_f32 v195, v128, v129
    v_mfma_f32_32x32x16_bf16 v[114:129], v[154:157], v[6:9], 0
    v_exp_f32 v98, v98
    v_exp_f32 v99, v99
    v_exp_f32 v100, v100
    v_mfma_f32_32x32x16_bf16 v[114:129], v[158:161], v[22:25], v[114:129]
    v_exp_f32 v101, v101
    v_exp_f32 v102, v102
    v_exp_f32 v103, v103
    v_mfma_f32_32x32x16_bf16 v[82:97], v[204:207], v[188:191], v[82:97]
    v_exp_f32 v104, v104
    v_exp_f32 v105, v105
    v_cvt_pk_bf16_f32 v130, v98, v99
    v_cvt_pk_bf16_f32 v131, v100, v101
    v_mfma_f32_32x32x16_bf16 v[82:97], v[208:211], v[192:195], v[82:97]
    buffer_load_dwordx4 v[204:207], v173, s[16:19], 0 offen sc1
    buffer_load_dwordx4 v[208:211], v173, s[16:19], 0 offen offset:640 sc1
    v_add_u32 v173, v173, v174
    v_exp_f32 v106, v106
    v_exp_f32 v107, v107
    v_cvt_pk_bf16_f32 v132, v102, v103
    v_cvt_pk_bf16_f32 v133, v104, v105
    v_exp_f32 v108, v108
    v_exp_f32 v109, v109
    v_exp_f32 v110, v110
    v_exp_f32 v111, v111
    v_cvt_pk_bf16_f32 v134, v106, v107
    v_cvt_pk_bf16_f32 v135, v108, v109
    v_exp_f32 v112, v112
    v_exp_f32 v113, v113
    v_cvt_pk_bf16_f32 v136, v110, v111
    v_cvt_pk_bf16_f32 v137, v112, v113
    v_mfma_f32_32x32x16_bf16 v[98:113], v[154:157], v[10:13], 0
    v_exp_f32 v114, v114
    v_exp_f32 v115, v115
    v_exp_f32 v116, v116
    v_mfma_f32_32x32x16_bf16 v[98:113], v[158:161], v[26:29], v[98:113]
    v_exp_f32 v117, v117
    v_exp_f32 v118, v118
    v_exp_f32 v119, v119
    s_waitcnt vmcnt(12)
    v_mfma_f32_32x32x16_bf16 v[34:49], v[212:215], v[130:133], v[34:49]
    v_exp_f32 v120, v120
    v_exp_f32 v121, v121
    v_cvt_pk_bf16_f32 v188, v114, v115
    v_cvt_pk_bf16_f32 v189, v116, v117
    v_mfma_f32_32x32x16_bf16 v[34:49], v[216:219], v[134:137], v[34:49]
    v_exp_f32 v122, v122
    v_exp_f32 v123, v123
    v_cvt_pk_bf16_f32 v190, v118, v119
    v_cvt_pk_bf16_f32 v191, v120, v121
    v_exp_f32 v124, v124
    v_exp_f32 v125, v125
    v_exp_f32 v126, v126
    v_exp_f32 v127, v127
    v_cvt_pk_bf16_f32 v192, v122, v123
    v_cvt_pk_bf16_f32 v193, v124, v125
    v_exp_f32 v128, v128
    v_exp_f32 v129, v129
    v_cvt_pk_bf16_f32 v194, v126, v127
    v_cvt_pk_bf16_f32 v195, v128, v129
    v_mfma_f32_32x32x16_bf16 v[114:129], v[154:157], v[14:17], 0
    v_exp_f32 v98, v98
    v_exp_f32 v99, v99
    v_exp_f32 v100, v100
    v_mfma_f32_32x32x16_bf16 v[114:129], v[158:161], v[30:33], v[114:129]
    v_exp_f32 v101, v101
    v_exp_f32 v102, v102
    v_exp_f32 v103, v103
    v_mfma_f32_32x32x16_bf16 v[50:65], v[212:215], v[188:191], v[50:65]
    v_exp_f32 v104, v104
    v_exp_f32 v105, v105
    v_cvt_pk_bf16_f32 v130, v98, v99
    v_cvt_pk_bf16_f32 v131, v100, v101
    v_mfma_f32_32x32x16_bf16 v[50:65], v[216:219], v[192:195], v[50:65]
    v_exp_f32 v106, v106
    v_exp_f32 v107, v107
    v_cvt_pk_bf16_f32 v132, v102, v103
    v_cvt_pk_bf16_f32 v133, v104, v105
    v_exp_f32 v108, v108
    v_exp_f32 v109, v109
    v_exp_f32 v110, v110
    v_exp_f32 v111, v111
    v_cvt_pk_bf16_f32 v134, v106, v107
    v_cvt_pk_bf16_f32 v135, v108, v109
    v_exp_f32 v112, v112
    v_exp_f32 v113, v113
    v_cvt_pk_bf16_f32 v136, v110, v111
    v_cvt_pk_bf16_f32 v137, v112, v113
    s_waitcnt vmcnt(10)
    v_mfma_f32_32x32x16_bf16 v[98:113], v[162:165], v[2:5], 0
    v_exp_f32 v114, v114
    v_exp_f32 v115, v115
    v_exp_f32 v116, v116
    v_mfma_f32_32x32x16_bf16 v[98:113], v[166:169], v[18:21], v[98:113]
    buffer_load_dwordx4 v[154:157], v170, s[8:11], s48 offen sc1
    s_mov_b32 exec_hi, 0
    buffer_load_dwordx4 v[158:161], v172, s[8:11], s49 offen sc1
    s_mov_b32 exec_hi, -1
    s_add_u32 s48, s48, 512
    s_add_u32 s49, s49, 512
    v_exp_f32 v117, v117
    v_exp_f32 v118, v118
    v_exp_f32 v119, v119
    v_mfma_f32_32x32x16_bf16 v[66:81], v[212:215], v[130:133], v[66:81]
    v_exp_f32 v120, v120
    v_exp_f32 v121, v121
    v_cvt_pk_bf16_f32 v188, v114, v115
    v_cvt_pk_bf16_f32 v189, v116, v117
    v_mfma_f32_32x32x16_bf16 v[66:81], v[216:219], v[134:137], v[66:81]
    v_exp_f32 v122, v122
    v_exp_f32 v123, v123
    v_cvt_pk_bf16_f32 v190, v118, v119
    v_cvt_pk_bf16_f32 v191, v120, v121
    v_exp_f32 v124, v124
    v_exp_f32 v125, v125
    v_exp_f32 v126, v126
    v_exp_f32 v127, v127
    v_cvt_pk_bf16_f32 v192, v122, v123
    v_cvt_pk_bf16_f32 v193, v124, v125
    v_exp_f32 v128, v128
    v_exp_f32 v129, v129
    v_cvt_pk_bf16_f32 v194, v126, v127
    v_cvt_pk_bf16_f32 v195, v128, v129
    v_mfma_f32_32x32x16_bf16 v[114:129], v[162:165], v[6:9], 0
    v_exp_f32 v98, v98
    v_exp_f32 v99, v99
    v_exp_f32 v100, v100
    v_mfma_f32_32x32x16_bf16 v[114:129], v[166:169], v[22:25], v[114:129]
    v_exp_f32 v101, v101
    v_exp_f32 v102, v102
    v_exp_f32 v103, v103
    v_mfma_f32_32x32x16_bf16 v[82:97], v[212:215], v[188:191], v[82:97]
    v_exp_f32 v104, v104
    v_exp_f32 v105, v105
    v_cvt_pk_bf16_f32 v130, v98, v99
    v_cvt_pk_bf16_f32 v131, v100, v101
    v_mfma_f32_32x32x16_bf16 v[82:97], v[216:219], v[192:195], v[82:97]
    buffer_load_dwordx4 v[212:215], v173, s[16:19], 0 offen sc1
    buffer_load_dwordx4 v[216:219], v173, s[16:19], 0 offen offset:640 sc1
    v_add_u32 v173, v173, v174
    v_exp_f32 v106, v106
    v_exp_f32 v107, v107
    v_cvt_pk_bf16_f32 v132, v102, v103
    v_cvt_pk_bf16_f32 v133, v104, v105
    v_exp_f32 v108, v108
    v_exp_f32 v109, v109
    v_exp_f32 v110, v110
    v_exp_f32 v111, v111
    v_cvt_pk_bf16_f32 v134, v106, v107
    v_cvt_pk_bf16_f32 v135, v108, v109
    v_exp_f32 v112, v112
    v_exp_f32 v113, v113
    v_cvt_pk_bf16_f32 v136, v110, v111
    v_cvt_pk_bf16_f32 v137, v112, v113
    v_mfma_f32_32x32x16_bf16 v[98:113], v[162:165], v[10:13], 0
    v_exp_f32 v114, v114
    v_exp_f32 v115, v115
    v_exp_f32 v116, v116
    v_mfma_f32_32x32x16_bf16 v[98:113], v[166:169], v[26:29], v[98:113]
    v_exp_f32 v117, v117
    v_exp_f32 v118, v118
    v_exp_f32 v119, v119
    s_waitcnt vmcnt(12)
    v_mfma_f32_32x32x16_bf16 v[34:49], v[220:223], v[130:133], v[34:49]
    v_exp_f32 v120, v120
    v_exp_f32 v121, v121
    v_cvt_pk_bf16_f32 v188, v114, v115
    v_cvt_pk_bf16_f32 v189, v116, v117
    v_mfma_f32_32x32x16_bf16 v[34:49], v[224:227], v[134:137], v[34:49]
    v_exp_f32 v122, v122
    v_exp_f32 v123, v123
    v_cvt_pk_bf16_f32 v190, v118, v119
    v_cvt_pk_bf16_f32 v191, v120, v121
    v_exp_f32 v124, v124
    v_exp_f32 v125, v125
    v_exp_f32 v126, v126
    v_exp_f32 v127, v127
    v_cvt_pk_bf16_f32 v192, v122, v123
    v_cvt_pk_bf16_f32 v193, v124, v125
    v_exp_f32 v128, v128
    v_exp_f32 v129, v129
    v_cvt_pk_bf16_f32 v194, v126, v127
    v_cvt_pk_bf16_f32 v195, v128, v129
    v_mfma_f32_32x32x16_bf16 v[114:129], v[162:165], v[14:17], 0
    v_exp_f32 v98, v98
    v_exp_f32 v99, v99
    v_exp_f32 v100, v100
    v_mfma_f32_32x32x16_bf16 v[114:129], v[166:169], v[30:33], v[114:129]
    v_exp_f32 v101, v101
    v_exp_f32 v102, v102
    v_exp_f32 v103, v103
    v_mfma_f32_32x32x16_bf16 v[50:65], v[220:223], v[188:191], v[50:65]
    v_exp_f32 v104, v104
    v_exp_f32 v105, v105
    v_cvt_pk_bf16_f32 v130, v98, v99
    v_cvt_pk_bf16_f32 v131, v100, v101
    v_mfma_f32_32x32x16_bf16 v[50:65], v[224:227], v[192:195], v[50:65]
    v_exp_f32 v106, v106
    v_exp_f32 v107, v107
    v_cvt_pk_bf16_f32 v132, v102, v103
    v_cvt_pk_bf16_f32 v133, v104, v105
    v_exp_f32 v108, v108
    v_exp_f32 v109, v109
    v_exp_f32 v110, v110
    v_exp_f32 v111, v111
    v_cvt_pk_bf16_f32 v134, v106, v107
    v_cvt_pk_bf16_f32 v135, v108, v109
    v_exp_f32 v112, v112
    v_exp_f32 v113, v113
    v_cvt_pk_bf16_f32 v136, v110, v111
    v_cvt_pk_bf16_f32 v137, v112, v113
    s_waitcnt vmcnt(10)
    v_mfma_f32_32x32x16_bf16 v[98:113], v[138:141], v[2:5], 0
    v_exp_f32 v114, v114
    v_exp_f32 v115, v115
    v_exp_f32 v116, v116
    v_mfma_f32_32x32x16_bf16 v[98:113], v[142:145], v[18:21], v[98:113]
    buffer_load_dwordx4 v[162:165], v170, s[8:11], s48 offen sc1
    s_mov_b32 exec_hi, 0
    buffer_load_dwordx4 v[166:169], v172, s[8:11], s49 offen sc1
    s_mov_b32 exec_hi, -1
    s_add_u32 s48, s48, 512
    s_add_u32 s49, s49, 512
    v_exp_f32 v117, v117
    v_exp_f32 v118, v118
    v_exp_f32 v119, v119
    v_mfma_f32_32x32x16_bf16 v[66:81], v[220:223], v[130:133], v[66:81]
    v_exp_f32 v120, v120
    v_exp_f32 v121, v121
    v_cvt_pk_bf16_f32 v188, v114, v115
    v_cvt_pk_bf16_f32 v189, v116, v117
    v_mfma_f32_32x32x16_bf16 v[66:81], v[224:227], v[134:137], v[66:81]
    v_exp_f32 v122, v122
    v_exp_f32 v123, v123
    v_cvt_pk_bf16_f32 v190, v118, v119
    v_cvt_pk_bf16_f32 v191, v120, v121
    v_exp_f32 v124, v124
    v_exp_f32 v125, v125
    v_exp_f32 v126, v126
    v_exp_f32 v127, v127
    v_cvt_pk_bf16_f32 v192, v122, v123
    v_cvt_pk_bf16_f32 v193, v124, v125
    v_exp_f32 v128, v128
    v_exp_f32 v129, v129
    v_cvt_pk_bf16_f32 v194, v126, v127
    v_cvt_pk_bf16_f32 v195, v128, v129
    s_sub_u32 s50, s50, 1
    s_cmp_lg_u32 s50, 0
    s_cbranch_scc1 L_at_loop
    s_nop 1
    v_mfma_f32_32x32x16_bf16 v[82:97], v[220:223], v[188:191], v[82:97]
    v_mfma_f32_32x32x16_bf16 v[82:97], v[224:227], v[192:195], v[82:97]
    v_lshlrev_b32 v176, 4, v1
    s_mul_i32 s51, s26, 6144
    v_add_u32 v177, s51, v176
    s_xor_b32 s52, s26, 2
    s_mul_i32 s52, s52, 6144
    v_add_u32 v178, s52, v176
    s_nop 10
    s_cmp_eq_u32 s28, 0
    s_cbranch_scc0 L_at_kh1
    ds_write_b128 v177, v[66:69] offset:0
    ds_write_b128 v177, v[70:73] offset:1024
    ds_write_b128 v177, v[74:77] offset:2048
    ds_write_b128 v177, v[82:85] offset:3072
    ds_write_b128 v177, v[86:89] offset:4096
    ds_write_b128 v177, v[90:93] offset:5120
    s_waitcnt lgkmcnt(0)
    s_barrier
    ds_read_b128 v[98:101], v178 offset:0
    ds_read_b128 v[102:105], v178 offset:1024
    ds_read_b128 v[106:109], v178 offset:2048
    ds_read_b128 v[110:113], v178 offset:3072
    ds_read_b128 v[114:117], v178 offset:4096
    ds_read_b128 v[118:121], v178 offset:5120
    s_waitcnt lgkmcnt(0)
    v_add_f32 v34, v34, v98
    v_add_f32 v35, v35, v99
    v_add_f32 v36, v36, v100
    v_add_f32 v37, v37, v101
    v_add_f32 v38, v38, v102
    v_add_f32 v39, v39, v103
    v_add_f32 v40, v40, v104
    v_add_f32 v41, v41, v105
    v_add_f32 v42, v42, v106
    v_add_f32 v43, v43, v107
    v_add_f32 v44, v44, v108
    v_add_f32 v45, v45, v109
    v_add_f32 v50, v50, v110
    v_add_f32 v51, v51, v111
    v_add_f32 v52, v52, v112
    v_add_f32 v53, v53, v113
    v_add_f32 v54, v54, v114
    v_add_f32 v55, v55, v115
    v_add_f32 v56, v56, v116
    v_add_f32 v57, v57, v117
    v_add_f32 v58, v58, v118
    v_add_f32 v59, v59, v119
    v_add_f32 v60, v60, v120
    v_add_f32 v61, v61, v121
    s_branch L_at_fin
L_at_kh1:
    ds_write_b128 v177, v[34:37] offset:0
    ds_write_b128 v177, v[38:41] offset:1024
    ds_write_b128 v177, v[42:45] offset:2048
    ds_write_b128 v177, v[50:53] offset:3072
    ds_write_b128 v177, v[54:57] offset:4096
    ds_write_b128 v177, v[58:61] offset:5120
    s_waitcnt lgkmcnt(0)
    s_barrier
    ds_read_b128 v[98:101], v178 offset:0
    ds_read_b128 v[102:105], v178 offset:1024
    ds_read_b128 v[106:109], v178 offset:2048
    ds_read_b128 v[110:113], v178 offset:3072
    ds_read_b128 v[114:117], v178 offset:4096
    ds_read_b128 v[118:121], v178 offset:5120
    s_waitcnt lgkmcnt(0)
    v_add_f32 v34, v66, v98
    v_add_f32 v35, v67, v99
    v_add_f32 v36, v68, v100
    v_add_f32 v37, v69, v101
    v_add_f32 v38, v70, v102
    v_add_f32 v39, v71, v103
    v_add_f32 v40, v72, v104
    v_add_f32 v41, v73, v105
    v_add_f32 v42, v74, v106
    v_add_f32 v43, v75, v107
    v_add_f32 v44, v76, v108
    v_add_f32 v45, v77, v109
    v_add_f32 v50, v82, v110
    v_add_f32 v51, v83, v111
    v_add_f32 v52, v84, v112
    v_add_f32 v53, v85, v113
    v_add_f32 v54, v86, v114
    v_add_f32 v55, v87, v115
    v_add_f32 v56, v88, v116
    v_add_f32 v57, v89, v117
    v_add_f32 v58, v90, v118
    v_add_f32 v59, v91, v119
    v_add_f32 v60, v92, v120
    v_add_f32 v61, v93, v121
L_at_fin:
    v_mov_b32 v180, v42
    v_mov_b32 v181, v42
    v_mov_b32 v182, v58
    v_mov_b32 v183, v58
    v_mul_f32 v184, 0, v34
    v_mul_f32 v185, 0, v50
    v_fmac_f32 v184, 0, v35
    v_fmac_f32 v185, 0, v51
    v_fmac_f32 v184, 0, v36
    v_fmac_f32 v185, 0, v52
    v_fmac_f32 v184, 0, v37
    v_fmac_f32 v185, 0, v53
    v_fmac_f32 v184, 0, v38
    v_fmac_f32 v185, 0, v54
    v_fmac_f32 v184, 0, v39
    v_fmac_f32 v185, 0, v55
    v_fmac_f32 v184, 0, v40
    v_fmac_f32 v185, 0, v56
    v_fmac_f32 v184, 0, v41
    v_fmac_f32 v185, 0, v57
    v_fmac_f32 v184, 0, v42
    v_fmac_f32 v185, 0, v58
    v_fmac_f32 v184, 0, v43
    v_fmac_f32 v185, 0, v59
    v_fmac_f32 v184, 0, v44
    v_fmac_f32 v185, 0, v60
    v_fmac_f32 v184, 0, v45
    v_fmac_f32 v185, 0, v61
    v_permlane32_swap_b32 v180, v181
    v_permlane32_swap_b32 v182, v183
    v_add_f32 v184, v184, v185
    v_cmp_u_f32 s[44:45], v184, v184
    v_cmp_nle_f32 vcc, 0x2b800000, v181
    s_or_b64 s[44:45], s[44:45], vcc
    v_cmp_nge_f32 vcc, 0x5d800000, v181
    s_or_b64 s[44:45], s[44:45], vcc
    v_cmp_nle_f32 vcc, 0x2b800000, v183
    s_or_b64 s[44:45], s[44:45], vcc
    v_cmp_nge_f32 vcc, 0x5d800000, v183
    s_or_b64 s[44:45], s[44:45], vcc
    s_cmp_lg_u64 s[44:45], 0
    s_cselect_b32 s44, 1, 0
    v_mov_b32 v184, s44
    s_lshl_b32 s45, s26, 2
    s_add_u32 s45, s45, 24576
    v_mov_b32 v185, s45
    ds_write_b32 v185, v184
    s_branch L_at_store
L_at_verdict:
    v_mov_b32 v185, 24576
    ds_read_b128 v[188:191], v185
    s_waitcnt lgkmcnt(0)
    v_or_b32 v188, v188, v189
    v_or_b32 v190, v190, v191
    v_or_b32 v188, v188, v190
    s_nop 0
    v_readfirstlane_b32 s44, v188
    s_cmp_eq_u32 s44, 0
    s_cbranch_scc1 L_at_done
    s_cmp_lg_u32 s55, 0
    s_cbranch_scc1 L_at_done
    s_waitcnt vmcnt(0)
    v_mov_b32 v34, 0xff800000
    v_mov_b32 v35, 0xff800000
    v_mov_b32 v36, 0xff800000
    v_mov_b32 v37, 0xff800000
    s_mov_b32 s48, s54
    s_mov_b32 s49, s53
    s_mov_b32 s50, 32
L_at_maxloop:
    buffer_load_dwordx4 v[138:141], v170, s[8:11], s48 offen sc1
    s_mov_b32 exec_hi, 0
    buffer_load_dwordx4 v[142:145], v172, s[8:11], s49 offen sc1
    s_mov_b32 exec_hi, -1
    s_add_u32 s48, s48, 512
    s_add_u32 s49, s49, 512
    s_waitcnt vmcnt(0)
    v_mfma_f32_32x32x16_bf16 v[98:113], v[138:141], v[2:5], 0
    v_mfma_f32_32x32x16_bf16 v[98:113], v[142:145], v[18:21], v[98:113]
    s_nop 15
    s_nop 3
    v_max_f32 v34, v34, v98
    v_max_f32 v34, v34, v99
    v_max_f32 v34, v34, v100
    v_max_f32 v34, v34, v101
    v_max_f32 v34, v34, v102
    v_max_f32 v34, v34, v103
    v_max_f32 v34, v34, v104
    v_max_f32 v34, v34, v105
    v_max_f32 v34, v34, v106
    v_max_f32 v34, v34, v107
    v_max_f32 v34, v34, v108
    v_max_f32 v34, v34, v109
    v_max_f32 v34, v34, v110
    v_max_f32 v34, v34, v111
    v_max_f32 v34, v34, v112
    v_max_f32 v34, v34, v113
    s_nop 3
    v_mfma_f32_32x32x16_bf16 v[98:113], v[138:141], v[6:9], 0
    v_mfma_f32_32x32x16_bf16 v[98:113], v[142:145], v[22:25], v[98:113]
    s_nop 15
    s_nop 3
    v_max_f32 v35, v35, v98
    v_max_f32 v35, v35, v99
    v_max_f32 v35, v35, v100
    v_max_f32 v35, v35, v101
    v_max_f32 v35, v35, v102
    v_max_f32 v35, v35, v103
    v_max_f32 v35, v35, v104
    v_max_f32 v35, v35, v105
    v_max_f32 v35, v35, v106
    v_max_f32 v35, v35, v107
    v_max_f32 v35, v35, v108
    v_max_f32 v35, v35, v109
    v_max_f32 v35, v35, v110
    v_max_f32 v35, v35, v111
    v_max_f32 v35, v35, v112
    v_max_f32 v35, v35, v113
    s_nop 3
    v_mfma_f32_32x32x16_bf16 v[98:113], v[138:141], v[10:13], 0
    v_mfma_f32_32x32x16_bf16 v[98:113], v[142:145], v[26:29], v[98:113]
    s_nop 15
    s_nop 3
    v_max_f32 v36, v36, v98
    v_max_f32 v36, v36, v99
    v_max_f32 v36, v36, v100
    v_max_f32 v36, v36, v101
    v_max_f32 v36, v36, v102
    v_max_f32 v36, v36, v103
    v_max_f32 v36, v36, v104
    v_max_f32 v36, v36, v105
    v_max_f32 v36, v36, v106
    v_max_f32 v36, v36, v107
    v_max_f32 v36, v36, v108
    v_max_f32 v36, v36, v109
    v_max_f32 v36, v36, v110
    v_max_f32 v36, v36, v111
    v_max_f32 v36, v36, v112
    v_max_f32 v36, v36, v113
    s_nop 3
    v_mfma_f32_32x32x16_bf16 v[98:113], v[138:141], v[14:17], 0
    v_mfma_f32_32x32x16_bf16 v[98:113], v[142:145], v[30:33], v[98:113]
    s_nop 15
    s_nop 3
    v_max_f32 v37, v37, v98
    v_max_f32 v37, v37, v99
    v_max_f32 v37, v37, v100
    v_max_f32 v37, v37, v101
    v_max_f32 v37, v37, v102
    v_max_f32 v37, v37, v103
    v_max_f32 v37, v37, v104
    v_max_f32 v37, v37, v105
    v_max_f32 v37, v37, v106
    v_max_f32 v37, v37, v107
    v_max_f32 v37, v37, v108
    v_max_f32 v37, v37, v109
    v_max_f32 v37, v37, v110
    v_max_f32 v37, v37, v111
    v_max_f32 v37, v37, v112
    v_max_f32 v37, v37, v113
    s_nop 3
    s_sub_u32 s50, s50, 1
    s_cmp_lg_u32 s50, 0
    s_cbranch_scc1 L_at_maxloop
    v_mov_b32 v180, v34
    v_mov_b32 v181, v34
    s_nop 1
    v_permlane32_swap_b32 v180, v181
    s_nop 1
    v_max_f32 v34, v180, v181
    v_mov_b32 v180, v35
    v_mov_b32 v181, v35
    s_nop 1
    v_permlane32_swap_b32 v180, v181
    s_nop 1
    v_max_f32 v35, v180, v181
    v_mov_b32 v180, v36
    v_mov_b32 v181, v36
    s_nop 1
    v_permlane32_swap_b32 v180, v181
    s_nop 1
    v_max_f32 v36, v180, v181
    v_mov_b32 v180, v37
    v_mov_b32 v181, v37
    s_nop 1
    v_permlane32_swap_b32 v180, v181
    s_nop 1
    v_max_f32 v37, v180, v181
    s_barrier
    s_mul_i32 s51, s26, 6144
    s_xor_b32 s52, s26, 2
    s_mul_i32 s52, s52, 6144
    v_lshlrev_b32 v176, 2, v1
    v_add_u32 v177, s51, v176
    v_add_u32 v178, s52, v176
    ds_write_b32 v177, v34 offset:0
    ds_write_b32 v177, v35 offset:256
    ds_write_b32 v177, v36 offset:512
    ds_write_b32 v177, v37 offset:768
    s_waitcnt lgkmcnt(0)
    s_barrier
    ds_read_b32 v114, v178 offset:0
    ds_read_b32 v115, v178 offset:256
    ds_read_b32 v116, v178 offset:512
    ds_read_b32 v117, v178 offset:768
    s_waitcnt lgkmcnt(0)
    v_max_f32 v34, v34, v114
    v_sub_f32 v180, 0, v34
    v_cvt_pk_bf16_f32 v181, v180, v180
    v_lshlrev_b32 v182, 16, v181
    v_sub_f32 v180, v180, v182
    v_cvt_pk_bf16_f32 v183, v180, v180
    v_lshlrev_b32 v184, 16, v183
    v_sub_f32 v180, v180, v184
    v_cvt_pk_bf16_f32 v185, v180, v180
    v_and_b32 v181, 0xffff, v181
    v_or_b32 v181, v181, v184
    v_and_b32 v185, 0xffff, v185
    s_mov_b32 exec_lo, 0
    v_mov_b32 v18, v181
    v_mov_b32 v19, v185
    s_mov_b32 exec_lo, -1
    v_max_f32 v35, v35, v115
    v_sub_f32 v180, 0, v35
    v_cvt_pk_bf16_f32 v181, v180, v180
    v_lshlrev_b32 v182, 16, v181
    v_sub_f32 v180, v180, v182
    v_cvt_pk_bf16_f32 v183, v180, v180
    v_lshlrev_b32 v184, 16, v183
    v_sub_f32 v180, v180, v184
    v_cvt_pk_bf16_f32 v185, v180, v180
    v_and_b32 v181, 0xffff, v181
    v_or_b32 v181, v181, v184
    v_and_b32 v185, 0xffff, v185
    s_mov_b32 exec_lo, 0
    v_mov_b32 v22, v181
    v_mov_b32 v23, v185
    s_mov_b32 exec_lo, -1
    v_max_f32 v36, v36, v116
    v_sub_f32 v180, 0, v36
    v_cvt_pk_bf16_f32 v181, v180, v180
    v_lshlrev_b32 v182, 16, v181
    v_sub_f32 v180, v180, v182
    v_cvt_pk_bf16_f32 v183, v180, v180
    v_lshlrev_b32 v184, 16, v183
    v_sub_f32 v180, v180, v184
    v_cvt_pk_bf16_f32 v185, v180, v180
    v_and_b32 v181, 0xffff, v181
    v_or_b32 v181, v181, v184
    v_and_b32 v185, 0xffff, v185
    s_mov_b32 exec_lo, 0
    v_mov_b32 v26, v181
    v_mov_b32 v27, v185
    s_mov_b32 exec_lo, -1
    v_max_f32 v37, v37, v117
    v_sub_f32 v180, 0, v37
    v_cvt_pk_bf16_f32 v181, v180, v180
    v_lshlrev_b32 v182, 16, v181
    v_sub_f32 v180, v180, v182
    v_cvt_pk_bf16_f32 v183, v180, v180
    v_lshlrev_b32 v184, 16, v183
    v_sub_f32 v180, v180, v184
    v_cvt_pk_bf16_f32 v185, v180, v180
    v_and_b32 v181, 0xffff, v181
    v_or_b32 v181, v181, v184
    v_and_b32 v185, 0xffff, v185
    s_mov_b32 exec_lo, 0
    v_mov_b32 v30, v181
    v_mov_b32 v31, v185
    s_mov_b32 exec_lo, -1
    s_barrier
    s_mov_b32 s55, 1
    s_branch L_att_pass
L_at_store:
    s_lshl_b32 s51, s28, 1
    s_add_u32 s51, s51, s43
    s_lshl_b32 s51, s51, 8
    s_mul_i32 s52, s40, 81920
    s_add_u32 s51, s51, s52
    v_and_b32 v176, 31, v1
    v_lshrrev_b32 v177, 5, v1
    v_lshlrev_b32 v178, 14, v177
    v_lshl_add_u32 v176, v176, 3, v178
    v_cmp_eq_u32 vcc, 0, v177
    v_mov_b32 v184, 0x7ffffff0
    s_nop 0
    v_cndmask_b32 v179, v184, v176, vcc
    v_rcp_f32 v185, v181
    s_nop 0
    v_mul_f32 v34, v34, v185
    v_mul_f32 v35, v35, v185
    v_mul_f32 v36, v36, v185
    v_mul_f32 v37, v37, v185
    v_mul_f32 v38, v38, v185
    v_mul_f32 v39, v39, v185
    v_mul_f32 v40, v40, v185
    v_mul_f32 v41, v41, v185
    v_mul_f32 v42, v42, v185
    v_mul_f32 v43, v43, v185
    v_mul_f32 v44, v44, v185
    v_mul_f32 v45, v45, v185
    v_cvt_pk_bf16_f32 v114, v34, v35
    v_cvt_pk_bf16_f32 v115, v36, v37
    v_cvt_pk_bf16_f32 v116, v38, v39
    v_cvt_pk_bf16_f32 v117, v40, v41
    v_cvt_pk_bf16_f32 v118, v42, v43
    v_cvt_pk_bf16_f32 v119, v44, v45
    s_add_u32 s30, s51, 0
    buffer_store_dwordx2 v[114:115], v176, s[12:15], s30 offen sc1
    s_add_u32 s30, s51, 32768
    buffer_store_dwordx2 v[116:117], v176, s[12:15], s30 offen sc1
    s_add_u32 s30, s51, 65536
    buffer_store_dwordx2 v[118:119], v179, s[12:15], s30 offen sc1
    v_rcp_f32 v185, v183
    s_nop 0
    v_mul_f32 v50, v50, v185
    v_mul_f32 v51, v51, v185
    v_mul_f32 v52, v52, v185
    v_mul_f32 v53, v53, v185
    v_mul_f32 v54, v54, v185
    v_mul_f32 v55, v55, v185
    v_mul_f32 v56, v56, v185
    v_mul_f32 v57, v57, v185
    v_mul_f32 v58, v58, v185
    v_mul_f32 v59, v59, v185
    v_mul_f32 v60, v60, v185
    v_mul_f32 v61, v61, v185
    v_cvt_pk_bf16_f32 v120, v50, v51
    v_cvt_pk_bf16_f32 v121, v52, v53
    v_cvt_pk_bf16_f32 v122, v54, v55
    v_cvt_pk_bf16_f32 v123, v56, v57
    v_cvt_pk_bf16_f32 v124, v58, v59
    v_cvt_pk_bf16_f32 v125, v60, v61
    s_add_u32 s30, s51, 256
    buffer_store_dwordx2 v[120:121], v176, s[12:15], s30 offen sc1
    s_add_u32 s30, s51, 33024
    buffer_store_dwordx2 v[122:123], v176, s[12:15], s30 offen sc1
    s_add_u32 s30, s51, 65792
    buffer_store_dwordx2 v[124:125], v179, s[12:15], s30 offen sc1
    s_waitcnt vmcnt(0) lgkmcnt(0)
    s_barrier
    s_branch L_at_verdict
L_at_done:
    s_add_u32 s21, s41, 184
    s_cmp_lg_u32 s26, 0
    s_cbranch_scc1 L_ls_19
    v_add_u32 v234, s21, v1
    v_lshlrev_b32 v234, 7, v234
    s_mov_b32 exec_lo, 1
    s_mov_b32 exec_hi, 0
    v_mov_b32 v235, 1
    buffer_atomic_add v235, v234, s[56:59], 0 offen sc1
    s_mov_b64 exec, -1
    s_branch L_ls_19_e
L_ls_19:
    v_mov_b32 v234, 0x7ffffff0
    buffer_store_dword v234, v234, s[56:59], 0 offen
L_ls_19_e:
    s_waitcnt vmcnt(0)
    s_endpgm
L_roleB:
    s_sub_u32 s3, s2, 256
    s_setprio 2
    s_waitcnt lgkmcnt(0)
    s_add_u32 s56, s76, 65536
    s_addc_u32 s57, s77, 0
    s_and_b32 s57, s57, 0xffff
    s_mov_b32 s58, 57344
    s_mov_b32 s59, 0x00020000
    s_cmp_lg_u32 s26, 3
    s_cbranch_scc1 L_cpf_20
    s_getpc_b64 s[30:31]
L_cpf_20_pc:
    s_sub_u32 s30, s30, L_cpf_20_pc - recurrent_scan__softmax_full_mha__glu_gated_glu__prompt_kernel
    s_subb_u32 s31, s31, 0
    s_lshr_b32 s32, s3, 3
    s_mul_i32 s32, s32, 3072
    v_lshlrev_b32 v14, 4, v1
    v_add_u32 v14, s32, v14
    v_min_u32 v15, L_code_end - recurrent_scan__softmax_full_mha__glu_gated_glu__prompt_kernel - 16, v14
    v_mov_b32 v17, s31
    v_add_co_u32 v16, vcc, s30, v15
    s_nop 1
    v_addc_co_u32 v17, vcc, 0, v17, vcc
    global_load_dwordx4 v[20:23], v[16:17], off
    v_add_u32 v14, 1024, v14
    v_min_u32 v15, L_code_end - recurrent_scan__softmax_full_mha__glu_gated_glu__prompt_kernel - 16, v14
    v_mov_b32 v17, s31
    v_add_co_u32 v16, vcc, s30, v15
    s_nop 1
    v_addc_co_u32 v17, vcc, 0, v17, vcc
    global_load_dwordx4 v[24:27], v[16:17], off
    v_add_u32 v14, 1024, v14
    v_min_u32 v15, L_code_end - recurrent_scan__softmax_full_mha__glu_gated_glu__prompt_kernel - 16, v14
    v_mov_b32 v17, s31
    v_add_co_u32 v16, vcc, s30, v15
    s_nop 1
    v_addc_co_u32 v17, vcc, 0, v17, vcc
    global_load_dwordx4 v[28:31], v[16:17], off
    v_add_u32 v14, 1024, v14
L_cpf_20:
    s_cmp_lg_u32 s2, 256
    s_cbranch_scc1 L_zc_21
    v_lshlrev_b32 v14, 7, v0
    v_mov_b32 v15, 0
    buffer_store_dword v15, v14, s[56:59], 0 offen sc1
    v_add_u32 v14, 0x8000, v14
    buffer_store_dword v15, v14, s[56:59], 0 offen sc1
    s_waitcnt vmcnt(0)
    s_barrier
    v_mov_b32 v14, 0
    v_mov_b32 v15, 1
    v_cmp_eq_u32 vcc, 0, v0
    s_and_saveexec_b64 s[30:31], vcc
    s_cbranch_execz L_zc_21_x
    global_store_dword v14, v15, s[74:75] sc1
L_zc_21_x:
    s_mov_b64 exec, s[30:31]
L_zc_21:
    s_cmp_ge_u32 s26, 2
    s_cbranch_scc1 L_b0_22_w
    s_mov_b32 s4, s60
    s_mov_b32 s5, s61
    s_and_b32 s5, s5, 0xffff
    s_mov_b32 s6, 2621440
    s_mov_b32 s7, 0x00020000
    s_mov_b32 s16, s76
    s_mov_b32 s17, s77
    s_and_b32 s17, s17, 0xffff
    s_mov_b32 s18, 65536
    s_mov_b32 s19, 0x00020000
    v_lshrrev_b32 v14, 4, v1
    s_lshl_b32 s30, s3, 3
    s_lshl_b32 s31, s26, 2
    s_add_u32 s30, s30, s31
    v_add_u32 v14, s30, v14
    v_mul_u32_u24 v15, 1280, v14
    v_and_b32 v16, 15, v1
    v_lshl_add_u32 v15, v16, 4, v15
    buffer_load_dwordx4 v[100:103], v15, s[4:7], 0 offen offset:0
    buffer_load_dwordx4 v[104:107], v15, s[4:7], 0 offen offset:256
    buffer_load_dwordx4 v[108:111], v15, s[4:7], 0 offen offset:512
    buffer_load_dwordx4 v[112:115], v15, s[4:7], 0 offen offset:768
    buffer_load_dwordx4 v[116:119], v15, s[4:7], 0 offen offset:1024
    s_waitcnt vmcnt(0)
    s_barrier
    v_lshlrev_b32 v24, 16, v100
    v_and_b32 v25, 0xffff0000, v100
    v_lshlrev_b32 v26, 16, v101
    v_and_b32 v27, 0xffff0000, v101
    v_lshlrev_b32 v28, 16, v102
    v_and_b32 v29, 0xffff0000, v102
    v_lshlrev_b32 v30, 16, v103
    v_and_b32 v31, 0xffff0000, v103
    v_lshlrev_b32 v32, 16, v104
    v_and_b32 v33, 0xffff0000, v104
    v_lshlrev_b32 v34, 16, v105
    v_and_b32 v35, 0xffff0000, v105
    v_lshlrev_b32 v36, 16, v106
    v_and_b32 v37, 0xffff0000, v106
    v_lshlrev_b32 v38, 16, v107
    v_and_b32 v39, 0xffff0000, v107
    v_lshlrev_b32 v40, 16, v108
    v_and_b32 v41, 0xffff0000, v108
    v_lshlrev_b32 v42, 16, v109
    v_and_b32 v43, 0xffff0000, v109
    v_lshlrev_b32 v44, 16, v110
    v_and_b32 v45, 0xffff0000, v110
    v_lshlrev_b32 v46, 16, v111
    v_and_b32 v47, 0xffff0000, v111
    v_lshlrev_b32 v48, 16, v112
    v_and_b32 v49, 0xffff0000, v112
    v_lshlrev_b32 v50, 16, v113
    v_and_b32 v51, 0xffff0000, v113
    v_lshlrev_b32 v52, 16, v114
    v_and_b32 v53, 0xffff0000, v114
    v_lshlrev_b32 v54, 16, v115
    v_and_b32 v55, 0xffff0000, v115
    v_lshlrev_b32 v56, 16, v116
    v_and_b32 v57, 0xffff0000, v116
    v_lshlrev_b32 v58, 16, v117
    v_and_b32 v59, 0xffff0000, v117
    v_lshlrev_b32 v60, 16, v118
    v_and_b32 v61, 0xffff0000, v118
    v_lshlrev_b32 v62, 16, v119
    v_and_b32 v63, 0xffff0000, v119
    v_add_f32 v64, v24, v25
    v_add_f32 v65, v26, v27
    v_add_f32 v64, v64, v28
    v_add_f32 v65, v65, v29
    v_add_f32 v64, v64, v30
    v_add_f32 v65, v65, v31
    v_add_f32 v64, v64, v32
    v_add_f32 v65, v65, v33
    v_add_f32 v64, v64, v34
    v_add_f32 v65, v65, v35
    v_add_f32 v64, v64, v36
    v_add_f32 v65, v65, v37
    v_add_f32 v64, v64, v38
    v_add_f32 v65, v65, v39
    v_add_f32 v64, v64, v40
    v_add_f32 v65, v65, v41
    v_add_f32 v64, v64, v42
    v_add_f32 v65, v65, v43
    v_add_f32 v64, v64, v44
    v_add_f32 v65, v65, v45
    v_add_f32 v64, v64, v46
    v_add_f32 v65, v65, v47
    v_add_f32 v64, v64, v48
    v_add_f32 v65, v65, v49
    v_add_f32 v64, v64, v50
    v_add_f32 v65, v65, v51
    v_add_f32 v64, v64, v52
    v_add_f32 v65, v65, v53
    v_add_f32 v64, v64, v54
    v_add_f32 v65, v65, v55
    v_add_f32 v64, v64, v56
    v_add_f32 v65, v65, v57
    v_add_f32 v64, v64, v58
    v_add_f32 v65, v65, v59
    v_add_f32 v64, v64, v60
    v_add_f32 v65, v65, v61
    v_add_f32 v64, v64, v62
    v_add_f32 v65, v65, v63
    v_add_f32 v64, v64, v65
    s_nop 1
    v_add_f32_dpp v64, v64, v64 row_ror:8 row_mask:0xf bank_mask:0xf
    s_nop 1
    v_add_f32_dpp v64, v64, v64 row_ror:4 row_mask:0xf bank_mask:0xf
    s_nop 1
    v_add_f32_dpp v64, v64, v64 row_ror:2 row_mask:0xf bank_mask:0xf
    s_nop 1
    v_add_f32_dpp v64, v64, v64 row_ror:1 row_mask:0xf bank_mask:0xf
    v_mul_f32 v64, 0x3acccccd, v64
    v_sub_f32 v24, v24, v64
    v_sub_f32 v25, v25, v64
    v_sub_f32 v26, v26, v64
    v_sub_f32 v27, v27, v64
    v_sub_f32 v28, v28, v64
    v_sub_f32 v29, v29, v64
    v_sub_f32 v30, v30, v64
    v_sub_f32 v31, v31, v64
    v_sub_f32 v32, v32, v64
    v_sub_f32 v33, v33, v64
    v_sub_f32 v34, v34, v64
    v_sub_f32 v35, v35, v64
    v_sub_f32 v36, v36, v64
    v_sub_f32 v37, v37, v64
    v_sub_f32 v38, v38, v64
    v_sub_f32 v39, v39, v64
    v_sub_f32 v40, v40, v64
    v_sub_f32 v41, v41, v64
    v_sub_f32 v42, v42, v64
    v_sub_f32 v43, v43, v64
    v_sub_f32 v44, v44, v64
    v_sub_f32 v45, v45, v64
    v_sub_f32 v46, v46, v64
    v_sub_f32 v47, v47, v64
    v_sub_f32 v48, v48, v64
    v_sub_f32 v49, v49, v64
    v_sub_f32 v50, v50, v64
    v_sub_f32 v51, v51, v64
    v_sub_f32 v52, v52, v64
    v_sub_f32 v53, v53, v64
    v_sub_f32 v54, v54, v64
    v_sub_f32 v55, v55, v64
    v_sub_f32 v56, v56, v64
    v_sub_f32 v57, v57, v64
    v_sub_f32 v58, v58, v64
    v_sub_f32 v59, v59, v64
    v_sub_f32 v60, v60, v64
    v_sub_f32 v61, v61, v64
    v_sub_f32 v62, v62, v64
    v_sub_f32 v63, v63, v64
    v_mul_f32 v65, v24, v24
    v_mul_f32 v66, v25, v25
    v_fmac_f32 v65, v26, v26
    v_fmac_f32 v66, v27, v27
    v_fmac_f32 v65, v28, v28
    v_fmac_f32 v66, v29, v29
    v_fmac_f32 v65, v30, v30
    v_fmac_f32 v66, v31, v31
    v_fmac_f32 v65, v32, v32
    v_fmac_f32 v66, v33, v33
    v_fmac_f32 v65, v34, v34
    v_fmac_f32 v66, v35, v35
    v_fmac_f32 v65, v36, v36
    v_fmac_f32 v66, v37, v37
    v_fmac_f32 v65, v38, v38
    v_fmac_f32 v66, v39, v39
    v_fmac_f32 v65, v40, v40
    v_fmac_f32 v66, v41, v41
    v_fmac_f32 v65, v42, v42
    v_fmac_f32 v66, v43, v43
    v_fmac_f32 v65, v44, v44
    v_fmac_f32 v66, v45, v45
    v_fmac_f32 v65, v46, v46
    v_fmac_f32 v66, v47, v47
    v_fmac_f32 v65, v48, v48
    v_fmac_f32 v66, v49, v49
    v_fmac_f32 v65, v50, v50
    v_fmac_f32 v66, v51, v51
    v_fmac_f32 v65, v52, v52
    v_fmac_f32 v66, v53, v53
    v_fmac_f32 v65, v54, v54
    v_fmac_f32 v66, v55, v55
    v_fmac_f32 v65, v56, v56
    v_fmac_f32 v66, v57, v57
    v_fmac_f32 v65, v58, v58
    v_fmac_f32 v66, v59, v59
    v_fmac_f32 v65, v60, v60
    v_fmac_f32 v66, v61, v61
    v_fmac_f32 v65, v62, v62
    v_fmac_f32 v66, v63, v63
    v_add_f32 v65, v65, v66
    s_nop 1
    v_add_f32_dpp v65, v65, v65 row_ror:8 row_mask:0xf bank_mask:0xf
    s_nop 1
    v_add_f32_dpp v65, v65, v65 row_ror:4 row_mask:0xf bank_mask:0xf
    s_nop 1
    v_add_f32_dpp v65, v65, v65 row_ror:2 row_mask:0xf bank_mask:0xf
    s_nop 1
    v_add_f32_dpp v65, v65, v65 row_ror:1 row_mask:0xf bank_mask:0xf
    v_mov_b32 v67, 0x3727c5ac
    v_fmac_f32 v67, 0x3acccccd, v65
    v_rsq_f32 v67, v67
    s_nop 0
    v_mul_f32 v66, v64, v67
    v_lshlrev_b32 v14, 3, v14
    v_cmp_eq_u32 vcc, 0, v16
    v_mov_b32 v15, 0x7ffffff0
    s_nop 0
    v_cndmask_b32 v14, v15, v14, vcc
    buffer_store_dwordx2 v[66:67], v14, s[16:19], 0 offen sc1
    s_cmp_lg_u32 s78, 0
    s_cbranch_scc1 L_rdyd_24
    v_mov_b32 v238, 0
    s_mov_b32 s30, 0x40000
L_rdy_23:
    global_load_dword v239, v238, s[74:75] sc1
    s_waitcnt vmcnt(0)
    v_readfirstlane_b32 s78, v239
    s_cmp_lg_u32 s78, 0
    s_cbranch_scc1 L_rdyd_24
    s_sleep 4
    s_sub_u32 s30, s30, 1
    s_cmp_lg_u32 s30, 0
    s_cbranch_scc1 L_rdy_23
L_rdyd_24:
    s_lshr_b32 s30, s3, 4
    s_lshl_b32 s30, s30, 3
    s_add_u32 s30, s30, 40
    v_add_u32 v14, s30, v1
    v_lshlrev_b32 v14, 7, v14
    v_mov_b32 v15, 1
    s_waitcnt vmcnt(0)
    s_mov_b32 exec_lo, 0xff
    s_mov_b32 exec_hi, 0
    buffer_atomic_add v15, v14, s[56:59], 0 offen sc1
    s_mov_b64 exec, -1
    s_branch L_b0_22_e
L_b0_22_w:
    s_barrier
L_b0_22_e:
    s_waitcnt vmcnt(0)
    s_add_u32 s50, s3, 192
    s_cmp_lg_u32 s26, 0
    s_cbranch_scc1 L_wcd_26
    s_lshl_b32 s31, s50, 7
    v_mov_b32 v238, s31
    s_mov_b32 exec_lo, 1
    s_mov_b32 exec_hi, 0
    s_mov_b32 s30, 0x40000
L_wc_25:
    buffer_load_dword v239, v238, s[56:59], 0 offen sc1
    s_waitcnt vmcnt(0)
    v_cmp_gt_u32 vcc, 1, v239
    s_nop 4
    s_cbranch_vccz L_wcd_26_x
    s_sleep 8
    s_sub_u32 s30, s30, 1
    s_cmp_lg_u32 s30, 0
    s_cbranch_scc1 L_wc_25
L_wcd_26_x:
    s_mov_b64 exec, -1
L_wcd_26:
    s_barrier
    s_mov_b32 s35, 0x100000
    s_and_b32 s40, s3, 7
    s_lshr_b32 s41, s3, 3
    s_add_u32 s41, s41, 32
    s_lshr_b32 s42, s40, 2
    s_and_b32 s43, s40, 3
    s_lshr_b32 s45, s41, 3
    s_cmp_eq_u32 s43, 3
    s_cselect_b32 s46, 6, 7
    s_cmp_ge_u32 s45, s46
    s_cbranch_scc1 L_gu_27_done
    s_mov_b32 s4, s60
    s_mov_b32 s5, s61
    s_and_b32 s5, s5, 0xffff
    s_mov_b32 s6, 2621440
    s_mov_b32 s7, 0x00020000
    s_mov_b32 s8, s66
    s_mov_b32 s9, s67
    s_and_b32 s9, s9, 0xffff
    s_mov_b32 s10, 2211840
    s_mov_b32 s11, 0x00020000
    s_mov_b32 s12, s68
    s_mov_b32 s13, s69
    s_and_b32 s13, s13, 0xffff
    s_mov_b32 s14, 2211840
    s_mov_b32 s15, 0x00020000
    s_mov_b32 s16, s76
    s_mov_b32 s17, s77
    s_and_b32 s17, s17, 0xffff
    s_mov_b32 s18, 65536
    s_mov_b32 s19, 0x00020000
    s_mul_i32 s46, s43, 7
    s_add_u32 s45, s45, s46
    s_lshl_b32 s44, s42, 3
    s_and_b32 s46, s41, 7
    s_add_u32 s44, s44, s46
    s_mul_i32 s20, s44, 163840
    s_lshl_b32 s21, s45, 7
    s_lshr_b32 s46, s41, 3
    s_mul_i32 s46, s46, 3
    s_and_b32 s25, s41, 7
    s_mul_i32 s25, s25, 1
    s_add_u32 s46, s46, s25
    s_mul_i32 s25, s46, 6554
    s_lshr_b32 s25, s25, 16
    s_mul_i32 s25, s25, 10
    s_sub_u32 s46, s46, s25
    s_mov_b32 s36, s20
    s_add_u32 s37, s20, 1280
    s_mul_i32 s25, s46, 128
    s_add_u32 s20, s20, s25
    s_mov_b32 s38, s21
    s_add_u32 s39, s21, 2211840
    s_mul_i32 s25, s46, 221184
    s_add_u32 s21, s21, s25
    v_lshrrev_b32 v14, 3, v1
    s_lshl_b32 s25, s26, 3
    v_add_u32 v14, s25, v14
    v_lshrrev_b32 v15, 4, v1
    s_lshl_b32 s25, s28, 2
    v_add_u32 v16, s25, v15
    v_and_b32 v17, 7, v1
    v_xor_b32 v16, v16, v17
    v_lshlrev_b32 v16, 4, v16
    s_mov_b32 s25, 1280
    v_mad_u32_u24 v2, v14, s25, v16
    v_and_b32 v15, 1, v15
    v_lshlrev_b32 v15, 2, v15
    v_xor_b32 v16, v15, v17
    v_lshlrev_b32 v16, 4, v16
    s_mov_b32 s25, 3456
    v_mad_u32_u24 v3, v14, s25, v16
    s_add_u32 m0, s23, 0
    s_add_u32 s25, s20, 0
    buffer_load_dwordx4 v2, s[4:7], s25 offen lds
    s_add_u32 m0, s23, 4096
    s_add_u32 s25, s20, 40960
    buffer_load_dwordx4 v2, s[4:7], s25 offen lds
    s_add_u32 m0, s23, 8192
    s_add_u32 s25, s20, 81920
    buffer_load_dwordx4 v2, s[4:7], s25 offen lds
    s_add_u32 m0, s23, 12288
    s_add_u32 s25, s20, 122880
    buffer_load_dwordx4 v2, s[4:7], s25 offen lds
    s_add_u32 s20, s20, 128
    s_cmp_eq_u32 s20, s37
    s_cselect_b32 s20, s36, s20
    s_add_u32 m0, s23, 16384
    s_add_u32 s25, s21, 0
    buffer_load_dwordx4 v3, s[8:11], s25 offen lds
    s_add_u32 m0, s23, 20480
    s_add_u32 s25, s21, 110592
    buffer_load_dwordx4 v3, s[8:11], s25 offen lds
    s_add_u32 m0, s23, 24576
    s_add_u32 s25, s21, 0
    buffer_load_dwordx4 v3, s[12:15], s25 offen lds
    s_add_u32 m0, s23, 28672
    s_add_u32 s25, s21, 110592
    buffer_load_dwordx4 v3, s[12:15], s25 offen lds
    s_add_u32 s21, s21, 221184
    s_cmp_eq_u32 s21, s39
    s_cselect_b32 s21, s38, s21
    v_and_b32 v14, 31, v1
    v_lshrrev_b32 v15, 5, v1
    v_bfe_u32 v16, v14, 1, 3
    v_xor_b32 v16, v16, v15
    s_mul_i32 s25, s27, 64
    v_add_u32 v17, s25, v14
    v_lshlrev_b32 v17, 7, v17
    v_xor_b32 v18, 0, v16
    v_lshl_add_u32 v4, v18, 4, v17
    v_add_u32 v8, 0x10000, v4
    v_xor_b32 v18, 2, v16
    v_lshl_add_u32 v5, v18, 4, v17
    v_add_u32 v9, 0x10000, v5
    v_xor_b32 v18, 4, v16
    v_lshl_add_u32 v6, v18, 4, v17
    v_add_u32 v10, 0x10000, v6
    v_xor_b32 v18, 6, v16
    v_lshl_add_u32 v7, v18, 4, v17
    v_add_u32 v11, 0x10000, v7
    v_lshrrev_b32 v14, 4, v1
    v_and_b32 v15, 1, v14
    v_lshrrev_b32 v14, 1, v14
    v_and_b32 v16, 15, v1
    v_lshrrev_b32 v17, 2, v16
    v_lshl_add_u32 v17, v14, 3, v17
    v_lshlrev_b32 v17, 7, v17
    v_bfe_u32 v18, v16, 1, 1
    v_lshl_add_u32 v18, v15, 1, v18
    s_lshl_b32 s25, s28, 2
    v_add_u32 v18, s25, v18
    v_bfe_u32 v19, v16, 3, 1
    v_lshlrev_b32 v19, 2, v19
    v_xor_b32 v18, v18, v19
    v_lshl_add_u32 v17, v18, 4, v17
    v_and_b32 v19, 1, v16
    v_lshl_add_u32 v12, v19, 3, v17
    s_lshl_b32 s25, s27, 13
    v_add_u32 v228, s25, v12
    s_xor_b32 s25, s25, 0x2000
    v_add_u32 v230, s25, v12
    v_add_u32 v229, 0x10000, v228
    v_add_u32 v231, 0x10000, v230
    v_and_b32 v14, 15, v1
    v_bfe_u32 v15, v1, 4, 1
    v_cmp_eq_u32 vcc, v14, v15
    v_mov_b32 v16, 0x3f803f80
    s_nop 0
    v_cndmask_b32 v224, 0, v16, vcc
    v_mov_b32 v225, v224
    v_mov_b32 v226, v224
    v_mov_b32 v227, v224
    s_lshl_b32 s46, s44, 7
    s_setprio 2
    s_waitcnt vmcnt(0)
    s_barrier
    ds_read_b128 v[32:35], v4 offset:0
    ds_read_b128 v[36:39], v4 offset:4096
    ds_read_b64_tr_b16 v[40:41], v228 offset:16384
    ds_read_b64_tr_b16 v[42:43], v228 offset:16896
    ds_read_b64_tr_b16 v[44:45], v230 offset:16384
    ds_read_b64_tr_b16 v[46:47], v230 offset:16896
    ds_read_b128 v[48:51], v5 offset:0
    ds_read_b128 v[52:55], v5 offset:4096
    ds_read_b64_tr_b16 v[56:57], v228 offset:18432
    ds_read_b64_tr_b16 v[58:59], v228 offset:18944
    ds_read_b64_tr_b16 v[60:61], v230 offset:18432
    ds_read_b64_tr_b16 v[62:63], v230 offset:18944
    s_waitcnt lgkmcnt(6)
    v_mfma_f32_32x32x16_bf16 v[64:79], v[40:43], v[32:35], 0
    ds_read_b128 v[240:243], v6 offset:0
    ds_read_b128 v[244:247], v6 offset:4096
    s_add_u32 m0, s23, 32768
    s_add_u32 s25, s20, 0
    buffer_load_dwordx4 v2, s[4:7], s25 offen lds
    v_mfma_f32_32x32x16_bf16 v[80:95], v[44:47], v[32:35], 0
    ds_read_b64_tr_b16 v[248:249], v228 offset:20480
    s_add_u32 m0, s23, 36864
    s_add_u32 s25, s20, 40960
    buffer_load_dwordx4 v2, s[4:7], s25 offen lds
    v_mfma_f32_16x16x32_bf16 v[208:211], v[40:43], v[224:227], 0
    ds_read_b64_tr_b16 v[250:251], v228 offset:20992
    s_add_u32 m0, s23, 40960
    s_add_u32 s25, s20, 81920
    buffer_load_dwordx4 v2, s[4:7], s25 offen lds
    v_mfma_f32_32x32x16_bf16 v[96:111], v[40:43], v[36:39], 0
    ds_read_b64_tr_b16 v[252:253], v230 offset:20480
    s_add_u32 m0, s23, 45056
    s_add_u32 s25, s20, 122880
    buffer_load_dwordx4 v2, s[4:7], s25 offen lds
    s_add_u32 s20, s20, 128
    s_cmp_eq_u32 s20, s37
    s_cselect_b32 s20, s36, s20
    v_mfma_f32_32x32x16_bf16 v[112:127], v[44:47], v[36:39], 0
    ds_read_b64_tr_b16 v[254:255], v230 offset:20992
    s_add_u32 m0, s23, 49152
    s_add_u32 s25, s21, 0
    buffer_load_dwordx4 v3, s[8:11], s25 offen lds
    s_add_u32 m0, s23, 53248
    s_add_u32 s25, s21, 110592
    buffer_load_dwordx4 v3, s[8:11], s25 offen lds
    s_waitcnt lgkmcnt(6)
    v_mfma_f32_32x32x16_bf16 v[64:79], v[56:59], v[48:51], v[64:79]
    ds_read_b128 v[32:35], v7 offset:0
    ds_read_b128 v[36:39], v7 offset:4096
    s_add_u32 m0, s23, 57344
    s_add_u32 s25, s21, 0
    buffer_load_dwordx4 v3, s[12:15], s25 offen lds
    v_mfma_f32_32x32x16_bf16 v[80:95], v[60:63], v[48:51], v[80:95]
    ds_read_b64_tr_b16 v[40:41], v228 offset:22528
    s_add_u32 m0, s23, 61440
    s_add_u32 s25, s21, 110592
    buffer_load_dwordx4 v3, s[12:15], s25 offen lds
    s_add_u32 s21, s21, 221184
    s_cmp_eq_u32 s21, s39
    s_cselect_b32 s21, s38, s21
    v_mfma_f32_16x16x32_bf16 v[208:211], v[56:59], v[224:227], v[208:211]
    ds_read_b64_tr_b16 v[42:43], v228 offset:23040
    s_add_u32 m0, s23, 65536
    s_add_u32 s25, s20, 0
    buffer_load_dwordx4 v2, s[4:7], s25 offen lds
    v_mfma_f32_32x32x16_bf16 v[96:111], v[56:59], v[52:55], v[96:111]
    ds_read_b64_tr_b16 v[44:45], v230 offset:22528
    s_add_u32 m0, s23, 69632
    s_add_u32 s25, s20, 40960
    buffer_load_dwordx4 v2, s[4:7], s25 offen lds
    v_mfma_f32_32x32x16_bf16 v[112:127], v[60:63], v[52:55], v[112:127]
    ds_read_b64_tr_b16 v[46:47], v230 offset:23040
    s_add_u32 m0, s23, 73728
    s_add_u32 s25, s20, 81920
    buffer_load_dwordx4 v2, s[4:7], s25 offen lds
    s_add_u32 m0, s23, 77824
    s_add_u32 s25, s20, 122880
    buffer_load_dwordx4 v2, s[4:7], s25 offen lds
    s_add_u32 s20, s20, 128
    s_cmp_eq_u32 s20, s37
    s_cselect_b32 s20, s36, s20
    s_waitcnt lgkmcnt(6)
    v_mfma_f32_32x32x16_bf16 v[64:79], v[248:251], v[240:243], v[64:79]
    v_mfma_f32_32x32x16_bf16 v[80:95], v[252:255], v[240:243], v[80:95]
    s_waitcnt vmcnt(4) lgkmcnt(0)
    s_barrier
    ds_read_b128 v[48:51], v4 offset:32768
    ds_read_b128 v[52:55], v4 offset:36864
    v_mfma_f32_16x16x32_bf16 v[208:211], v[248:251], v[224:227], v[208:211]
    ds_read_b64_tr_b16 v[56:57], v228 offset:49152
    s_add_u32 m0, s23, 0
    s_add_u32 s25, s21, 0
    buffer_load_dwordx4 v3, s[8:11], s25 offen lds
    v_mfma_f32_32x32x16_bf16 v[96:111], v[248:251], v[244:247], v[96:111]
    ds_read_b64_tr_b16 v[58:59], v228 offset:49664
    ds_read_b64_tr_b16 v[60:61], v230 offset:49152
    v_mfma_f32_32x32x16_bf16 v[112:127], v[252:255], v[244:247], v[112:127]
    ds_read_b64_tr_b16 v[62:63], v230 offset:49664
    s_add_u32 m0, s23, 4096
    s_add_u32 s25, s21, 110592
    buffer_load_dwordx4 v3, s[8:11], s25 offen lds
    s_waitcnt lgkmcnt(6)
    v_mfma_f32_32x32x16_bf16 v[64:79], v[40:43], v[32:35], v[64:79]
    ds_read_b128 v[240:243], v5 offset:32768
    ds_read_b128 v[244:247], v5 offset:36864
    v_mfma_f32_32x32x16_bf16 v[80:95], v[44:47], v[32:35], v[80:95]
    ds_read_b64_tr_b16 v[248:249], v228 offset:51200
    v_mfma_f32_16x16x32_bf16 v[208:211], v[40:43], v[224:227], v[208:211]
    ds_read_b64_tr_b16 v[250:251], v228 offset:51712
    s_add_u32 m0, s23, 8192
    s_add_u32 s25, s21, 0
    buffer_load_dwordx4 v3, s[12:15], s25 offen lds
    v_mfma_f32_32x32x16_bf16 v[96:111], v[40:43], v[36:39], v[96:111]
    ds_read_b64_tr_b16 v[252:253], v230 offset:51200
    v_mfma_f32_32x32x16_bf16 v[112:127], v[44:47], v[36:39], v[112:127]
    ds_read_b64_tr_b16 v[254:255], v230 offset:51712
    s_add_u32 m0, s23, 12288
    s_add_u32 s25, s21, 110592
    buffer_load_dwordx4 v3, s[12:15], s25 offen lds
    s_add_u32 s21, s21, 221184
    s_cmp_eq_u32 s21, s39
    s_cselect_b32 s21, s38, s21
    s_waitcnt lgkmcnt(6)
    v_mfma_f32_32x32x16_bf16 v[64:79], v[56:59], v[48:51], v[64:79]
    ds_read_b128 v[32:35], v6 offset:32768
    ds_read_b128 v[36:39], v6 offset:36864
    v_mfma_f32_32x32x16_bf16 v[80:95], v[60:63], v[48:51], v[80:95]
    ds_read_b64_tr_b16 v[40:41], v228 offset:53248
    v_mfma_f32_16x16x32_bf16 v[208:211], v[56:59], v[224:227], v[208:211]
    ds_read_b64_tr_b16 v[42:43], v228 offset:53760
    s_add_u32 m0, s23, 16384
    s_add_u32 s25, s20, 0
    buffer_load_dwordx4 v2, s[4:7], s25 offen lds
    v_mfma_f32_32x32x16_bf16 v[96:111], v[56:59], v[52:55], v[96:111]
    ds_read_b64_tr_b16 v[44:45], v230 offset:53248
    v_mfma_f32_32x32x16_bf16 v[112:127], v[60:63], v[52:55], v[112:127]
    ds_read_b64_tr_b16 v[46:47], v230 offset:53760
    s_add_u32 m0, s23, 20480
    s_add_u32 s25, s20, 40960
    buffer_load_dwordx4 v2, s[4:7], s25 offen lds
    s_waitcnt lgkmcnt(6)
    v_mfma_f32_32x32x16_bf16 v[64:79], v[248:251], v[240:243], v[64:79]
    ds_read_b128 v[48:51], v7 offset:32768
    ds_read_b128 v[52:55], v7 offset:36864
    v_mfma_f32_32x32x16_bf16 v[80:95], v[252:255], v[240:243], v[80:95]
    ds_read_b64_tr_b16 v[56:57], v228 offset:55296
    v_mfma_f32_16x16x32_bf16 v[208:211], v[248:251], v[224:227], v[208:211]
    ds_read_b64_tr_b16 v[58:59], v228 offset:55808
    s_add_u32 m0, s23, 24576
    s_add_u32 s25, s20, 81920
    buffer_load_dwordx4 v2, s[4:7], s25 offen lds
    v_mfma_f32_32x32x16_bf16 v[96:111], v[248:251], v[244:247], v[96:111]
    ds_read_b64_tr_b16 v[60:61], v230 offset:55296
    v_mfma_f32_32x32x16_bf16 v[112:127], v[252:255], v[244:247], v[112:127]
    ds_read_b64_tr_b16 v[62:63], v230 offset:55808
    s_add_u32 m0, s23, 28672
    s_add_u32 s25, s20, 122880
    buffer_load_dwordx4 v2, s[4:7], s25 offen lds
    s_add_u32 s20, s20, 128
    s_cmp_eq_u32 s20, s37
    s_cselect_b32 s20, s36, s20
    s_waitcnt lgkmcnt(6)
    v_mfma_f32_32x32x16_bf16 v[64:79], v[40:43], v[32:35], v[64:79]
    v_mfma_f32_32x32x16_bf16 v[80:95], v[44:47], v[32:35], v[80:95]
    s_waitcnt vmcnt(4) lgkmcnt(0)
    s_barrier
    ds_read_b128 v[240:243], v8 offset:0
    ds_read_b128 v[244:247], v8 offset:4096
    v_mfma_f32_16x16x32_bf16 v[208:211], v[40:43], v[224:227], v[208:211]
    ds_read_b64_tr_b16 v[248:249], v228 offset:0
    s_add_u32 m0, s23, 32768
    s_add_u32 s25, s21, 0
    buffer_load_dwordx4 v3, s[8:11], s25 offen lds
    v_mfma_f32_32x32x16_bf16 v[96:111], v[40:43], v[36:39], v[96:111]
    ds_read_b64_tr_b16 v[250:251], v228 offset:512
    ds_read_b64_tr_b16 v[252:253], v230 offset:0
    v_mfma_f32_32x32x16_bf16 v[112:127], v[44:47], v[36:39], v[112:127]
    ds_read_b64_tr_b16 v[254:255], v230 offset:512
    s_add_u32 m0, s23, 36864
    s_add_u32 s25, s21, 110592
    buffer_load_dwordx4 v3, s[8:11], s25 offen lds
    s_waitcnt lgkmcnt(6)
    v_mfma_f32_32x32x16_bf16 v[64:79], v[56:59], v[48:51], v[64:79]
    ds_read_b128 v[32:35], v9 offset:0
    ds_read_b128 v[36:39], v9 offset:4096
    v_mfma_f32_32x32x16_bf16 v[80:95], v[60:63], v[48:51], v[80:95]
    ds_read_b64_tr_b16 v[40:41], v228 offset:2048
    v_mfma_f32_16x16x32_bf16 v[208:211], v[56:59], v[224:227], v[208:211]
    ds_read_b64_tr_b16 v[42:43], v228 offset:2560
    s_add_u32 m0, s23, 40960
    s_add_u32 s25, s21, 0
    buffer_load_dwordx4 v3, s[12:15], s25 offen lds
    v_mfma_f32_32x32x16_bf16 v[96:111], v[56:59], v[52:55], v[96:111]
    ds_read_b64_tr_b16 v[44:45], v230 offset:2048
    v_mfma_f32_32x32x16_bf16 v[112:127], v[60:63], v[52:55], v[112:127]
    ds_read_b64_tr_b16 v[46:47], v230 offset:2560
    s_add_u32 m0, s23, 45056
    s_add_u32 s25, s21, 110592
    buffer_load_dwordx4 v3, s[12:15], s25 offen lds
    s_add_u32 s21, s21, 221184
    s_cmp_eq_u32 s21, s39
    s_cselect_b32 s21, s38, s21
    s_waitcnt lgkmcnt(6)
    v_mfma_f32_32x32x16_bf16 v[64:79], v[248:251], v[240:243], v[64:79]
    ds_read_b128 v[48:51], v10 offset:0
    ds_read_b128 v[52:55], v10 offset:4096
    v_mfma_f32_32x32x16_bf16 v[80:95], v[252:255], v[240:243], v[80:95]
    ds_read_b64_tr_b16 v[56:57], v228 offset:4096
    v_mfma_f32_16x16x32_bf16 v[208:211], v[248:251], v[224:227], v[208:211]
    ds_read_b64_tr_b16 v[58:59], v228 offset:4608
    s_add_u32 m0, s23, 49152
    s_add_u32 s25, s20, 0
    buffer_load_dwordx4 v2, s[4:7], s25 offen lds
    v_mfma_f32_32x32x16_bf16 v[96:111], v[248:251], v[244:247], v[96:111]
    ds_read_b64_tr_b16 v[60:61], v230 offset:4096
    v_mfma_f32_32x32x16_bf16 v[112:127], v[252:255], v[244:247], v[112:127]
    ds_read_b64_tr_b16 v[62:63], v230 offset:4608
    s_add_u32 m0, s23, 53248
    s_add_u32 s25, s20, 40960
    buffer_load_dwordx4 v2, s[4:7], s25 offen lds
    s_waitcnt lgkmcnt(6)
    v_mfma_f32_32x32x16_bf16 v[64:79], v[40:43], v[32:35], v[64:79]
    ds_read_b128 v[240:243], v11 offset:0
    ds_read_b128 v[244:247], v11 offset:4096
    v_mfma_f32_32x32x16_bf16 v[80:95], v[44:47], v[32:35], v[80:95]
    ds_read_b64_tr_b16 v[248:249], v228 offset:6144
    v_mfma_f32_16x16x32_bf16 v[208:211], v[40:43], v[224:227], v[208:211]
    ds_read_b64_tr_b16 v[250:251], v228 offset:6656
    s_add_u32 m0, s23, 57344
    s_add_u32 s25, s20, 81920
    buffer_load_dwordx4 v2, s[4:7], s25 offen lds
    v_mfma_f32_32x32x16_bf16 v[96:111], v[40:43], v[36:39], v[96:111]
    ds_read_b64_tr_b16 v[252:253], v230 offset:6144
    v_mfma_f32_32x32x16_bf16 v[112:127], v[44:47], v[36:39], v[112:127]
    ds_read_b64_tr_b16 v[254:255], v230 offset:6656
    s_add_u32 m0, s23, 61440
    s_add_u32 s25, s20, 122880
    buffer_load_dwordx4 v2, s[4:7], s25 offen lds
    s_add_u32 s20, s20, 128
    s_cmp_eq_u32 s20, s37
    s_cselect_b32 s20, s36, s20
    s_waitcnt lgkmcnt(6)
    v_mfma_f32_32x32x16_bf16 v[64:79], v[56:59], v[48:51], v[64:79]
    v_mfma_f32_32x32x16_bf16 v[80:95], v[60:63], v[48:51], v[80:95]
    s_waitcnt vmcnt(4) lgkmcnt(0)
    s_barrier
    ds_read_b128 v[32:35], v4 offset:16384
    ds_read_b128 v[36:39], v4 offset:20480
    v_mfma_f32_16x16x32_bf16 v[208:211], v[56:59], v[224:227], v[208:211]
    ds_read_b64_tr_b16 v[40:41], v228 offset:32768
    s_add_u32 m0, s23, 65536
    s_add_u32 s25, s21, 0
    buffer_load_dwordx4 v3, s[8:11], s25 offen lds
    v_mfma_f32_32x32x16_bf16 v[96:111], v[56:59], v[52:55], v[96:111]
    ds_read_b64_tr_b16 v[42:43], v228 offset:33280
    ds_read_b64_tr_b16 v[44:45], v230 offset:32768
    v_mfma_f32_32x32x16_bf16 v[112:127], v[60:63], v[52:55], v[112:127]
    ds_read_b64_tr_b16 v[46:47], v230 offset:33280
    s_add_u32 m0, s23, 69632
    s_add_u32 s25, s21, 110592
    buffer_load_dwordx4 v3, s[8:11], s25 offen lds
    s_waitcnt lgkmcnt(6)
    v_mfma_f32_32x32x16_bf16 v[64:79], v[248:251], v[240:243], v[64:79]
    ds_read_b128 v[48:51], v5 offset:16384
    ds_read_b128 v[52:55], v5 offset:20480
    v_mfma_f32_32x32x16_bf16 v[80:95], v[252:255], v[240:243], v[80:95]
    ds_read_b64_tr_b16 v[56:57], v228 offset:34816
    v_mfma_f32_16x16x32_bf16 v[208:211], v[248:251], v[224:227], v[208:211]
    ds_read_b64_tr_b16 v[58:59], v228 offset:35328
    s_add_u32 m0, s23, 73728
    s_add_u32 s25, s21, 0
    buffer_load_dwordx4 v3, s[12:15], s25 offen lds
    v_mfma_f32_32x32x16_bf16 v[96:111], v[248:251], v[244:247], v[96:111]
    ds_read_b64_tr_b16 v[60:61], v230 offset:34816
    v_mfma_f32_32x32x16_bf16 v[112:127], v[252:255], v[244:247], v[112:127]
    ds_read_b64_tr_b16 v[62:63], v230 offset:35328
    s_add_u32 m0, s23, 77824
    s_add_u32 s25, s21, 110592
    buffer_load_dwordx4 v3, s[12:15], s25 offen lds
    s_add_u32 s21, s21, 221184
    s_cmp_eq_u32 s21, s39
    s_cselect_b32 s21, s38, s21
    v_mov_b32 v234, 0
    global_load_dword v232, v234, s[74:75] sc1
    s_waitcnt lgkmcnt(6)
    v_mfma_f32_32x32x16_bf16 v[64:79], v[40:43], v[32:35], v[64:79]
    ds_read_b128 v[240:243], v6 offset:16384
    ds_read_b128 v[244:247], v6 offset:20480
    v_mfma_f32_32x32x16_bf16 v[80:95], v[44:47], v[32:35], v[80:95]
    ds_read_b64_tr_b16 v[248:249], v228 offset:36864
    v_mfma_f32_16x16x32_bf16 v[208:211], v[40:43], v[224:227], v[208:211]
    ds_read_b64_tr_b16 v[250:251], v228 offset:37376
    s_add_u32 m0, s23, 0
    s_add_u32 s25, s20, 0
    buffer_load_dwordx4 v2, s[4:7], s25 offen lds
    v_mfma_f32_32x32x16_bf16 v[96:111], v[40:43], v[36:39], v[96:111]
    ds_read_b64_tr_b16 v[252:253], v230 offset:36864
    v_mfma_f32_32x32x16_bf16 v[112:127], v[44:47], v[36:39], v[112:127]
    ds_read_b64_tr_b16 v[254:255], v230 offset:37376
    s_add_u32 m0, s23, 4096
    s_add_u32 s25, s20, 40960
    buffer_load_dwordx4 v2, s[4:7], s25 offen lds
    s_waitcnt lgkmcnt(6)
    v_mfma_f32_32x32x16_bf16 v[64:79], v[56:59], v[48:51], v[64:79]
    ds_read_b128 v[32:35], v7 offset:16384
    ds_read_b128 v[36:39], v7 offset:20480
    v_mfma_f32_32x32x16_bf16 v[80:95], v[60:63], v[48:51], v[80:95]
    ds_read_b64_tr_b16 v[40:41], v228 offset:38912
    v_mfma_f32_16x16x32_bf16 v[208:211], v[56:59], v[224:227], v[208:211]
    ds_read_b64_tr_b16 v[42:43], v228 offset:39424
    s_add_u32 m0, s23, 8192
    s_add_u32 s25, s20, 81920
    buffer_load_dwordx4 v2, s[4:7], s25 offen lds
    v_mfma_f32_32x32x16_bf16 v[96:111], v[56:59], v[52:55], v[96:111]
    ds_read_b64_tr_b16 v[44:45], v230 offset:38912
    v_mfma_f32_32x32x16_bf16 v[112:127], v[60:63], v[52:55], v[112:127]
    ds_read_b64_tr_b16 v[46:47], v230 offset:39424
    s_add_u32 m0, s23, 12288
    s_add_u32 s25, s20, 122880
    buffer_load_dwordx4 v2, s[4:7], s25 offen lds
    s_add_u32 s20, s20, 128
    s_cmp_eq_u32 s20, s37
    s_cselect_b32 s20, s36, s20
    s_waitcnt lgkmcnt(6)
    v_mfma_f32_32x32x16_bf16 v[64:79], v[248:251], v[240:243], v[64:79]
    v_mfma_f32_32x32x16_bf16 v[80:95], v[252:255], v[240:243], v[80:95]
    s_waitcnt vmcnt(5) lgkmcnt(0)
    s_barrier
    ds_read_b128 v[48:51], v4 offset:49152
    ds_read_b128 v[52:55], v4 offset:53248
    v_mfma_f32_16x16x32_bf16 v[208:211], v[248:251], v[224:227], v[208:211]
    ds_read_b64_tr_b16 v[56:57], v229 offset:0
    s_add_u32 m0, s23, 16384
    s_add_u32 s25, s21, 0
    buffer_load_dwordx4 v3, s[8:11], s25 offen lds
    v_mfma_f32_32x32x16_bf16 v[96:111], v[248:251], v[244:247], v[96:111]
    ds_read_b64_tr_b16 v[58:59], v229 offset:512
    ds_read_b64_tr_b16 v[60:61], v231 offset:0
    v_mfma_f32_32x32x16_bf16 v[112:127], v[252:255], v[244:247], v[112:127]
    ds_read_b64_tr_b16 v[62:63], v231 offset:512
    s_add_u32 m0, s23, 20480
    s_add_u32 s25, s21, 110592
    buffer_load_dwordx4 v3, s[8:11], s25 offen lds
    s_waitcnt lgkmcnt(6)
    v_mfma_f32_32x32x16_bf16 v[64:79], v[40:43], v[32:35], v[64:79]
    ds_read_b128 v[240:243], v5 offset:49152
    ds_read_b128 v[244:247], v5 offset:53248
    v_mfma_f32_32x32x16_bf16 v[80:95], v[44:47], v[32:35], v[80:95]
    ds_read_b64_tr_b16 v[248:249], v229 offset:2048
    v_mfma_f32_16x16x32_bf16 v[208:211], v[40:43], v[224:227], v[208:211]
    ds_read_b64_tr_b16 v[250:251], v229 offset:2560
    s_add_u32 m0, s23, 24576
    s_add_u32 s25, s21, 0
    buffer_load_dwordx4 v3, s[12:15], s25 offen lds
    v_mfma_f32_32x32x16_bf16 v[96:111], v[40:43], v[36:39], v[96:111]
    ds_read_b64_tr_b16 v[252:253], v231 offset:2048
    v_mfma_f32_32x32x16_bf16 v[112:127], v[44:47], v[36:39], v[112:127]
    ds_read_b64_tr_b16 v[254:255], v231 offset:2560
    s_add_u32 m0, s23, 28672
    s_add_u32 s25, s21, 110592
    buffer_load_dwordx4 v3, s[12:15], s25 offen lds
    s_add_u32 s21, s21, 221184
    s_cmp_eq_u32 s21, s39
    s_cselect_b32 s21, s38, s21
    s_waitcnt lgkmcnt(6)
    v_mfma_f32_32x32x16_bf16 v[64:79], v[56:59], v[48:51], v[64:79]
    ds_read_b128 v[32:35], v6 offset:49152
    ds_read_b128 v[36:39], v6 offset:53248
    v_mfma_f32_32x32x16_bf16 v[80:95], v[60:63], v[48:51], v[80:95]
    ds_read_b64_tr_b16 v[40:41], v229 offset:4096
    v_mfma_f32_16x16x32_bf16 v[208:211], v[56:59], v[224:227], v[208:211]
    ds_read_b64_tr_b16 v[42:43], v229 offset:4608
    s_add_u32 m0, s23, 32768
    s_add_u32 s25, s20, 0
    buffer_load_dwordx4 v2, s[4:7], s25 offen lds
    v_mfma_f32_32x32x16_bf16 v[96:111], v[56:59], v[52:55], v[96:111]
    ds_read_b64_tr_b16 v[44:45], v231 offset:4096
    v_mfma_f32_32x32x16_bf16 v[112:127], v[60:63], v[52:55], v[112:127]
    ds_read_b64_tr_b16 v[46:47], v231 offset:4608
    s_add_u32 m0, s23, 36864
    s_add_u32 s25, s20, 40960
    buffer_load_dwordx4 v2, s[4:7], s25 offen lds
    s_waitcnt lgkmcnt(6)
    v_mfma_f32_32x32x16_bf16 v[64:79], v[248:251], v[240:243], v[64:79]
    ds_read_b128 v[48:51], v7 offset:49152
    ds_read_b128 v[52:55], v7 offset:53248
    v_mfma_f32_32x32x16_bf16 v[80:95], v[252:255], v[240:243], v[80:95]
    ds_read_b64_tr_b16 v[56:57], v229 offset:6144
    v_mfma_f32_16x16x32_bf16 v[208:211], v[248:251], v[224:227], v[208:211]
    ds_read_b64_tr_b16 v[58:59], v229 offset:6656
    s_add_u32 m0, s23, 40960
    s_add_u32 s25, s20, 81920
    buffer_load_dwordx4 v2, s[4:7], s25 offen lds
    v_mfma_f32_32x32x16_bf16 v[96:111], v[248:251], v[244:247], v[96:111]
    ds_read_b64_tr_b16 v[60:61], v231 offset:6144
    v_mfma_f32_32x32x16_bf16 v[112:127], v[252:255], v[244:247], v[112:127]
    ds_read_b64_tr_b16 v[62:63], v231 offset:6656
    s_add_u32 m0, s23, 45056
    s_add_u32 s25, s20, 122880
    buffer_load_dwordx4 v2, s[4:7], s25 offen lds
    s_add_u32 s20, s20, 128
    s_cmp_eq_u32 s20, s37
    s_cselect_b32 s20, s36, s20
    s_waitcnt lgkmcnt(6)
    v_mfma_f32_32x32x16_bf16 v[64:79], v[40:43], v[32:35], v[64:79]
    v_mfma_f32_32x32x16_bf16 v[80:95], v[44:47], v[32:35], v[80:95]
    s_waitcnt vmcnt(4) lgkmcnt(0)
    s_barrier
    ds_read_b128 v[240:243], v4 offset:0
    ds_read_b128 v[244:247], v4 offset:4096
    v_mfma_f32_16x16x32_bf16 v[208:211], v[40:43], v[224:227], v[208:211]
    ds_read_b64_tr_b16 v[248:249], v228 offset:16384
    s_add_u32 m0, s23, 49152
    s_add_u32 s25, s21, 0
    buffer_load_dwordx4 v3, s[8:11], s25 offen lds
    v_mfma_f32_32x32x16_bf16 v[96:111], v[40:43], v[36:39], v[96:111]
    ds_read_b64_tr_b16 v[250:251], v228 offset:16896
    ds_read_b64_tr_b16 v[252:253], v230 offset:16384
    v_mfma_f32_32x32x16_bf16 v[112:127], v[44:47], v[36:39], v[112:127]
    ds_read_b64_tr_b16 v[254:255], v230 offset:16896
    s_add_u32 m0, s23, 53248
    s_add_u32 s25, s21, 110592
    buffer_load_dwordx4 v3, s[8:11], s25 offen lds
    s_waitcnt lgkmcnt(6)
    v_mfma_f32_32x32x16_bf16 v[64:79], v[56:59], v[48:51], v[64:79]
    ds_read_b128 v[32:35], v5 offset:0
    ds_read_b128 v[36:39], v5 offset:4096
    v_mfma_f32_32x32x16_bf16 v[80:95], v[60:63], v[48:51], v[80:95]
    ds_read_b64_tr_b16 v[40:41], v228 offset:18432
    v_mfma_f32_16x16x32_bf16 v[208:211], v[56:59], v[224:227], v[208:211]
    ds_read_b64_tr_b16 v[42:43], v228 offset:18944
    s_add_u32 m0, s23, 57344
    s_add_u32 s25, s21, 0
    buffer_load_dwordx4 v3, s[12:15], s25 offen lds
    v_mfma_f32_32x32x16_bf16 v[96:111], v[56:59], v[52:55], v[96:111]
    ds_read_b64_tr_b16 v[44:45], v230 offset:18432
    v_mfma_f32_32x32x16_bf16 v[112:127], v[60:63], v[52:55], v[112:127]
    ds_read_b64_tr_b16 v[46:47], v230 offset:18944
    s_add_u32 m0, s23, 61440
    s_add_u32 s25, s21, 110592
    buffer_load_dwordx4 v3, s[12:15], s25 offen lds
    s_add_u32 s21, s21, 221184
    s_cmp_eq_u32 s21, s39
    s_cselect_b32 s21, s38, s21
    s_waitcnt lgkmcnt(6)
    v_mfma_f32_32x32x16_bf16 v[64:79], v[248:251], v[240:243], v[64:79]
    ds_read_b128 v[48:51], v6 offset:0
    ds_read_b128 v[52:55], v6 offset:4096
    v_mfma_f32_32x32x16_bf16 v[80:95], v[252:255], v[240:243], v[80:95]
    ds_read_b64_tr_b16 v[56:57], v228 offset:20480
    v_mfma_f32_16x16x32_bf16 v[208:211], v[248:251], v[224:227], v[208:211]
    ds_read_b64_tr_b16 v[58:59], v228 offset:20992
    s_add_u32 m0, s23, 65536
    s_add_u32 s25, s20, 0
    buffer_load_dwordx4 v2, s[4:7], s25 offen lds
    v_mfma_f32_32x32x16_bf16 v[96:111], v[248:251], v[244:247], v[96:111]
    ds_read_b64_tr_b16 v[60:61], v230 offset:20480
    v_mfma_f32_32x32x16_bf16 v[112:127], v[252:255], v[244:247], v[112:127]
    ds_read_b64_tr_b16 v[62:63], v230 offset:20992
    s_add_u32 m0, s23, 69632
    s_add_u32 s25, s20, 40960
    buffer_load_dwordx4 v2, s[4:7], s25 offen lds
    s_waitcnt lgkmcnt(6)
    v_mfma_f32_32x32x16_bf16 v[64:79], v[40:43], v[32:35], v[64:79]
    ds_read_b128 v[240:243], v7 offset:0
    ds_read_b128 v[244:247], v7 offset:4096
    v_mfma_f32_32x32x16_bf16 v[80:95], v[44:47], v[32:35], v[80:95]
    ds_read_b64_tr_b16 v[248:249], v228 offset:22528
    v_mfma_f32_16x16x32_bf16 v[208:211], v[40:43], v[224:227], v[208:211]
    ds_read_b64_tr_b16 v[250:251], v228 offset:23040
    s_add_u32 m0, s23, 73728
    s_add_u32 s25, s20, 81920
    buffer_load_dwordx4 v2, s[4:7], s25 offen lds
    v_mfma_f32_32x32x16_bf16 v[96:111], v[40:43], v[36:39], v[96:111]
    ds_read_b64_tr_b16 v[252:253], v230 offset:22528
    v_mfma_f32_32x32x16_bf16 v[112:127], v[44:47], v[36:39], v[112:127]
    ds_read_b64_tr_b16 v[254:255], v230 offset:23040
    s_add_u32 m0, s23, 77824
    s_add_u32 s25, s20, 122880
    buffer_load_dwordx4 v2, s[4:7], s25 offen lds
    s_add_u32 s20, s20, 128
    s_cmp_eq_u32 s20, s37
    s_cselect_b32 s20, s36, s20
    s_waitcnt lgkmcnt(6)
    v_mfma_f32_32x32x16_bf16 v[64:79], v[56:59], v[48:51], v[64:79]
    v_mfma_f32_32x32x16_bf16 v[80:95], v[60:63], v[48:51], v[80:95]
    s_waitcnt vmcnt(4) lgkmcnt(0)
    s_barrier
    ds_read_b128 v[32:35], v4 offset:32768
    ds_read_b128 v[36:39], v4 offset:36864
    v_mfma_f32_16x16x32_bf16 v[208:211], v[56:59], v[224:227], v[208:211]
    ds_read_b64_tr_b16 v[40:41], v228 offset:49152
    s_add_u32 m0, s23, 0
    s_add_u32 s25, s21, 0
    buffer_load_dwordx4 v3, s[8:11], s25 offen lds
    v_mfma_f32_32x32x16_bf16 v[96:111], v[56:59], v[52:55], v[96:111]
    ds_read_b64_tr_b16 v[42:43], v228 offset:49664
    ds_read_b64_tr_b16 v[44:45], v230 offset:49152
    v_mfma_f32_32x32x16_bf16 v[112:127], v[60:63], v[52:55], v[112:127]
    ds_read_b64_tr_b16 v[46:47], v230 offset:49664
    s_add_u32 m0, s23, 4096
    s_add_u32 s25, s21, 110592
    buffer_load_dwordx4 v3, s[8:11], s25 offen lds
    s_waitcnt lgkmcnt(6)
    v_mfma_f32_32x32x16_bf16 v[64:79], v[248:251], v[240:243], v[64:79]
    ds_read_b128 v[48:51], v5 offset:32768
    ds_read_b128 v[52:55], v5 offset:36864
    v_mfma_f32_32x32x16_bf16 v[80:95], v[252:255], v[240:243], v[80:95]
    ds_read_b64_tr_b16 v[56:57], v228 offset:51200
    v_mfma_f32_16x16x32_bf16 v[208:211], v[248:251], v[224:227], v[208:211]
    ds_read_b64_tr_b16 v[58:59], v228 offset:51712
    s_add_u32 m0, s23, 8192
    s_add_u32 s25, s21, 0
    buffer_load_dwordx4 v3, s[12:15], s25 offen lds
    v_mfma_f32_32x32x16_bf16 v[96:111], v[248:251], v[244:247], v[96:111]
    ds_read_b64_tr_b16 v[60:61], v230 offset:51200
    v_mfma_f32_32x32x16_bf16 v[112:127], v[252:255], v[244:247], v[112:127]
    ds_read_b64_tr_b16 v[62:63], v230 offset:51712
    s_add_u32 m0, s23, 12288
    s_add_u32 s25, s21, 110592
    buffer_load_dwordx4 v3, s[12:15], s25 offen lds
    s_add_u32 s21, s21, 221184
    s_cmp_eq_u32 s21, s39
    s_cselect_b32 s21, s38, s21
    v_readfirstlane_b32 s29, v232
    s_or_b32 s78, s78, s29
    s_and_b32 s22, s2, 7
    s_lshl_b32 s29, s44, 3
    s_add_u32 s22, s22, s29
    s_add_u32 s22, s22, 40
    s_lshl_b32 s29, s22, 7
    v_mov_b32 v234, s29
    buffer_load_dword v233, v234, s[56:59], 0 offen sc1
    s_waitcnt lgkmcnt(6)
    v_mfma_f32_32x32x16_bf16 v[64:79], v[40:43], v[32:35], v[64:79]
    ds_read_b128 v[240:243], v6 offset:32768
    ds_read_b128 v[244:247], v6 offset:36864
    v_mfma_f32_32x32x16_bf16 v[80:95], v[44:47], v[32:35], v[80:95]
    ds_read_b64_tr_b16 v[248:249], v228 offset:53248
    v_mfma_f32_16x16x32_bf16 v[208:211], v[40:43], v[224:227], v[208:211]
    ds_read_b64_tr_b16 v[250:251], v228 offset:53760
    s_add_u32 m0, s23, 16384
    s_add_u32 s25, s20, 0
    buffer_load_dwordx4 v2, s[4:7], s25 offen lds
    v_mfma_f32_32x32x16_bf16 v[96:111], v[40:43], v[36:39], v[96:111]
    ds_read_b64_tr_b16 v[252:253], v230 offset:53248
    v_mfma_f32_32x32x16_bf16 v[112:127], v[44:47], v[36:39], v[112:127]
    ds_read_b64_tr_b16 v[254:255], v230 offset:53760
    s_add_u32 m0, s23, 20480
    s_add_u32 s25, s20, 40960
    buffer_load_dwordx4 v2, s[4:7], s25 offen lds
    s_waitcnt lgkmcnt(6)
    v_mfma_f32_32x32x16_bf16 v[64:79], v[56:59], v[48:51], v[64:79]
    ds_read_b128 v[32:35], v7 offset:32768
    ds_read_b128 v[36:39], v7 offset:36864
    v_mfma_f32_32x32x16_bf16 v[80:95], v[60:63], v[48:51], v[80:95]
    ds_read_b64_tr_b16 v[40:41], v228 offset:55296
    v_mfma_f32_16x16x32_bf16 v[208:211], v[56:59], v[224:227], v[208:211]
    ds_read_b64_tr_b16 v[42:43], v228 offset:55808
    s_add_u32 m0, s23, 24576
    s_add_u32 s25, s20, 81920
    buffer_load_dwordx4 v2, s[4:7], s25 offen lds
    v_mfma_f32_32x32x16_bf16 v[96:111], v[56:59], v[52:55], v[96:111]
    ds_read_b64_tr_b16 v[44:45], v230 offset:55296
    v_mfma_f32_32x32x16_bf16 v[112:127], v[60:63], v[52:55], v[112:127]
    ds_read_b64_tr_b16 v[46:47], v230 offset:55808
    s_add_u32 m0, s23, 28672
    s_add_u32 s25, s20, 122880
    buffer_load_dwordx4 v2, s[4:7], s25 offen lds
    s_add_u32 s20, s20, 128
    s_cmp_eq_u32 s20, s37
    s_cselect_b32 s20, s36, s20
    s_waitcnt lgkmcnt(6)
    v_mfma_f32_32x32x16_bf16 v[64:79], v[248:251], v[240:243], v[64:79]
    v_mfma_f32_32x32x16_bf16 v[80:95], v[252:255], v[240:243], v[80:95]
    s_waitcnt vmcnt(5) lgkmcnt(0)
    s_barrier
    ds_read_b128 v[48:51], v8 offset:0
    ds_read_b128 v[52:55], v8 offset:4096
    v_mfma_f32_16x16x32_bf16 v[208:211], v[248:251], v[224:227], v[208:211]
    ds_read_b64_tr_b16 v[56:57], v228 offset:0
    s_add_u32 m0, s23, 32768
    s_add_u32 s25, s21, 0
    buffer_load_dwordx4 v3, s[8:11], s25 offen lds
    v_mfma_f32_32x32x16_bf16 v[96:111], v[248:251], v[244:247], v[96:111]
    ds_read_b64_tr_b16 v[58:59], v228 offset:512
    ds_read_b64_tr_b16 v[60:61], v230 offset:0
    v_mfma_f32_32x32x16_bf16 v[112:127], v[252:255], v[244:247], v[112:127]
    ds_read_b64_tr_b16 v[62:63], v230 offset:512
    s_add_u32 m0, s23, 36864
    s_add_u32 s25, s21, 110592
    buffer_load_dwordx4 v3, s[8:11], s25 offen lds
    s_waitcnt lgkmcnt(6)
    v_mfma_f32_32x32x16_bf16 v[64:79], v[40:43], v[32:35], v[64:79]
    ds_read_b128 v[240:243], v9 offset:0
    ds_read_b128 v[244:247], v9 offset:4096
    v_mfma_f32_32x32x16_bf16 v[80:95], v[44:47], v[32:35], v[80:95]
    ds_read_b64_tr_b16 v[248:249], v228 offset:2048
    v_mfma_f32_16x16x32_bf16 v[208:211], v[40:43], v[224:227], v[208:211]
    ds_read_b64_tr_b16 v[250:251], v228 offset:2560
    s_add_u32 m0, s23, 40960
    s_add_u32 s25, s21, 0
    buffer_load_dwordx4 v3, s[12:15], s25 offen lds
    v_mfma_f32_32x32x16_bf16 v[96:111], v[40:43], v[36:39], v[96:111]
    ds_read_b64_tr_b16 v[252:253], v230 offset:2048
    v_mfma_f32_32x32x16_bf16 v[112:127], v[44:47], v[36:39], v[112:127]
    ds_read_b64_tr_b16 v[254:255], v230 offset:2560
    s_add_u32 m0, s23, 45056
    s_add_u32 s25, s21, 110592
    buffer_load_dwordx4 v3, s[12:15], s25 offen lds
    s_add_u32 s21, s21, 221184
    s_cmp_eq_u32 s21, s39
    s_cselect_b32 s21, s38, s21
    s_waitcnt lgkmcnt(6)
    v_mfma_f32_32x32x16_bf16 v[64:79], v[56:59], v[48:51], v[64:79]
    ds_read_b128 v[32:35], v10 offset:0
    ds_read_b128 v[36:39], v10 offset:4096
    v_mfma_f32_32x32x16_bf16 v[80:95], v[60:63], v[48:51], v[80:95]
    ds_read_b64_tr_b16 v[40:41], v228 offset:4096
    v_mfma_f32_16x16x32_bf16 v[208:211], v[56:59], v[224:227], v[208:211]
    ds_read_b64_tr_b16 v[42:43], v228 offset:4608
    s_add_u32 m0, s23, 49152
    s_add_u32 s25, s20, 0
    buffer_load_dwordx4 v2, s[4:7], s25 offen lds
    v_mfma_f32_32x32x16_bf16 v[96:111], v[56:59], v[52:55], v[96:111]
    ds_read_b64_tr_b16 v[44:45], v230 offset:4096
    v_mfma_f32_32x32x16_bf16 v[112:127], v[60:63], v[52:55], v[112:127]
    ds_read_b64_tr_b16 v[46:47], v230 offset:4608
    s_add_u32 m0, s23, 53248
    s_add_u32 s25, s20, 40960
    buffer_load_dwordx4 v2, s[4:7], s25 offen lds
    s_waitcnt lgkmcnt(6)
    v_mfma_f32_32x32x16_bf16 v[64:79], v[248:251], v[240:243], v[64:79]
    ds_read_b128 v[48:51], v11 offset:0
    ds_read_b128 v[52:55], v11 offset:4096
    v_mfma_f32_32x32x16_bf16 v[80:95], v[252:255], v[240:243], v[80:95]
    ds_read_b64_tr_b16 v[56:57], v228 offset:6144
    v_mfma_f32_16x16x32_bf16 v[208:211], v[248:251], v[224:227], v[208:211]
    ds_read_b64_tr_b16 v[58:59], v228 offset:6656
    s_add_u32 m0, s23, 57344
    s_add_u32 s25, s20, 81920
    buffer_load_dwordx4 v2, s[4:7], s25 offen lds
    v_mfma_f32_32x32x16_bf16 v[96:111], v[248:251], v[244:247], v[96:111]
    ds_read_b64_tr_b16 v[60:61], v230 offset:6144
    v_mfma_f32_32x32x16_bf16 v[112:127], v[252:255], v[244:247], v[112:127]
    ds_read_b64_tr_b16 v[62:63], v230 offset:6656
    s_add_u32 m0, s23, 61440
    s_add_u32 s25, s20, 122880
    buffer_load_dwordx4 v2, s[4:7], s25 offen lds
    s_add_u32 s20, s20, 128
    s_cmp_eq_u32 s20, s37
    s_cselect_b32 s20, s36, s20
    s_waitcnt lgkmcnt(6)
    v_mfma_f32_32x32x16_bf16 v[64:79], v[40:43], v[32:35], v[64:79]
    v_mfma_f32_32x32x16_bf16 v[80:95], v[44:47], v[32:35], v[80:95]
    s_waitcnt vmcnt(4) lgkmcnt(0)
    s_barrier
    ds_read_b128 v[240:243], v4 offset:16384
    ds_read_b128 v[244:247], v4 offset:20480
    v_mfma_f32_16x16x32_bf16 v[208:211], v[40:43], v[224:227], v[208:211]
    ds_read_b64_tr_b16 v[248:249], v228 offset:32768
    v_mfma_f32_32x32x16_bf16 v[96:111], v[40:43], v[36:39], v[96:111]
    ds_read_b64_tr_b16 v[250:251], v228 offset:33280
    ds_read_b64_tr_b16 v[252:253], v230 offset:32768
    v_mfma_f32_32x32x16_bf16 v[112:127], v[44:47], v[36:39], v[112:127]
    ds_read_b64_tr_b16 v[254:255], v230 offset:33280
    s_add_u32 m0, s23, 65536
    s_add_u32 s25, s21, 0
    buffer_load_dwordx4 v3, s[8:11], s25 offen lds
    s_waitcnt lgkmcnt(6)
    v_mfma_f32_32x32x16_bf16 v[64:79], v[56:59], v[48:51], v[64:79]
    ds_read_b128 v[32:35], v5 offset:16384
    ds_read_b128 v[36:39], v5 offset:20480
    v_mfma_f32_32x32x16_bf16 v[80:95], v[60:63], v[48:51], v[80:95]
    ds_read_b64_tr_b16 v[40:41], v228 offset:34816
    v_mfma_f32_16x16x32_bf16 v[208:211], v[56:59], v[224:227], v[208:211]
    ds_read_b64_tr_b16 v[42:43], v228 offset:35328
    v_mfma_f32_32x32x16_bf16 v[96:111], v[56:59], v[52:55], v[96:111]
    ds_read_b64_tr_b16 v[44:45], v230 offset:34816
    v_mfma_f32_32x32x16_bf16 v[112:127], v[60:63], v[52:55], v[112:127]
    ds_read_b64_tr_b16 v[46:47], v230 offset:35328
    s_add_u32 m0, s23, 69632
    s_add_u32 s25, s21, 110592
    buffer_load_dwordx4 v3, s[8:11], s25 offen lds
    v_and_b32 v14, 31, v1
    s_lshl_b32 s30, s27, 6
    s_add_u32 s30, s30, s46
    v_add_u32 v14, s30, v14
    v_lshlrev_b32 v14, 3, v14
    buffer_load_dwordx2 v[132:133], v14, s[16:19], 0 offen sc1
    buffer_load_dwordx2 v[134:135], v14, s[16:19], 0 offen offset:256 sc1
    s_waitcnt lgkmcnt(6)
    v_mfma_f32_32x32x16_bf16 v[64:79], v[248:251], v[240:243], v[64:79]
    ds_read_b128 v[48:51], v6 offset:16384
    ds_read_b128 v[52:55], v6 offset:20480
    v_mfma_f32_32x32x16_bf16 v[80:95], v[252:255], v[240:243], v[80:95]
    ds_read_b64_tr_b16 v[56:57], v228 offset:36864
    v_mfma_f32_16x16x32_bf16 v[208:211], v[248:251], v[224:227], v[208:211]
    ds_read_b64_tr_b16 v[58:59], v228 offset:37376
    v_mfma_f32_32x32x16_bf16 v[96:111], v[248:251], v[244:247], v[96:111]
    ds_read_b64_tr_b16 v[60:61], v230 offset:36864
    v_mfma_f32_32x32x16_bf16 v[112:127], v[252:255], v[244:247], v[112:127]
    ds_read_b64_tr_b16 v[62:63], v230 offset:37376
    s_add_u32 m0, s23, 73728
    s_add_u32 s25, s21, 0
    buffer_load_dwordx4 v3, s[12:15], s25 offen lds
    s_waitcnt lgkmcnt(6)
    v_mfma_f32_32x32x16_bf16 v[64:79], v[40:43], v[32:35], v[64:79]
    ds_read_b128 v[240:243], v7 offset:16384
    ds_read_b128 v[244:247], v7 offset:20480
    v_mfma_f32_32x32x16_bf16 v[80:95], v[44:47], v[32:35], v[80:95]
    ds_read_b64_tr_b16 v[248:249], v228 offset:38912
    v_mfma_f32_16x16x32_bf16 v[208:211], v[40:43], v[224:227], v[208:211]
    ds_read_b64_tr_b16 v[250:251], v228 offset:39424
    v_mfma_f32_32x32x16_bf16 v[96:111], v[40:43], v[36:39], v[96:111]
    ds_read_b64_tr_b16 v[252:253], v230 offset:38912
    v_mfma_f32_32x32x16_bf16 v[112:127], v[44:47], v[36:39], v[112:127]
    ds_read_b64_tr_b16 v[254:255], v230 offset:39424
    s_add_u32 m0, s23, 77824
    s_add_u32 s25, s21, 110592
    buffer_load_dwordx4 v3, s[12:15], s25 offen lds
    s_add_u32 s21, s21, 221184
    s_cmp_eq_u32 s21, s39
    s_cselect_b32 s21, s38, s21
    s_waitcnt lgkmcnt(6)
    v_mfma_f32_32x32x16_bf16 v[64:79], v[56:59], v[48:51], v[64:79]
    v_mfma_f32_32x32x16_bf16 v[80:95], v[60:63], v[48:51], v[80:95]
    s_waitcnt vmcnt(0) lgkmcnt(0)
    s_barrier
    ds_read_b128 v[32:35], v4 offset:49152
    ds_read_b128 v[36:39], v4 offset:53248
    v_mfma_f32_16x16x32_bf16 v[208:211], v[56:59], v[224:227], v[208:211]
    ds_read_b64_tr_b16 v[40:41], v229 offset:0
    v_mfma_f32_32x32x16_bf16 v[96:111], v[56:59], v[52:55], v[96:111]
    ds_read_b64_tr_b16 v[42:43], v229 offset:512
    ds_read_b64_tr_b16 v[44:45], v231 offset:0
    v_mfma_f32_32x32x16_bf16 v[112:127], v[60:63], v[52:55], v[112:127]
    ds_read_b64_tr_b16 v[46:47], v231 offset:512
    s_waitcnt lgkmcnt(6)
    v_mfma_f32_32x32x16_bf16 v[64:79], v[248:251], v[240:243], v[64:79]
    ds_read_b128 v[48:51], v5 offset:49152
    ds_read_b128 v[52:55], v5 offset:53248
    v_mfma_f32_32x32x16_bf16 v[80:95], v[252:255], v[240:243], v[80:95]
    ds_read_b64_tr_b16 v[56:57], v229 offset:2048
    v_mfma_f32_16x16x32_bf16 v[208:211], v[248:251], v[224:227], v[208:211]
    ds_read_b64_tr_b16 v[58:59], v229 offset:2560
    v_mfma_f32_32x32x16_bf16 v[96:111], v[248:251], v[244:247], v[96:111]
    ds_read_b64_tr_b16 v[60:61], v231 offset:2048
    v_mfma_f32_32x32x16_bf16 v[112:127], v[252:255], v[244:247], v[112:127]
    ds_read_b64_tr_b16 v[62:63], v231 offset:2560
    s_waitcnt lgkmcnt(6)
    v_mfma_f32_32x32x16_bf16 v[64:79], v[40:43], v[32:35], v[64:79]
    ds_read_b128 v[240:243], v6 offset:49152
    ds_read_b128 v[244:247], v6 offset:53248
    v_mfma_f32_32x32x16_bf16 v[80:95], v[44:47], v[32:35], v[80:95]
    ds_read_b64_tr_b16 v[248:249], v229 offset:4096
    v_mfma_f32_16x16x32_bf16 v[208:211], v[40:43], v[224:227], v[208:211]
    ds_read_b64_tr_b16 v[250:251], v229 offset:4608
    v_mfma_f32_32x32x16_bf16 v[96:111], v[40:43], v[36:39], v[96:111]
    ds_read_b64_tr_b16 v[252:253], v231 offset:4096
    v_mfma_f32_32x32x16_bf16 v[112:127], v[44:47], v[36:39], v[112:127]
    ds_read_b64_tr_b16 v[254:255], v231 offset:4608
    s_waitcnt lgkmcnt(6)
    v_mfma_f32_32x32x16_bf16 v[64:79], v[56:59], v[48:51], v[64:79]
    ds_read_b128 v[32:35], v7 offset:49152
    ds_read_b128 v[36:39], v7 offset:53248
    v_mfma_f32_32x32x16_bf16 v[80:95], v[60:63], v[48:51], v[80:95]
    ds_read_b64_tr_b16 v[40:41], v229 offset:6144
    v_mfma_f32_16x16x32_bf16 v[208:211], v[56:59], v[224:227], v[208:211]
    ds_read_b64_tr_b16 v[42:43], v229 offset:6656
    v_mfma_f32_32x32x16_bf16 v[96:111], v[56:59], v[52:55], v[96:111]
    ds_read_b64_tr_b16 v[44:45], v231 offset:6144
    v_mfma_f32_32x32x16_bf16 v[112:127], v[60:63], v[52:55], v[112:127]
    ds_read_b64_tr_b16 v[46:47], v231 offset:6656
    s_waitcnt lgkmcnt(6)
    v_mfma_f32_32x32x16_bf16 v[64:79], v[248:251], v[240:243], v[64:79]
    v_mfma_f32_32x32x16_bf16 v[80:95], v[252:255], v[240:243], v[80:95]
    v_mfma_f32_16x16x32_bf16 v[208:211], v[248:251], v[224:227], v[208:211]
    v_mfma_f32_32x32x16_bf16 v[96:111], v[248:251], v[244:247], v[96:111]
    v_mfma_f32_32x32x16_bf16 v[112:127], v[252:255], v[244:247], v[112:127]
    s_waitcnt lgkmcnt(0)
    v_mfma_f32_32x32x16_bf16 v[64:79], v[40:43], v[32:35], v[64:79]
    v_mfma_f32_32x32x16_bf16 v[80:95], v[44:47], v[32:35], v[80:95]
    v_mfma_f32_16x16x32_bf16 v[208:211], v[40:43], v[224:227], v[208:211]
    v_mfma_f32_32x32x16_bf16 v[96:111], v[40:43], v[36:39], v[96:111]
    v_mfma_f32_32x32x16_bf16 v[112:127], v[44:47], v[36:39], v[112:127]
    s_nop 15
    s_setprio 2
    v_and_b32 v14, 15, v1
    v_lshrrev_b32 v15, 4, v1
    v_lshlrev_b32 v15, 4, v15
    v_lshl_add_u32 v15, v14, 6, v15
    s_lshl_b32 s30, s28, 8
    s_lshl_b32 s31, s27, 7
    s_add_u32 s31, s31, s30
    v_add_u32 v15, s31, v15
    v_cmp_gt_u32 vcc, 2, v14
    s_and_saveexec_b64 s[32:33], vcc
    ds_write_b128 v15, v[208:211]
    s_mov_b64 exec, s[32:33]
    v_lshrrev_b32 v14, 5, v1
    v_lshlrev_b32 v14, 4, v14
    v_add_u32 v14, s30, v14
    s_waitcnt lgkmcnt(0)
    s_barrier
    ds_read_b128 v[136:139], v14 offset:0
    ds_read_b128 v[140:143], v14 offset:32
    ds_read_b128 v[144:147], v14 offset:64
    ds_read_b128 v[148:151], v14 offset:96
    ds_read_b128 v[152:155], v14 offset:128
    ds_read_b128 v[156:159], v14 offset:160
    ds_read_b128 v[160:163], v14 offset:192
    ds_read_b128 v[164:167], v14 offset:224
    s_waitcnt vmcnt(0)
    v_readfirstlane_b32 s34, v233
    s_cmp_eq_u32 s78, 0
    s_cbranch_scc1 L_stc_28_slow
    s_cmp_ge_u32 s34, 32
    s_cbranch_scc1 L_stc_28
L_stc_28_slow:
    s_mov_b32 s34, s24
    s_cmp_lg_u32 s78, 0
    s_cbranch_scc1 L_rdyd_30
    v_mov_b32 v238, 0
    s_mov_b32 s30, 0x40000
L_rdy_29:
    global_load_dword v239, v238, s[74:75] sc1
    s_waitcnt vmcnt(0)
    v_readfirstlane_b32 s78, v239
    s_cmp_lg_u32 s78, 0
    s_cbranch_scc1 L_rdyd_30
    s_sleep 4
    s_sub_u32 s30, s30, 1
    s_cmp_lg_u32 s30, 0
    s_cbranch_scc1 L_rdy_29
L_rdyd_30:
    s_lshl_b32 s31, s22, 7
    v_mov_b32 v238, s31
    s_mov_b32 exec_lo, 1
    s_mov_b32 exec_hi, 0
    s_mov_b32 s30, 0x40000
L_wc_31:
    buffer_load_dword v239, v238, s[56:59], 0 offen sc1
    s_waitcnt vmcnt(0)
    v_cmp_gt_u32 vcc, 32, v239
    s_nop 4
    s_cbranch_vccz L_wcd_32_x
    s_sleep 1
    s_sub_u32 s30, s30, 1
    s_cmp_lg_u32 s30, 0
    s_cbranch_scc1 L_wc_31
L_wcd_32_x:
    s_mov_b64 exec, -1
L_wcd_32:
    v_and_b32 v14, 31, v1
    s_lshl_b32 s30, s27, 6
    s_add_u32 s30, s30, s46
    v_add_u32 v14, s30, v14
    v_lshlrev_b32 v14, 3, v14
    buffer_load_dwordx2 v[132:133], v14, s[16:19], 0 offen sc1
    buffer_load_dwordx2 v[134:135], v14, s[16:19], 0 offen offset:256 sc1
    s_waitcnt vmcnt(0)
L_stc_28:
    s_add_u32 s8, s76, 8912896
    s_addc_u32 s9, s77, 0
    s_and_b32 s9, s9, 0xffff
    s_mov_b32 s10, 7077888
    s_mov_b32 s11, 0x00020000
    s_lshl_b32 s30, s45, 3
    s_lshl_b32 s31, s28, 2
    s_add_u32 s30, s30, s31
    s_lshl_b32 s30, s30, 15
    s_lshl_b32 s31, s27, 6
    s_add_u32 s31, s31, s46
    s_lshl_b32 s31, s31, 4
    s_add_u32 s51, s30, s31
    v_lshrrev_b32 v14, 5, v1
    v_lshlrev_b32 v14, 15, v14
    v_and_b32 v15, 31, v1
    v_lshl_add_u32 v14, v15, 4, v14
    s_waitcnt lgkmcnt(0)
    s_cmp_eq_u32 s27, 0
    s_cbranch_scc1 L_gu_27_w0
    v_swap_b32 v64, v80
    v_swap_b32 v65, v81
    v_swap_b32 v66, v82
    v_swap_b32 v67, v83
    v_swap_b32 v68, v84
    v_swap_b32 v69, v85
    v_swap_b32 v70, v86
    v_swap_b32 v71, v87
    v_swap_b32 v72, v88
    v_swap_b32 v73, v89
    v_swap_b32 v74, v90
    v_swap_b32 v75, v91
    v_swap_b32 v76, v92
    v_swap_b32 v77, v93
    v_swap_b32 v78, v94
    v_swap_b32 v79, v95
    v_swap_b32 v96, v112
    v_swap_b32 v97, v113
    v_swap_b32 v98, v114
    v_swap_b32 v99, v115
    v_swap_b32 v100, v116
    v_swap_b32 v101, v117
    v_swap_b32 v102, v118
    v_swap_b32 v103, v119
    v_swap_b32 v104, v120
    v_swap_b32 v105, v121
    v_swap_b32 v106, v122
    v_swap_b32 v107, v123
    v_swap_b32 v108, v124
    v_swap_b32 v109, v125
    v_swap_b32 v110, v126
    v_swap_b32 v111, v127
L_gu_27_w0:
    v_mul_f32 v16, 0xbfb8aa3b, v132
    v_mul_f32 v17, 0xbfb8aa3b, v133
    v_mul_f32 v208, v16, v136
    v_mul_f32 v212, v132, v152
    v_mul_f32 v209, v16, v137
    v_mul_f32 v213, v132, v153
    v_mul_f32 v210, v16, v138
    v_mul_f32 v214, v132, v154
    v_mul_f32 v211, v16, v139
    v_mul_f32 v215, v132, v155
    v_fma_f32 v208, v64, v17, -v208
    v_fma_f32 v212, v80, v133, -v212
    v_fma_f32 v209, v65, v17, -v209
    v_fma_f32 v213, v81, v133, -v213
    v_fma_f32 v210, v66, v17, -v210
    v_fma_f32 v214, v82, v133, -v214
    v_fma_f32 v211, v67, v17, -v211
    v_fma_f32 v215, v83, v133, -v215
    v_exp_f32 v208, v208
    v_exp_f32 v209, v209
    v_exp_f32 v210, v210
    v_exp_f32 v211, v211
    v_add_f32 v208, 1.0, v208
    v_add_f32 v209, 1.0, v209
    v_add_f32 v210, 1.0, v210
    v_add_f32 v211, 1.0, v211
    v_rcp_f32 v208, v208
    v_rcp_f32 v209, v209
    v_rcp_f32 v210, v210
    v_rcp_f32 v211, v211
    s_nop 0
    v_mul_f32 v208, v208, v212
    v_mul_f32 v209, v209, v213
    v_mul_f32 v210, v210, v214
    v_mul_f32 v211, v211, v215
    v_cvt_pk_bf16_f32 v248, v208, v209
    v_cvt_pk_bf16_f32 v249, v210, v211
    v_mul_f32 v216, v16, v140
    v_mul_f32 v220, v132, v156
    v_mul_f32 v217, v16, v141
    v_mul_f32 v221, v132, v157
    v_mul_f32 v218, v16, v142
    v_mul_f32 v222, v132, v158
    v_mul_f32 v219, v16, v143
    v_mul_f32 v223, v132, v159
    v_fma_f32 v216, v68, v17, -v216
    v_fma_f32 v220, v84, v133, -v220
    v_fma_f32 v217, v69, v17, -v217
    v_fma_f32 v221, v85, v133, -v221
    v_fma_f32 v218, v70, v17, -v218
    v_fma_f32 v222, v86, v133, -v222
    v_fma_f32 v219, v71, v17, -v219
    v_fma_f32 v223, v87, v133, -v223
    v_exp_f32 v216, v216
    v_exp_f32 v217, v217
    v_exp_f32 v218, v218
    v_exp_f32 v219, v219
    v_add_f32 v216, 1.0, v216
    v_add_f32 v217, 1.0, v217
    v_add_f32 v218, 1.0, v218
    v_add_f32 v219, 1.0, v219
    v_rcp_f32 v216, v216
    v_rcp_f32 v217, v217
    v_rcp_f32 v218, v218
    v_rcp_f32 v219, v219
    s_nop 0
    v_mul_f32 v216, v216, v220
    v_mul_f32 v217, v217, v221
    v_mul_f32 v218, v218, v222
    v_mul_f32 v219, v219, v223
    v_cvt_pk_bf16_f32 v250, v216, v217
    v_cvt_pk_bf16_f32 v251, v218, v219
    s_add_u32 s30, s51, 0
    s_nop 0
    v_permlane32_swap_b32 v248, v250
    v_permlane32_swap_b32 v249, v251
    buffer_store_dwordx4 v[248:251], v14, s[8:11], s30 offen sc1
    v_mul_f32 v208, v16, v144
    v_mul_f32 v212, v132, v160
    v_mul_f32 v209, v16, v145
    v_mul_f32 v213, v132, v161
    v_mul_f32 v210, v16, v146
    v_mul_f32 v214, v132, v162
    v_mul_f32 v211, v16, v147
    v_mul_f32 v215, v132, v163
    v_fma_f32 v208, v72, v17, -v208
    v_fma_f32 v212, v88, v133, -v212
    v_fma_f32 v209, v73, v17, -v209
    v_fma_f32 v213, v89, v133, -v213
    v_fma_f32 v210, v74, v17, -v210
    v_fma_f32 v214, v90, v133, -v214
    v_fma_f32 v211, v75, v17, -v211
    v_fma_f32 v215, v91, v133, -v215
    v_exp_f32 v208, v208
    v_exp_f32 v209, v209
    v_exp_f32 v210, v210
    v_exp_f32 v211, v211
    v_add_f32 v208, 1.0, v208
    v_add_f32 v209, 1.0, v209
    v_add_f32 v210, 1.0, v210
    v_add_f32 v211, 1.0, v211
    v_rcp_f32 v208, v208
    v_rcp_f32 v209, v209
    v_rcp_f32 v210, v210
    v_rcp_f32 v211, v211
    s_nop 0
    v_mul_f32 v208, v208, v212
    v_mul_f32 v209, v209, v213
    v_mul_f32 v210, v210, v214
    v_mul_f32 v211, v211, v215
    v_cvt_pk_bf16_f32 v252, v208, v209
    v_cvt_pk_bf16_f32 v253, v210, v211
    v_mul_f32 v216, v16, v148
    v_mul_f32 v220, v132, v164
    v_mul_f32 v217, v16, v149
    v_mul_f32 v221, v132, v165
    v_mul_f32 v218, v16, v150
    v_mul_f32 v222, v132, v166
    v_mul_f32 v219, v16, v151
    v_mul_f32 v223, v132, v167
    v_fma_f32 v216, v76, v17, -v216
    v_fma_f32 v220, v92, v133, -v220
    v_fma_f32 v217, v77, v17, -v217
    v_fma_f32 v221, v93, v133, -v221
    v_fma_f32 v218, v78, v17, -v218
    v_fma_f32 v222, v94, v133, -v222
    v_fma_f32 v219, v79, v17, -v219
    v_fma_f32 v223, v95, v133, -v223
    v_exp_f32 v216, v216
    v_exp_f32 v217, v217
    v_exp_f32 v218, v218
    v_exp_f32 v219, v219
    v_add_f32 v216, 1.0, v216
    v_add_f32 v217, 1.0, v217
    v_add_f32 v218, 1.0, v218
    v_add_f32 v219, 1.0, v219
    v_rcp_f32 v216, v216
    v_rcp_f32 v217, v217
    v_rcp_f32 v218, v218
    v_rcp_f32 v219, v219
    s_nop 0
    v_mul_f32 v216, v216, v220
    v_mul_f32 v217, v217, v221
    v_mul_f32 v218, v218, v222
    v_mul_f32 v219, v219, v223
    v_cvt_pk_bf16_f32 v254, v216, v217
    v_cvt_pk_bf16_f32 v255, v218, v219
    s_add_u32 s30, s51, 65536
    s_nop 0
    v_permlane32_swap_b32 v252, v254
    v_permlane32_swap_b32 v253, v255
    buffer_store_dwordx4 v[252:255], v14, s[8:11], s30 offen sc1
    v_mul_f32 v16, 0xbfb8aa3b, v134
    v_mul_f32 v17, 0xbfb8aa3b, v135
    v_mul_f32 v208, v16, v136
    v_mul_f32 v212, v134, v152
    v_mul_f32 v209, v16, v137
    v_mul_f32 v213, v134, v153
    v_mul_f32 v210, v16, v138
    v_mul_f32 v214, v134, v154
    v_mul_f32 v211, v16, v139
    v_mul_f32 v215, v134, v155
    v_fma_f32 v208, v96, v17, -v208
    v_fma_f32 v212, v112, v135, -v212
    v_fma_f32 v209, v97, v17, -v209
    v_fma_f32 v213, v113, v135, -v213
    v_fma_f32 v210, v98, v17, -v210
    v_fma_f32 v214, v114, v135, -v214
    v_fma_f32 v211, v99, v17, -v211
    v_fma_f32 v215, v115, v135, -v215
    v_exp_f32 v208, v208
    v_exp_f32 v209, v209
    v_exp_f32 v210, v210
    v_exp_f32 v211, v211
    v_add_f32 v208, 1.0, v208
    v_add_f32 v209, 1.0, v209
    v_add_f32 v210, 1.0, v210
    v_add_f32 v211, 1.0, v211
    v_rcp_f32 v208, v208
    v_rcp_f32 v209, v209
    v_rcp_f32 v210, v210
    v_rcp_f32 v211, v211
    s_nop 0
    v_mul_f32 v208, v208, v212
    v_mul_f32 v209, v209, v213
    v_mul_f32 v210, v210, v214
    v_mul_f32 v211, v211, v215
    v_cvt_pk_bf16_f32 v248, v208, v209
    v_cvt_pk_bf16_f32 v249, v210, v211
    v_mul_f32 v216, v16, v140
    v_mul_f32 v220, v134, v156
    v_mul_f32 v217, v16, v141
    v_mul_f32 v221, v134, v157
    v_mul_f32 v218, v16, v142
    v_mul_f32 v222, v134, v158
    v_mul_f32 v219, v16, v143
    v_mul_f32 v223, v134, v159
    v_fma_f32 v216, v100, v17, -v216
    v_fma_f32 v220, v116, v135, -v220
    v_fma_f32 v217, v101, v17, -v217
    v_fma_f32 v221, v117, v135, -v221
    v_fma_f32 v218, v102, v17, -v218
    v_fma_f32 v222, v118, v135, -v222
    v_fma_f32 v219, v103, v17, -v219
    v_fma_f32 v223, v119, v135, -v223
    v_exp_f32 v216, v216
    v_exp_f32 v217, v217
    v_exp_f32 v218, v218
    v_exp_f32 v219, v219
    v_add_f32 v216, 1.0, v216
    v_add_f32 v217, 1.0, v217
    v_add_f32 v218, 1.0, v218
    v_add_f32 v219, 1.0, v219
    v_rcp_f32 v216, v216
    v_rcp_f32 v217, v217
    v_rcp_f32 v218, v218
    v_rcp_f32 v219, v219
    s_nop 0
    v_mul_f32 v216, v216, v220
    v_mul_f32 v217, v217, v221
    v_mul_f32 v218, v218, v222
    v_mul_f32 v219, v219, v223
    v_cvt_pk_bf16_f32 v250, v216, v217
    v_cvt_pk_bf16_f32 v251, v218, v219
    s_add_u32 s30, s51, 512
    s_nop 0
    v_permlane32_swap_b32 v248, v250
    v_permlane32_swap_b32 v249, v251
    buffer_store_dwordx4 v[248:251], v14, s[8:11], s30 offen sc1
    v_mul_f32 v208, v16, v144
    v_mul_f32 v212, v134, v160
    v_mul_f32 v209, v16, v145
    v_mul_f32 v213, v134, v161
    v_mul_f32 v210, v16, v146
    v_mul_f32 v214, v134, v162
    v_mul_f32 v211, v16, v147
    v_mul_f32 v215, v134, v163
    v_fma_f32 v208, v104, v17, -v208
    v_fma_f32 v212, v120, v135, -v212
    v_fma_f32 v209, v105, v17, -v209
    v_fma_f32 v213, v121, v135, -v213
    v_fma_f32 v210, v106, v17, -v210
    v_fma_f32 v214, v122, v135, -v214
    v_fma_f32 v211, v107, v17, -v211
    v_fma_f32 v215, v123, v135, -v215
    v_exp_f32 v208, v208
    v_exp_f32 v209, v209
    v_exp_f32 v210, v210
    v_exp_f32 v211, v211
    v_add_f32 v208, 1.0, v208
    v_add_f32 v209, 1.0, v209
    v_add_f32 v210, 1.0, v210
    v_add_f32 v211, 1.0, v211
    v_rcp_f32 v208, v208
    v_rcp_f32 v209, v209
    v_rcp_f32 v210, v210
    v_rcp_f32 v211, v211
    s_nop 0
    v_mul_f32 v208, v208, v212
    v_mul_f32 v209, v209, v213
    v_mul_f32 v210, v210, v214
    v_mul_f32 v211, v211, v215
    v_cvt_pk_bf16_f32 v252, v208, v209
    v_cvt_pk_bf16_f32 v253, v210, v211
    v_mul_f32 v216, v16, v148
    v_mul_f32 v220, v134, v164
    v_mul_f32 v217, v16, v149
    v_mul_f32 v221, v134, v165
    v_mul_f32 v218, v16, v150
    v_mul_f32 v222, v134, v166
    v_mul_f32 v219, v16, v151
    v_mul_f32 v223, v134, v167
    v_fma_f32 v216, v108, v17, -v216
    v_fma_f32 v220, v124, v135, -v220
    v_fma_f32 v217, v109, v17, -v217
    v_fma_f32 v221, v125, v135, -v221
    v_fma_f32 v218, v110, v17, -v218
    v_fma_f32 v222, v126, v135, -v222
    v_fma_f32 v219, v111, v17, -v219
    v_fma_f32 v223, v127, v135, -v223
    v_exp_f32 v216, v216
    v_exp_f32 v217, v217
    v_exp_f32 v218, v218
    v_exp_f32 v219, v219
    v_add_f32 v216, 1.0, v216
    v_add_f32 v217, 1.0, v217
    v_add_f32 v218, 1.0, v218
    v_add_f32 v219, 1.0, v219
    v_rcp_f32 v216, v216
    v_rcp_f32 v217, v217
    v_rcp_f32 v218, v218
    v_rcp_f32 v219, v219
    s_nop 0
    v_mul_f32 v216, v216, v220
    v_mul_f32 v217, v217, v221
    v_mul_f32 v218, v218, v222
    v_mul_f32 v219, v219, v223
    v_cvt_pk_bf16_f32 v254, v216, v217
    v_cvt_pk_bf16_f32 v255, v218, v219
    s_add_u32 s30, s51, 66048
    s_nop 0
    v_permlane32_swap_b32 v252, v254
    v_permlane32_swap_b32 v253, v255
    buffer_store_dwordx4 v[252:255], v14, s[8:11], s30 offen sc1
    s_add_u32 s35, s44, 168
L_gu_27_done:
    s_lshl_b32 s30, s35, 7
    v_mov_b32 v14, s30
    s_waitcnt vmcnt(0)
    s_barrier
    s_cmp_lg_u32 s26, 0
    s_cbranch_scc1 L_sg_33
    s_mov_b64 s[30:31], exec
    s_mov_b32 exec_lo, 1
    s_mov_b32 exec_hi, 0
    v_mov_b32 v15, 4
    buffer_atomic_add v15, v14, s[56:59], 0 offen sc1
    s_mov_b64 exec, s[30:31]
L_sg_33:
    s_barrier
    s_and_b32 s40, s3, 7
    s_lshr_b32 s41, s3, 3
    s_and_b32 s43, s40, 3
    s_cmp_eq_u32 s43, 3
    s_cselect_b32 s42, 16, 24
    s_cmp_lt_u32 s41, s42
    s_cbranch_scc1 L_b23_half
    s_sub_u32 s41, s41, s42
    s_lshr_b32 s42, s42, 1
    s_sub_u32 s42, 20, s42
    s_cmp_ge_u32 s41, s42
    s_cbranch_scc1 L_b23_done
    s_lshl_b32 s44, s40, 2
    s_and_b32 s45, s41, 3
    s_add_u32 s44, s44, s45
    s_lshr_b32 s45, s41, 2
    s_lshl_b32 s45, s45, 1
    v_and_b32 v14, 31, v1
    v_lshrrev_b32 v15, 5, v1
    v_bfe_u32 v16, v14, 1, 3
    v_xor_b32 v16, v16, v15
    s_mul_i32 s25, s27, 32
    v_add_u32 v17, s25, v14
    v_lshlrev_b32 v17, 7, v17
    v_xor_b32 v18, 0, v16
    v_lshl_add_u32 v4, v18, 4, v17
    v_add_u32 v8, 0x10000, v4
    v_xor_b32 v18, 2, v16
    v_lshl_add_u32 v5, v18, 4, v17
    v_add_u32 v9, 0x10000, v5
    v_xor_b32 v18, 4, v16
    v_lshl_add_u32 v6, v18, 4, v17
    v_add_u32 v10, 0x10000, v6
    v_xor_b32 v18, 6, v16
    v_lshl_add_u32 v7, v18, 4, v17
    v_add_u32 v11, 0x10000, v7
    v_lshrrev_b32 v14, 4, v1
    v_and_b32 v15, 1, v14
    v_lshrrev_b32 v14, 1, v14
    v_and_b32 v16, 15, v1
    v_lshrrev_b32 v17, 2, v16
    v_lshl_add_u32 v17, v14, 3, v17
    v_lshlrev_b32 v17, 7, v17
    v_bfe_u32 v18, v16, 1, 1
    v_lshl_add_u32 v18, v15, 1, v18
    s_lshl_b32 s25, s28, 2
    v_add_u32 v18, s25, v18
    v_bfe_u32 v19, v16, 3, 1
    v_lshlrev_b32 v19, 2, v19
    v_xor_b32 v18, v18, v19
    v_lshl_add_u32 v17, v18, 4, v17
    v_and_b32 v19, 1, v16
    v_lshl_add_u32 v12, v19, 3, v17
    v_mov_b32 v228, v12
    v_add_u32 v230, 0x2000, v12
    v_add_u32 v229, 0x10000, v228
    v_add_u32 v231, 0x10000, v230
    v_lshrrev_b32 v14, 3, v1
    s_lshl_b32 s25, s26, 3
    v_add_u32 v14, s25, v14
    v_lshrrev_b32 v15, 4, v1
    s_lshl_b32 s25, s28, 2
    v_add_u32 v16, s25, v15
    v_and_b32 v17, 7, v1
    v_xor_b32 v16, v16, v17
    v_lshlrev_b32 v16, 4, v16
    s_mov_b32 s25, 1280
    v_mad_u32_u24 v2, v14, s25, v16
    v_and_b32 v15, 1, v15
    v_lshlrev_b32 v15, 2, v15
    v_xor_b32 v16, v15, v17
    v_lshlrev_b32 v16, 4, v16
    s_mov_b32 s25, 1280
    v_mad_u32_u24 v3, v14, s25, v16
    s_lshl_b32 s25, s26, 15
    v_lshlrev_b32 v14, 4, v1
    v_add_u32 v2, s25, v14
    v_lshrrev_b32 v14, 5, v1
    v_lshlrev_b32 v14, 10, v14
    v_and_b32 v15, 31, v1
    s_lshl_b32 s25, s27, 5
    v_add_u32 v15, s25, v15
    v_lshl_add_u32 v4, v15, 4, v14
    s_add_u32 s4, s76, 8912896
    s_addc_u32 s5, s77, 0
    s_and_b32 s5, s5, 0xffff
    s_mov_b32 s6, 7077888
    s_mov_b32 s7, 0x00020000
    s_mov_b32 s8, s70
    s_mov_b32 s9, s71
    s_and_b32 s9, s9, 0xffff
    s_mov_b32 s10, 2211840
    s_mov_b32 s11, 0x00020000
    s_mov_b32 s12, s70
    s_mov_b32 s13, s71
    s_and_b32 s13, s13, 0xffff
    s_mov_b32 s14, 2211840
    s_mov_b32 s15, 0x00020000
    s_lshl_b32 s20, s44, 10
    s_lshl_b32 s21, s45, 7
    s_lshr_b32 s46, s41, 2
    s_mul_i32 s46, s46, 5
    s_and_b32 s25, s41, 3
    s_mul_i32 s25, s25, 7
    s_add_u32 s46, s46, s25
    s_mul_i32 s25, s46, 2428
    s_lshr_b32 s25, s25, 16
    s_mul_i32 s25, s25, 27
    s_sub_u32 s46, s46, s25
    s_mov_b32 s36, s20
    s_add_u32 s37, s20, 7077888
    s_mul_i32 s25, s46, 262144
    s_add_u32 s20, s20, s25
    s_mov_b32 s38, s21
    s_add_u32 s39, s21, 2211840
    s_mul_i32 s25, s46, 81920
    s_add_u32 s21, s21, s25
    s_cmp_lg_u32 s78, 0
    s_cbranch_scc1 L_rdyd_35
    v_mov_b32 v238, 0
    s_mov_b32 s30, 0x40000
L_rdy_34:
    global_load_dword v239, v238, s[74:75] sc1
    s_waitcnt vmcnt(0)
    v_readfirstlane_b32 s78, v239
    s_cmp_lg_u32 s78, 0
    s_cbranch_scc1 L_rdyd_35
    s_sleep 4
    s_sub_u32 s30, s30, 1
    s_cmp_lg_u32 s30, 0
    s_cbranch_scc1 L_rdy_34
L_rdyd_35:
    s_add_u32 s50, s3, 192
    s_cmp_lg_u32 s26, 0
    s_cbranch_scc1 L_wcd_37
    s_lshl_b32 s31, s50, 7
    v_mov_b32 v238, s31
    s_mov_b32 exec_lo, 1
    s_mov_b32 exec_hi, 0
    s_mov_b32 s30, 0x40000
L_wc_36:
    buffer_load_dword v239, v238, s[56:59], 0 offen sc1
    s_waitcnt vmcnt(0)
    v_cmp_gt_u32 vcc, 2, v239
    s_nop 4
    s_cbranch_vccz L_wcd_37_x
    s_sleep 16
    s_sub_u32 s30, s30, 1
    s_cmp_lg_u32 s30, 0
    s_cbranch_scc1 L_wc_36
L_wcd_37_x:
    s_mov_b64 exec, -1
L_wcd_37:
    s_lshr_b32 s50, s44, 1
    s_add_u32 s50, s50, 168
    s_cmp_lg_u32 s26, 0
    s_cbranch_scc1 L_wcd_39
    s_lshl_b32 s31, s50, 7
    v_mov_b32 v238, s31
    s_mov_b32 exec_lo, 1
    s_mov_b32 exec_hi, 0
    s_mov_b32 s30, 0x40000
L_wc_38:
    buffer_load_dword v239, v238, s[56:59], 0 offen sc1
    s_waitcnt vmcnt(0)
    v_cmp_gt_u32 vcc, 108, v239
    s_nop 4
    s_cbranch_vccz L_wcd_39_x
    s_sleep 8
    s_sub_u32 s30, s30, 1
    s_cmp_lg_u32 s30, 0
    s_cbranch_scc1 L_wc_38
L_wcd_39_x:
    s_mov_b64 exec, -1
L_wcd_39:
    s_waitcnt vmcnt(0)
    s_barrier
    s_add_u32 m0, s23, 0
    s_add_u32 s25, s20, 0
    buffer_load_dwordx4 v2, s[4:7], s25 offen sc1 lds
    s_add_u32 m0, s23, 4096
    s_add_u32 s25, s20, 131072
    buffer_load_dwordx4 v2, s[4:7], s25 offen sc1 lds
    s_add_u32 s20, s20, 262144
    s_cmp_eq_u32 s20, s37
    s_cselect_b32 s20, s36, s20
    s_add_u32 m0, s23, 8192
    s_add_u32 s25, s21, 0
    buffer_load_dwordx4 v3, s[8:11], s25 offen lds
    s_add_u32 m0, s23, 12288
    s_add_u32 s25, s21, 40960
    buffer_load_dwordx4 v3, s[8:11], s25 offen lds
    s_add_u32 m0, s23, 16384
    s_add_u32 s25, s21, 128
    buffer_load_dwordx4 v3, s[12:15], s25 offen lds
    s_add_u32 m0, s23, 20480
    s_add_u32 s25, s21, 41088
    buffer_load_dwordx4 v3, s[12:15], s25 offen lds
    s_add_u32 s21, s21, 81920
    s_cmp_eq_u32 s21, s39
    s_cselect_b32 s21, s38, s21
    s_add_u32 m0, s23, 24576
    s_add_u32 s25, s20, 0
    buffer_load_dwordx4 v2, s[4:7], s25 offen sc1 lds
    s_add_u32 m0, s23, 28672
    s_add_u32 s25, s20, 131072
    buffer_load_dwordx4 v2, s[4:7], s25 offen sc1 lds
    s_add_u32 s20, s20, 262144
    s_cmp_eq_u32 s20, s37
    s_cselect_b32 s20, s36, s20
    s_add_u32 m0, s23, 32768
    s_add_u32 s25, s21, 0
    buffer_load_dwordx4 v3, s[8:11], s25 offen lds
    s_add_u32 m0, s23, 36864
    s_add_u32 s25, s21, 40960
    buffer_load_dwordx4 v3, s[8:11], s25 offen lds
    s_add_u32 m0, s23, 40960
    s_add_u32 s25, s21, 128
    buffer_load_dwordx4 v3, s[12:15], s25 offen lds
    s_add_u32 m0, s23, 45056
    s_add_u32 s25, s21, 41088
    buffer_load_dwordx4 v3, s[12:15], s25 offen lds
    s_add_u32 s21, s21, 81920
    s_cmp_eq_u32 s21, s39
    s_cselect_b32 s21, s38, s21
    s_add_u32 m0, s23, 49152
    s_add_u32 s25, s20, 0
    buffer_load_dwordx4 v2, s[4:7], s25 offen sc1 lds
    s_add_u32 m0, s23, 53248
    s_add_u32 s25, s20, 131072
    buffer_load_dwordx4 v2, s[4:7], s25 offen sc1 lds
    s_add_u32 s20, s20, 262144
    s_cmp_eq_u32 s20, s37
    s_cselect_b32 s20, s36, s20
    s_add_u32 m0, s23, 57344
    s_add_u32 s25, s21, 0
    buffer_load_dwordx4 v3, s[8:11], s25 offen lds
    s_add_u32 m0, s23, 61440
    s_add_u32 s25, s21, 40960
    buffer_load_dwordx4 v3, s[8:11], s25 offen lds
    s_add_u32 m0, s23, 65536
    s_add_u32 s25, s21, 128
    buffer_load_dwordx4 v3, s[12:15], s25 offen lds
    s_add_u32 m0, s23, 69632
    s_add_u32 s25, s21, 41088
    buffer_load_dwordx4 v3, s[12:15], s25 offen lds
    s_add_u32 s21, s21, 81920
    s_cmp_eq_u32 s21, s39
    s_cselect_b32 s21, s38, s21
    s_setprio 0
    s_waitcnt vmcnt(12)
    s_barrier
    ds_read_b128 v[32:35], v4 offset:0
    ds_read_b64_tr_b16 v[40:41], v228 offset:8192
    ds_read_b64_tr_b16 v[42:43], v228 offset:8704
    ds_read_b64_tr_b16 v[44:45], v230 offset:8192
    ds_read_b64_tr_b16 v[46:47], v230 offset:8704
    ds_read_b128 v[48:51], v4 offset:2048
    ds_read_b64_tr_b16 v[56:57], v228 offset:10240
    ds_read_b64_tr_b16 v[58:59], v228 offset:10752
    ds_read_b64_tr_b16 v[60:61], v230 offset:10240
    ds_read_b64_tr_b16 v[62:63], v230 offset:10752
    s_waitcnt lgkmcnt(5)
    v_mfma_f32_32x32x16_bf16 v[64:79], v[40:43], v[32:35], 0
    ds_read_b128 v[240:243], v4 offset:4096
    ds_read_b64_tr_b16 v[248:249], v228 offset:12288
    ds_read_b64_tr_b16 v[250:251], v228 offset:12800
    v_mfma_f32_32x32x16_bf16 v[80:95], v[44:47], v[32:35], 0
    ds_read_b64_tr_b16 v[252:253], v230 offset:12288
    ds_read_b64_tr_b16 v[254:255], v230 offset:12800
    s_waitcnt lgkmcnt(5)
    v_mfma_f32_32x32x16_bf16 v[64:79], v[56:59], v[48:51], v[64:79]
    ds_read_b128 v[32:35], v4 offset:6144
    ds_read_b64_tr_b16 v[40:41], v228 offset:14336
    ds_read_b64_tr_b16 v[42:43], v228 offset:14848
    v_mfma_f32_32x32x16_bf16 v[80:95], v[60:63], v[48:51], v[80:95]
    ds_read_b64_tr_b16 v[44:45], v230 offset:14336
    ds_read_b64_tr_b16 v[46:47], v230 offset:14848
    s_waitcnt lgkmcnt(5)
    v_mfma_f32_32x32x16_bf16 v[64:79], v[248:251], v[240:243], v[64:79]
    s_waitcnt vmcnt(6) lgkmcnt(0)
    s_barrier
    ds_read_b128 v[48:51], v4 offset:24576
    ds_read_b64_tr_b16 v[56:57], v228 offset:32768
    ds_read_b64_tr_b16 v[58:59], v228 offset:33280
    s_add_u32 m0, s23, 0
    s_add_u32 s25, s20, 0
    buffer_load_dwordx4 v2, s[4:7], s25 offen sc1 lds
    v_mfma_f32_32x32x16_bf16 v[80:95], v[252:255], v[240:243], v[80:95]
    ds_read_b64_tr_b16 v[60:61], v230 offset:32768
    ds_read_b64_tr_b16 v[62:63], v230 offset:33280
    s_add_u32 m0, s23, 4096
    s_add_u32 s25, s20, 131072
    buffer_load_dwordx4 v2, s[4:7], s25 offen sc1 lds
    s_add_u32 s20, s20, 262144
    s_cmp_eq_u32 s20, s37
    s_cselect_b32 s20, s36, s20
    s_waitcnt lgkmcnt(5)
    v_mfma_f32_32x32x16_bf16 v[64:79], v[40:43], v[32:35], v[64:79]
    ds_read_b128 v[240:243], v4 offset:26624
    ds_read_b64_tr_b16 v[248:249], v228 offset:34816
    ds_read_b64_tr_b16 v[250:251], v228 offset:35328
    s_add_u32 m0, s23, 8192
    s_add_u32 s25, s21, 0
    buffer_load_dwordx4 v3, s[8:11], s25 offen lds
    v_mfma_f32_32x32x16_bf16 v[80:95], v[44:47], v[32:35], v[80:95]
    ds_read_b64_tr_b16 v[252:253], v230 offset:34816
    ds_read_b64_tr_b16 v[254:255], v230 offset:35328
    s_add_u32 m0, s23, 12288
    s_add_u32 s25, s21, 40960
    buffer_load_dwordx4 v3, s[8:11], s25 offen lds
    s_waitcnt lgkmcnt(5)
    v_mfma_f32_32x32x16_bf16 v[64:79], v[56:59], v[48:51], v[64:79]
    ds_read_b128 v[32:35], v4 offset:28672
    ds_read_b64_tr_b16 v[40:41], v228 offset:36864
    ds_read_b64_tr_b16 v[42:43], v228 offset:37376
    v_mfma_f32_32x32x16_bf16 v[80:95], v[60:63], v[48:51], v[80:95]
    ds_read_b64_tr_b16 v[44:45], v230 offset:36864
    ds_read_b64_tr_b16 v[46:47], v230 offset:37376
    s_add_u32 m0, s23, 16384
    s_add_u32 s25, s21, 128
    buffer_load_dwordx4 v3, s[12:15], s25 offen lds
    s_waitcnt lgkmcnt(5)
    v_mfma_f32_32x32x16_bf16 v[64:79], v[248:251], v[240:243], v[64:79]
    ds_read_b128 v[48:51], v4 offset:30720
    ds_read_b64_tr_b16 v[56:57], v228 offset:38912
    ds_read_b64_tr_b16 v[58:59], v228 offset:39424
    v_mfma_f32_32x32x16_bf16 v[80:95], v[252:255], v[240:243], v[80:95]
    ds_read_b64_tr_b16 v[60:61], v230 offset:38912
    ds_read_b64_tr_b16 v[62:63], v230 offset:39424
    s_add_u32 m0, s23, 20480
    s_add_u32 s25, s21, 41088
    buffer_load_dwordx4 v3, s[12:15], s25 offen lds
    s_add_u32 s21, s21, 81920
    s_cmp_eq_u32 s21, s39
    s_cselect_b32 s21, s38, s21
    s_waitcnt lgkmcnt(5)
    v_mfma_f32_32x32x16_bf16 v[64:79], v[40:43], v[32:35], v[64:79]
    s_waitcnt vmcnt(6) lgkmcnt(0)
    s_barrier
    ds_read_b128 v[240:243], v4 offset:49152
    ds_read_b64_tr_b16 v[248:249], v228 offset:57344
    ds_read_b64_tr_b16 v[250:251], v228 offset:57856
    s_add_u32 m0, s23, 24576
    s_add_u32 s25, s20, 0
    buffer_load_dwordx4 v2, s[4:7], s25 offen sc1 lds
    v_mfma_f32_32x32x16_bf16 v[80:95], v[44:47], v[32:35], v[80:95]
    ds_read_b64_tr_b16 v[252:253], v230 offset:57344
    ds_read_b64_tr_b16 v[254:255], v230 offset:57856
    s_add_u32 m0, s23, 28672
    s_add_u32 s25, s20, 131072
    buffer_load_dwordx4 v2, s[4:7], s25 offen sc1 lds
    s_add_u32 s20, s20, 262144
    s_cmp_eq_u32 s20, s37
    s_cselect_b32 s20, s36, s20
    s_waitcnt lgkmcnt(5)
    v_mfma_f32_32x32x16_bf16 v[64:79], v[56:59], v[48:51], v[64:79]
    ds_read_b128 v[32:35], v4 offset:51200
    ds_read_b64_tr_b16 v[40:41], v228 offset:59392
    ds_read_b64_tr_b16 v[42:43], v228 offset:59904
    s_add_u32 m0, s23, 32768
    s_add_u32 s25, s21, 0
    buffer_load_dwordx4 v3, s[8:11], s25 offen lds
    v_mfma_f32_32x32x16_bf16 v[80:95], v[60:63], v[48:51], v[80:95]
    ds_read_b64_tr_b16 v[44:45], v230 offset:59392
    ds_read_b64_tr_b16 v[46:47], v230 offset:59904
    s_add_u32 m0, s23, 36864
    s_add_u32 s25, s21, 40960
    buffer_load_dwordx4 v3, s[8:11], s25 offen lds
    s_waitcnt lgkmcnt(5)
    v_mfma_f32_32x32x16_bf16 v[64:79], v[248:251], v[240:243], v[64:79]
    ds_read_b128 v[48:51], v4 offset:53248
    ds_read_b64_tr_b16 v[56:57], v228 offset:61440
    ds_read_b64_tr_b16 v[58:59], v228 offset:61952
    v_mfma_f32_32x32x16_bf16 v[80:95], v[252:255], v[240:243], v[80:95]
    ds_read_b64_tr_b16 v[60:61], v230 offset:61440
    ds_read_b64_tr_b16 v[62:63], v230 offset:61952
    s_add_u32 m0, s23, 40960
    s_add_u32 s25, s21, 128
    buffer_load_dwordx4 v3, s[12:15], s25 offen lds
    s_waitcnt lgkmcnt(5)
    v_mfma_f32_32x32x16_bf16 v[64:79], v[40:43], v[32:35], v[64:79]
    ds_read_b128 v[240:243], v4 offset:55296
    ds_read_b64_tr_b16 v[248:249], v228 offset:63488
    ds_read_b64_tr_b16 v[250:251], v228 offset:64000
    v_mfma_f32_32x32x16_bf16 v[80:95], v[44:47], v[32:35], v[80:95]
    ds_read_b64_tr_b16 v[252:253], v230 offset:63488
    ds_read_b64_tr_b16 v[254:255], v230 offset:64000
    s_add_u32 m0, s23, 45056
    s_add_u32 s25, s21, 41088
    buffer_load_dwordx4 v3, s[12:15], s25 offen lds
    s_add_u32 s21, s21, 81920
    s_cmp_eq_u32 s21, s39
    s_cselect_b32 s21, s38, s21
    s_waitcnt lgkmcnt(5)
    v_mfma_f32_32x32x16_bf16 v[64:79], v[56:59], v[48:51], v[64:79]
    s_waitcnt vmcnt(6) lgkmcnt(0)
    s_barrier
    ds_read_b128 v[32:35], v4 offset:0
    ds_read_b64_tr_b16 v[40:41], v228 offset:8192
    ds_read_b64_tr_b16 v[42:43], v228 offset:8704
    s_add_u32 m0, s23, 49152
    s_add_u32 s25, s20, 0
    buffer_load_dwordx4 v2, s[4:7], s25 offen sc1 lds
    v_mfma_f32_32x32x16_bf16 v[80:95], v[60:63], v[48:51], v[80:95]
    ds_read_b64_tr_b16 v[44:45], v230 offset:8192
    ds_read_b64_tr_b16 v[46:47], v230 offset:8704
    s_add_u32 m0, s23, 53248
    s_add_u32 s25, s20, 131072
    buffer_load_dwordx4 v2, s[4:7], s25 offen sc1 lds
    s_add_u32 s20, s20, 262144
    s_cmp_eq_u32 s20, s37
    s_cselect_b32 s20, s36, s20
    s_waitcnt lgkmcnt(5)
    v_mfma_f32_32x32x16_bf16 v[64:79], v[248:251], v[240:243], v[64:79]
    ds_read_b128 v[48:51], v4 offset:2048
    ds_read_b64_tr_b16 v[56:57], v228 offset:10240
    ds_read_b64_tr_b16 v[58:59], v228 offset:10752
    s_add_u32 m0, s23, 57344
    s_add_u32 s25, s21, 0
    buffer_load_dwordx4 v3, s[8:11], s25 offen lds
    v_mfma_f32_32x32x16_bf16 v[80:95], v[252:255], v[240:243], v[80:95]
    ds_read_b64_tr_b16 v[60:61], v230 offset:10240
    ds_read_b64_tr_b16 v[62:63], v230 offset:10752
    s_add_u32 m0, s23, 61440
    s_add_u32 s25, s21, 40960
    buffer_load_dwordx4 v3, s[8:11], s25 offen lds
    s_waitcnt lgkmcnt(5)
    v_mfma_f32_32x32x16_bf16 v[64:79], v[40:43], v[32:35], v[64:79]
    ds_read_b128 v[240:243], v4 offset:4096
    ds_read_b64_tr_b16 v[248:249], v228 offset:12288
    ds_read_b64_tr_b16 v[250:251], v228 offset:12800
    v_mfma_f32_32x32x16_bf16 v[80:95], v[44:47], v[32:35], v[80:95]
    ds_read_b64_tr_b16 v[252:253], v230 offset:12288
    ds_read_b64_tr_b16 v[254:255], v230 offset:12800
    s_add_u32 m0, s23, 65536
    s_add_u32 s25, s21, 128
    buffer_load_dwordx4 v3, s[12:15], s25 offen lds
    s_waitcnt lgkmcnt(5)
    v_mfma_f32_32x32x16_bf16 v[64:79], v[56:59], v[48:51], v[64:79]
    ds_read_b128 v[32:35], v4 offset:6144
    ds_read_b64_tr_b16 v[40:41], v228 offset:14336
    ds_read_b64_tr_b16 v[42:43], v228 offset:14848
    v_mfma_f32_32x32x16_bf16 v[80:95], v[60:63], v[48:51], v[80:95]
    ds_read_b64_tr_b16 v[44:45], v230 offset:14336
    ds_read_b64_tr_b16 v[46:47], v230 offset:14848
    s_add_u32 m0, s23, 69632
    s_add_u32 s25, s21, 41088
    buffer_load_dwordx4 v3, s[12:15], s25 offen lds
    s_add_u32 s21, s21, 81920
    s_cmp_eq_u32 s21, s39
    s_cselect_b32 s21, s38, s21
    s_waitcnt lgkmcnt(5)
    v_mfma_f32_32x32x16_bf16 v[64:79], v[248:251], v[240:243], v[64:79]
    s_waitcnt vmcnt(6) lgkmcnt(0)
    s_barrier
    ds_read_b128 v[48:51], v4 offset:24576
    ds_read_b64_tr_b16 v[56:57], v228 offset:32768
    ds_read_b64_tr_b16 v[58:59], v228 offset:33280
    s_add_u32 m0, s23, 0
    s_add_u32 s25, s20, 0
    buffer_load_dwordx4 v2, s[4:7], s25 offen sc1 lds
    v_mfma_f32_32x32x16_bf16 v[80:95], v[252:255], v[240:243], v[80:95]
    ds_read_b64_tr_b16 v[60:61], v230 offset:32768
    ds_read_b64_tr_b16 v[62:63], v230 offset:33280
    s_add_u32 m0, s23, 4096
    s_add_u32 s25, s20, 131072
    buffer_load_dwordx4 v2, s[4:7], s25 offen sc1 lds
    s_add_u32 s20, s20, 262144
    s_cmp_eq_u32 s20, s37
    s_cselect_b32 s20, s36, s20
    s_waitcnt lgkmcnt(5)
    v_mfma_f32_32x32x16_bf16 v[64:79], v[40:43], v[32:35], v[64:79]
    ds_read_b128 v[240:243], v4 offset:26624
    ds_read_b64_tr_b16 v[248:249], v228 offset:34816
    ds_read_b64_tr_b16 v[250:251], v228 offset:35328
    s_add_u32 m0, s23, 8192
    s_add_u32 s25, s21, 0
    buffer_load_dwordx4 v3, s[8:11], s25 offen lds
    v_mfma_f32_32x32x16_bf16 v[80:95], v[44:47], v[32:35], v[80:95]
    ds_read_b64_tr_b16 v[252:253], v230 offset:34816
    ds_read_b64_tr_b16 v[254:255], v230 offset:35328
    s_add_u32 m0, s23, 12288
    s_add_u32 s25, s21, 40960
    buffer_load_dwordx4 v3, s[8:11], s25 offen lds
    s_waitcnt lgkmcnt(5)
    v_mfma_f32_32x32x16_bf16 v[64:79], v[56:59], v[48:51], v[64:79]
    ds_read_b128 v[32:35], v4 offset:28672
    ds_read_b64_tr_b16 v[40:41], v228 offset:36864
    ds_read_b64_tr_b16 v[42:43], v228 offset:37376
    v_mfma_f32_32x32x16_bf16 v[80:95], v[60:63], v[48:51], v[80:95]
    ds_read_b64_tr_b16 v[44:45], v230 offset:36864
    ds_read_b64_tr_b16 v[46:47], v230 offset:37376
    s_add_u32 m0, s23, 16384
    s_add_u32 s25, s21, 128
    buffer_load_dwordx4 v3, s[12:15], s25 offen lds
    s_waitcnt lgkmcnt(5)
    v_mfma_f32_32x32x16_bf16 v[64:79], v[248:251], v[240:243], v[64:79]
    ds_read_b128 v[48:51], v4 offset:30720
    ds_read_b64_tr_b16 v[56:57], v228 offset:38912
    ds_read_b64_tr_b16 v[58:59], v228 offset:39424
    v_mfma_f32_32x32x16_bf16 v[80:95], v[252:255], v[240:243], v[80:95]
    ds_read_b64_tr_b16 v[60:61], v230 offset:38912
    ds_read_b64_tr_b16 v[62:63], v230 offset:39424
    s_add_u32 m0, s23, 20480
    s_add_u32 s25, s21, 41088
    buffer_load_dwordx4 v3, s[12:15], s25 offen lds
    s_add_u32 s21, s21, 81920
    s_cmp_eq_u32 s21, s39
    s_cselect_b32 s21, s38, s21
    s_waitcnt lgkmcnt(5)
    v_mfma_f32_32x32x16_bf16 v[64:79], v[40:43], v[32:35], v[64:79]
    s_waitcnt vmcnt(6) lgkmcnt(0)
    s_barrier
    ds_read_b128 v[240:243], v4 offset:49152
    ds_read_b64_tr_b16 v[248:249], v228 offset:57344
    ds_read_b64_tr_b16 v[250:251], v228 offset:57856
    s_add_u32 m0, s23, 24576
    s_add_u32 s25, s20, 0
    buffer_load_dwordx4 v2, s[4:7], s25 offen sc1 lds
    v_mfma_f32_32x32x16_bf16 v[80:95], v[44:47], v[32:35], v[80:95]
    ds_read_b64_tr_b16 v[252:253], v230 offset:57344
    ds_read_b64_tr_b16 v[254:255], v230 offset:57856
    s_add_u32 m0, s23, 28672
    s_add_u32 s25, s20, 131072
    buffer_load_dwordx4 v2, s[4:7], s25 offen sc1 lds
    s_add_u32 s20, s20, 262144
    s_cmp_eq_u32 s20, s37
    s_cselect_b32 s20, s36, s20
    s_waitcnt lgkmcnt(5)
    v_mfma_f32_32x32x16_bf16 v[64:79], v[56:59], v[48:51], v[64:79]
    ds_read_b128 v[32:35], v4 offset:51200
    ds_read_b64_tr_b16 v[40:41], v228 offset:59392
    ds_read_b64_tr_b16 v[42:43], v228 offset:59904
    s_add_u32 m0, s23, 32768
    s_add_u32 s25, s21, 0
    buffer_load_dwordx4 v3, s[8:11], s25 offen lds
    v_mfma_f32_32x32x16_bf16 v[80:95], v[60:63], v[48:51], v[80:95]
    ds_read_b64_tr_b16 v[44:45], v230 offset:59392
    ds_read_b64_tr_b16 v[46:47], v230 offset:59904
    s_add_u32 m0, s23, 36864
    s_add_u32 s25, s21, 40960
    buffer_load_dwordx4 v3, s[8:11], s25 offen lds
    s_waitcnt lgkmcnt(5)
    v_mfma_f32_32x32x16_bf16 v[64:79], v[248:251], v[240:243], v[64:79]
    ds_read_b128 v[48:51], v4 offset:53248
    ds_read_b64_tr_b16 v[56:57], v228 offset:61440
    ds_read_b64_tr_b16 v[58:59], v228 offset:61952
    v_mfma_f32_32x32x16_bf16 v[80:95], v[252:255], v[240:243], v[80:95]
    ds_read_b64_tr_b16 v[60:61], v230 offset:61440
    ds_read_b64_tr_b16 v[62:63], v230 offset:61952
    s_add_u32 m0, s23, 40960
    s_add_u32 s25, s21, 128
    buffer_load_dwordx4 v3, s[12:15], s25 offen lds
    s_waitcnt lgkmcnt(5)
    v_mfma_f32_32x32x16_bf16 v[64:79], v[40:43], v[32:35], v[64:79]
    ds_read_b128 v[240:243], v4 offset:55296
    ds_read_b64_tr_b16 v[248:249], v228 offset:63488
    ds_read_b64_tr_b16 v[250:251], v228 offset:64000
    v_mfma_f32_32x32x16_bf16 v[80:95], v[44:47], v[32:35], v[80:95]
    ds_read_b64_tr_b16 v[252:253], v230 offset:63488
    ds_read_b64_tr_b16 v[254:255], v230 offset:64000
    s_add_u32 m0, s23, 45056
    s_add_u32 s25, s21, 41088
    buffer_load_dwordx4 v3, s[12:15], s25 offen lds
    s_add_u32 s21, s21, 81920
    s_cmp_eq_u32 s21, s39
    s_cselect_b32 s21, s38, s21
    s_waitcnt lgkmcnt(5)
    v_mfma_f32_32x32x16_bf16 v[64:79], v[56:59], v[48:51], v[64:79]
    s_waitcnt vmcnt(6) lgkmcnt(0)
    s_barrier
    ds_read_b128 v[32:35], v4 offset:0
    ds_read_b64_tr_b16 v[40:41], v228 offset:8192
    ds_read_b64_tr_b16 v[42:43], v228 offset:8704
    s_add_u32 m0, s23, 49152
    s_add_u32 s25, s20, 0
    buffer_load_dwordx4 v2, s[4:7], s25 offen sc1 lds
    v_mfma_f32_32x32x16_bf16 v[80:95], v[60:63], v[48:51], v[80:95]
    ds_read_b64_tr_b16 v[44:45], v230 offset:8192
    ds_read_b64_tr_b16 v[46:47], v230 offset:8704
    s_add_u32 m0, s23, 53248
    s_add_u32 s25, s20, 131072
    buffer_load_dwordx4 v2, s[4:7], s25 offen sc1 lds
    s_add_u32 s20, s20, 262144
    s_cmp_eq_u32 s20, s37
    s_cselect_b32 s20, s36, s20
    s_waitcnt lgkmcnt(5)
    v_mfma_f32_32x32x16_bf16 v[64:79], v[248:251], v[240:243], v[64:79]
    ds_read_b128 v[48:51], v4 offset:2048
    ds_read_b64_tr_b16 v[56:57], v228 offset:10240
    ds_read_b64_tr_b16 v[58:59], v228 offset:10752
    s_add_u32 m0, s23, 57344
    s_add_u32 s25, s21, 0
    buffer_load_dwordx4 v3, s[8:11], s25 offen lds
    v_mfma_f32_32x32x16_bf16 v[80:95], v[252:255], v[240:243], v[80:95]
    ds_read_b64_tr_b16 v[60:61], v230 offset:10240
    ds_read_b64_tr_b16 v[62:63], v230 offset:10752
    s_add_u32 m0, s23, 61440
    s_add_u32 s25, s21, 40960
    buffer_load_dwordx4 v3, s[8:11], s25 offen lds
    s_waitcnt lgkmcnt(5)
    v_mfma_f32_32x32x16_bf16 v[64:79], v[40:43], v[32:35], v[64:79]
    ds_read_b128 v[240:243], v4 offset:4096
    ds_read_b64_tr_b16 v[248:249], v228 offset:12288
    ds_read_b64_tr_b16 v[250:251], v228 offset:12800
    v_mfma_f32_32x32x16_bf16 v[80:95], v[44:47], v[32:35], v[80:95]
    ds_read_b64_tr_b16 v[252:253], v230 offset:12288
    ds_read_b64_tr_b16 v[254:255], v230 offset:12800
    s_add_u32 m0, s23, 65536
    s_add_u32 s25, s21, 128
    buffer_load_dwordx4 v3, s[12:15], s25 offen lds
    s_waitcnt lgkmcnt(5)
    v_mfma_f32_32x32x16_bf16 v[64:79], v[56:59], v[48:51], v[64:79]
    ds_read_b128 v[32:35], v4 offset:6144
    ds_read_b64_tr_b16 v[40:41], v228 offset:14336
    ds_read_b64_tr_b16 v[42:43], v228 offset:14848
    v_mfma_f32_32x32x16_bf16 v[80:95], v[60:63], v[48:51], v[80:95]
    ds_read_b64_tr_b16 v[44:45], v230 offset:14336
    ds_read_b64_tr_b16 v[46:47], v230 offset:14848
    s_add_u32 m0, s23, 69632
    s_add_u32 s25, s21, 41088
    buffer_load_dwordx4 v3, s[12:15], s25 offen lds
    s_add_u32 s21, s21, 81920
    s_cmp_eq_u32 s21, s39
    s_cselect_b32 s21, s38, s21
    s_waitcnt lgkmcnt(5)
    v_mfma_f32_32x32x16_bf16 v[64:79], v[248:251], v[240:243], v[64:79]
    s_waitcnt vmcnt(6) lgkmcnt(0)
    s_barrier
    ds_read_b128 v[48:51], v4 offset:24576
    ds_read_b64_tr_b16 v[56:57], v228 offset:32768
    ds_read_b64_tr_b16 v[58:59], v228 offset:33280
    s_add_u32 m0, s23, 0
    s_add_u32 s25, s20, 0
    buffer_load_dwordx4 v2, s[4:7], s25 offen sc1 lds
    v_mfma_f32_32x32x16_bf16 v[80:95], v[252:255], v[240:243], v[80:95]
    ds_read_b64_tr_b16 v[60:61], v230 offset:32768
    ds_read_b64_tr_b16 v[62:63], v230 offset:33280
    s_add_u32 m0, s23, 4096
    s_add_u32 s25, s20, 131072
    buffer_load_dwordx4 v2, s[4:7], s25 offen sc1 lds
    s_add_u32 s20, s20, 262144
    s_cmp_eq_u32 s20, s37
    s_cselect_b32 s20, s36, s20
    s_waitcnt lgkmcnt(5)
    v_mfma_f32_32x32x16_bf16 v[64:79], v[40:43], v[32:35], v[64:79]
    ds_read_b128 v[240:243], v4 offset:26624
    ds_read_b64_tr_b16 v[248:249], v228 offset:34816
    ds_read_b64_tr_b16 v[250:251], v228 offset:35328
    s_add_u32 m0, s23, 8192
    s_add_u32 s25, s21, 0
    buffer_load_dwordx4 v3, s[8:11], s25 offen lds
    v_mfma_f32_32x32x16_bf16 v[80:95], v[44:47], v[32:35], v[80:95]
    ds_read_b64_tr_b16 v[252:253], v230 offset:34816
    ds_read_b64_tr_b16 v[254:255], v230 offset:35328
    s_add_u32 m0, s23, 12288
    s_add_u32 s25, s21, 40960
    buffer_load_dwordx4 v3, s[8:11], s25 offen lds
    s_waitcnt lgkmcnt(5)
    v_mfma_f32_32x32x16_bf16 v[64:79], v[56:59], v[48:51], v[64:79]
    ds_read_b128 v[32:35], v4 offset:28672
    ds_read_b64_tr_b16 v[40:41], v228 offset:36864
    ds_read_b64_tr_b16 v[42:43], v228 offset:37376
    v_mfma_f32_32x32x16_bf16 v[80:95], v[60:63], v[48:51], v[80:95]
    ds_read_b64_tr_b16 v[44:45], v230 offset:36864
    ds_read_b64_tr_b16 v[46:47], v230 offset:37376
    s_add_u32 m0, s23, 16384
    s_add_u32 s25, s21, 128
    buffer_load_dwordx4 v3, s[12:15], s25 offen lds
    s_waitcnt lgkmcnt(5)
    v_mfma_f32_32x32x16_bf16 v[64:79], v[248:251], v[240:243], v[64:79]
    ds_read_b128 v[48:51], v4 offset:30720
    ds_read_b64_tr_b16 v[56:57], v228 offset:38912
    ds_read_b64_tr_b16 v[58:59], v228 offset:39424
    v_mfma_f32_32x32x16_bf16 v[80:95], v[252:255], v[240:243], v[80:95]
    ds_read_b64_tr_b16 v[60:61], v230 offset:38912
    ds_read_b64_tr_b16 v[62:63], v230 offset:39424
    s_add_u32 m0, s23, 20480
    s_add_u32 s25, s21, 41088
    buffer_load_dwordx4 v3, s[12:15], s25 offen lds
    s_add_u32 s21, s21, 81920
    s_cmp_eq_u32 s21, s39
    s_cselect_b32 s21, s38, s21
    s_waitcnt lgkmcnt(5)
    v_mfma_f32_32x32x16_bf16 v[64:79], v[40:43], v[32:35], v[64:79]
    s_waitcnt vmcnt(6) lgkmcnt(0)
    s_barrier
    ds_read_b128 v[240:243], v4 offset:49152
    ds_read_b64_tr_b16 v[248:249], v228 offset:57344
    ds_read_b64_tr_b16 v[250:251], v228 offset:57856
    s_add_u32 m0, s23, 24576
    s_add_u32 s25, s20, 0
    buffer_load_dwordx4 v2, s[4:7], s25 offen sc1 lds
    v_mfma_f32_32x32x16_bf16 v[80:95], v[44:47], v[32:35], v[80:95]
    ds_read_b64_tr_b16 v[252:253], v230 offset:57344
    ds_read_b64_tr_b16 v[254:255], v230 offset:57856
    s_add_u32 m0, s23, 28672
    s_add_u32 s25, s20, 131072
    buffer_load_dwordx4 v2, s[4:7], s25 offen sc1 lds
    s_add_u32 s20, s20, 262144
    s_cmp_eq_u32 s20, s37
    s_cselect_b32 s20, s36, s20
    s_waitcnt lgkmcnt(5)
    v_mfma_f32_32x32x16_bf16 v[64:79], v[56:59], v[48:51], v[64:79]
    ds_read_b128 v[32:35], v4 offset:51200
    ds_read_b64_tr_b16 v[40:41], v228 offset:59392
    ds_read_b64_tr_b16 v[42:43], v228 offset:59904
    s_add_u32 m0, s23, 32768
    s_add_u32 s25, s21, 0
    buffer_load_dwordx4 v3, s[8:11], s25 offen lds
    v_mfma_f32_32x32x16_bf16 v[80:95], v[60:63], v[48:51], v[80:95]
    ds_read_b64_tr_b16 v[44:45], v230 offset:59392
    ds_read_b64_tr_b16 v[46:47], v230 offset:59904
    s_add_u32 m0, s23, 36864
    s_add_u32 s25, s21, 40960
    buffer_load_dwordx4 v3, s[8:11], s25 offen lds
    s_waitcnt lgkmcnt(5)
    v_mfma_f32_32x32x16_bf16 v[64:79], v[248:251], v[240:243], v[64:79]
    ds_read_b128 v[48:51], v4 offset:53248
    ds_read_b64_tr_b16 v[56:57], v228 offset:61440
    ds_read_b64_tr_b16 v[58:59], v228 offset:61952
    v_mfma_f32_32x32x16_bf16 v[80:95], v[252:255], v[240:243], v[80:95]
    ds_read_b64_tr_b16 v[60:61], v230 offset:61440
    ds_read_b64_tr_b16 v[62:63], v230 offset:61952
    s_add_u32 m0, s23, 40960
    s_add_u32 s25, s21, 128
    buffer_load_dwordx4 v3, s[12:15], s25 offen lds
    s_waitcnt lgkmcnt(5)
    v_mfma_f32_32x32x16_bf16 v[64:79], v[40:43], v[32:35], v[64:79]
    ds_read_b128 v[240:243], v4 offset:55296
    ds_read_b64_tr_b16 v[248:249], v228 offset:63488
    ds_read_b64_tr_b16 v[250:251], v228 offset:64000
    v_mfma_f32_32x32x16_bf16 v[80:95], v[44:47], v[32:35], v[80:95]
    ds_read_b64_tr_b16 v[252:253], v230 offset:63488
    ds_read_b64_tr_b16 v[254:255], v230 offset:64000
    s_add_u32 m0, s23, 45056
    s_add_u32 s25, s21, 41088
    buffer_load_dwordx4 v3, s[12:15], s25 offen lds
    s_add_u32 s21, s21, 81920
    s_cmp_eq_u32 s21, s39
    s_cselect_b32 s21, s38, s21
    s_waitcnt lgkmcnt(5)
    v_mfma_f32_32x32x16_bf16 v[64:79], v[56:59], v[48:51], v[64:79]
    s_waitcnt vmcnt(6) lgkmcnt(0)
    s_barrier
    ds_read_b128 v[32:35], v4 offset:0
    ds_read_b64_tr_b16 v[40:41], v228 offset:8192
    ds_read_b64_tr_b16 v[42:43], v228 offset:8704
    s_add_u32 m0, s23, 49152
    s_add_u32 s25, s20, 0
    buffer_load_dwordx4 v2, s[4:7], s25 offen sc1 lds
    v_mfma_f32_32x32x16_bf16 v[80:95], v[60:63], v[48:51], v[80:95]
    ds_read_b64_tr_b16 v[44:45], v230 offset:8192
    ds_read_b64_tr_b16 v[46:47], v230 offset:8704
    s_add_u32 m0, s23, 53248
    s_add_u32 s25, s20, 131072
    buffer_load_dwordx4 v2, s[4:7], s25 offen sc1 lds
    s_add_u32 s20, s20, 262144
    s_cmp_eq_u32 s20, s37
    s_cselect_b32 s20, s36, s20
    s_waitcnt lgkmcnt(5)
    v_mfma_f32_32x32x16_bf16 v[64:79], v[248:251], v[240:243], v[64:79]
    ds_read_b128 v[48:51], v4 offset:2048
    ds_read_b64_tr_b16 v[56:57], v228 offset:10240
    ds_read_b64_tr_b16 v[58:59], v228 offset:10752
    s_add_u32 m0, s23, 57344
    s_add_u32 s25, s21, 0
    buffer_load_dwordx4 v3, s[8:11], s25 offen lds
    v_mfma_f32_32x32x16_bf16 v[80:95], v[252:255], v[240:243], v[80:95]
    ds_read_b64_tr_b16 v[60:61], v230 offset:10240
    ds_read_b64_tr_b16 v[62:63], v230 offset:10752
    s_add_u32 m0, s23, 61440
    s_add_u32 s25, s21, 40960
    buffer_load_dwordx4 v3, s[8:11], s25 offen lds
    s_waitcnt lgkmcnt(5)
    v_mfma_f32_32x32x16_bf16 v[64:79], v[40:43], v[32:35], v[64:79]
    ds_read_b128 v[240:243], v4 offset:4096
    ds_read_b64_tr_b16 v[248:249], v228 offset:12288
    ds_read_b64_tr_b16 v[250:251], v228 offset:12800
    v_mfma_f32_32x32x16_bf16 v[80:95], v[44:47], v[32:35], v[80:95]
    ds_read_b64_tr_b16 v[252:253], v230 offset:12288
    ds_read_b64_tr_b16 v[254:255], v230 offset:12800
    s_add_u32 m0, s23, 65536
    s_add_u32 s25, s21, 128
    buffer_load_dwordx4 v3, s[12:15], s25 offen lds
    s_waitcnt lgkmcnt(5)
    v_mfma_f32_32x32x16_bf16 v[64:79], v[56:59], v[48:51], v[64:79]
    ds_read_b128 v[32:35], v4 offset:6144
    ds_read_b64_tr_b16 v[40:41], v228 offset:14336
    ds_read_b64_tr_b16 v[42:43], v228 offset:14848
    v_mfma_f32_32x32x16_bf16 v[80:95], v[60:63], v[48:51], v[80:95]
    ds_read_b64_tr_b16 v[44:45], v230 offset:14336
    ds_read_b64_tr_b16 v[46:47], v230 offset:14848
    s_add_u32 m0, s23, 69632
    s_add_u32 s25, s21, 41088
    buffer_load_dwordx4 v3, s[12:15], s25 offen lds
    s_add_u32 s21, s21, 81920
    s_cmp_eq_u32 s21, s39
    s_cselect_b32 s21, s38, s21
    s_waitcnt lgkmcnt(5)
    v_mfma_f32_32x32x16_bf16 v[64:79], v[248:251], v[240:243], v[64:79]
    s_waitcnt vmcnt(6) lgkmcnt(0)
    s_barrier
    ds_read_b128 v[48:51], v4 offset:24576
    ds_read_b64_tr_b16 v[56:57], v228 offset:32768
    ds_read_b64_tr_b16 v[58:59], v228 offset:33280
    s_add_u32 m0, s23, 0
    s_add_u32 s25, s20, 0
    buffer_load_dwordx4 v2, s[4:7], s25 offen sc1 lds
    v_mfma_f32_32x32x16_bf16 v[80:95], v[252:255], v[240:243], v[80:95]
    ds_read_b64_tr_b16 v[60:61], v230 offset:32768
    ds_read_b64_tr_b16 v[62:63], v230 offset:33280
    s_add_u32 m0, s23, 4096
    s_add_u32 s25, s20, 131072
    buffer_load_dwordx4 v2, s[4:7], s25 offen sc1 lds
    s_add_u32 s20, s20, 262144
    s_cmp_eq_u32 s20, s37
    s_cselect_b32 s20, s36, s20
    s_waitcnt lgkmcnt(5)
    v_mfma_f32_32x32x16_bf16 v[64:79], v[40:43], v[32:35], v[64:79]
    ds_read_b128 v[240:243], v4 offset:26624
    ds_read_b64_tr_b16 v[248:249], v228 offset:34816
    ds_read_b64_tr_b16 v[250:251], v228 offset:35328
    s_add_u32 m0, s23, 8192
    s_add_u32 s25, s21, 0
    buffer_load_dwordx4 v3, s[8:11], s25 offen lds
    v_mfma_f32_32x32x16_bf16 v[80:95], v[44:47], v[32:35], v[80:95]
    ds_read_b64_tr_b16 v[252:253], v230 offset:34816
    ds_read_b64_tr_b16 v[254:255], v230 offset:35328
    s_add_u32 m0, s23, 12288
    s_add_u32 s25, s21, 40960
    buffer_load_dwordx4 v3, s[8:11], s25 offen lds
    s_waitcnt lgkmcnt(5)
    v_mfma_f32_32x32x16_bf16 v[64:79], v[56:59], v[48:51], v[64:79]
    ds_read_b128 v[32:35], v4 offset:28672
    ds_read_b64_tr_b16 v[40:41], v228 offset:36864
    ds_read_b64_tr_b16 v[42:43], v228 offset:37376
    v_mfma_f32_32x32x16_bf16 v[80:95], v[60:63], v[48:51], v[80:95]
    ds_read_b64_tr_b16 v[44:45], v230 offset:36864
    ds_read_b64_tr_b16 v[46:47], v230 offset:37376
    s_add_u32 m0, s23, 16384
    s_add_u32 s25, s21, 128
    buffer_load_dwordx4 v3, s[12:15], s25 offen lds
    s_waitcnt lgkmcnt(5)
    v_mfma_f32_32x32x16_bf16 v[64:79], v[248:251], v[240:243], v[64:79]
    ds_read_b128 v[48:51], v4 offset:30720
    ds_read_b64_tr_b16 v[56:57], v228 offset:38912
    ds_read_b64_tr_b16 v[58:59], v228 offset:39424
    v_mfma_f32_32x32x16_bf16 v[80:95], v[252:255], v[240:243], v[80:95]
    ds_read_b64_tr_b16 v[60:61], v230 offset:38912
    ds_read_b64_tr_b16 v[62:63], v230 offset:39424
    s_add_u32 m0, s23, 20480
    s_add_u32 s25, s21, 41088
    buffer_load_dwordx4 v3, s[12:15], s25 offen lds
    s_add_u32 s21, s21, 81920
    s_cmp_eq_u32 s21, s39
    s_cselect_b32 s21, s38, s21
    s_waitcnt lgkmcnt(5)
    v_mfma_f32_32x32x16_bf16 v[64:79], v[40:43], v[32:35], v[64:79]
    s_waitcnt vmcnt(6) lgkmcnt(0)
    s_barrier
    ds_read_b128 v[240:243], v4 offset:49152
    ds_read_b64_tr_b16 v[248:249], v228 offset:57344
    ds_read_b64_tr_b16 v[250:251], v228 offset:57856
    s_add_u32 m0, s23, 24576
    s_add_u32 s25, s20, 0
    buffer_load_dwordx4 v2, s[4:7], s25 offen sc1 lds
    v_mfma_f32_32x32x16_bf16 v[80:95], v[44:47], v[32:35], v[80:95]
    ds_read_b64_tr_b16 v[252:253], v230 offset:57344
    ds_read_b64_tr_b16 v[254:255], v230 offset:57856
    s_add_u32 m0, s23, 28672
    s_add_u32 s25, s20, 131072
    buffer_load_dwordx4 v2, s[4:7], s25 offen sc1 lds
    s_add_u32 s20, s20, 262144
    s_cmp_eq_u32 s20, s37
    s_cselect_b32 s20, s36, s20
    s_waitcnt lgkmcnt(5)
    v_mfma_f32_32x32x16_bf16 v[64:79], v[56:59], v[48:51], v[64:79]
    ds_read_b128 v[32:35], v4 offset:51200
    ds_read_b64_tr_b16 v[40:41], v228 offset:59392
    ds_read_b64_tr_b16 v[42:43], v228 offset:59904
    s_add_u32 m0, s23, 32768
    s_add_u32 s25, s21, 0
    buffer_load_dwordx4 v3, s[8:11], s25 offen lds
    v_mfma_f32_32x32x16_bf16 v[80:95], v[60:63], v[48:51], v[80:95]
    ds_read_b64_tr_b16 v[44:45], v230 offset:59392
    ds_read_b64_tr_b16 v[46:47], v230 offset:59904
    s_add_u32 m0, s23, 36864
    s_add_u32 s25, s21, 40960
    buffer_load_dwordx4 v3, s[8:11], s25 offen lds
    s_waitcnt lgkmcnt(5)
    v_mfma_f32_32x32x16_bf16 v[64:79], v[248:251], v[240:243], v[64:79]
    ds_read_b128 v[48:51], v4 offset:53248
    ds_read_b64_tr_b16 v[56:57], v228 offset:61440
    ds_read_b64_tr_b16 v[58:59], v228 offset:61952
    v_mfma_f32_32x32x16_bf16 v[80:95], v[252:255], v[240:243], v[80:95]
    ds_read_b64_tr_b16 v[60:61], v230 offset:61440
    ds_read_b64_tr_b16 v[62:63], v230 offset:61952
    s_add_u32 m0, s23, 40960
    s_add_u32 s25, s21, 128
    buffer_load_dwordx4 v3, s[12:15], s25 offen lds
    s_waitcnt lgkmcnt(5)
    v_mfma_f32_32x32x16_bf16 v[64:79], v[40:43], v[32:35], v[64:79]
    ds_read_b128 v[240:243], v4 offset:55296
    ds_read_b64_tr_b16 v[248:249], v228 offset:63488
    ds_read_b64_tr_b16 v[250:251], v228 offset:64000
    v_mfma_f32_32x32x16_bf16 v[80:95], v[44:47], v[32:35], v[80:95]
    ds_read_b64_tr_b16 v[252:253], v230 offset:63488
    ds_read_b64_tr_b16 v[254:255], v230 offset:64000
    s_add_u32 m0, s23, 45056
    s_add_u32 s25, s21, 41088
    buffer_load_dwordx4 v3, s[12:15], s25 offen lds
    s_add_u32 s21, s21, 81920
    s_cmp_eq_u32 s21, s39
    s_cselect_b32 s21, s38, s21
    s_waitcnt lgkmcnt(5)
    v_mfma_f32_32x32x16_bf16 v[64:79], v[56:59], v[48:51], v[64:79]
    s_waitcnt vmcnt(6) lgkmcnt(0)
    s_barrier
    ds_read_b128 v[32:35], v4 offset:0
    ds_read_b64_tr_b16 v[40:41], v228 offset:8192
    ds_read_b64_tr_b16 v[42:43], v228 offset:8704
    s_add_u32 m0, s23, 49152
    s_add_u32 s25, s20, 0
    buffer_load_dwordx4 v2, s[4:7], s25 offen sc1 lds
    v_mfma_f32_32x32x16_bf16 v[80:95], v[60:63], v[48:51], v[80:95]
    ds_read_b64_tr_b16 v[44:45], v230 offset:8192
    ds_read_b64_tr_b16 v[46:47], v230 offset:8704
    s_add_u32 m0, s23, 53248
    s_add_u32 s25, s20, 131072
    buffer_load_dwordx4 v2, s[4:7], s25 offen sc1 lds
    s_add_u32 s20, s20, 262144
    s_cmp_eq_u32 s20, s37
    s_cselect_b32 s20, s36, s20
    s_waitcnt lgkmcnt(5)
    v_mfma_f32_32x32x16_bf16 v[64:79], v[248:251], v[240:243], v[64:79]
    ds_read_b128 v[48:51], v4 offset:2048
    ds_read_b64_tr_b16 v[56:57], v228 offset:10240
    ds_read_b64_tr_b16 v[58:59], v228 offset:10752
    s_add_u32 m0, s23, 57344
    s_add_u32 s25, s21, 0
    buffer_load_dwordx4 v3, s[8:11], s25 offen lds
    v_mfma_f32_32x32x16_bf16 v[80:95], v[252:255], v[240:243], v[80:95]
    ds_read_b64_tr_b16 v[60:61], v230 offset:10240
    ds_read_b64_tr_b16 v[62:63], v230 offset:10752
    s_add_u32 m0, s23, 61440
    s_add_u32 s25, s21, 40960
    buffer_load_dwordx4 v3, s[8:11], s25 offen lds
    s_waitcnt lgkmcnt(5)
    v_mfma_f32_32x32x16_bf16 v[64:79], v[40:43], v[32:35], v[64:79]
    ds_read_b128 v[240:243], v4 offset:4096
    ds_read_b64_tr_b16 v[248:249], v228 offset:12288
    ds_read_b64_tr_b16 v[250:251], v228 offset:12800
    v_mfma_f32_32x32x16_bf16 v[80:95], v[44:47], v[32:35], v[80:95]
    ds_read_b64_tr_b16 v[252:253], v230 offset:12288
    ds_read_b64_tr_b16 v[254:255], v230 offset:12800
    s_add_u32 m0, s23, 65536
    s_add_u32 s25, s21, 128
    buffer_load_dwordx4 v3, s[12:15], s25 offen lds
    s_waitcnt lgkmcnt(5)
    v_mfma_f32_32x32x16_bf16 v[64:79], v[56:59], v[48:51], v[64:79]
    ds_read_b128 v[32:35], v4 offset:6144
    ds_read_b64_tr_b16 v[40:41], v228 offset:14336
    ds_read_b64_tr_b16 v[42:43], v228 offset:14848
    v_mfma_f32_32x32x16_bf16 v[80:95], v[60:63], v[48:51], v[80:95]
    ds_read_b64_tr_b16 v[44:45], v230 offset:14336
    ds_read_b64_tr_b16 v[46:47], v230 offset:14848
    s_add_u32 m0, s23, 69632
    s_add_u32 s25, s21, 41088
    buffer_load_dwordx4 v3, s[12:15], s25 offen lds
    s_add_u32 s21, s21, 81920
    s_cmp_eq_u32 s21, s39
    s_cselect_b32 s21, s38, s21
    s_waitcnt lgkmcnt(5)
    v_mfma_f32_32x32x16_bf16 v[64:79], v[248:251], v[240:243], v[64:79]
    s_waitcnt vmcnt(6) lgkmcnt(0)
    s_barrier
    ds_read_b128 v[48:51], v4 offset:24576
    ds_read_b64_tr_b16 v[56:57], v228 offset:32768
    ds_read_b64_tr_b16 v[58:59], v228 offset:33280
    s_add_u32 m0, s23, 0
    s_add_u32 s25, s20, 0
    buffer_load_dwordx4 v2, s[4:7], s25 offen sc1 lds
    v_mfma_f32_32x32x16_bf16 v[80:95], v[252:255], v[240:243], v[80:95]
    ds_read_b64_tr_b16 v[60:61], v230 offset:32768
    ds_read_b64_tr_b16 v[62:63], v230 offset:33280
    s_add_u32 m0, s23, 4096
    s_add_u32 s25, s20, 131072
    buffer_load_dwordx4 v2, s[4:7], s25 offen sc1 lds
    s_add_u32 s20, s20, 262144
    s_cmp_eq_u32 s20, s37
    s_cselect_b32 s20, s36, s20
    s_waitcnt lgkmcnt(5)
    v_mfma_f32_32x32x16_bf16 v[64:79], v[40:43], v[32:35], v[64:79]
    ds_read_b128 v[240:243], v4 offset:26624
    ds_read_b64_tr_b16 v[248:249], v228 offset:34816
    ds_read_b64_tr_b16 v[250:251], v228 offset:35328
    s_add_u32 m0, s23, 8192
    s_add_u32 s25, s21, 0
    buffer_load_dwordx4 v3, s[8:11], s25 offen lds
    v_mfma_f32_32x32x16_bf16 v[80:95], v[44:47], v[32:35], v[80:95]
    ds_read_b64_tr_b16 v[252:253], v230 offset:34816
    ds_read_b64_tr_b16 v[254:255], v230 offset:35328
    s_add_u32 m0, s23, 12288
    s_add_u32 s25, s21, 40960
    buffer_load_dwordx4 v3, s[8:11], s25 offen lds
    s_waitcnt lgkmcnt(5)
    v_mfma_f32_32x32x16_bf16 v[64:79], v[56:59], v[48:51], v[64:79]
    ds_read_b128 v[32:35], v4 offset:28672
    ds_read_b64_tr_b16 v[40:41], v228 offset:36864
    ds_read_b64_tr_b16 v[42:43], v228 offset:37376
    v_mfma_f32_32x32x16_bf16 v[80:95], v[60:63], v[48:51], v[80:95]
    ds_read_b64_tr_b16 v[44:45], v230 offset:36864
    ds_read_b64_tr_b16 v[46:47], v230 offset:37376
    s_add_u32 m0, s23, 16384
    s_add_u32 s25, s21, 128
    buffer_load_dwordx4 v3, s[12:15], s25 offen lds
    s_waitcnt lgkmcnt(5)
    v_mfma_f32_32x32x16_bf16 v[64:79], v[248:251], v[240:243], v[64:79]
    ds_read_b128 v[48:51], v4 offset:30720
    ds_read_b64_tr_b16 v[56:57], v228 offset:38912
    ds_read_b64_tr_b16 v[58:59], v228 offset:39424
    v_mfma_f32_32x32x16_bf16 v[80:95], v[252:255], v[240:243], v[80:95]
    ds_read_b64_tr_b16 v[60:61], v230 offset:38912
    ds_read_b64_tr_b16 v[62:63], v230 offset:39424
    s_add_u32 m0, s23, 20480
    s_add_u32 s25, s21, 41088
    buffer_load_dwordx4 v3, s[12:15], s25 offen lds
    s_add_u32 s21, s21, 81920
    s_cmp_eq_u32 s21, s39
    s_cselect_b32 s21, s38, s21
    s_waitcnt lgkmcnt(5)
    v_mfma_f32_32x32x16_bf16 v[64:79], v[40:43], v[32:35], v[64:79]
    s_waitcnt vmcnt(6) lgkmcnt(0)
    s_barrier
    ds_read_b128 v[240:243], v4 offset:49152
    ds_read_b64_tr_b16 v[248:249], v228 offset:57344
    ds_read_b64_tr_b16 v[250:251], v228 offset:57856
    s_add_u32 m0, s23, 24576
    s_add_u32 s25, s20, 0
    buffer_load_dwordx4 v2, s[4:7], s25 offen sc1 lds
    v_mfma_f32_32x32x16_bf16 v[80:95], v[44:47], v[32:35], v[80:95]
    ds_read_b64_tr_b16 v[252:253], v230 offset:57344
    ds_read_b64_tr_b16 v[254:255], v230 offset:57856
    s_add_u32 m0, s23, 28672
    s_add_u32 s25, s20, 131072
    buffer_load_dwordx4 v2, s[4:7], s25 offen sc1 lds
    s_add_u32 s20, s20, 262144
    s_cmp_eq_u32 s20, s37
    s_cselect_b32 s20, s36, s20
    s_waitcnt lgkmcnt(5)
    v_mfma_f32_32x32x16_bf16 v[64:79], v[56:59], v[48:51], v[64:79]
    ds_read_b128 v[32:35], v4 offset:51200
    ds_read_b64_tr_b16 v[40:41], v228 offset:59392
    ds_read_b64_tr_b16 v[42:43], v228 offset:59904
    s_add_u32 m0, s23, 32768
    s_add_u32 s25, s21, 0
    buffer_load_dwordx4 v3, s[8:11], s25 offen lds
    v_mfma_f32_32x32x16_bf16 v[80:95], v[60:63], v[48:51], v[80:95]
    ds_read_b64_tr_b16 v[44:45], v230 offset:59392
    ds_read_b64_tr_b16 v[46:47], v230 offset:59904
    s_add_u32 m0, s23, 36864
    s_add_u32 s25, s21, 40960
    buffer_load_dwordx4 v3, s[8:11], s25 offen lds
    s_waitcnt lgkmcnt(5)
    v_mfma_f32_32x32x16_bf16 v[64:79], v[248:251], v[240:243], v[64:79]
    ds_read_b128 v[48:51], v4 offset:53248
    ds_read_b64_tr_b16 v[56:57], v228 offset:61440
    ds_read_b64_tr_b16 v[58:59], v228 offset:61952
    v_mfma_f32_32x32x16_bf16 v[80:95], v[252:255], v[240:243], v[80:95]
    ds_read_b64_tr_b16 v[60:61], v230 offset:61440
    ds_read_b64_tr_b16 v[62:63], v230 offset:61952
    s_add_u32 m0, s23, 40960
    s_add_u32 s25, s21, 128
    buffer_load_dwordx4 v3, s[12:15], s25 offen lds
    s_waitcnt lgkmcnt(5)
    v_mfma_f32_32x32x16_bf16 v[64:79], v[40:43], v[32:35], v[64:79]
    ds_read_b128 v[240:243], v4 offset:55296
    ds_read_b64_tr_b16 v[248:249], v228 offset:63488
    ds_read_b64_tr_b16 v[250:251], v228 offset:64000
    v_mfma_f32_32x32x16_bf16 v[80:95], v[44:47], v[32:35], v[80:95]
    ds_read_b64_tr_b16 v[252:253], v230 offset:63488
    ds_read_b64_tr_b16 v[254:255], v230 offset:64000
    s_add_u32 m0, s23, 45056
    s_add_u32 s25, s21, 41088
    buffer_load_dwordx4 v3, s[12:15], s25 offen lds
    s_add_u32 s21, s21, 81920
    s_cmp_eq_u32 s21, s39
    s_cselect_b32 s21, s38, s21
    s_waitcnt lgkmcnt(5)
    v_mfma_f32_32x32x16_bf16 v[64:79], v[56:59], v[48:51], v[64:79]
    s_waitcnt vmcnt(6) lgkmcnt(0)
    s_barrier
    ds_read_b128 v[32:35], v4 offset:0
    ds_read_b64_tr_b16 v[40:41], v228 offset:8192
    ds_read_b64_tr_b16 v[42:43], v228 offset:8704
    s_add_u32 m0, s23, 49152
    s_add_u32 s25, s20, 0
    buffer_load_dwordx4 v2, s[4:7], s25 offen sc1 lds
    v_mfma_f32_32x32x16_bf16 v[80:95], v[60:63], v[48:51], v[80:95]
    ds_read_b64_tr_b16 v[44:45], v230 offset:8192
    ds_read_b64_tr_b16 v[46:47], v230 offset:8704
    s_add_u32 m0, s23, 53248
    s_add_u32 s25, s20, 131072
    buffer_load_dwordx4 v2, s[4:7], s25 offen sc1 lds
    s_add_u32 s20, s20, 262144
    s_cmp_eq_u32 s20, s37
    s_cselect_b32 s20, s36, s20
    s_waitcnt lgkmcnt(5)
    v_mfma_f32_32x32x16_bf16 v[64:79], v[248:251], v[240:243], v[64:79]
    ds_read_b128 v[48:51], v4 offset:2048
    ds_read_b64_tr_b16 v[56:57], v228 offset:10240
    ds_read_b64_tr_b16 v[58:59], v228 offset:10752
    s_add_u32 m0, s23, 57344
    s_add_u32 s25, s21, 0
    buffer_load_dwordx4 v3, s[8:11], s25 offen lds
    v_mfma_f32_32x32x16_bf16 v[80:95], v[252:255], v[240:243], v[80:95]
    ds_read_b64_tr_b16 v[60:61], v230 offset:10240
    ds_read_b64_tr_b16 v[62:63], v230 offset:10752
    s_add_u32 m0, s23, 61440
    s_add_u32 s25, s21, 40960
    buffer_load_dwordx4 v3, s[8:11], s25 offen lds
    s_waitcnt lgkmcnt(5)
    v_mfma_f32_32x32x16_bf16 v[64:79], v[40:43], v[32:35], v[64:79]
    ds_read_b128 v[240:243], v4 offset:4096
    ds_read_b64_tr_b16 v[248:249], v228 offset:12288
    ds_read_b64_tr_b16 v[250:251], v228 offset:12800
    v_mfma_f32_32x32x16_bf16 v[80:95], v[44:47], v[32:35], v[80:95]
    ds_read_b64_tr_b16 v[252:253], v230 offset:12288
    ds_read_b64_tr_b16 v[254:255], v230 offset:12800
    s_add_u32 m0, s23, 65536
    s_add_u32 s25, s21, 128
    buffer_load_dwordx4 v3, s[12:15], s25 offen lds
    s_waitcnt lgkmcnt(5)
    v_mfma_f32_32x32x16_bf16 v[64:79], v[56:59], v[48:51], v[64:79]
    ds_read_b128 v[32:35], v4 offset:6144
    ds_read_b64_tr_b16 v[40:41], v228 offset:14336
    ds_read_b64_tr_b16 v[42:43], v228 offset:14848
    v_mfma_f32_32x32x16_bf16 v[80:95], v[60:63], v[48:51], v[80:95]
    ds_read_b64_tr_b16 v[44:45], v230 offset:14336
    ds_read_b64_tr_b16 v[46:47], v230 offset:14848
    s_add_u32 m0, s23, 69632
    s_add_u32 s25, s21, 41088
    buffer_load_dwordx4 v3, s[12:15], s25 offen lds
    s_add_u32 s21, s21, 81920
    s_cmp_eq_u32 s21, s39
    s_cselect_b32 s21, s38, s21
    s_waitcnt lgkmcnt(5)
    v_mfma_f32_32x32x16_bf16 v[64:79], v[248:251], v[240:243], v[64:79]
    s_waitcnt vmcnt(6) lgkmcnt(0)
    s_barrier
    ds_read_b128 v[48:51], v4 offset:24576
    ds_read_b64_tr_b16 v[56:57], v228 offset:32768
    ds_read_b64_tr_b16 v[58:59], v228 offset:33280
    s_add_u32 m0, s23, 0
    s_add_u32 s25, s20, 0
    buffer_load_dwordx4 v2, s[4:7], s25 offen sc1 lds
    v_mfma_f32_32x32x16_bf16 v[80:95], v[252:255], v[240:243], v[80:95]
    ds_read_b64_tr_b16 v[60:61], v230 offset:32768
    ds_read_b64_tr_b16 v[62:63], v230 offset:33280
    s_add_u32 m0, s23, 4096
    s_add_u32 s25, s20, 131072
    buffer_load_dwordx4 v2, s[4:7], s25 offen sc1 lds
    s_add_u32 s20, s20, 262144
    s_cmp_eq_u32 s20, s37
    s_cselect_b32 s20, s36, s20
    s_waitcnt lgkmcnt(5)
    v_mfma_f32_32x32x16_bf16 v[64:79], v[40:43], v[32:35], v[64:79]
    ds_read_b128 v[240:243], v4 offset:26624
    ds_read_b64_tr_b16 v[248:249], v228 offset:34816
    ds_read_b64_tr_b16 v[250:251], v228 offset:35328
    s_add_u32 m0, s23, 8192
    s_add_u32 s25, s21, 0
    buffer_load_dwordx4 v3, s[8:11], s25 offen lds
    v_mfma_f32_32x32x16_bf16 v[80:95], v[44:47], v[32:35], v[80:95]
    ds_read_b64_tr_b16 v[252:253], v230 offset:34816
    ds_read_b64_tr_b16 v[254:255], v230 offset:35328
    s_add_u32 m0, s23, 12288
    s_add_u32 s25, s21, 40960
    buffer_load_dwordx4 v3, s[8:11], s25 offen lds
    s_waitcnt lgkmcnt(5)
    v_mfma_f32_32x32x16_bf16 v[64:79], v[56:59], v[48:51], v[64:79]
    ds_read_b128 v[32:35], v4 offset:28672
    ds_read_b64_tr_b16 v[40:41], v228 offset:36864
    ds_read_b64_tr_b16 v[42:43], v228 offset:37376
    v_mfma_f32_32x32x16_bf16 v[80:95], v[60:63], v[48:51], v[80:95]
    ds_read_b64_tr_b16 v[44:45], v230 offset:36864
    ds_read_b64_tr_b16 v[46:47], v230 offset:37376
    s_add_u32 m0, s23, 16384
    s_add_u32 s25, s21, 128
    buffer_load_dwordx4 v3, s[12:15], s25 offen lds
    s_waitcnt lgkmcnt(5)
    v_mfma_f32_32x32x16_bf16 v[64:79], v[248:251], v[240:243], v[64:79]
    ds_read_b128 v[48:51], v4 offset:30720
    ds_read_b64_tr_b16 v[56:57], v228 offset:38912
    ds_read_b64_tr_b16 v[58:59], v228 offset:39424
    v_mfma_f32_32x32x16_bf16 v[80:95], v[252:255], v[240:243], v[80:95]
    ds_read_b64_tr_b16 v[60:61], v230 offset:38912
    ds_read_b64_tr_b16 v[62:63], v230 offset:39424
    s_add_u32 m0, s23, 20480
    s_add_u32 s25, s21, 41088
    buffer_load_dwordx4 v3, s[12:15], s25 offen lds
    s_add_u32 s21, s21, 81920
    s_cmp_eq_u32 s21, s39
    s_cselect_b32 s21, s38, s21
    s_waitcnt lgkmcnt(5)
    v_mfma_f32_32x32x16_bf16 v[64:79], v[40:43], v[32:35], v[64:79]
    s_waitcnt vmcnt(6) lgkmcnt(0)
    s_barrier
    ds_read_b128 v[240:243], v4 offset:49152
    ds_read_b64_tr_b16 v[248:249], v228 offset:57344
    ds_read_b64_tr_b16 v[250:251], v228 offset:57856
    s_add_u32 m0, s23, 24576
    s_add_u32 s25, s20, 0
    buffer_load_dwordx4 v2, s[4:7], s25 offen sc1 lds
    v_mfma_f32_32x32x16_bf16 v[80:95], v[44:47], v[32:35], v[80:95]
    ds_read_b64_tr_b16 v[252:253], v230 offset:57344
    ds_read_b64_tr_b16 v[254:255], v230 offset:57856
    s_add_u32 m0, s23, 28672
    s_add_u32 s25, s20, 131072
    buffer_load_dwordx4 v2, s[4:7], s25 offen sc1 lds
    s_add_u32 s20, s20, 262144
    s_cmp_eq_u32 s20, s37
    s_cselect_b32 s20, s36, s20
    s_waitcnt lgkmcnt(5)
    v_mfma_f32_32x32x16_bf16 v[64:79], v[56:59], v[48:51], v[64:79]
    ds_read_b128 v[32:35], v4 offset:51200
    ds_read_b64_tr_b16 v[40:41], v228 offset:59392
    ds_read_b64_tr_b16 v[42:43], v228 offset:59904
    s_add_u32 m0, s23, 32768
    s_add_u32 s25, s21, 0
    buffer_load_dwordx4 v3, s[8:11], s25 offen lds
    v_mfma_f32_32x32x16_bf16 v[80:95], v[60:63], v[48:51], v[80:95]
    ds_read_b64_tr_b16 v[44:45], v230 offset:59392
    ds_read_b64_tr_b16 v[46:47], v230 offset:59904
    s_add_u32 m0, s23, 36864
    s_add_u32 s25, s21, 40960
    buffer_load_dwordx4 v3, s[8:11], s25 offen lds
    s_waitcnt lgkmcnt(5)
    v_mfma_f32_32x32x16_bf16 v[64:79], v[248:251], v[240:243], v[64:79]
    ds_read_b128 v[48:51], v4 offset:53248
    ds_read_b64_tr_b16 v[56:57], v228 offset:61440
    ds_read_b64_tr_b16 v[58:59], v228 offset:61952
    v_mfma_f32_32x32x16_bf16 v[80:95], v[252:255], v[240:243], v[80:95]
    ds_read_b64_tr_b16 v[60:61], v230 offset:61440
    ds_read_b64_tr_b16 v[62:63], v230 offset:61952
    s_add_u32 m0, s23, 40960
    s_add_u32 s25, s21, 128
    buffer_load_dwordx4 v3, s[12:15], s25 offen lds
    s_waitcnt lgkmcnt(5)
    v_mfma_f32_32x32x16_bf16 v[64:79], v[40:43], v[32:35], v[64:79]
    ds_read_b128 v[240:243], v4 offset:55296
    ds_read_b64_tr_b16 v[248:249], v228 offset:63488
    ds_read_b64_tr_b16 v[250:251], v228 offset:64000
    v_mfma_f32_32x32x16_bf16 v[80:95], v[44:47], v[32:35], v[80:95]
    ds_read_b64_tr_b16 v[252:253], v230 offset:63488
    ds_read_b64_tr_b16 v[254:255], v230 offset:64000
    s_add_u32 m0, s23, 45056
    s_add_u32 s25, s21, 41088
    buffer_load_dwordx4 v3, s[12:15], s25 offen lds
    s_add_u32 s21, s21, 81920
    s_cmp_eq_u32 s21, s39
    s_cselect_b32 s21, s38, s21
    s_waitcnt lgkmcnt(5)
    v_mfma_f32_32x32x16_bf16 v[64:79], v[56:59], v[48:51], v[64:79]
    s_waitcnt vmcnt(6) lgkmcnt(0)
    s_barrier
    ds_read_b128 v[32:35], v4 offset:0
    ds_read_b64_tr_b16 v[40:41], v228 offset:8192
    ds_read_b64_tr_b16 v[42:43], v228 offset:8704
    s_add_u32 m0, s23, 49152
    s_add_u32 s25, s20, 0
    buffer_load_dwordx4 v2, s[4:7], s25 offen sc1 lds
    v_mfma_f32_32x32x16_bf16 v[80:95], v[60:63], v[48:51], v[80:95]
    ds_read_b64_tr_b16 v[44:45], v230 offset:8192
    ds_read_b64_tr_b16 v[46:47], v230 offset:8704
    s_add_u32 m0, s23, 53248
    s_add_u32 s25, s20, 131072
    buffer_load_dwordx4 v2, s[4:7], s25 offen sc1 lds
    s_add_u32 s20, s20, 262144
    s_cmp_eq_u32 s20, s37
    s_cselect_b32 s20, s36, s20
    s_waitcnt lgkmcnt(5)
    v_mfma_f32_32x32x16_bf16 v[64:79], v[248:251], v[240:243], v[64:79]
    ds_read_b128 v[48:51], v4 offset:2048
    ds_read_b64_tr_b16 v[56:57], v228 offset:10240
    ds_read_b64_tr_b16 v[58:59], v228 offset:10752
    s_add_u32 m0, s23, 57344
    s_add_u32 s25, s21, 0
    buffer_load_dwordx4 v3, s[8:11], s25 offen lds
    v_mfma_f32_32x32x16_bf16 v[80:95], v[252:255], v[240:243], v[80:95]
    ds_read_b64_tr_b16 v[60:61], v230 offset:10240
    ds_read_b64_tr_b16 v[62:63], v230 offset:10752
    s_add_u32 m0, s23, 61440
    s_add_u32 s25, s21, 40960
    buffer_load_dwordx4 v3, s[8:11], s25 offen lds
    s_waitcnt lgkmcnt(5)
    v_mfma_f32_32x32x16_bf16 v[64:79], v[40:43], v[32:35], v[64:79]
    ds_read_b128 v[240:243], v4 offset:4096
    ds_read_b64_tr_b16 v[248:249], v228 offset:12288
    ds_read_b64_tr_b16 v[250:251], v228 offset:12800
    v_mfma_f32_32x32x16_bf16 v[80:95], v[44:47], v[32:35], v[80:95]
    ds_read_b64_tr_b16 v[252:253], v230 offset:12288
    ds_read_b64_tr_b16 v[254:255], v230 offset:12800
    s_add_u32 m0, s23, 65536
    s_add_u32 s25, s21, 128
    buffer_load_dwordx4 v3, s[12:15], s25 offen lds
    s_waitcnt lgkmcnt(5)
    v_mfma_f32_32x32x16_bf16 v[64:79], v[56:59], v[48:51], v[64:79]
    ds_read_b128 v[32:35], v4 offset:6144
    ds_read_b64_tr_b16 v[40:41], v228 offset:14336
    ds_read_b64_tr_b16 v[42:43], v228 offset:14848
    v_mfma_f32_32x32x16_bf16 v[80:95], v[60:63], v[48:51], v[80:95]
    ds_read_b64_tr_b16 v[44:45], v230 offset:14336
    ds_read_b64_tr_b16 v[46:47], v230 offset:14848
    s_add_u32 m0, s23, 69632
    s_add_u32 s25, s21, 41088
    buffer_load_dwordx4 v3, s[12:15], s25 offen lds
    s_add_u32 s21, s21, 81920
    s_cmp_eq_u32 s21, s39
    s_cselect_b32 s21, s38, s21
    s_waitcnt lgkmcnt(5)
    v_mfma_f32_32x32x16_bf16 v[64:79], v[248:251], v[240:243], v[64:79]
    s_waitcnt vmcnt(6) lgkmcnt(0)
    s_barrier
    ds_read_b128 v[48:51], v4 offset:24576
    ds_read_b64_tr_b16 v[56:57], v228 offset:32768
    ds_read_b64_tr_b16 v[58:59], v228 offset:33280
    s_add_u32 m0, s23, 0
    s_add_u32 s25, s20, 0
    buffer_load_dwordx4 v2, s[4:7], s25 offen sc1 lds
    v_mfma_f32_32x32x16_bf16 v[80:95], v[252:255], v[240:243], v[80:95]
    ds_read_b64_tr_b16 v[60:61], v230 offset:32768
    ds_read_b64_tr_b16 v[62:63], v230 offset:33280
    s_add_u32 m0, s23, 4096
    s_add_u32 s25, s20, 131072
    buffer_load_dwordx4 v2, s[4:7], s25 offen sc1 lds
    s_add_u32 s20, s20, 262144
    s_cmp_eq_u32 s20, s37
    s_cselect_b32 s20, s36, s20
    s_waitcnt lgkmcnt(5)
    v_mfma_f32_32x32x16_bf16 v[64:79], v[40:43], v[32:35], v[64:79]
    ds_read_b128 v[240:243], v4 offset:26624
    ds_read_b64_tr_b16 v[248:249], v228 offset:34816
    ds_read_b64_tr_b16 v[250:251], v228 offset:35328
    s_add_u32 m0, s23, 8192
    s_add_u32 s25, s21, 0
    buffer_load_dwordx4 v3, s[8:11], s25 offen lds
    v_mfma_f32_32x32x16_bf16 v[80:95], v[44:47], v[32:35], v[80:95]
    ds_read_b64_tr_b16 v[252:253], v230 offset:34816
    ds_read_b64_tr_b16 v[254:255], v230 offset:35328
    s_add_u32 m0, s23, 12288
    s_add_u32 s25, s21, 40960
    buffer_load_dwordx4 v3, s[8:11], s25 offen lds
    s_waitcnt lgkmcnt(5)
    v_mfma_f32_32x32x16_bf16 v[64:79], v[56:59], v[48:51], v[64:79]
    ds_read_b128 v[32:35], v4 offset:28672
    ds_read_b64_tr_b16 v[40:41], v228 offset:36864
    ds_read_b64_tr_b16 v[42:43], v228 offset:37376
    v_mfma_f32_32x32x16_bf16 v[80:95], v[60:63], v[48:51], v[80:95]
    ds_read_b64_tr_b16 v[44:45], v230 offset:36864
    ds_read_b64_tr_b16 v[46:47], v230 offset:37376
    s_add_u32 m0, s23, 16384
    s_add_u32 s25, s21, 128
    buffer_load_dwordx4 v3, s[12:15], s25 offen lds
    s_waitcnt lgkmcnt(5)
    v_mfma_f32_32x32x16_bf16 v[64:79], v[248:251], v[240:243], v[64:79]
    ds_read_b128 v[48:51], v4 offset:30720
    ds_read_b64_tr_b16 v[56:57], v228 offset:38912
    ds_read_b64_tr_b16 v[58:59], v228 offset:39424
    v_mfma_f32_32x32x16_bf16 v[80:95], v[252:255], v[240:243], v[80:95]
    ds_read_b64_tr_b16 v[60:61], v230 offset:38912
    ds_read_b64_tr_b16 v[62:63], v230 offset:39424
    s_add_u32 m0, s23, 20480
    s_add_u32 s25, s21, 41088
    buffer_load_dwordx4 v3, s[12:15], s25 offen lds
    s_add_u32 s21, s21, 81920
    s_cmp_eq_u32 s21, s39
    s_cselect_b32 s21, s38, s21
    s_waitcnt lgkmcnt(5)
    v_mfma_f32_32x32x16_bf16 v[64:79], v[40:43], v[32:35], v[64:79]
    s_waitcnt vmcnt(6) lgkmcnt(0)
    s_barrier
    ds_read_b128 v[240:243], v4 offset:49152
    ds_read_b64_tr_b16 v[248:249], v228 offset:57344
    ds_read_b64_tr_b16 v[250:251], v228 offset:57856
    s_add_u32 m0, s23, 24576
    s_add_u32 s25, s20, 0
    buffer_load_dwordx4 v2, s[4:7], s25 offen sc1 lds
    v_mfma_f32_32x32x16_bf16 v[80:95], v[44:47], v[32:35], v[80:95]
    ds_read_b64_tr_b16 v[252:253], v230 offset:57344
    ds_read_b64_tr_b16 v[254:255], v230 offset:57856
    s_add_u32 m0, s23, 28672
    s_add_u32 s25, s20, 131072
    buffer_load_dwordx4 v2, s[4:7], s25 offen sc1 lds
    s_add_u32 s20, s20, 262144
    s_cmp_eq_u32 s20, s37
    s_cselect_b32 s20, s36, s20
    s_waitcnt lgkmcnt(5)
    v_mfma_f32_32x32x16_bf16 v[64:79], v[56:59], v[48:51], v[64:79]
    ds_read_b128 v[32:35], v4 offset:51200
    ds_read_b64_tr_b16 v[40:41], v228 offset:59392
    ds_read_b64_tr_b16 v[42:43], v228 offset:59904
    s_add_u32 m0, s23, 32768
    s_add_u32 s25, s21, 0
    buffer_load_dwordx4 v3, s[8:11], s25 offen lds
    v_mfma_f32_32x32x16_bf16 v[80:95], v[60:63], v[48:51], v[80:95]
    ds_read_b64_tr_b16 v[44:45], v230 offset:59392
    ds_read_b64_tr_b16 v[46:47], v230 offset:59904
    s_add_u32 m0, s23, 36864
    s_add_u32 s25, s21, 40960
    buffer_load_dwordx4 v3, s[8:11], s25 offen lds
    s_waitcnt lgkmcnt(5)
    v_mfma_f32_32x32x16_bf16 v[64:79], v[248:251], v[240:243], v[64:79]
    ds_read_b128 v[48:51], v4 offset:53248
    ds_read_b64_tr_b16 v[56:57], v228 offset:61440
    ds_read_b64_tr_b16 v[58:59], v228 offset:61952
    v_mfma_f32_32x32x16_bf16 v[80:95], v[252:255], v[240:243], v[80:95]
    ds_read_b64_tr_b16 v[60:61], v230 offset:61440
    ds_read_b64_tr_b16 v[62:63], v230 offset:61952
    s_add_u32 m0, s23, 40960
    s_add_u32 s25, s21, 128
    buffer_load_dwordx4 v3, s[12:15], s25 offen lds
    s_waitcnt lgkmcnt(5)
    v_mfma_f32_32x32x16_bf16 v[64:79], v[40:43], v[32:35], v[64:79]
    ds_read_b128 v[240:243], v4 offset:55296
    ds_read_b64_tr_b16 v[248:249], v228 offset:63488
    ds_read_b64_tr_b16 v[250:251], v228 offset:64000
    v_mfma_f32_32x32x16_bf16 v[80:95], v[44:47], v[32:35], v[80:95]
    ds_read_b64_tr_b16 v[252:253], v230 offset:63488
    ds_read_b64_tr_b16 v[254:255], v230 offset:64000
    s_add_u32 m0, s23, 45056
    s_add_u32 s25, s21, 41088
    buffer_load_dwordx4 v3, s[12:15], s25 offen lds
    s_add_u32 s21, s21, 81920
    s_cmp_eq_u32 s21, s39
    s_cselect_b32 s21, s38, s21
    s_waitcnt lgkmcnt(5)
    v_mfma_f32_32x32x16_bf16 v[64:79], v[56:59], v[48:51], v[64:79]
    s_waitcnt vmcnt(6) lgkmcnt(0)
    s_barrier
    ds_read_b128 v[32:35], v4 offset:0
    ds_read_b64_tr_b16 v[40:41], v228 offset:8192
    ds_read_b64_tr_b16 v[42:43], v228 offset:8704
    s_add_u32 m0, s23, 49152
    s_add_u32 s25, s20, 0
    buffer_load_dwordx4 v2, s[4:7], s25 offen sc1 lds
    v_mfma_f32_32x32x16_bf16 v[80:95], v[60:63], v[48:51], v[80:95]
    ds_read_b64_tr_b16 v[44:45], v230 offset:8192
    ds_read_b64_tr_b16 v[46:47], v230 offset:8704
    s_add_u32 m0, s23, 53248
    s_add_u32 s25, s20, 131072
    buffer_load_dwordx4 v2, s[4:7], s25 offen sc1 lds
    s_add_u32 s20, s20, 262144
    s_cmp_eq_u32 s20, s37
    s_cselect_b32 s20, s36, s20
    s_waitcnt lgkmcnt(5)
    v_mfma_f32_32x32x16_bf16 v[64:79], v[248:251], v[240:243], v[64:79]
    ds_read_b128 v[48:51], v4 offset:2048
    ds_read_b64_tr_b16 v[56:57], v228 offset:10240
    ds_read_b64_tr_b16 v[58:59], v228 offset:10752
    s_add_u32 m0, s23, 57344
    s_add_u32 s25, s21, 0
    buffer_load_dwordx4 v3, s[8:11], s25 offen lds
    v_mfma_f32_32x32x16_bf16 v[80:95], v[252:255], v[240:243], v[80:95]
    ds_read_b64_tr_b16 v[60:61], v230 offset:10240
    ds_read_b64_tr_b16 v[62:63], v230 offset:10752
    s_add_u32 m0, s23, 61440
    s_add_u32 s25, s21, 40960
    buffer_load_dwordx4 v3, s[8:11], s25 offen lds
    s_waitcnt lgkmcnt(5)
    v_mfma_f32_32x32x16_bf16 v[64:79], v[40:43], v[32:35], v[64:79]
    ds_read_b128 v[240:243], v4 offset:4096
    ds_read_b64_tr_b16 v[248:249], v228 offset:12288
    ds_read_b64_tr_b16 v[250:251], v228 offset:12800
    v_mfma_f32_32x32x16_bf16 v[80:95], v[44:47], v[32:35], v[80:95]
    ds_read_b64_tr_b16 v[252:253], v230 offset:12288
    ds_read_b64_tr_b16 v[254:255], v230 offset:12800
    s_add_u32 m0, s23, 65536
    s_add_u32 s25, s21, 128
    buffer_load_dwordx4 v3, s[12:15], s25 offen lds
    s_waitcnt lgkmcnt(5)
    v_mfma_f32_32x32x16_bf16 v[64:79], v[56:59], v[48:51], v[64:79]
    ds_read_b128 v[32:35], v4 offset:6144
    ds_read_b64_tr_b16 v[40:41], v228 offset:14336
    ds_read_b64_tr_b16 v[42:43], v228 offset:14848
    v_mfma_f32_32x32x16_bf16 v[80:95], v[60:63], v[48:51], v[80:95]
    ds_read_b64_tr_b16 v[44:45], v230 offset:14336
    ds_read_b64_tr_b16 v[46:47], v230 offset:14848
    s_add_u32 m0, s23, 69632
    s_add_u32 s25, s21, 41088
    buffer_load_dwordx4 v3, s[12:15], s25 offen lds
    s_add_u32 s21, s21, 81920
    s_cmp_eq_u32 s21, s39
    s_cselect_b32 s21, s38, s21
    s_waitcnt lgkmcnt(5)
    v_mfma_f32_32x32x16_bf16 v[64:79], v[248:251], v[240:243], v[64:79]
    s_waitcnt vmcnt(6) lgkmcnt(0)
    s_barrier
    ds_read_b128 v[48:51], v4 offset:24576
    ds_read_b64_tr_b16 v[56:57], v228 offset:32768
    ds_read_b64_tr_b16 v[58:59], v228 offset:33280
    s_add_u32 m0, s23, 0
    s_add_u32 s25, s20, 0
    buffer_load_dwordx4 v2, s[4:7], s25 offen sc1 lds
    v_mfma_f32_32x32x16_bf16 v[80:95], v[252:255], v[240:243], v[80:95]
    ds_read_b64_tr_b16 v[60:61], v230 offset:32768
    ds_read_b64_tr_b16 v[62:63], v230 offset:33280
    s_add_u32 m0, s23, 4096
    s_add_u32 s25, s20, 131072
    buffer_load_dwordx4 v2, s[4:7], s25 offen sc1 lds
    s_add_u32 s20, s20, 262144
    s_cmp_eq_u32 s20, s37
    s_cselect_b32 s20, s36, s20
    s_waitcnt lgkmcnt(5)
    v_mfma_f32_32x32x16_bf16 v[64:79], v[40:43], v[32:35], v[64:79]
    ds_read_b128 v[240:243], v4 offset:26624
    ds_read_b64_tr_b16 v[248:249], v228 offset:34816
    ds_read_b64_tr_b16 v[250:251], v228 offset:35328
    s_add_u32 m0, s23, 8192
    s_add_u32 s25, s21, 0
    buffer_load_dwordx4 v3, s[8:11], s25 offen lds
    v_mfma_f32_32x32x16_bf16 v[80:95], v[44:47], v[32:35], v[80:95]
    ds_read_b64_tr_b16 v[252:253], v230 offset:34816
    ds_read_b64_tr_b16 v[254:255], v230 offset:35328
    s_add_u32 m0, s23, 12288
    s_add_u32 s25, s21, 40960
    buffer_load_dwordx4 v3, s[8:11], s25 offen lds
    s_waitcnt lgkmcnt(5)
    v_mfma_f32_32x32x16_bf16 v[64:79], v[56:59], v[48:51], v[64:79]
    ds_read_b128 v[32:35], v4 offset:28672
    ds_read_b64_tr_b16 v[40:41], v228 offset:36864
    ds_read_b64_tr_b16 v[42:43], v228 offset:37376
    v_mfma_f32_32x32x16_bf16 v[80:95], v[60:63], v[48:51], v[80:95]
    ds_read_b64_tr_b16 v[44:45], v230 offset:36864
    ds_read_b64_tr_b16 v[46:47], v230 offset:37376
    s_add_u32 m0, s23, 16384
    s_add_u32 s25, s21, 128
    buffer_load_dwordx4 v3, s[12:15], s25 offen lds
    s_waitcnt lgkmcnt(5)
    v_mfma_f32_32x32x16_bf16 v[64:79], v[248:251], v[240:243], v[64:79]
    ds_read_b128 v[48:51], v4 offset:30720
    ds_read_b64_tr_b16 v[56:57], v228 offset:38912
    ds_read_b64_tr_b16 v[58:59], v228 offset:39424
    v_mfma_f32_32x32x16_bf16 v[80:95], v[252:255], v[240:243], v[80:95]
    ds_read_b64_tr_b16 v[60:61], v230 offset:38912
    ds_read_b64_tr_b16 v[62:63], v230 offset:39424
    s_add_u32 m0, s23, 20480
    s_add_u32 s25, s21, 41088
    buffer_load_dwordx4 v3, s[12:15], s25 offen lds
    s_add_u32 s21, s21, 81920
    s_cmp_eq_u32 s21, s39
    s_cselect_b32 s21, s38, s21
    s_waitcnt lgkmcnt(5)
    v_mfma_f32_32x32x16_bf16 v[64:79], v[40:43], v[32:35], v[64:79]
    s_waitcnt vmcnt(6) lgkmcnt(0)
    s_barrier
    ds_read_b128 v[240:243], v4 offset:49152
    ds_read_b64_tr_b16 v[248:249], v228 offset:57344
    ds_read_b64_tr_b16 v[250:251], v228 offset:57856
    s_add_u32 m0, s23, 24576
    s_add_u32 s25, s20, 0
    buffer_load_dwordx4 v2, s[4:7], s25 offen sc1 lds
    v_mfma_f32_32x32x16_bf16 v[80:95], v[44:47], v[32:35], v[80:95]
    ds_read_b64_tr_b16 v[252:253], v230 offset:57344
    ds_read_b64_tr_b16 v[254:255], v230 offset:57856
    s_add_u32 m0, s23, 28672
    s_add_u32 s25, s20, 131072
    buffer_load_dwordx4 v2, s[4:7], s25 offen sc1 lds
    s_add_u32 s20, s20, 262144
    s_cmp_eq_u32 s20, s37
    s_cselect_b32 s20, s36, s20
    s_waitcnt lgkmcnt(5)
    v_mfma_f32_32x32x16_bf16 v[64:79], v[56:59], v[48:51], v[64:79]
    ds_read_b128 v[32:35], v4 offset:51200
    ds_read_b64_tr_b16 v[40:41], v228 offset:59392
    ds_read_b64_tr_b16 v[42:43], v228 offset:59904
    s_add_u32 m0, s23, 32768
    s_add_u32 s25, s21, 0
    buffer_load_dwordx4 v3, s[8:11], s25 offen lds
    v_mfma_f32_32x32x16_bf16 v[80:95], v[60:63], v[48:51], v[80:95]
    ds_read_b64_tr_b16 v[44:45], v230 offset:59392
    ds_read_b64_tr_b16 v[46:47], v230 offset:59904
    s_add_u32 m0, s23, 36864
    s_add_u32 s25, s21, 40960
    buffer_load_dwordx4 v3, s[8:11], s25 offen lds
    s_waitcnt lgkmcnt(5)
    v_mfma_f32_32x32x16_bf16 v[64:79], v[248:251], v[240:243], v[64:79]
    ds_read_b128 v[48:51], v4 offset:53248
    ds_read_b64_tr_b16 v[56:57], v228 offset:61440
    ds_read_b64_tr_b16 v[58:59], v228 offset:61952
    v_mfma_f32_32x32x16_bf16 v[80:95], v[252:255], v[240:243], v[80:95]
    ds_read_b64_tr_b16 v[60:61], v230 offset:61440
    ds_read_b64_tr_b16 v[62:63], v230 offset:61952
    s_add_u32 m0, s23, 40960
    s_add_u32 s25, s21, 128
    buffer_load_dwordx4 v3, s[12:15], s25 offen lds
    s_waitcnt lgkmcnt(5)
    v_mfma_f32_32x32x16_bf16 v[64:79], v[40:43], v[32:35], v[64:79]
    ds_read_b128 v[240:243], v4 offset:55296
    ds_read_b64_tr_b16 v[248:249], v228 offset:63488
    ds_read_b64_tr_b16 v[250:251], v228 offset:64000
    v_mfma_f32_32x32x16_bf16 v[80:95], v[44:47], v[32:35], v[80:95]
    ds_read_b64_tr_b16 v[252:253], v230 offset:63488
    ds_read_b64_tr_b16 v[254:255], v230 offset:64000
    s_add_u32 m0, s23, 45056
    s_add_u32 s25, s21, 41088
    buffer_load_dwordx4 v3, s[12:15], s25 offen lds
    s_add_u32 s21, s21, 81920
    s_cmp_eq_u32 s21, s39
    s_cselect_b32 s21, s38, s21
    s_waitcnt lgkmcnt(5)
    v_mfma_f32_32x32x16_bf16 v[64:79], v[56:59], v[48:51], v[64:79]
    s_waitcnt vmcnt(6) lgkmcnt(0)
    s_barrier
    ds_read_b128 v[32:35], v4 offset:0
    ds_read_b64_tr_b16 v[40:41], v228 offset:8192
    ds_read_b64_tr_b16 v[42:43], v228 offset:8704
    s_add_u32 m0, s23, 49152
    s_add_u32 s25, s20, 0
    buffer_load_dwordx4 v2, s[4:7], s25 offen sc1 lds
    v_mfma_f32_32x32x16_bf16 v[80:95], v[60:63], v[48:51], v[80:95]
    ds_read_b64_tr_b16 v[44:45], v230 offset:8192
    ds_read_b64_tr_b16 v[46:47], v230 offset:8704
    s_add_u32 m0, s23, 53248
    s_add_u32 s25, s20, 131072
    buffer_load_dwordx4 v2, s[4:7], s25 offen sc1 lds
    s_add_u32 s20, s20, 262144
    s_cmp_eq_u32 s20, s37
    s_cselect_b32 s20, s36, s20
    s_waitcnt lgkmcnt(5)
    v_mfma_f32_32x32x16_bf16 v[64:79], v[248:251], v[240:243], v[64:79]
    ds_read_b128 v[48:51], v4 offset:2048
    ds_read_b64_tr_b16 v[56:57], v228 offset:10240
    ds_read_b64_tr_b16 v[58:59], v228 offset:10752
    s_add_u32 m0, s23, 57344
    s_add_u32 s25, s21, 0
    buffer_load_dwordx4 v3, s[8:11], s25 offen lds
    v_mfma_f32_32x32x16_bf16 v[80:95], v[252:255], v[240:243], v[80:95]
    ds_read_b64_tr_b16 v[60:61], v230 offset:10240
    ds_read_b64_tr_b16 v[62:63], v230 offset:10752
    s_add_u32 m0, s23, 61440
    s_add_u32 s25, s21, 40960
    buffer_load_dwordx4 v3, s[8:11], s25 offen lds
    s_waitcnt lgkmcnt(5)
    v_mfma_f32_32x32x16_bf16 v[64:79], v[40:43], v[32:35], v[64:79]
    ds_read_b128 v[240:243], v4 offset:4096
    ds_read_b64_tr_b16 v[248:249], v228 offset:12288
    ds_read_b64_tr_b16 v[250:251], v228 offset:12800
    v_mfma_f32_32x32x16_bf16 v[80:95], v[44:47], v[32:35], v[80:95]
    ds_read_b64_tr_b16 v[252:253], v230 offset:12288
    ds_read_b64_tr_b16 v[254:255], v230 offset:12800
    s_add_u32 m0, s23, 65536
    s_add_u32 s25, s21, 128
    buffer_load_dwordx4 v3, s[12:15], s25 offen lds
    s_waitcnt lgkmcnt(5)
    v_mfma_f32_32x32x16_bf16 v[64:79], v[56:59], v[48:51], v[64:79]
    ds_read_b128 v[32:35], v4 offset:6144
    ds_read_b64_tr_b16 v[40:41], v228 offset:14336
    ds_read_b64_tr_b16 v[42:43], v228 offset:14848
    v_mfma_f32_32x32x16_bf16 v[80:95], v[60:63], v[48:51], v[80:95]
    ds_read_b64_tr_b16 v[44:45], v230 offset:14336
    ds_read_b64_tr_b16 v[46:47], v230 offset:14848
    s_add_u32 m0, s23, 69632
    s_add_u32 s25, s21, 41088
    buffer_load_dwordx4 v3, s[12:15], s25 offen lds
    s_add_u32 s21, s21, 81920
    s_cmp_eq_u32 s21, s39
    s_cselect_b32 s21, s38, s21
    s_waitcnt lgkmcnt(5)
    v_mfma_f32_32x32x16_bf16 v[64:79], v[248:251], v[240:243], v[64:79]
    s_waitcnt vmcnt(6) lgkmcnt(0)
    s_barrier
    ds_read_b128 v[48:51], v4 offset:24576
    ds_read_b64_tr_b16 v[56:57], v228 offset:32768
    ds_read_b64_tr_b16 v[58:59], v228 offset:33280
    v_mfma_f32_32x32x16_bf16 v[80:95], v[252:255], v[240:243], v[80:95]
    ds_read_b64_tr_b16 v[60:61], v230 offset:32768
    ds_read_b64_tr_b16 v[62:63], v230 offset:33280
    s_waitcnt lgkmcnt(5)
    v_mfma_f32_32x32x16_bf16 v[64:79], v[40:43], v[32:35], v[64:79]
    ds_read_b128 v[240:243], v4 offset:26624
    ds_read_b64_tr_b16 v[248:249], v228 offset:34816
    ds_read_b64_tr_b16 v[250:251], v228 offset:35328
    v_mfma_f32_32x32x16_bf16 v[80:95], v[44:47], v[32:35], v[80:95]
    ds_read_b64_tr_b16 v[252:253], v230 offset:34816
    ds_read_b64_tr_b16 v[254:255], v230 offset:35328
    s_waitcnt lgkmcnt(5)
    v_mfma_f32_32x32x16_bf16 v[64:79], v[56:59], v[48:51], v[64:79]
    ds_read_b128 v[32:35], v4 offset:28672
    ds_read_b64_tr_b16 v[40:41], v228 offset:36864
    ds_read_b64_tr_b16 v[42:43], v228 offset:37376
    v_mfma_f32_32x32x16_bf16 v[80:95], v[60:63], v[48:51], v[80:95]
    ds_read_b64_tr_b16 v[44:45], v230 offset:36864
    ds_read_b64_tr_b16 v[46:47], v230 offset:37376
    s_waitcnt lgkmcnt(5)
    v_mfma_f32_32x32x16_bf16 v[64:79], v[248:251], v[240:243], v[64:79]
    ds_read_b128 v[48:51], v4 offset:30720
    ds_read_b64_tr_b16 v[56:57], v228 offset:38912
    ds_read_b64_tr_b16 v[58:59], v228 offset:39424
    v_mfma_f32_32x32x16_bf16 v[80:95], v[252:255], v[240:243], v[80:95]
    ds_read_b64_tr_b16 v[60:61], v230 offset:38912
    ds_read_b64_tr_b16 v[62:63], v230 offset:39424
    s_waitcnt lgkmcnt(5)
    v_mfma_f32_32x32x16_bf16 v[64:79], v[40:43], v[32:35], v[64:79]
    s_waitcnt vmcnt(0) lgkmcnt(0)
    s_barrier
    ds_read_b128 v[240:243], v4 offset:49152
    ds_read_b64_tr_b16 v[248:249], v228 offset:57344
    ds_read_b64_tr_b16 v[250:251], v228 offset:57856
    v_mfma_f32_32x32x16_bf16 v[80:95], v[44:47], v[32:35], v[80:95]
    ds_read_b64_tr_b16 v[252:253], v230 offset:57344
    ds_read_b64_tr_b16 v[254:255], v230 offset:57856
    s_waitcnt lgkmcnt(5)
    v_mfma_f32_32x32x16_bf16 v[64:79], v[56:59], v[48:51], v[64:79]
    ds_read_b128 v[32:35], v4 offset:51200
    ds_read_b64_tr_b16 v[40:41], v228 offset:59392
    ds_read_b64_tr_b16 v[42:43], v228 offset:59904
    v_mfma_f32_32x32x16_bf16 v[80:95], v[60:63], v[48:51], v[80:95]
    ds_read_b64_tr_b16 v[44:45], v230 offset:59392
    ds_read_b64_tr_b16 v[46:47], v230 offset:59904
    s_waitcnt lgkmcnt(5)
    v_mfma_f32_32x32x16_bf16 v[64:79], v[248:251], v[240:243], v[64:79]
    ds_read_b128 v[48:51], v4 offset:53248
    ds_read_b64_tr_b16 v[56:57], v228 offset:61440
    ds_read_b64_tr_b16 v[58:59], v228 offset:61952
    v_mfma_f32_32x32x16_bf16 v[80:95], v[252:255], v[240:243], v[80:95]
    ds_read_b64_tr_b16 v[60:61], v230 offset:61440
    ds_read_b64_tr_b16 v[62:63], v230 offset:61952
    s_waitcnt lgkmcnt(5)
    v_mfma_f32_32x32x16_bf16 v[64:79], v[40:43], v[32:35], v[64:79]
    ds_read_b128 v[240:243], v4 offset:55296
    ds_read_b64_tr_b16 v[248:249], v228 offset:63488
    ds_read_b64_tr_b16 v[250:251], v228 offset:64000
    v_mfma_f32_32x32x16_bf16 v[80:95], v[44:47], v[32:35], v[80:95]
    ds_read_b64_tr_b16 v[252:253], v230 offset:63488
    ds_read_b64_tr_b16 v[254:255], v230 offset:64000
    s_waitcnt lgkmcnt(5)
    v_mfma_f32_32x32x16_bf16 v[64:79], v[56:59], v[48:51], v[64:79]
    v_mfma_f32_32x32x16_bf16 v[80:95], v[60:63], v[48:51], v[80:95]
    s_waitcnt lgkmcnt(0)
    v_mfma_f32_32x32x16_bf16 v[64:79], v[248:251], v[240:243], v[64:79]
    v_mfma_f32_32x32x16_bf16 v[80:95], v[252:255], v[240:243], v[80:95]
    s_nop 15
    s_setprio 2
    v_mul_f32 v14, 0xbfb8aa3b, v64
    v_mul_f32 v15, 0xbfb8aa3b, v65
    v_mul_f32 v16, 0xbfb8aa3b, v66
    v_mul_f32 v17, 0xbfb8aa3b, v67
    v_exp_f32 v14, v14
    v_exp_f32 v15, v15
    v_exp_f32 v16, v16
    v_exp_f32 v17, v17
    v_add_f32 v14, 1.0, v14
    v_add_f32 v15, 1.0, v15
    v_add_f32 v16, 1.0, v16
    v_add_f32 v17, 1.0, v17
    v_rcp_f32 v14, v14
    v_rcp_f32 v15, v15
    v_rcp_f32 v16, v16
    v_rcp_f32 v17, v17
    s_nop 0
    v_mul_f32 v128, v64, v14
    v_mul_f32 v129, v65, v15
    v_mul_f32 v130, v66, v16
    v_mul_f32 v131, v67, v17
    v_mul_f32 v14, 0xbfb8aa3b, v68
    v_mul_f32 v15, 0xbfb8aa3b, v69
    v_mul_f32 v16, 0xbfb8aa3b, v70
    v_mul_f32 v17, 0xbfb8aa3b, v71
    v_exp_f32 v14, v14
    v_exp_f32 v15, v15
    v_exp_f32 v16, v16
    v_exp_f32 v17, v17
    v_add_f32 v14, 1.0, v14
    v_add_f32 v15, 1.0, v15
    v_add_f32 v16, 1.0, v16
    v_add_f32 v17, 1.0, v17
    v_rcp_f32 v14, v14
    v_rcp_f32 v15, v15
    v_rcp_f32 v16, v16
    v_rcp_f32 v17, v17
    s_nop 0
    v_mul_f32 v132, v68, v14
    v_mul_f32 v133, v69, v15
    v_mul_f32 v134, v70, v16
    v_mul_f32 v135, v71, v17
    v_mul_f32 v14, 0xbfb8aa3b, v72
    v_mul_f32 v15, 0xbfb8aa3b, v73
    v_mul_f32 v16, 0xbfb8aa3b, v74
    v_mul_f32 v17, 0xbfb8aa3b, v75
    v_exp_f32 v14, v14
    v_exp_f32 v15, v15
    v_exp_f32 v16, v16
    v_exp_f32 v17, v17
    v_add_f32 v14, 1.0, v14
    v_add_f32 v15, 1.0, v15
    v_add_f32 v16, 1.0, v16
    v_add_f32 v17, 1.0, v17
    v_rcp_f32 v14, v14
    v_rcp_f32 v15, v15
    v_rcp_f32 v16, v16
    v_rcp_f32 v17, v17
    s_nop 0
    v_mul_f32 v136, v72, v14
    v_mul_f32 v137, v73, v15
    v_mul_f32 v138, v74, v16
    v_mul_f32 v139, v75, v17
    v_mul_f32 v14, 0xbfb8aa3b, v76
    v_mul_f32 v15, 0xbfb8aa3b, v77
    v_mul_f32 v16, 0xbfb8aa3b, v78
    v_mul_f32 v17, 0xbfb8aa3b, v79
    v_exp_f32 v14, v14
    v_exp_f32 v15, v15
    v_exp_f32 v16, v16
    v_exp_f32 v17, v17
    v_add_f32 v14, 1.0, v14
    v_add_f32 v15, 1.0, v15
    v_add_f32 v16, 1.0, v16
    v_add_f32 v17, 1.0, v17
    v_rcp_f32 v14, v14
    v_rcp_f32 v15, v15
    v_rcp_f32 v16, v16
    v_rcp_f32 v17, v17
    s_nop 0
    v_mul_f32 v140, v76, v14
    v_mul_f32 v141, v77, v15
    v_mul_f32 v142, v78, v16
    v_mul_f32 v143, v79, v17
    v_mul_f32 v14, 0xbfb8aa3b, v80
    v_mul_f32 v15, 0xbfb8aa3b, v81
    v_mul_f32 v16, 0xbfb8aa3b, v82
    v_mul_f32 v17, 0xbfb8aa3b, v83
    v_exp_f32 v14, v14
    v_exp_f32 v15, v15
    v_exp_f32 v16, v16
    v_exp_f32 v17, v17
    v_add_f32 v14, 1.0, v14
    v_add_f32 v15, 1.0, v15
    v_add_f32 v16, 1.0, v16
    v_add_f32 v17, 1.0, v17
    v_rcp_f32 v14, v14
    v_rcp_f32 v15, v15
    v_rcp_f32 v16, v16
    v_rcp_f32 v17, v17
    s_nop 0
    v_mul_f32 v144, v80, v14
    v_mul_f32 v145, v81, v15
    v_mul_f32 v146, v82, v16
    v_mul_f32 v147, v83, v17
    v_mul_f32 v14, 0xbfb8aa3b, v84
    v_mul_f32 v15, 0xbfb8aa3b, v85
    v_mul_f32 v16, 0xbfb8aa3b, v86
    v_mul_f32 v17, 0xbfb8aa3b, v87
    v_exp_f32 v14, v14
    v_exp_f32 v15, v15
    v_exp_f32 v16, v16
    v_exp_f32 v17, v17
    v_add_f32 v14, 1.0, v14
    v_add_f32 v15, 1.0, v15
    v_add_f32 v16, 1.0, v16
    v_add_f32 v17, 1.0, v17
    v_rcp_f32 v14, v14
    v_rcp_f32 v15, v15
    v_rcp_f32 v16, v16
    v_rcp_f32 v17, v17
    s_nop 0
    v_mul_f32 v148, v84, v14
    v_mul_f32 v149, v85, v15
    v_mul_f32 v150, v86, v16
    v_mul_f32 v151, v87, v17
    v_mul_f32 v14, 0xbfb8aa3b, v88
    v_mul_f32 v15, 0xbfb8aa3b, v89
    v_mul_f32 v16, 0xbfb8aa3b, v90
    v_mul_f32 v17, 0xbfb8aa3b, v91
    v_exp_f32 v14, v14
    v_exp_f32 v15, v15
    v_exp_f32 v16, v16
    v_exp_f32 v17, v17
    v_add_f32 v14, 1.0, v14
    v_add_f32 v15, 1.0, v15
    v_add_f32 v16, 1.0, v16
    v_add_f32 v17, 1.0, v17
    v_rcp_f32 v14, v14
    v_rcp_f32 v15, v15
    v_rcp_f32 v16, v16
    v_rcp_f32 v17, v17
    s_nop 0
    v_mul_f32 v152, v88, v14
    v_mul_f32 v153, v89, v15
    v_mul_f32 v154, v90, v16
    v_mul_f32 v155, v91, v17
    v_mul_f32 v14, 0xbfb8aa3b, v92
    v_mul_f32 v15, 0xbfb8aa3b, v93
    v_mul_f32 v16, 0xbfb8aa3b, v94
    v_mul_f32 v17, 0xbfb8aa3b, v95
    v_exp_f32 v14, v14
    v_exp_f32 v15, v15
    v_exp_f32 v16, v16
    v_exp_f32 v17, v17
    v_add_f32 v14, 1.0, v14
    v_add_f32 v15, 1.0, v15
    v_add_f32 v16, 1.0, v16
    v_add_f32 v17, 1.0, v17
    v_rcp_f32 v14, v14
    v_rcp_f32 v15, v15
    v_rcp_f32 v16, v16
    v_rcp_f32 v17, v17
    s_nop 0
    v_mul_f32 v156, v92, v14
    v_mul_f32 v157, v93, v15
    v_mul_f32 v158, v94, v16
    v_mul_f32 v159, v95, v17
    s_add_u32 s50, s3, 192
    s_cmp_lg_u32 s26, 0
    s_cbranch_scc1 L_wcd_41
    s_lshl_b32 s31, s50, 7
    v_mov_b32 v238, s31
    s_mov_b32 exec_lo, 1
    s_mov_b32 exec_hi, 0
    s_mov_b32 s30, 0x40000
L_wc_40:
    buffer_load_dword v239, v238, s[56:59], 0 offen sc1
    s_waitcnt vmcnt(0)
    v_cmp_gt_u32 vcc, 3, v239
    s_nop 4
    s_cbranch_vccz L_wcd_41_x
    s_sleep 16
    s_sub_u32 s30, s30, 1
    s_cmp_lg_u32 s30, 0
    s_cbranch_scc1 L_wc_40
L_wcd_41_x:
    s_mov_b64 exec, -1
L_wcd_41:
    s_barrier
    v_lshrrev_b32 v14, 5, v1
    s_lshl_b32 s25, s26, 1
    v_add_u32 v14, s25, v14
    v_lshlrev_b32 v14, 14, v14
    v_and_b32 v15, 31, v1
    v_lshl_add_u32 v2, v15, 4, v14
    v_lshrrev_b32 v14, 5, v1
    v_lshlrev_b32 v14, 10, v14
    s_lshl_b32 s25, s27, 5
    v_add_u32 v15, s25, v15
    v_lshl_add_u32 v4, v15, 3, v14
    s_add_u32 s4, s76, 15990784
    s_addc_u32 s5, s77, 0
    s_and_b32 s5, s5, 0xffff
    s_mov_b32 s6, 2621440
    s_mov_b32 s7, 0x00020000
    s_mov_b32 s8, s64
    s_mov_b32 s9, s65
    s_and_b32 s9, s9, 0xffff
    s_mov_b32 s10, 819200
    s_mov_b32 s11, 0x00020000
    s_mov_b32 s12, s64
    s_mov_b32 s13, s65
    s_and_b32 s13, s13, 0xffff
    s_mov_b32 s14, 819200
    s_mov_b32 s15, 0x00020000
    s_lshl_b32 s20, s44, 9
    s_lshl_b32 s21, s45, 7
    s_lshr_b32 s46, s41, 2
    s_mul_i32 s46, s46, 2
    s_and_b32 s25, s41, 3
    s_mul_i32 s25, s25, 3
    s_add_u32 s46, s46, s25
    s_mul_i32 s25, s46, 6554
    s_lshr_b32 s25, s25, 16
    s_mul_i32 s25, s25, 10
    s_sub_u32 s46, s46, s25
    s_mov_b32 s36, s20
    s_add_u32 s37, s20, 2621440
    s_mul_i32 s25, s46, 262144
    s_add_u32 s20, s20, s25
    s_mov_b32 s38, s21
    s_add_u32 s39, s21, 819200
    s_mul_i32 s25, s46, 81920
    s_add_u32 s21, s21, s25
    s_mov_b32 s16, s60
    s_mov_b32 s17, s61
    s_and_b32 s17, s17, 0xffff
    s_mov_b32 s18, 2621440
    s_mov_b32 s19, 0x00020000
    s_lshl_b32 s51, s44, 6
    s_lshl_b32 s52, s27, 5
    s_add_u32 s51, s51, s52
    v_and_b32 v160, 31, v1
    v_add_u32 v160, s51, v160
    v_mul_u32_u24 v160, 1280, v160
    s_lshl_b32 s52, s45, 7
    s_lshl_b32 s53, s28, 6
    s_add_u32 s52, s52, s53
    v_lshrrev_b32 v161, 5, v1
    v_lshlrev_b32 v161, 4, v161
    v_add3_u32 v160, v160, v161, s52
    buffer_load_dwordx4 v[164:167], v160, s[16:19], 0 offen offset:0
    buffer_load_dwordx4 v[168:171], v160, s[16:19], 0 offen offset:32
    buffer_load_dwordx4 v[172:175], v160, s[16:19], 0 offen offset:128
    buffer_load_dwordx4 v[176:179], v160, s[16:19], 0 offen offset:160
    s_add_u32 m0, s23, 8192
    s_add_u32 s25, s21, 0
    buffer_load_dwordx4 v3, s[8:11], s25 offen lds
    s_add_u32 m0, s23, 12288
    s_add_u32 s25, s21, 40960
    buffer_load_dwordx4 v3, s[8:11], s25 offen lds
    s_add_u32 m0, s23, 16384
    s_add_u32 s25, s21, 128
    buffer_load_dwordx4 v3, s[12:15], s25 offen lds
    s_add_u32 m0, s23, 20480
    s_add_u32 s25, s21, 41088
    buffer_load_dwordx4 v3, s[12:15], s25 offen lds
    s_add_u32 s21, s21, 81920
    s_cmp_eq_u32 s21, s39
    s_cselect_b32 s21, s38, s21
    s_add_u32 m0, s23, 32768
    s_add_u32 s25, s21, 0
    buffer_load_dwordx4 v3, s[8:11], s25 offen lds
    s_add_u32 m0, s23, 36864
    s_add_u32 s25, s21, 40960
    buffer_load_dwordx4 v3, s[8:11], s25 offen lds
    s_add_u32 m0, s23, 40960
    s_add_u32 s25, s21, 128
    buffer_load_dwordx4 v3, s[12:15], s25 offen lds
    s_add_u32 m0, s23, 45056
    s_add_u32 s25, s21, 41088
    buffer_load_dwordx4 v3, s[12:15], s25 offen lds
    s_add_u32 s21, s21, 81920
    s_cmp_eq_u32 s21, s39
    s_cselect_b32 s21, s38, s21
    s_add_u32 m0, s23, 57344
    s_add_u32 s25, s21, 0
    buffer_load_dwordx4 v3, s[8:11], s25 offen lds
    s_add_u32 m0, s23, 61440
    s_add_u32 s25, s21, 40960
    buffer_load_dwordx4 v3, s[8:11], s25 offen lds
    s_add_u32 m0, s23, 65536
    s_add_u32 s25, s21, 128
    buffer_load_dwordx4 v3, s[12:15], s25 offen lds
    s_add_u32 m0, s23, 69632
    s_add_u32 s25, s21, 41088
    buffer_load_dwordx4 v3, s[12:15], s25 offen lds
    s_add_u32 s21, s21, 81920
    s_cmp_eq_u32 s21, s39
    s_cselect_b32 s21, s38, s21
    s_add_u32 s50, s40, 184
    s_cmp_lg_u32 s26, 0
    s_cbranch_scc1 L_wcd_43
    s_lshl_b32 s31, s50, 7
    v_mov_b32 v238, s31
    s_mov_b32 exec_lo, 1
    s_mov_b32 exec_hi, 0
    s_mov_b32 s30, 0x40000
L_wc_42:
    buffer_load_dword v239, v238, s[56:59], 0 offen sc1
    s_waitcnt vmcnt(0)
    v_cmp_gt_u32 vcc, 32, v239
    s_nop 4
    s_cbranch_vccz L_wcd_43_x
    s_sleep 4
    s_sub_u32 s30, s30, 1
    s_cmp_lg_u32 s30, 0
    s_cbranch_scc1 L_wc_42
L_wcd_43_x:
    s_mov_b64 exec, -1
L_wcd_43:
    s_waitcnt vmcnt(0)
    s_barrier
    s_add_u32 m0, s23, 0
    s_add_u32 s25, s20, 0
    buffer_load_dwordx4 v2, s[4:7], s25 offen sc1 lds
    s_add_u32 m0, s23, 4096
    s_add_u32 s25, s20, 131072
    buffer_load_dwordx4 v2, s[4:7], s25 offen sc1 lds
    s_add_u32 s20, s20, 262144
    s_cmp_eq_u32 s20, s37
    s_cselect_b32 s20, s36, s20
    s_add_u32 m0, s23, 24576
    s_add_u32 s25, s20, 0
    buffer_load_dwordx4 v2, s[4:7], s25 offen sc1 lds
    s_add_u32 m0, s23, 28672
    s_add_u32 s25, s20, 131072
    buffer_load_dwordx4 v2, s[4:7], s25 offen sc1 lds
    s_add_u32 s20, s20, 262144
    s_cmp_eq_u32 s20, s37
    s_cselect_b32 s20, s36, s20
    s_add_u32 m0, s23, 49152
    s_add_u32 s25, s20, 0
    buffer_load_dwordx4 v2, s[4:7], s25 offen sc1 lds
    s_add_u32 m0, s23, 53248
    s_add_u32 s25, s20, 131072
    buffer_load_dwordx4 v2, s[4:7], s25 offen sc1 lds
    s_add_u32 s20, s20, 262144
    s_cmp_eq_u32 s20, s37
    s_cselect_b32 s20, s36, s20
    s_waitcnt vmcnt(4)
    s_barrier
    ds_read_b64 v[32:33], v4 offset:0
    ds_read_b64 v[34:35], v4 offset:512
    ds_read_b64_tr_b16 v[40:41], v228 offset:8192
    ds_read_b64_tr_b16 v[42:43], v228 offset:8704
    ds_read_b64_tr_b16 v[44:45], v230 offset:8192
    ds_read_b64_tr_b16 v[46:47], v230 offset:8704
    ds_read_b64 v[48:49], v4 offset:2048
    ds_read_b64 v[50:51], v4 offset:2560
    ds_read_b64_tr_b16 v[56:57], v228 offset:10240
    ds_read_b64_tr_b16 v[58:59], v228 offset:10752
    ds_read_b64_tr_b16 v[60:61], v230 offset:10240
    ds_read_b64_tr_b16 v[62:63], v230 offset:10752
    s_waitcnt lgkmcnt(6)
    v_mfma_f32_32x32x16_bf16 v[64:79], v[40:43], v[32:35], 0
    ds_read_b64 v[240:241], v4 offset:4096
    ds_read_b64 v[242:243], v4 offset:4608
    ds_read_b64_tr_b16 v[248:249], v228 offset:12288
    v_mfma_f32_32x32x16_bf16 v[80:95], v[44:47], v[32:35], 0
    ds_read_b64_tr_b16 v[250:251], v228 offset:12800
    ds_read_b64_tr_b16 v[252:253], v230 offset:12288
    ds_read_b64_tr_b16 v[254:255], v230 offset:12800
    s_waitcnt lgkmcnt(6)
    v_mfma_f32_32x32x16_bf16 v[64:79], v[56:59], v[48:51], v[64:79]
    ds_read_b64 v[32:33], v4 offset:6144
    ds_read_b64 v[34:35], v4 offset:6656
    ds_read_b64_tr_b16 v[40:41], v228 offset:14336
    v_mfma_f32_32x32x16_bf16 v[80:95], v[60:63], v[48:51], v[80:95]
    ds_read_b64_tr_b16 v[42:43], v228 offset:14848
    ds_read_b64_tr_b16 v[44:45], v230 offset:14336
    ds_read_b64_tr_b16 v[46:47], v230 offset:14848
    s_waitcnt lgkmcnt(6)
    v_mfma_f32_32x32x16_bf16 v[64:79], v[248:251], v[240:243], v[64:79]
    s_waitcnt vmcnt(2) lgkmcnt(0)
    s_barrier
    ds_read_b64 v[48:49], v4 offset:24576
    ds_read_b64 v[50:51], v4 offset:25088
    ds_read_b64_tr_b16 v[56:57], v228 offset:32768
    s_add_u32 m0, s23, 0
    s_add_u32 s25, s20, 0
    buffer_load_dwordx4 v2, s[4:7], s25 offen sc1 lds
    v_mfma_f32_32x32x16_bf16 v[80:95], v[252:255], v[240:243], v[80:95]
    ds_read_b64_tr_b16 v[58:59], v228 offset:33280
    ds_read_b64_tr_b16 v[60:61], v230 offset:32768
    ds_read_b64_tr_b16 v[62:63], v230 offset:33280
    s_add_u32 m0, s23, 4096
    s_add_u32 s25, s20, 131072
    buffer_load_dwordx4 v2, s[4:7], s25 offen sc1 lds
    s_add_u32 s20, s20, 262144
    s_cmp_eq_u32 s20, s37
    s_cselect_b32 s20, s36, s20
    s_waitcnt lgkmcnt(6)
    v_mfma_f32_32x32x16_bf16 v[64:79], v[40:43], v[32:35], v[64:79]
    ds_read_b64 v[240:241], v4 offset:26624
    ds_read_b64 v[242:243], v4 offset:27136
    ds_read_b64_tr_b16 v[248:249], v228 offset:34816
    s_add_u32 m0, s23, 8192
    s_add_u32 s25, s21, 0
    buffer_load_dwordx4 v3, s[8:11], s25 offen lds
    v_mfma_f32_32x32x16_bf16 v[80:95], v[44:47], v[32:35], v[80:95]
    ds_read_b64_tr_b16 v[250:251], v228 offset:35328
    ds_read_b64_tr_b16 v[252:253], v230 offset:34816
    ds_read_b64_tr_b16 v[254:255], v230 offset:35328
    s_add_u32 m0, s23, 12288
    s_add_u32 s25, s21, 40960
    buffer_load_dwordx4 v3, s[8:11], s25 offen lds
    s_waitcnt lgkmcnt(6)
    v_mfma_f32_32x32x16_bf16 v[64:79], v[56:59], v[48:51], v[64:79]
    ds_read_b64 v[32:33], v4 offset:28672
    ds_read_b64 v[34:35], v4 offset:29184
    ds_read_b64_tr_b16 v[40:41], v228 offset:36864
    v_mfma_f32_32x32x16_bf16 v[80:95], v[60:63], v[48:51], v[80:95]
    ds_read_b64_tr_b16 v[42:43], v228 offset:37376
    ds_read_b64_tr_b16 v[44:45], v230 offset:36864
    ds_read_b64_tr_b16 v[46:47], v230 offset:37376
    s_add_u32 m0, s23, 16384
    s_add_u32 s25, s21, 128
    buffer_load_dwordx4 v3, s[12:15], s25 offen lds
    s_waitcnt lgkmcnt(6)
    v_mfma_f32_32x32x16_bf16 v[64:79], v[248:251], v[240:243], v[64:79]
    ds_read_b64 v[48:49], v4 offset:30720
    ds_read_b64 v[50:51], v4 offset:31232
    ds_read_b64_tr_b16 v[56:57], v228 offset:38912
    v_mfma_f32_32x32x16_bf16 v[80:95], v[252:255], v[240:243], v[80:95]
    ds_read_b64_tr_b16 v[58:59], v228 offset:39424
    ds_read_b64_tr_b16 v[60:61], v230 offset:38912
    ds_read_b64_tr_b16 v[62:63], v230 offset:39424
    s_add_u32 m0, s23, 20480
    s_add_u32 s25, s21, 41088
    buffer_load_dwordx4 v3, s[12:15], s25 offen lds
    s_add_u32 s21, s21, 81920
    s_cmp_eq_u32 s21, s39
    s_cselect_b32 s21, s38, s21
    s_waitcnt lgkmcnt(6)
    v_mfma_f32_32x32x16_bf16 v[64:79], v[40:43], v[32:35], v[64:79]
    s_waitcnt vmcnt(6) lgkmcnt(0)
    s_barrier
    ds_read_b64 v[240:241], v4 offset:49152
    ds_read_b64 v[242:243], v4 offset:49664
    ds_read_b64_tr_b16 v[248:249], v228 offset:57344
    s_add_u32 m0, s23, 24576
    s_add_u32 s25, s20, 0
    buffer_load_dwordx4 v2, s[4:7], s25 offen sc1 lds
    v_mfma_f32_32x32x16_bf16 v[80:95], v[44:47], v[32:35], v[80:95]
    ds_read_b64_tr_b16 v[250:251], v228 offset:57856
    ds_read_b64_tr_b16 v[252:253], v230 offset:57344
    ds_read_b64_tr_b16 v[254:255], v230 offset:57856
    s_add_u32 m0, s23, 28672
    s_add_u32 s25, s20, 131072
    buffer_load_dwordx4 v2, s[4:7], s25 offen sc1 lds
    s_add_u32 s20, s20, 262144
    s_cmp_eq_u32 s20, s37
    s_cselect_b32 s20, s36, s20
    s_waitcnt lgkmcnt(6)
    v_mfma_f32_32x32x16_bf16 v[64:79], v[56:59], v[48:51], v[64:79]
    ds_read_b64 v[32:33], v4 offset:51200
    ds_read_b64 v[34:35], v4 offset:51712
    ds_read_b64_tr_b16 v[40:41], v228 offset:59392
    s_add_u32 m0, s23, 32768
    s_add_u32 s25, s21, 0
    buffer_load_dwordx4 v3, s[8:11], s25 offen lds
    v_mfma_f32_32x32x16_bf16 v[80:95], v[60:63], v[48:51], v[80:95]
    ds_read_b64_tr_b16 v[42:43], v228 offset:59904
    ds_read_b64_tr_b16 v[44:45], v230 offset:59392
    ds_read_b64_tr_b16 v[46:47], v230 offset:59904
    s_add_u32 m0, s23, 36864
    s_add_u32 s25, s21, 40960
    buffer_load_dwordx4 v3, s[8:11], s25 offen lds
    s_waitcnt lgkmcnt(6)
    v_mfma_f32_32x32x16_bf16 v[64:79], v[248:251], v[240:243], v[64:79]
    ds_read_b64 v[48:49], v4 offset:53248
    ds_read_b64 v[50:51], v4 offset:53760
    ds_read_b64_tr_b16 v[56:57], v228 offset:61440
    v_mfma_f32_32x32x16_bf16 v[80:95], v[252:255], v[240:243], v[80:95]
    ds_read_b64_tr_b16 v[58:59], v228 offset:61952
    ds_read_b64_tr_b16 v[60:61], v230 offset:61440
    ds_read_b64_tr_b16 v[62:63], v230 offset:61952
    s_add_u32 m0, s23, 40960
    s_add_u32 s25, s21, 128
    buffer_load_dwordx4 v3, s[12:15], s25 offen lds
    s_waitcnt lgkmcnt(6)
    v_mfma_f32_32x32x16_bf16 v[64:79], v[40:43], v[32:35], v[64:79]
    ds_read_b64 v[240:241], v4 offset:55296
    ds_read_b64 v[242:243], v4 offset:55808
    ds_read_b64_tr_b16 v[248:249], v228 offset:63488
    v_mfma_f32_32x32x16_bf16 v[80:95], v[44:47], v[32:35], v[80:95]
    ds_read_b64_tr_b16 v[250:251], v228 offset:64000
    ds_read_b64_tr_b16 v[252:253], v230 offset:63488
    ds_read_b64_tr_b16 v[254:255], v230 offset:64000
    s_add_u32 m0, s23, 45056
    s_add_u32 s25, s21, 41088
    buffer_load_dwordx4 v3, s[12:15], s25 offen lds
    s_add_u32 s21, s21, 81920
    s_cmp_eq_u32 s21, s39
    s_cselect_b32 s21, s38, s21
    s_waitcnt lgkmcnt(6)
    v_mfma_f32_32x32x16_bf16 v[64:79], v[56:59], v[48:51], v[64:79]
    s_waitcnt vmcnt(6) lgkmcnt(0)
    s_barrier
    ds_read_b64 v[32:33], v4 offset:0
    ds_read_b64 v[34:35], v4 offset:512
    ds_read_b64_tr_b16 v[40:41], v228 offset:8192
    s_add_u32 m0, s23, 49152
    s_add_u32 s25, s20, 0
    buffer_load_dwordx4 v2, s[4:7], s25 offen sc1 lds
    v_mfma_f32_32x32x16_bf16 v[80:95], v[60:63], v[48:51], v[80:95]
    ds_read_b64_tr_b16 v[42:43], v228 offset:8704
    ds_read_b64_tr_b16 v[44:45], v230 offset:8192
    ds_read_b64_tr_b16 v[46:47], v230 offset:8704
    s_add_u32 m0, s23, 53248
    s_add_u32 s25, s20, 131072
    buffer_load_dwordx4 v2, s[4:7], s25 offen sc1 lds
    s_add_u32 s20, s20, 262144
    s_cmp_eq_u32 s20, s37
    s_cselect_b32 s20, s36, s20
    s_waitcnt lgkmcnt(6)
    v_mfma_f32_32x32x16_bf16 v[64:79], v[248:251], v[240:243], v[64:79]
    ds_read_b64 v[48:49], v4 offset:2048
    ds_read_b64 v[50:51], v4 offset:2560
    ds_read_b64_tr_b16 v[56:57], v228 offset:10240
    s_add_u32 m0, s23, 57344
    s_add_u32 s25, s21, 0
    buffer_load_dwordx4 v3, s[8:11], s25 offen lds
    v_mfma_f32_32x32x16_bf16 v[80:95], v[252:255], v[240:243], v[80:95]
    ds_read_b64_tr_b16 v[58:59], v228 offset:10752
    ds_read_b64_tr_b16 v[60:61], v230 offset:10240
    ds_read_b64_tr_b16 v[62:63], v230 offset:10752
    s_add_u32 m0, s23, 61440
    s_add_u32 s25, s21, 40960
    buffer_load_dwordx4 v3, s[8:11], s25 offen lds
    s_waitcnt lgkmcnt(6)
    v_mfma_f32_32x32x16_bf16 v[64:79], v[40:43], v[32:35], v[64:79]
    ds_read_b64 v[240:241], v4 offset:4096
    ds_read_b64 v[242:243], v4 offset:4608
    ds_read_b64_tr_b16 v[248:249], v228 offset:12288
    v_mfma_f32_32x32x16_bf16 v[80:95], v[44:47], v[32:35], v[80:95]
    ds_read_b64_tr_b16 v[250:251], v228 offset:12800
    ds_read_b64_tr_b16 v[252:253], v230 offset:12288
    ds_read_b64_tr_b16 v[254:255], v230 offset:12800
    s_add_u32 m0, s23, 65536
    s_add_u32 s25, s21, 128
    buffer_load_dwordx4 v3, s[12:15], s25 offen lds
    s_waitcnt lgkmcnt(6)
    v_mfma_f32_32x32x16_bf16 v[64:79], v[56:59], v[48:51], v[64:79]
    ds_read_b64 v[32:33], v4 offset:6144
    ds_read_b64 v[34:35], v4 offset:6656
    ds_read_b64_tr_b16 v[40:41], v228 offset:14336
    v_mfma_f32_32x32x16_bf16 v[80:95], v[60:63], v[48:51], v[80:95]
    ds_read_b64_tr_b16 v[42:43], v228 offset:14848
    ds_read_b64_tr_b16 v[44:45], v230 offset:14336
    ds_read_b64_tr_b16 v[46:47], v230 offset:14848
    s_add_u32 m0, s23, 69632
    s_add_u32 s25, s21, 41088
    buffer_load_dwordx4 v3, s[12:15], s25 offen lds
    s_add_u32 s21, s21, 81920
    s_cmp_eq_u32 s21, s39
    s_cselect_b32 s21, s38, s21
    s_waitcnt lgkmcnt(6)
    v_mfma_f32_32x32x16_bf16 v[64:79], v[248:251], v[240:243], v[64:79]
    s_waitcnt vmcnt(6) lgkmcnt(0)
    s_barrier
    ds_read_b64 v[48:49], v4 offset:24576
    ds_read_b64 v[50:51], v4 offset:25088
    ds_read_b64_tr_b16 v[56:57], v228 offset:32768
    s_add_u32 m0, s23, 0
    s_add_u32 s25, s20, 0
    buffer_load_dwordx4 v2, s[4:7], s25 offen sc1 lds
    v_mfma_f32_32x32x16_bf16 v[80:95], v[252:255], v[240:243], v[80:95]
    ds_read_b64_tr_b16 v[58:59], v228 offset:33280
    ds_read_b64_tr_b16 v[60:61], v230 offset:32768
    ds_read_b64_tr_b16 v[62:63], v230 offset:33280
    s_add_u32 m0, s23, 4096
    s_add_u32 s25, s20, 131072
    buffer_load_dwordx4 v2, s[4:7], s25 offen sc1 lds
    s_add_u32 s20, s20, 262144
    s_cmp_eq_u32 s20, s37
    s_cselect_b32 s20, s36, s20
    s_waitcnt lgkmcnt(6)
    v_mfma_f32_32x32x16_bf16 v[64:79], v[40:43], v[32:35], v[64:79]
    ds_read_b64 v[240:241], v4 offset:26624
    ds_read_b64 v[242:243], v4 offset:27136
    ds_read_b64_tr_b16 v[248:249], v228 offset:34816
    s_add_u32 m0, s23, 8192
    s_add_u32 s25, s21, 0
    buffer_load_dwordx4 v3, s[8:11], s25 offen lds
    v_mfma_f32_32x32x16_bf16 v[80:95], v[44:47], v[32:35], v[80:95]
    ds_read_b64_tr_b16 v[250:251], v228 offset:35328
    ds_read_b64_tr_b16 v[252:253], v230 offset:34816
    ds_read_b64_tr_b16 v[254:255], v230 offset:35328
    s_add_u32 m0, s23, 12288
    s_add_u32 s25, s21, 40960
    buffer_load_dwordx4 v3, s[8:11], s25 offen lds
    s_waitcnt lgkmcnt(6)
    v_mfma_f32_32x32x16_bf16 v[64:79], v[56:59], v[48:51], v[64:79]
    ds_read_b64 v[32:33], v4 offset:28672
    ds_read_b64 v[34:35], v4 offset:29184
    ds_read_b64_tr_b16 v[40:41], v228 offset:36864
    v_mfma_f32_32x32x16_bf16 v[80:95], v[60:63], v[48:51], v[80:95]
    ds_read_b64_tr_b16 v[42:43], v228 offset:37376
    ds_read_b64_tr_b16 v[44:45], v230 offset:36864
    ds_read_b64_tr_b16 v[46:47], v230 offset:37376
    s_add_u32 m0, s23, 16384
    s_add_u32 s25, s21, 128
    buffer_load_dwordx4 v3, s[12:15], s25 offen lds
    s_waitcnt lgkmcnt(6)
    v_mfma_f32_32x32x16_bf16 v[64:79], v[248:251], v[240:243], v[64:79]
    ds_read_b64 v[48:49], v4 offset:30720
    ds_read_b64 v[50:51], v4 offset:31232
    ds_read_b64_tr_b16 v[56:57], v228 offset:38912
    v_mfma_f32_32x32x16_bf16 v[80:95], v[252:255], v[240:243], v[80:95]
    ds_read_b64_tr_b16 v[58:59], v228 offset:39424
    ds_read_b64_tr_b16 v[60:61], v230 offset:38912
    ds_read_b64_tr_b16 v[62:63], v230 offset:39424
    s_add_u32 m0, s23, 20480
    s_add_u32 s25, s21, 41088
    buffer_load_dwordx4 v3, s[12:15], s25 offen lds
    s_add_u32 s21, s21, 81920
    s_cmp_eq_u32 s21, s39
    s_cselect_b32 s21, s38, s21
    s_waitcnt lgkmcnt(6)
    v_mfma_f32_32x32x16_bf16 v[64:79], v[40:43], v[32:35], v[64:79]
    s_waitcnt vmcnt(6) lgkmcnt(0)
    s_barrier
    ds_read_b64 v[240:241], v4 offset:49152
    ds_read_b64 v[242:243], v4 offset:49664
    ds_read_b64_tr_b16 v[248:249], v228 offset:57344
    s_add_u32 m0, s23, 24576
    s_add_u32 s25, s20, 0
    buffer_load_dwordx4 v2, s[4:7], s25 offen sc1 lds
    v_mfma_f32_32x32x16_bf16 v[80:95], v[44:47], v[32:35], v[80:95]
    ds_read_b64_tr_b16 v[250:251], v228 offset:57856
    ds_read_b64_tr_b16 v[252:253], v230 offset:57344
    ds_read_b64_tr_b16 v[254:255], v230 offset:57856
    s_add_u32 m0, s23, 28672
    s_add_u32 s25, s20, 131072
    buffer_load_dwordx4 v2, s[4:7], s25 offen sc1 lds
    s_add_u32 s20, s20, 262144
    s_cmp_eq_u32 s20, s37
    s_cselect_b32 s20, s36, s20
    s_waitcnt lgkmcnt(6)
    v_mfma_f32_32x32x16_bf16 v[64:79], v[56:59], v[48:51], v[64:79]
    ds_read_b64 v[32:33], v4 offset:51200
    ds_read_b64 v[34:35], v4 offset:51712
    ds_read_b64_tr_b16 v[40:41], v228 offset:59392
    s_add_u32 m0, s23, 32768
    s_add_u32 s25, s21, 0
    buffer_load_dwordx4 v3, s[8:11], s25 offen lds
    v_mfma_f32_32x32x16_bf16 v[80:95], v[60:63], v[48:51], v[80:95]
    ds_read_b64_tr_b16 v[42:43], v228 offset:59904
    ds_read_b64_tr_b16 v[44:45], v230 offset:59392
    ds_read_b64_tr_b16 v[46:47], v230 offset:59904
    s_add_u32 m0, s23, 36864
    s_add_u32 s25, s21, 40960
    buffer_load_dwordx4 v3, s[8:11], s25 offen lds
    s_waitcnt lgkmcnt(6)
    v_mfma_f32_32x32x16_bf16 v[64:79], v[248:251], v[240:243], v[64:79]
    ds_read_b64 v[48:49], v4 offset:53248
    ds_read_b64 v[50:51], v4 offset:53760
    ds_read_b64_tr_b16 v[56:57], v228 offset:61440
    v_mfma_f32_32x32x16_bf16 v[80:95], v[252:255], v[240:243], v[80:95]
    ds_read_b64_tr_b16 v[58:59], v228 offset:61952
    ds_read_b64_tr_b16 v[60:61], v230 offset:61440
    ds_read_b64_tr_b16 v[62:63], v230 offset:61952
    s_add_u32 m0, s23, 40960
    s_add_u32 s25, s21, 128
    buffer_load_dwordx4 v3, s[12:15], s25 offen lds
    s_waitcnt lgkmcnt(6)
    v_mfma_f32_32x32x16_bf16 v[64:79], v[40:43], v[32:35], v[64:79]
    ds_read_b64 v[240:241], v4 offset:55296
    ds_read_b64 v[242:243], v4 offset:55808
    ds_read_b64_tr_b16 v[248:249], v228 offset:63488
    v_mfma_f32_32x32x16_bf16 v[80:95], v[44:47], v[32:35], v[80:95]
    ds_read_b64_tr_b16 v[250:251], v228 offset:64000
    ds_read_b64_tr_b16 v[252:253], v230 offset:63488
    ds_read_b64_tr_b16 v[254:255], v230 offset:64000
    s_add_u32 m0, s23, 45056
    s_add_u32 s25, s21, 41088
    buffer_load_dwordx4 v3, s[12:15], s25 offen lds
    s_add_u32 s21, s21, 81920
    s_cmp_eq_u32 s21, s39
    s_cselect_b32 s21, s38, s21
    s_waitcnt lgkmcnt(6)
    v_mfma_f32_32x32x16_bf16 v[64:79], v[56:59], v[48:51], v[64:79]
    s_waitcnt vmcnt(6) lgkmcnt(0)
    s_barrier
    ds_read_b64 v[32:33], v4 offset:0
    ds_read_b64 v[34:35], v4 offset:512
    ds_read_b64_tr_b16 v[40:41], v228 offset:8192
    s_add_u32 m0, s23, 49152
    s_add_u32 s25, s20, 0
    buffer_load_dwordx4 v2, s[4:7], s25 offen sc1 lds
    v_mfma_f32_32x32x16_bf16 v[80:95], v[60:63], v[48:51], v[80:95]
    ds_read_b64_tr_b16 v[42:43], v228 offset:8704
    ds_read_b64_tr_b16 v[44:45], v230 offset:8192
    ds_read_b64_tr_b16 v[46:47], v230 offset:8704
    s_add_u32 m0, s23, 53248
    s_add_u32 s25, s20, 131072
    buffer_load_dwordx4 v2, s[4:7], s25 offen sc1 lds
    s_add_u32 s20, s20, 262144
    s_cmp_eq_u32 s20, s37
    s_cselect_b32 s20, s36, s20
    s_waitcnt lgkmcnt(6)
    v_mfma_f32_32x32x16_bf16 v[64:79], v[248:251], v[240:243], v[64:79]
    ds_read_b64 v[48:49], v4 offset:2048
    ds_read_b64 v[50:51], v4 offset:2560
    ds_read_b64_tr_b16 v[56:57], v228 offset:10240
    s_add_u32 m0, s23, 57344
    s_add_u32 s25, s21, 0
    buffer_load_dwordx4 v3, s[8:11], s25 offen lds
    v_mfma_f32_32x32x16_bf16 v[80:95], v[252:255], v[240:243], v[80:95]
    ds_read_b64_tr_b16 v[58:59], v228 offset:10752
    ds_read_b64_tr_b16 v[60:61], v230 offset:10240
    ds_read_b64_tr_b16 v[62:63], v230 offset:10752
    s_add_u32 m0, s23, 61440
    s_add_u32 s25, s21, 40960
    buffer_load_dwordx4 v3, s[8:11], s25 offen lds
    s_waitcnt lgkmcnt(6)
    v_mfma_f32_32x32x16_bf16 v[64:79], v[40:43], v[32:35], v[64:79]
    ds_read_b64 v[240:241], v4 offset:4096
    ds_read_b64 v[242:243], v4 offset:4608
    ds_read_b64_tr_b16 v[248:249], v228 offset:12288
    v_mfma_f32_32x32x16_bf16 v[80:95], v[44:47], v[32:35], v[80:95]
    ds_read_b64_tr_b16 v[250:251], v228 offset:12800
    ds_read_b64_tr_b16 v[252:253], v230 offset:12288
    ds_read_b64_tr_b16 v[254:255], v230 offset:12800
    s_add_u32 m0, s23, 65536
    s_add_u32 s25, s21, 128
    buffer_load_dwordx4 v3, s[12:15], s25 offen lds
    s_waitcnt lgkmcnt(6)
    v_mfma_f32_32x32x16_bf16 v[64:79], v[56:59], v[48:51], v[64:79]
    ds_read_b64 v[32:33], v4 offset:6144
    ds_read_b64 v[34:35], v4 offset:6656
    ds_read_b64_tr_b16 v[40:41], v228 offset:14336
    v_mfma_f32_32x32x16_bf16 v[80:95], v[60:63], v[48:51], v[80:95]
    ds_read_b64_tr_b16 v[42:43], v228 offset:14848
    ds_read_b64_tr_b16 v[44:45], v230 offset:14336
    ds_read_b64_tr_b16 v[46:47], v230 offset:14848
    s_add_u32 m0, s23, 69632
    s_add_u32 s25, s21, 41088
    buffer_load_dwordx4 v3, s[12:15], s25 offen lds
    s_add_u32 s21, s21, 81920
    s_cmp_eq_u32 s21, s39
    s_cselect_b32 s21, s38, s21
    s_waitcnt lgkmcnt(6)
    v_mfma_f32_32x32x16_bf16 v[64:79], v[248:251], v[240:243], v[64:79]
    s_waitcnt vmcnt(6) lgkmcnt(0)
    s_barrier
    ds_read_b64 v[48:49], v4 offset:24576
    ds_read_b64 v[50:51], v4 offset:25088
    ds_read_b64_tr_b16 v[56:57], v228 offset:32768
    s_add_u32 m0, s23, 0
    s_add_u32 s25, s20, 0
    buffer_load_dwordx4 v2, s[4:7], s25 offen sc1 lds
    v_mfma_f32_32x32x16_bf16 v[80:95], v[252:255], v[240:243], v[80:95]
    ds_read_b64_tr_b16 v[58:59], v228 offset:33280
    ds_read_b64_tr_b16 v[60:61], v230 offset:32768
    ds_read_b64_tr_b16 v[62:63], v230 offset:33280
    s_add_u32 m0, s23, 4096
    s_add_u32 s25, s20, 131072
    buffer_load_dwordx4 v2, s[4:7], s25 offen sc1 lds
    s_add_u32 s20, s20, 262144
    s_cmp_eq_u32 s20, s37
    s_cselect_b32 s20, s36, s20
    s_waitcnt lgkmcnt(6)
    v_mfma_f32_32x32x16_bf16 v[64:79], v[40:43], v[32:35], v[64:79]
    ds_read_b64 v[240:241], v4 offset:26624
    ds_read_b64 v[242:243], v4 offset:27136
    ds_read_b64_tr_b16 v[248:249], v228 offset:34816
    s_add_u32 m0, s23, 8192
    s_add_u32 s25, s21, 0
    buffer_load_dwordx4 v3, s[8:11], s25 offen lds
    v_mfma_f32_32x32x16_bf16 v[80:95], v[44:47], v[32:35], v[80:95]
    ds_read_b64_tr_b16 v[250:251], v228 offset:35328
    ds_read_b64_tr_b16 v[252:253], v230 offset:34816
    ds_read_b64_tr_b16 v[254:255], v230 offset:35328
    s_add_u32 m0, s23, 12288
    s_add_u32 s25, s21, 40960
    buffer_load_dwordx4 v3, s[8:11], s25 offen lds
    s_waitcnt lgkmcnt(6)
    v_mfma_f32_32x32x16_bf16 v[64:79], v[56:59], v[48:51], v[64:79]
    ds_read_b64 v[32:33], v4 offset:28672
    ds_read_b64 v[34:35], v4 offset:29184
    ds_read_b64_tr_b16 v[40:41], v228 offset:36864
    v_mfma_f32_32x32x16_bf16 v[80:95], v[60:63], v[48:51], v[80:95]
    ds_read_b64_tr_b16 v[42:43], v228 offset:37376
    ds_read_b64_tr_b16 v[44:45], v230 offset:36864
    ds_read_b64_tr_b16 v[46:47], v230 offset:37376
    s_add_u32 m0, s23, 16384
    s_add_u32 s25, s21, 128
    buffer_load_dwordx4 v3, s[12:15], s25 offen lds
    s_waitcnt lgkmcnt(6)
    v_mfma_f32_32x32x16_bf16 v[64:79], v[248:251], v[240:243], v[64:79]
    ds_read_b64 v[48:49], v4 offset:30720
    ds_read_b64 v[50:51], v4 offset:31232
    ds_read_b64_tr_b16 v[56:57], v228 offset:38912
    v_mfma_f32_32x32x16_bf16 v[80:95], v[252:255], v[240:243], v[80:95]
    ds_read_b64_tr_b16 v[58:59], v228 offset:39424
    ds_read_b64_tr_b16 v[60:61], v230 offset:38912
    ds_read_b64_tr_b16 v[62:63], v230 offset:39424
    s_add_u32 m0, s23, 20480
    s_add_u32 s25, s21, 41088
    buffer_load_dwordx4 v3, s[12:15], s25 offen lds
    s_add_u32 s21, s21, 81920
    s_cmp_eq_u32 s21, s39
    s_cselect_b32 s21, s38, s21
    s_waitcnt lgkmcnt(6)
    v_mfma_f32_32x32x16_bf16 v[64:79], v[40:43], v[32:35], v[64:79]
    s_waitcnt vmcnt(6) lgkmcnt(0)
    s_barrier
    ds_read_b64 v[240:241], v4 offset:49152
    ds_read_b64 v[242:243], v4 offset:49664
    ds_read_b64_tr_b16 v[248:249], v228 offset:57344
    v_mfma_f32_32x32x16_bf16 v[80:95], v[44:47], v[32:35], v[80:95]
    ds_read_b64_tr_b16 v[250:251], v228 offset:57856
    ds_read_b64_tr_b16 v[252:253], v230 offset:57344
    ds_read_b64_tr_b16 v[254:255], v230 offset:57856
    s_waitcnt lgkmcnt(6)
    v_mfma_f32_32x32x16_bf16 v[64:79], v[56:59], v[48:51], v[64:79]
    ds_read_b64 v[32:33], v4 offset:51200
    ds_read_b64 v[34:35], v4 offset:51712
    ds_read_b64_tr_b16 v[40:41], v228 offset:59392
    v_mfma_f32_32x32x16_bf16 v[80:95], v[60:63], v[48:51], v[80:95]
    ds_read_b64_tr_b16 v[42:43], v228 offset:59904
    ds_read_b64_tr_b16 v[44:45], v230 offset:59392
    ds_read_b64_tr_b16 v[46:47], v230 offset:59904
    s_waitcnt lgkmcnt(6)
    v_mfma_f32_32x32x16_bf16 v[64:79], v[248:251], v[240:243], v[64:79]
    ds_read_b64 v[48:49], v4 offset:53248
    ds_read_b64 v[50:51], v4 offset:53760
    ds_read_b64_tr_b16 v[56:57], v228 offset:61440
    v_mfma_f32_32x32x16_bf16 v[80:95], v[252:255], v[240:243], v[80:95]
    ds_read_b64_tr_b16 v[58:59], v228 offset:61952
    ds_read_b64_tr_b16 v[60:61], v230 offset:61440
    ds_read_b64_tr_b16 v[62:63], v230 offset:61952
    s_waitcnt lgkmcnt(6)
    v_mfma_f32_32x32x16_bf16 v[64:79], v[40:43], v[32:35], v[64:79]
    ds_read_b64 v[240:241], v4 offset:55296
    ds_read_b64 v[242:243], v4 offset:55808
    ds_read_b64_tr_b16 v[248:249], v228 offset:63488
    v_mfma_f32_32x32x16_bf16 v[80:95], v[44:47], v[32:35], v[80:95]
    ds_read_b64_tr_b16 v[250:251], v228 offset:64000
    ds_read_b64_tr_b16 v[252:253], v230 offset:63488
    ds_read_b64_tr_b16 v[254:255], v230 offset:64000
    s_waitcnt lgkmcnt(6)
    v_mfma_f32_32x32x16_bf16 v[64:79], v[56:59], v[48:51], v[64:79]
    s_waitcnt vmcnt(0) lgkmcnt(0)
    s_barrier
    ds_read_b64 v[32:33], v4 offset:0
    ds_read_b64 v[34:35], v4 offset:512
    ds_read_b64_tr_b16 v[40:41], v228 offset:8192
    v_mfma_f32_32x32x16_bf16 v[80:95], v[60:63], v[48:51], v[80:95]
    ds_read_b64_tr_b16 v[42:43], v228 offset:8704
    ds_read_b64_tr_b16 v[44:45], v230 offset:8192
    ds_read_b64_tr_b16 v[46:47], v230 offset:8704
    s_waitcnt lgkmcnt(6)
    v_mfma_f32_32x32x16_bf16 v[64:79], v[248:251], v[240:243], v[64:79]
    ds_read_b64 v[48:49], v4 offset:2048
    ds_read_b64 v[50:51], v4 offset:2560
    ds_read_b64_tr_b16 v[56:57], v228 offset:10240
    v_mfma_f32_32x32x16_bf16 v[80:95], v[252:255], v[240:243], v[80:95]
    ds_read_b64_tr_b16 v[58:59], v228 offset:10752
    ds_read_b64_tr_b16 v[60:61], v230 offset:10240
    ds_read_b64_tr_b16 v[62:63], v230 offset:10752
    s_waitcnt lgkmcnt(6)
    v_mfma_f32_32x32x16_bf16 v[64:79], v[40:43], v[32:35], v[64:79]
    ds_read_b64 v[240:241], v4 offset:4096
    ds_read_b64 v[242:243], v4 offset:4608
    ds_read_b64_tr_b16 v[248:249], v228 offset:12288
    v_mfma_f32_32x32x16_bf16 v[80:95], v[44:47], v[32:35], v[80:95]
    ds_read_b64_tr_b16 v[250:251], v228 offset:12800
    ds_read_b64_tr_b16 v[252:253], v230 offset:12288
    ds_read_b64_tr_b16 v[254:255], v230 offset:12800
    s_waitcnt lgkmcnt(6)
    v_mfma_f32_32x32x16_bf16 v[64:79], v[56:59], v[48:51], v[64:79]
    ds_read_b64 v[32:33], v4 offset:6144
    ds_read_b64 v[34:35], v4 offset:6656
    ds_read_b64_tr_b16 v[40:41], v228 offset:14336
    v_mfma_f32_32x32x16_bf16 v[80:95], v[60:63], v[48:51], v[80:95]
    ds_read_b64_tr_b16 v[42:43], v228 offset:14848
    ds_read_b64_tr_b16 v[44:45], v230 offset:14336
    ds_read_b64_tr_b16 v[46:47], v230 offset:14848
    s_waitcnt lgkmcnt(6)
    v_mfma_f32_32x32x16_bf16 v[64:79], v[248:251], v[240:243], v[64:79]
    v_mfma_f32_32x32x16_bf16 v[80:95], v[252:255], v[240:243], v[80:95]
    s_waitcnt lgkmcnt(0)
    v_mfma_f32_32x32x16_bf16 v[64:79], v[40:43], v[32:35], v[64:79]
    v_mfma_f32_32x32x16_bf16 v[80:95], v[44:47], v[32:35], v[80:95]
    s_nop 15
    s_mov_b32 s16, s72
    s_mov_b32 s17, s73
    s_and_b32 s17, s17, 0xffff
    s_mov_b32 s18, 2621440
    s_mov_b32 s19, 0x00020000
    v_permlane32_swap_b32 v164, v166
    v_permlane32_swap_b32 v165, v167
    s_nop 0
    v_lshlrev_b32 v14, 16, v164
    v_and_b32 v15, 0xffff0000, v164
    v_lshlrev_b32 v16, 16, v165
    v_and_b32 v17, 0xffff0000, v165
    v_fmac_f32 v14, v64, v128
    v_fmac_f32 v15, v65, v129
    v_fmac_f32 v16, v66, v130
    v_fmac_f32 v17, v67, v131
    v_lshlrev_b32 v18, 16, v166
    v_and_b32 v19, 0xffff0000, v166
    v_lshlrev_b32 v20, 16, v167
    v_and_b32 v21, 0xffff0000, v167
    v_fmac_f32 v18, v68, v132
    v_fmac_f32 v19, v69, v133
    v_fmac_f32 v20, v70, v134
    v_fmac_f32 v21, v71, v135
    v_cvt_pk_bf16_f32 v22, v14, v15
    v_cvt_pk_bf16_f32 v23, v16, v17
    v_cvt_pk_bf16_f32 v24, v18, v19
    v_cvt_pk_bf16_f32 v25, v20, v21
    s_nop 1
    v_permlane32_swap_b32 v22, v24
    v_permlane32_swap_b32 v23, v25
    buffer_store_dwordx4 v[22:25], v160, s[16:19], 0 offen offset:0
    v_permlane32_swap_b32 v168, v170
    v_permlane32_swap_b32 v169, v171
    s_nop 0
    v_lshlrev_b32 v26, 16, v168
    v_and_b32 v27, 0xffff0000, v168
    v_lshlrev_b32 v28, 16, v169
    v_and_b32 v29, 0xffff0000, v169
    v_fmac_f32 v26, v72, v136
    v_fmac_f32 v27, v73, v137
    v_fmac_f32 v28, v74, v138
    v_fmac_f32 v29, v75, v139
    v_lshlrev_b32 v30, 16, v170
    v_and_b32 v31, 0xffff0000, v170
    v_lshlrev_b32 v32, 16, v171
    v_and_b32 v33, 0xffff0000, v171
    v_fmac_f32 v30, v76, v140
    v_fmac_f32 v31, v77, v141
    v_fmac_f32 v32, v78, v142
    v_fmac_f32 v33, v79, v143
    v_cvt_pk_bf16_f32 v34, v26, v27
    v_cvt_pk_bf16_f32 v35, v28, v29
    v_cvt_pk_bf16_f32 v36, v30, v31
    v_cvt_pk_bf16_f32 v37, v32, v33
    s_nop 1
    v_permlane32_swap_b32 v34, v36
    v_permlane32_swap_b32 v35, v37
    buffer_store_dwordx4 v[34:37], v160, s[16:19], 0 offen offset:32
    v_permlane32_swap_b32 v172, v174
    v_permlane32_swap_b32 v173, v175
    s_nop 0
    v_lshlrev_b32 v14, 16, v172
    v_and_b32 v15, 0xffff0000, v172
    v_lshlrev_b32 v16, 16, v173
    v_and_b32 v17, 0xffff0000, v173
    v_fmac_f32 v14, v80, v144
    v_fmac_f32 v15, v81, v145
    v_fmac_f32 v16, v82, v146
    v_fmac_f32 v17, v83, v147
    v_lshlrev_b32 v18, 16, v174
    v_and_b32 v19, 0xffff0000, v174
    v_lshlrev_b32 v20, 16, v175
    v_and_b32 v21, 0xffff0000, v175
    v_fmac_f32 v18, v84, v148
    v_fmac_f32 v19, v85, v149
    v_fmac_f32 v20, v86, v150
    v_fmac_f32 v21, v87, v151
    v_cvt_pk_bf16_f32 v22, v14, v15
    v_cvt_pk_bf16_f32 v23, v16, v17
    v_cvt_pk_bf16_f32 v24, v18, v19
    v_cvt_pk_bf16_f32 v25, v20, v21
    s_nop 1
    v_permlane32_swap_b32 v22, v24
    v_permlane32_swap_b32 v23, v25
    buffer_store_dwordx4 v[22:25], v160, s[16:19], 0 offen offset:128
    v_permlane32_swap_b32 v176, v178
    v_permlane32_swap_b32 v177, v179
    s_nop 0
    v_lshlrev_b32 v26, 16, v176
    v_and_b32 v27, 0xffff0000, v176
    v_lshlrev_b32 v28, 16, v177
    v_and_b32 v29, 0xffff0000, v177
    v_fmac_f32 v26, v88, v152
    v_fmac_f32 v27, v89, v153
    v_fmac_f32 v28, v90, v154
    v_fmac_f32 v29, v91, v155
    v_lshlrev_b32 v30, 16, v178
    v_and_b32 v31, 0xffff0000, v178
    v_lshlrev_b32 v32, 16, v179
    v_and_b32 v33, 0xffff0000, v179
    v_fmac_f32 v30, v92, v156
    v_fmac_f32 v31, v93, v157
    v_fmac_f32 v32, v94, v158
    v_fmac_f32 v33, v95, v159
    v_cvt_pk_bf16_f32 v34, v26, v27
    v_cvt_pk_bf16_f32 v35, v28, v29
    v_cvt_pk_bf16_f32 v36, v30, v31
    v_cvt_pk_bf16_f32 v37, v32, v33
    s_nop 1
    v_permlane32_swap_b32 v34, v36
    v_permlane32_swap_b32 v35, v37
    buffer_store_dwordx4 v[34:37], v160, s[16:19], 0 offen offset:160
    s_branch L_b23_done
L_b23_half:
    s_lshr_b32 s42, s42, 1
    s_sub_u32 s42, 20, s42
    s_and_b32 s43, s41, 1
    s_lshr_b32 s41, s41, 1
    s_add_u32 s41, s41, s42
    s_lshl_b32 s44, s40, 2
    s_and_b32 s45, s41, 3
    s_add_u32 s44, s44, s45
    s_lshr_b32 s45, s41, 2
    s_lshl_b32 s45, s45, 1
    s_add_u32 s45, s45, s43
    v_and_b32 v14, 31, v1
    v_lshrrev_b32 v15, 5, v1
    v_bfe_u32 v16, v14, 1, 3
    v_xor_b32 v16, v16, v15
    s_mul_i32 s25, s27, 32
    v_add_u32 v17, s25, v14
    v_lshlrev_b32 v17, 7, v17
    v_xor_b32 v18, 0, v16
    v_lshl_add_u32 v4, v18, 4, v17
    v_add_u32 v8, 0x10000, v4
    v_xor_b32 v18, 2, v16
    v_lshl_add_u32 v5, v18, 4, v17
    v_add_u32 v9, 0x10000, v5
    v_xor_b32 v18, 4, v16
    v_lshl_add_u32 v6, v18, 4, v17
    v_add_u32 v10, 0x10000, v6
    v_xor_b32 v18, 6, v16
    v_lshl_add_u32 v7, v18, 4, v17
    v_add_u32 v11, 0x10000, v7
    v_lshrrev_b32 v14, 4, v1
    v_and_b32 v15, 1, v14
    v_lshrrev_b32 v14, 1, v14
    v_and_b32 v16, 15, v1
    v_lshrrev_b32 v17, 2, v16
    v_lshl_add_u32 v17, v14, 3, v17
    v_lshlrev_b32 v17, 7, v17
    v_bfe_u32 v18, v16, 1, 1
    v_lshl_add_u32 v18, v15, 1, v18
    s_lshl_b32 s25, s28, 2
    v_add_u32 v18, s25, v18
    v_bfe_u32 v19, v16, 3, 1
    v_lshlrev_b32 v19, 2, v19
    v_xor_b32 v18, v18, v19
    v_lshl_add_u32 v17, v18, 4, v17
    v_and_b32 v19, 1, v16
    v_lshl_add_u32 v12, v19, 3, v17
    v_mov_b32 v228, v12
    v_add_u32 v230, 0x2000, v12
    v_add_u32 v229, 0x10000, v228
    v_add_u32 v231, 0x10000, v230
    v_lshrrev_b32 v14, 3, v1
    s_lshl_b32 s25, s26, 3
    v_add_u32 v14, s25, v14
    v_lshrrev_b32 v15, 4, v1
    s_lshl_b32 s25, s28, 2
    v_add_u32 v16, s25, v15
    v_and_b32 v17, 7, v1
    v_xor_b32 v16, v16, v17
    v_lshlrev_b32 v16, 4, v16
    s_mov_b32 s25, 1280
    v_mad_u32_u24 v2, v14, s25, v16
    v_and_b32 v15, 1, v15
    v_lshlrev_b32 v15, 2, v15
    v_xor_b32 v16, v15, v17
    v_lshlrev_b32 v16, 4, v16
    s_mov_b32 s25, 1280
    v_mad_u32_u24 v3, v14, s25, v16
    s_lshl_b32 s25, s26, 15
    v_lshlrev_b32 v14, 4, v1
    v_add_u32 v2, s25, v14
    v_lshrrev_b32 v14, 5, v1
    v_lshlrev_b32 v14, 10, v14
    v_and_b32 v15, 31, v1
    s_lshl_b32 s25, s27, 5
    v_add_u32 v15, s25, v15
    v_lshl_add_u32 v4, v15, 4, v14
    s_add_u32 s4, s76, 8912896
    s_addc_u32 s5, s77, 0
    s_and_b32 s5, s5, 0xffff
    s_mov_b32 s6, 7077888
    s_mov_b32 s7, 0x00020000
    s_mov_b32 s8, s70
    s_mov_b32 s9, s71
    s_and_b32 s9, s9, 0xffff
    s_mov_b32 s10, 2211840
    s_mov_b32 s11, 0x00020000
    s_mov_b32 s12, s70
    s_mov_b32 s13, s71
    s_and_b32 s13, s13, 0xffff
    s_mov_b32 s14, 2211840
    s_mov_b32 s15, 0x00020000
    s_lshl_b32 s20, s44, 10
    s_lshl_b32 s21, s45, 7
    s_lshr_b32 s46, s41, 2
    s_mul_i32 s46, s46, 5
    s_and_b32 s25, s41, 3
    s_mul_i32 s25, s25, 7
    s_add_u32 s46, s46, s25
    s_mul_i32 s25, s46, 2428
    s_lshr_b32 s25, s25, 16
    s_mul_i32 s25, s25, 27
    s_sub_u32 s46, s46, s25
    s_mov_b32 s36, s20
    s_add_u32 s37, s20, 7077888
    s_mul_i32 s25, s46, 262144
    s_add_u32 s20, s20, s25
    s_mov_b32 s38, s21
    s_add_u32 s39, s21, 2211840
    s_mul_i32 s25, s46, 81920
    s_add_u32 s21, s21, s25
    s_cmp_lg_u32 s78, 0
    s_cbranch_scc1 L_rdyd_45
    v_mov_b32 v238, 0
    s_mov_b32 s30, 0x40000
L_rdy_44:
    global_load_dword v239, v238, s[74:75] sc1
    s_waitcnt vmcnt(0)
    v_readfirstlane_b32 s78, v239
    s_cmp_lg_u32 s78, 0
    s_cbranch_scc1 L_rdyd_45
    s_sleep 4
    s_sub_u32 s30, s30, 1
    s_cmp_lg_u32 s30, 0
    s_cbranch_scc1 L_rdy_44
L_rdyd_45:
    s_add_u32 s50, s3, 192
    s_cmp_lg_u32 s26, 0
    s_cbranch_scc1 L_wcd_47
    s_lshl_b32 s31, s50, 7
    v_mov_b32 v238, s31
    s_mov_b32 exec_lo, 1
    s_mov_b32 exec_hi, 0
    s_mov_b32 s30, 0x40000
L_wc_46:
    buffer_load_dword v239, v238, s[56:59], 0 offen sc1
    s_waitcnt vmcnt(0)
    v_cmp_gt_u32 vcc, 3, v239
    s_nop 4
    s_cbranch_vccz L_wcd_47_x
    s_sleep 16
    s_sub_u32 s30, s30, 1
    s_cmp_lg_u32 s30, 0
    s_cbranch_scc1 L_wc_46
L_wcd_47_x:
    s_mov_b64 exec, -1
L_wcd_47:
    s_lshr_b32 s50, s44, 1
    s_add_u32 s50, s50, 168
    s_cmp_lg_u32 s26, 0
    s_cbranch_scc1 L_wcd_49
    s_lshl_b32 s31, s50, 7
    v_mov_b32 v238, s31
    s_mov_b32 exec_lo, 1
    s_mov_b32 exec_hi, 0
    s_mov_b32 s30, 0x40000
L_wc_48:
    buffer_load_dword v239, v238, s[56:59], 0 offen sc1
    s_waitcnt vmcnt(0)
    v_cmp_gt_u32 vcc, 108, v239
    s_nop 4
    s_cbranch_vccz L_wcd_49_x
    s_sleep 8
    s_sub_u32 s30, s30, 1
    s_cmp_lg_u32 s30, 0
    s_cbranch_scc1 L_wc_48
L_wcd_49_x:
    s_mov_b64 exec, -1
L_wcd_49:
    s_waitcnt vmcnt(0)
    s_barrier
    s_add_u32 m0, s23, 0
    s_add_u32 s25, s20, 0
    buffer_load_dwordx4 v2, s[4:7], s25 offen sc1 lds
    s_add_u32 m0, s23, 4096
    s_add_u32 s25, s20, 131072
    buffer_load_dwordx4 v2, s[4:7], s25 offen sc1 lds
    s_add_u32 s20, s20, 262144
    s_cmp_eq_u32 s20, s37
    s_cselect_b32 s20, s36, s20
    s_add_u32 m0, s23, 8192
    s_add_u32 s25, s21, 0
    buffer_load_dwordx4 v3, s[8:11], s25 offen lds
    s_add_u32 m0, s23, 12288
    s_add_u32 s25, s21, 40960
    buffer_load_dwordx4 v3, s[8:11], s25 offen lds
    s_add_u32 s21, s21, 81920
    s_cmp_eq_u32 s21, s39
    s_cselect_b32 s21, s38, s21
    s_add_u32 m0, s23, 16384
    s_add_u32 s25, s20, 0
    buffer_load_dwordx4 v2, s[4:7], s25 offen sc1 lds
    s_add_u32 m0, s23, 20480
    s_add_u32 s25, s20, 131072
    buffer_load_dwordx4 v2, s[4:7], s25 offen sc1 lds
    s_add_u32 s20, s20, 262144
    s_cmp_eq_u32 s20, s37
    s_cselect_b32 s20, s36, s20
    s_add_u32 m0, s23, 24576
    s_add_u32 s25, s21, 0
    buffer_load_dwordx4 v3, s[8:11], s25 offen lds
    s_add_u32 m0, s23, 28672
    s_add_u32 s25, s21, 40960
    buffer_load_dwordx4 v3, s[8:11], s25 offen lds
    s_add_u32 s21, s21, 81920
    s_cmp_eq_u32 s21, s39
    s_cselect_b32 s21, s38, s21
    s_add_u32 m0, s23, 32768
    s_add_u32 s25, s20, 0
    buffer_load_dwordx4 v2, s[4:7], s25 offen sc1 lds
    s_add_u32 m0, s23, 36864
    s_add_u32 s25, s20, 131072
    buffer_load_dwordx4 v2, s[4:7], s25 offen sc1 lds
    s_add_u32 s20, s20, 262144
    s_cmp_eq_u32 s20, s37
    s_cselect_b32 s20, s36, s20
    s_add_u32 m0, s23, 40960
    s_add_u32 s25, s21, 0
    buffer_load_dwordx4 v3, s[8:11], s25 offen lds
    s_add_u32 m0, s23, 45056
    s_add_u32 s25, s21, 40960
    buffer_load_dwordx4 v3, s[8:11], s25 offen lds
    s_add_u32 s21, s21, 81920
    s_cmp_eq_u32 s21, s39
    s_cselect_b32 s21, s38, s21
    s_add_u32 m0, s23, 49152
    s_add_u32 s25, s20, 0
    buffer_load_dwordx4 v2, s[4:7], s25 offen sc1 lds
    s_add_u32 m0, s23, 53248
    s_add_u32 s25, s20, 131072
    buffer_load_dwordx4 v2, s[4:7], s25 offen sc1 lds
    s_add_u32 s20, s20, 262144
    s_cmp_eq_u32 s20, s37
    s_cselect_b32 s20, s36, s20
    s_add_u32 m0, s23, 57344
    s_add_u32 s25, s21, 0
    buffer_load_dwordx4 v3, s[8:11], s25 offen lds
    s_add_u32 m0, s23, 61440
    s_add_u32 s25, s21, 40960
    buffer_load_dwordx4 v3, s[8:11], s25 offen lds
    s_add_u32 s21, s21, 81920
    s_cmp_eq_u32 s21, s39
    s_cselect_b32 s21, s38, s21
    s_setprio 0
    s_waitcnt vmcnt(12)
    s_barrier
    ds_read_b128 v[32:35], v4 offset:0
    ds_read_b64_tr_b16 v[40:41], v228 offset:8192
    ds_read_b64_tr_b16 v[42:43], v228 offset:8704
    ds_read_b128 v[48:51], v4 offset:2048
    ds_read_b64_tr_b16 v[56:57], v228 offset:10240
    ds_read_b64_tr_b16 v[58:59], v228 offset:10752
    s_waitcnt lgkmcnt(3)
    v_mfma_f32_32x32x16_bf16 v[64:79], v[40:43], v[32:35], 0
    ds_read_b128 v[240:243], v4 offset:4096
    ds_read_b64_tr_b16 v[248:249], v228 offset:12288
    ds_read_b64_tr_b16 v[250:251], v228 offset:12800
    s_waitcnt lgkmcnt(3)
    v_mfma_f32_32x32x16_bf16 v[64:79], v[56:59], v[48:51], v[64:79]
    ds_read_b128 v[32:35], v4 offset:6144
    ds_read_b64_tr_b16 v[40:41], v228 offset:14336
    ds_read_b64_tr_b16 v[42:43], v228 offset:14848
    s_waitcnt lgkmcnt(3)
    v_mfma_f32_32x32x16_bf16 v[64:79], v[248:251], v[240:243], v[64:79]
    s_waitcnt vmcnt(8) lgkmcnt(0)
    s_barrier
    ds_read_b128 v[48:51], v4 offset:16384
    ds_read_b64_tr_b16 v[56:57], v228 offset:24576
    ds_read_b64_tr_b16 v[58:59], v228 offset:25088
    s_add_u32 m0, s23, 0
    s_add_u32 s25, s20, 0
    buffer_load_dwordx4 v2, s[4:7], s25 offen sc1 lds
    s_waitcnt lgkmcnt(3)
    v_mfma_f32_32x32x16_bf16 v[64:79], v[40:43], v[32:35], v[64:79]
    ds_read_b128 v[240:243], v4 offset:18432
    ds_read_b64_tr_b16 v[248:249], v228 offset:26624
    ds_read_b64_tr_b16 v[250:251], v228 offset:27136
    s_add_u32 m0, s23, 4096
    s_add_u32 s25, s20, 131072
    buffer_load_dwordx4 v2, s[4:7], s25 offen sc1 lds
    s_add_u32 s20, s20, 262144
    s_cmp_eq_u32 s20, s37
    s_cselect_b32 s20, s36, s20
    s_waitcnt lgkmcnt(3)
    v_mfma_f32_32x32x16_bf16 v[64:79], v[56:59], v[48:51], v[64:79]
    ds_read_b128 v[32:35], v4 offset:20480
    ds_read_b64_tr_b16 v[40:41], v228 offset:28672
    ds_read_b64_tr_b16 v[42:43], v228 offset:29184
    s_add_u32 m0, s23, 8192
    s_add_u32 s25, s21, 0
    buffer_load_dwordx4 v3, s[8:11], s25 offen lds
    s_waitcnt lgkmcnt(3)
    v_mfma_f32_32x32x16_bf16 v[64:79], v[248:251], v[240:243], v[64:79]
    ds_read_b128 v[48:51], v4 offset:22528
    ds_read_b64_tr_b16 v[56:57], v228 offset:30720
    ds_read_b64_tr_b16 v[58:59], v228 offset:31232
    s_add_u32 m0, s23, 12288
    s_add_u32 s25, s21, 40960
    buffer_load_dwordx4 v3, s[8:11], s25 offen lds
    s_add_u32 s21, s21, 81920
    s_cmp_eq_u32 s21, s39
    s_cselect_b32 s21, s38, s21
    s_waitcnt lgkmcnt(3)
    v_mfma_f32_32x32x16_bf16 v[64:79], v[40:43], v[32:35], v[64:79]
    s_waitcnt vmcnt(8) lgkmcnt(0)
    s_barrier
    ds_read_b128 v[240:243], v4 offset:32768
    ds_read_b64_tr_b16 v[248:249], v228 offset:40960
    ds_read_b64_tr_b16 v[250:251], v228 offset:41472
    s_add_u32 m0, s23, 16384
    s_add_u32 s25, s20, 0
    buffer_load_dwordx4 v2, s[4:7], s25 offen sc1 lds
    s_waitcnt lgkmcnt(3)
    v_mfma_f32_32x32x16_bf16 v[64:79], v[56:59], v[48:51], v[64:79]
    ds_read_b128 v[32:35], v4 offset:34816
    ds_read_b64_tr_b16 v[40:41], v228 offset:43008
    ds_read_b64_tr_b16 v[42:43], v228 offset:43520
    s_add_u32 m0, s23, 20480
    s_add_u32 s25, s20, 131072
    buffer_load_dwordx4 v2, s[4:7], s25 offen sc1 lds
    s_add_u32 s20, s20, 262144
    s_cmp_eq_u32 s20, s37
    s_cselect_b32 s20, s36, s20
    s_waitcnt lgkmcnt(3)
    v_mfma_f32_32x32x16_bf16 v[64:79], v[248:251], v[240:243], v[64:79]
    ds_read_b128 v[48:51], v4 offset:36864
    ds_read_b64_tr_b16 v[56:57], v228 offset:45056
    ds_read_b64_tr_b16 v[58:59], v228 offset:45568
    s_add_u32 m0, s23, 24576
    s_add_u32 s25, s21, 0
    buffer_load_dwordx4 v3, s[8:11], s25 offen lds
    s_waitcnt lgkmcnt(3)
    v_mfma_f32_32x32x16_bf16 v[64:79], v[40:43], v[32:35], v[64:79]
    ds_read_b128 v[240:243], v4 offset:38912
    ds_read_b64_tr_b16 v[248:249], v228 offset:47104
    ds_read_b64_tr_b16 v[250:251], v228 offset:47616
    s_add_u32 m0, s23, 28672
    s_add_u32 s25, s21, 40960
    buffer_load_dwordx4 v3, s[8:11], s25 offen lds
    s_add_u32 s21, s21, 81920
    s_cmp_eq_u32 s21, s39
    s_cselect_b32 s21, s38, s21
    s_waitcnt lgkmcnt(3)
    v_mfma_f32_32x32x16_bf16 v[64:79], v[56:59], v[48:51], v[64:79]
    s_waitcnt vmcnt(8) lgkmcnt(0)
    s_barrier
    ds_read_b128 v[32:35], v4 offset:49152
    ds_read_b64_tr_b16 v[40:41], v228 offset:57344
    ds_read_b64_tr_b16 v[42:43], v228 offset:57856
    s_add_u32 m0, s23, 32768
    s_add_u32 s25, s20, 0
    buffer_load_dwordx4 v2, s[4:7], s25 offen sc1 lds
    s_waitcnt lgkmcnt(3)
    v_mfma_f32_32x32x16_bf16 v[64:79], v[248:251], v[240:243], v[64:79]
    ds_read_b128 v[48:51], v4 offset:51200
    ds_read_b64_tr_b16 v[56:57], v228 offset:59392
    ds_read_b64_tr_b16 v[58:59], v228 offset:59904
    s_add_u32 m0, s23, 36864
    s_add_u32 s25, s20, 131072
    buffer_load_dwordx4 v2, s[4:7], s25 offen sc1 lds
    s_add_u32 s20, s20, 262144
    s_cmp_eq_u32 s20, s37
    s_cselect_b32 s20, s36, s20
    s_waitcnt lgkmcnt(3)
    v_mfma_f32_32x32x16_bf16 v[64:79], v[40:43], v[32:35], v[64:79]
    ds_read_b128 v[240:243], v4 offset:53248
    ds_read_b64_tr_b16 v[248:249], v228 offset:61440
    ds_read_b64_tr_b16 v[250:251], v228 offset:61952
    s_add_u32 m0, s23, 40960
    s_add_u32 s25, s21, 0
    buffer_load_dwordx4 v3, s[8:11], s25 offen lds
    s_waitcnt lgkmcnt(3)
    v_mfma_f32_32x32x16_bf16 v[64:79], v[56:59], v[48:51], v[64:79]
    ds_read_b128 v[32:35], v4 offset:55296
    ds_read_b64_tr_b16 v[40:41], v228 offset:63488
    ds_read_b64_tr_b16 v[42:43], v228 offset:64000
    s_add_u32 m0, s23, 45056
    s_add_u32 s25, s21, 40960
    buffer_load_dwordx4 v3, s[8:11], s25 offen lds
    s_add_u32 s21, s21, 81920
    s_cmp_eq_u32 s21, s39
    s_cselect_b32 s21, s38, s21
    s_waitcnt lgkmcnt(3)
    v_mfma_f32_32x32x16_bf16 v[64:79], v[248:251], v[240:243], v[64:79]
    s_waitcnt vmcnt(8) lgkmcnt(0)
    s_barrier
    ds_read_b128 v[48:51], v4 offset:0
    ds_read_b64_tr_b16 v[56:57], v228 offset:8192
    ds_read_b64_tr_b16 v[58:59], v228 offset:8704
    s_add_u32 m0, s23, 49152
    s_add_u32 s25, s20, 0
    buffer_load_dwordx4 v2, s[4:7], s25 offen sc1 lds
    s_waitcnt lgkmcnt(3)
    v_mfma_f32_32x32x16_bf16 v[64:79], v[40:43], v[32:35], v[64:79]
    ds_read_b128 v[240:243], v4 offset:2048
    ds_read_b64_tr_b16 v[248:249], v228 offset:10240
    ds_read_b64_tr_b16 v[250:251], v228 offset:10752
    s_add_u32 m0, s23, 53248
    s_add_u32 s25, s20, 131072
    buffer_load_dwordx4 v2, s[4:7], s25 offen sc1 lds
    s_add_u32 s20, s20, 262144
    s_cmp_eq_u32 s20, s37
    s_cselect_b32 s20, s36, s20
    s_waitcnt lgkmcnt(3)
    v_mfma_f32_32x32x16_bf16 v[64:79], v[56:59], v[48:51], v[64:79]
    ds_read_b128 v[32:35], v4 offset:4096
    ds_read_b64_tr_b16 v[40:41], v228 offset:12288
    ds_read_b64_tr_b16 v[42:43], v228 offset:12800
    s_add_u32 m0, s23, 57344
    s_add_u32 s25, s21, 0
    buffer_load_dwordx4 v3, s[8:11], s25 offen lds
    s_waitcnt lgkmcnt(3)
    v_mfma_f32_32x32x16_bf16 v[64:79], v[248:251], v[240:243], v[64:79]
    ds_read_b128 v[48:51], v4 offset:6144
    ds_read_b64_tr_b16 v[56:57], v228 offset:14336
    ds_read_b64_tr_b16 v[58:59], v228 offset:14848
    s_add_u32 m0, s23, 61440
    s_add_u32 s25, s21, 40960
    buffer_load_dwordx4 v3, s[8:11], s25 offen lds
    s_add_u32 s21, s21, 81920
    s_cmp_eq_u32 s21, s39
    s_cselect_b32 s21, s38, s21
    s_waitcnt lgkmcnt(3)
    v_mfma_f32_32x32x16_bf16 v[64:79], v[40:43], v[32:35], v[64:79]
    s_waitcnt vmcnt(8) lgkmcnt(0)
    s_barrier
    ds_read_b128 v[240:243], v4 offset:16384
    ds_read_b64_tr_b16 v[248:249], v228 offset:24576
    ds_read_b64_tr_b16 v[250:251], v228 offset:25088
    s_add_u32 m0, s23, 0
    s_add_u32 s25, s20, 0
    buffer_load_dwordx4 v2, s[4:7], s25 offen sc1 lds
    s_waitcnt lgkmcnt(3)
    v_mfma_f32_32x32x16_bf16 v[64:79], v[56:59], v[48:51], v[64:79]
    ds_read_b128 v[32:35], v4 offset:18432
    ds_read_b64_tr_b16 v[40:41], v228 offset:26624
    ds_read_b64_tr_b16 v[42:43], v228 offset:27136
    s_add_u32 m0, s23, 4096
    s_add_u32 s25, s20, 131072
    buffer_load_dwordx4 v2, s[4:7], s25 offen sc1 lds
    s_add_u32 s20, s20, 262144
    s_cmp_eq_u32 s20, s37
    s_cselect_b32 s20, s36, s20
    s_waitcnt lgkmcnt(3)
    v_mfma_f32_32x32x16_bf16 v[64:79], v[248:251], v[240:243], v[64:79]
    ds_read_b128 v[48:51], v4 offset:20480
    ds_read_b64_tr_b16 v[56:57], v228 offset:28672
    ds_read_b64_tr_b16 v[58:59], v228 offset:29184
    s_add_u32 m0, s23, 8192
    s_add_u32 s25, s21, 0
    buffer_load_dwordx4 v3, s[8:11], s25 offen lds
    s_waitcnt lgkmcnt(3)
    v_mfma_f32_32x32x16_bf16 v[64:79], v[40:43], v[32:35], v[64:79]
    ds_read_b128 v[240:243], v4 offset:22528
    ds_read_b64_tr_b16 v[248:249], v228 offset:30720
    ds_read_b64_tr_b16 v[250:251], v228 offset:31232
    s_add_u32 m0, s23, 12288
    s_add_u32 s25, s21, 40960
    buffer_load_dwordx4 v3, s[8:11], s25 offen lds
    s_add_u32 s21, s21, 81920
    s_cmp_eq_u32 s21, s39
    s_cselect_b32 s21, s38, s21
    s_waitcnt lgkmcnt(3)
    v_mfma_f32_32x32x16_bf16 v[64:79], v[56:59], v[48:51], v[64:79]
    s_waitcnt vmcnt(8) lgkmcnt(0)
    s_barrier
    ds_read_b128 v[32:35], v4 offset:32768
    ds_read_b64_tr_b16 v[40:41], v228 offset:40960
    ds_read_b64_tr_b16 v[42:43], v228 offset:41472
    s_add_u32 m0, s23, 16384
    s_add_u32 s25, s20, 0
    buffer_load_dwordx4 v2, s[4:7], s25 offen sc1 lds
    s_waitcnt lgkmcnt(3)
    v_mfma_f32_32x32x16_bf16 v[64:79], v[248:251], v[240:243], v[64:79]
    ds_read_b128 v[48:51], v4 offset:34816
    ds_read_b64_tr_b16 v[56:57], v228 offset:43008
    ds_read_b64_tr_b16 v[58:59], v228 offset:43520
    s_add_u32 m0, s23, 20480
    s_add_u32 s25, s20, 131072
    buffer_load_dwordx4 v2, s[4:7], s25 offen sc1 lds
    s_add_u32 s20, s20, 262144
    s_cmp_eq_u32 s20, s37
    s_cselect_b32 s20, s36, s20
    s_waitcnt lgkmcnt(3)
    v_mfma_f32_32x32x16_bf16 v[64:79], v[40:43], v[32:35], v[64:79]
    ds_read_b128 v[240:243], v4 offset:36864
    ds_read_b64_tr_b16 v[248:249], v228 offset:45056
    ds_read_b64_tr_b16 v[250:251], v228 offset:45568
    s_add_u32 m0, s23, 24576
    s_add_u32 s25, s21, 0
    buffer_load_dwordx4 v3, s[8:11], s25 offen lds
    s_waitcnt lgkmcnt(3)
    v_mfma_f32_32x32x16_bf16 v[64:79], v[56:59], v[48:51], v[64:79]
    ds_read_b128 v[32:35], v4 offset:38912
    ds_read_b64_tr_b16 v[40:41], v228 offset:47104
    ds_read_b64_tr_b16 v[42:43], v228 offset:47616
    s_add_u32 m0, s23, 28672
    s_add_u32 s25, s21, 40960
    buffer_load_dwordx4 v3, s[8:11], s25 offen lds
    s_add_u32 s21, s21, 81920
    s_cmp_eq_u32 s21, s39
    s_cselect_b32 s21, s38, s21
    s_waitcnt lgkmcnt(3)
    v_mfma_f32_32x32x16_bf16 v[64:79], v[248:251], v[240:243], v[64:79]
    s_waitcnt vmcnt(8) lgkmcnt(0)
    s_barrier
    ds_read_b128 v[48:51], v4 offset:49152
    ds_read_b64_tr_b16 v[56:57], v228 offset:57344
    ds_read_b64_tr_b16 v[58:59], v228 offset:57856
    s_add_u32 m0, s23, 32768
    s_add_u32 s25, s20, 0
    buffer_load_dwordx4 v2, s[4:7], s25 offen sc1 lds
    s_waitcnt lgkmcnt(3)
    v_mfma_f32_32x32x16_bf16 v[64:79], v[40:43], v[32:35], v[64:79]
    ds_read_b128 v[240:243], v4 offset:51200
    ds_read_b64_tr_b16 v[248:249], v228 offset:59392
    ds_read_b64_tr_b16 v[250:251], v228 offset:59904
    s_add_u32 m0, s23, 36864
    s_add_u32 s25, s20, 131072
    buffer_load_dwordx4 v2, s[4:7], s25 offen sc1 lds
    s_add_u32 s20, s20, 262144
    s_cmp_eq_u32 s20, s37
    s_cselect_b32 s20, s36, s20
    s_waitcnt lgkmcnt(3)
    v_mfma_f32_32x32x16_bf16 v[64:79], v[56:59], v[48:51], v[64:79]
    ds_read_b128 v[32:35], v4 offset:53248
    ds_read_b64_tr_b16 v[40:41], v228 offset:61440
    ds_read_b64_tr_b16 v[42:43], v228 offset:61952
    s_add_u32 m0, s23, 40960
    s_add_u32 s25, s21, 0
    buffer_load_dwordx4 v3, s[8:11], s25 offen lds
    s_waitcnt lgkmcnt(3)
    v_mfma_f32_32x32x16_bf16 v[64:79], v[248:251], v[240:243], v[64:79]
    ds_read_b128 v[48:51], v4 offset:55296
    ds_read_b64_tr_b16 v[56:57], v228 offset:63488
    ds_read_b64_tr_b16 v[58:59], v228 offset:64000
    s_add_u32 m0, s23, 45056
    s_add_u32 s25, s21, 40960
    buffer_load_dwordx4 v3, s[8:11], s25 offen lds
    s_add_u32 s21, s21, 81920
    s_cmp_eq_u32 s21, s39
    s_cselect_b32 s21, s38, s21
    s_waitcnt lgkmcnt(3)
    v_mfma_f32_32x32x16_bf16 v[64:79], v[40:43], v[32:35], v[64:79]
    s_waitcnt vmcnt(8) lgkmcnt(0)
    s_barrier
    ds_read_b128 v[240:243], v4 offset:0
    ds_read_b64_tr_b16 v[248:249], v228 offset:8192
    ds_read_b64_tr_b16 v[250:251], v228 offset:8704
    s_add_u32 m0, s23, 49152
    s_add_u32 s25, s20, 0
    buffer_load_dwordx4 v2, s[4:7], s25 offen sc1 lds
    s_waitcnt lgkmcnt(3)
    v_mfma_f32_32x32x16_bf16 v[64:79], v[56:59], v[48:51], v[64:79]
    ds_read_b128 v[32:35], v4 offset:2048
    ds_read_b64_tr_b16 v[40:41], v228 offset:10240
    ds_read_b64_tr_b16 v[42:43], v228 offset:10752
    s_add_u32 m0, s23, 53248
    s_add_u32 s25, s20, 131072
    buffer_load_dwordx4 v2, s[4:7], s25 offen sc1 lds
    s_add_u32 s20, s20, 262144
    s_cmp_eq_u32 s20, s37
    s_cselect_b32 s20, s36, s20
    s_waitcnt lgkmcnt(3)
    v_mfma_f32_32x32x16_bf16 v[64:79], v[248:251], v[240:243], v[64:79]
    ds_read_b128 v[48:51], v4 offset:4096
    ds_read_b64_tr_b16 v[56:57], v228 offset:12288
    ds_read_b64_tr_b16 v[58:59], v228 offset:12800
    s_add_u32 m0, s23, 57344
    s_add_u32 s25, s21, 0
    buffer_load_dwordx4 v3, s[8:11], s25 offen lds
    s_waitcnt lgkmcnt(3)
    v_mfma_f32_32x32x16_bf16 v[64:79], v[40:43], v[32:35], v[64:79]
    ds_read_b128 v[240:243], v4 offset:6144
    ds_read_b64_tr_b16 v[248:249], v228 offset:14336
    ds_read_b64_tr_b16 v[250:251], v228 offset:14848
    s_add_u32 m0, s23, 61440
    s_add_u32 s25, s21, 40960
    buffer_load_dwordx4 v3, s[8:11], s25 offen lds
    s_add_u32 s21, s21, 81920
    s_cmp_eq_u32 s21, s39
    s_cselect_b32 s21, s38, s21
    s_waitcnt lgkmcnt(3)
    v_mfma_f32_32x32x16_bf16 v[64:79], v[56:59], v[48:51], v[64:79]
    s_waitcnt vmcnt(8) lgkmcnt(0)
    s_barrier
    ds_read_b128 v[32:35], v4 offset:16384
    ds_read_b64_tr_b16 v[40:41], v228 offset:24576
    ds_read_b64_tr_b16 v[42:43], v228 offset:25088
    s_add_u32 m0, s23, 0
    s_add_u32 s25, s20, 0
    buffer_load_dwordx4 v2, s[4:7], s25 offen sc1 lds
    s_waitcnt lgkmcnt(3)
    v_mfma_f32_32x32x16_bf16 v[64:79], v[248:251], v[240:243], v[64:79]
    ds_read_b128 v[48:51], v4 offset:18432
    ds_read_b64_tr_b16 v[56:57], v228 offset:26624
    ds_read_b64_tr_b16 v[58:59], v228 offset:27136
    s_add_u32 m0, s23, 4096
    s_add_u32 s25, s20, 131072
    buffer_load_dwordx4 v2, s[4:7], s25 offen sc1 lds
    s_add_u32 s20, s20, 262144
    s_cmp_eq_u32 s20, s37
    s_cselect_b32 s20, s36, s20
    s_waitcnt lgkmcnt(3)
    v_mfma_f32_32x32x16_bf16 v[64:79], v[40:43], v[32:35], v[64:79]
    ds_read_b128 v[240:243], v4 offset:20480
    ds_read_b64_tr_b16 v[248:249], v228 offset:28672
    ds_read_b64_tr_b16 v[250:251], v228 offset:29184
    s_add_u32 m0, s23, 8192
    s_add_u32 s25, s21, 0
    buffer_load_dwordx4 v3, s[8:11], s25 offen lds
    s_waitcnt lgkmcnt(3)
    v_mfma_f32_32x32x16_bf16 v[64:79], v[56:59], v[48:51], v[64:79]
    ds_read_b128 v[32:35], v4 offset:22528
    ds_read_b64_tr_b16 v[40:41], v228 offset:30720
    ds_read_b64_tr_b16 v[42:43], v228 offset:31232
    s_add_u32 m0, s23, 12288
    s_add_u32 s25, s21, 40960
    buffer_load_dwordx4 v3, s[8:11], s25 offen lds
    s_add_u32 s21, s21, 81920
    s_cmp_eq_u32 s21, s39
    s_cselect_b32 s21, s38, s21
    s_waitcnt lgkmcnt(3)
    v_mfma_f32_32x32x16_bf16 v[64:79], v[248:251], v[240:243], v[64:79]
    s_waitcnt vmcnt(8) lgkmcnt(0)
    s_barrier
    ds_read_b128 v[48:51], v4 offset:32768
    ds_read_b64_tr_b16 v[56:57], v228 offset:40960
    ds_read_b64_tr_b16 v[58:59], v228 offset:41472
    s_add_u32 m0, s23, 16384
    s_add_u32 s25, s20, 0
    buffer_load_dwordx4 v2, s[4:7], s25 offen sc1 lds
    s_waitcnt lgkmcnt(3)
    v_mfma_f32_32x32x16_bf16 v[64:79], v[40:43], v[32:35], v[64:79]
    ds_read_b128 v[240:243], v4 offset:34816
    ds_read_b64_tr_b16 v[248:249], v228 offset:43008
    ds_read_b64_tr_b16 v[250:251], v228 offset:43520
    s_add_u32 m0, s23, 20480
    s_add_u32 s25, s20, 131072
    buffer_load_dwordx4 v2, s[4:7], s25 offen sc1 lds
    s_add_u32 s20, s20, 262144
    s_cmp_eq_u32 s20, s37
    s_cselect_b32 s20, s36, s20
    s_waitcnt lgkmcnt(3)
    v_mfma_f32_32x32x16_bf16 v[64:79], v[56:59], v[48:51], v[64:79]
    ds_read_b128 v[32:35], v4 offset:36864
    ds_read_b64_tr_b16 v[40:41], v228 offset:45056
    ds_read_b64_tr_b16 v[42:43], v228 offset:45568
    s_add_u32 m0, s23, 24576
    s_add_u32 s25, s21, 0
    buffer_load_dwordx4 v3, s[8:11], s25 offen lds
    s_waitcnt lgkmcnt(3)
    v_mfma_f32_32x32x16_bf16 v[64:79], v[248:251], v[240:243], v[64:79]
    ds_read_b128 v[48:51], v4 offset:38912
    ds_read_b64_tr_b16 v[56:57], v228 offset:47104
    ds_read_b64_tr_b16 v[58:59], v228 offset:47616
    s_add_u32 m0, s23, 28672
    s_add_u32 s25, s21, 40960
    buffer_load_dwordx4 v3, s[8:11], s25 offen lds
    s_add_u32 s21, s21, 81920
    s_cmp_eq_u32 s21, s39
    s_cselect_b32 s21, s38, s21
    s_waitcnt lgkmcnt(3)
    v_mfma_f32_32x32x16_bf16 v[64:79], v[40:43], v[32:35], v[64:79]
    s_waitcnt vmcnt(8) lgkmcnt(0)
    s_barrier
    ds_read_b128 v[240:243], v4 offset:49152
    ds_read_b64_tr_b16 v[248:249], v228 offset:57344
    ds_read_b64_tr_b16 v[250:251], v228 offset:57856
    s_add_u32 m0, s23, 32768
    s_add_u32 s25, s20, 0
    buffer_load_dwordx4 v2, s[4:7], s25 offen sc1 lds
    s_waitcnt lgkmcnt(3)
    v_mfma_f32_32x32x16_bf16 v[64:79], v[56:59], v[48:51], v[64:79]
    ds_read_b128 v[32:35], v4 offset:51200
    ds_read_b64_tr_b16 v[40:41], v228 offset:59392
    ds_read_b64_tr_b16 v[42:43], v228 offset:59904
    s_add_u32 m0, s23, 36864
    s_add_u32 s25, s20, 131072
    buffer_load_dwordx4 v2, s[4:7], s25 offen sc1 lds
    s_add_u32 s20, s20, 262144
    s_cmp_eq_u32 s20, s37
    s_cselect_b32 s20, s36, s20
    s_waitcnt lgkmcnt(3)
    v_mfma_f32_32x32x16_bf16 v[64:79], v[248:251], v[240:243], v[64:79]
    ds_read_b128 v[48:51], v4 offset:53248
    ds_read_b64_tr_b16 v[56:57], v228 offset:61440
    ds_read_b64_tr_b16 v[58:59], v228 offset:61952
    s_add_u32 m0, s23, 40960
    s_add_u32 s25, s21, 0
    buffer_load_dwordx4 v3, s[8:11], s25 offen lds
    s_waitcnt lgkmcnt(3)
    v_mfma_f32_32x32x16_bf16 v[64:79], v[40:43], v[32:35], v[64:79]
    ds_read_b128 v[240:243], v4 offset:55296
    ds_read_b64_tr_b16 v[248:249], v228 offset:63488
    ds_read_b64_tr_b16 v[250:251], v228 offset:64000
    s_add_u32 m0, s23, 45056
    s_add_u32 s25, s21, 40960
    buffer_load_dwordx4 v3, s[8:11], s25 offen lds
    s_add_u32 s21, s21, 81920
    s_cmp_eq_u32 s21, s39
    s_cselect_b32 s21, s38, s21
    s_waitcnt lgkmcnt(3)
    v_mfma_f32_32x32x16_bf16 v[64:79], v[56:59], v[48:51], v[64:79]
    s_waitcnt vmcnt(8) lgkmcnt(0)
    s_barrier
    ds_read_b128 v[32:35], v4 offset:0
    ds_read_b64_tr_b16 v[40:41], v228 offset:8192
    ds_read_b64_tr_b16 v[42:43], v228 offset:8704
    s_add_u32 m0, s23, 49152
    s_add_u32 s25, s20, 0
    buffer_load_dwordx4 v2, s[4:7], s25 offen sc1 lds
    s_waitcnt lgkmcnt(3)
    v_mfma_f32_32x32x16_bf16 v[64:79], v[248:251], v[240:243], v[64:79]
    ds_read_b128 v[48:51], v4 offset:2048
    ds_read_b64_tr_b16 v[56:57], v228 offset:10240
    ds_read_b64_tr_b16 v[58:59], v228 offset:10752
    s_add_u32 m0, s23, 53248
    s_add_u32 s25, s20, 131072
    buffer_load_dwordx4 v2, s[4:7], s25 offen sc1 lds
    s_add_u32 s20, s20, 262144
    s_cmp_eq_u32 s20, s37
    s_cselect_b32 s20, s36, s20
    s_waitcnt lgkmcnt(3)
    v_mfma_f32_32x32x16_bf16 v[64:79], v[40:43], v[32:35], v[64:79]
    ds_read_b128 v[240:243], v4 offset:4096
    ds_read_b64_tr_b16 v[248:249], v228 offset:12288
    ds_read_b64_tr_b16 v[250:251], v228 offset:12800
    s_add_u32 m0, s23, 57344
    s_add_u32 s25, s21, 0
    buffer_load_dwordx4 v3, s[8:11], s25 offen lds
    s_waitcnt lgkmcnt(3)
    v_mfma_f32_32x32x16_bf16 v[64:79], v[56:59], v[48:51], v[64:79]
    ds_read_b128 v[32:35], v4 offset:6144
    ds_read_b64_tr_b16 v[40:41], v228 offset:14336
    ds_read_b64_tr_b16 v[42:43], v228 offset:14848
    s_add_u32 m0, s23, 61440
    s_add_u32 s25, s21, 40960
    buffer_load_dwordx4 v3, s[8:11], s25 offen lds
    s_add_u32 s21, s21, 81920
    s_cmp_eq_u32 s21, s39
    s_cselect_b32 s21, s38, s21
    s_waitcnt lgkmcnt(3)
    v_mfma_f32_32x32x16_bf16 v[64:79], v[248:251], v[240:243], v[64:79]
    s_waitcnt vmcnt(8) lgkmcnt(0)
    s_barrier
    ds_read_b128 v[48:51], v4 offset:16384
    ds_read_b64_tr_b16 v[56:57], v228 offset:24576
    ds_read_b64_tr_b16 v[58:59], v228 offset:25088
    s_add_u32 m0, s23, 0
    s_add_u32 s25, s20, 0
    buffer_load_dwordx4 v2, s[4:7], s25 offen sc1 lds
    s_waitcnt lgkmcnt(3)
    v_mfma_f32_32x32x16_bf16 v[64:79], v[40:43], v[32:35], v[64:79]
    ds_read_b128 v[240:243], v4 offset:18432
    ds_read_b64_tr_b16 v[248:249], v228 offset:26624
    ds_read_b64_tr_b16 v[250:251], v228 offset:27136
    s_add_u32 m0, s23, 4096
    s_add_u32 s25, s20, 131072
    buffer_load_dwordx4 v2, s[4:7], s25 offen sc1 lds
    s_add_u32 s20, s20, 262144
    s_cmp_eq_u32 s20, s37
    s_cselect_b32 s20, s36, s20
    s_waitcnt lgkmcnt(3)
    v_mfma_f32_32x32x16_bf16 v[64:79], v[56:59], v[48:51], v[64:79]
    ds_read_b128 v[32:35], v4 offset:20480
    ds_read_b64_tr_b16 v[40:41], v228 offset:28672
    ds_read_b64_tr_b16 v[42:43], v228 offset:29184
    s_add_u32 m0, s23, 8192
    s_add_u32 s25, s21, 0
    buffer_load_dwordx4 v3, s[8:11], s25 offen lds
    s_waitcnt lgkmcnt(3)
    v_mfma_f32_32x32x16_bf16 v[64:79], v[248:251], v[240:243], v[64:79]
    ds_read_b128 v[48:51], v4 offset:22528
    ds_read_b64_tr_b16 v[56:57], v228 offset:30720
    ds_read_b64_tr_b16 v[58:59], v228 offset:31232
    s_add_u32 m0, s23, 12288
    s_add_u32 s25, s21, 40960
    buffer_load_dwordx4 v3, s[8:11], s25 offen lds
    s_add_u32 s21, s21, 81920
    s_cmp_eq_u32 s21, s39
    s_cselect_b32 s21, s38, s21
    s_waitcnt lgkmcnt(3)
    v_mfma_f32_32x32x16_bf16 v[64:79], v[40:43], v[32:35], v[64:79]
    s_waitcnt vmcnt(8) lgkmcnt(0)
    s_barrier
    ds_read_b128 v[240:243], v4 offset:32768
    ds_read_b64_tr_b16 v[248:249], v228 offset:40960
    ds_read_b64_tr_b16 v[250:251], v228 offset:41472
    s_add_u32 m0, s23, 16384
    s_add_u32 s25, s20, 0
    buffer_load_dwordx4 v2, s[4:7], s25 offen sc1 lds
    s_waitcnt lgkmcnt(3)
    v_mfma_f32_32x32x16_bf16 v[64:79], v[56:59], v[48:51], v[64:79]
    ds_read_b128 v[32:35], v4 offset:34816
    ds_read_b64_tr_b16 v[40:41], v228 offset:43008
    ds_read_b64_tr_b16 v[42:43], v228 offset:43520
    s_add_u32 m0, s23, 20480
    s_add_u32 s25, s20, 131072
    buffer_load_dwordx4 v2, s[4:7], s25 offen sc1 lds
    s_add_u32 s20, s20, 262144
    s_cmp_eq_u32 s20, s37
    s_cselect_b32 s20, s36, s20
    s_waitcnt lgkmcnt(3)
    v_mfma_f32_32x32x16_bf16 v[64:79], v[248:251], v[240:243], v[64:79]
    ds_read_b128 v[48:51], v4 offset:36864
    ds_read_b64_tr_b16 v[56:57], v228 offset:45056
    ds_read_b64_tr_b16 v[58:59], v228 offset:45568
    s_add_u32 m0, s23, 24576
    s_add_u32 s25, s21, 0
    buffer_load_dwordx4 v3, s[8:11], s25 offen lds
    s_waitcnt lgkmcnt(3)
    v_mfma_f32_32x32x16_bf16 v[64:79], v[40:43], v[32:35], v[64:79]
    ds_read_b128 v[240:243], v4 offset:38912
    ds_read_b64_tr_b16 v[248:249], v228 offset:47104
    ds_read_b64_tr_b16 v[250:251], v228 offset:47616
    s_add_u32 m0, s23, 28672
    s_add_u32 s25, s21, 40960
    buffer_load_dwordx4 v3, s[8:11], s25 offen lds
    s_add_u32 s21, s21, 81920
    s_cmp_eq_u32 s21, s39
    s_cselect_b32 s21, s38, s21
    s_waitcnt lgkmcnt(3)
    v_mfma_f32_32x32x16_bf16 v[64:79], v[56:59], v[48:51], v[64:79]
    s_waitcnt vmcnt(8) lgkmcnt(0)
    s_barrier
    ds_read_b128 v[32:35], v4 offset:49152
    ds_read_b64_tr_b16 v[40:41], v228 offset:57344
    ds_read_b64_tr_b16 v[42:43], v228 offset:57856
    s_add_u32 m0, s23, 32768
    s_add_u32 s25, s20, 0
    buffer_load_dwordx4 v2, s[4:7], s25 offen sc1 lds
    s_waitcnt lgkmcnt(3)
    v_mfma_f32_32x32x16_bf16 v[64:79], v[248:251], v[240:243], v[64:79]
    ds_read_b128 v[48:51], v4 offset:51200
    ds_read_b64_tr_b16 v[56:57], v228 offset:59392
    ds_read_b64_tr_b16 v[58:59], v228 offset:59904
    s_add_u32 m0, s23, 36864
    s_add_u32 s25, s20, 131072
    buffer_load_dwordx4 v2, s[4:7], s25 offen sc1 lds
    s_add_u32 s20, s20, 262144
    s_cmp_eq_u32 s20, s37
    s_cselect_b32 s20, s36, s20
    s_waitcnt lgkmcnt(3)
    v_mfma_f32_32x32x16_bf16 v[64:79], v[40:43], v[32:35], v[64:79]
    ds_read_b128 v[240:243], v4 offset:53248
    ds_read_b64_tr_b16 v[248:249], v228 offset:61440
    ds_read_b64_tr_b16 v[250:251], v228 offset:61952
    s_add_u32 m0, s23, 40960
    s_add_u32 s25, s21, 0
    buffer_load_dwordx4 v3, s[8:11], s25 offen lds
    s_waitcnt lgkmcnt(3)
    v_mfma_f32_32x32x16_bf16 v[64:79], v[56:59], v[48:51], v[64:79]
    ds_read_b128 v[32:35], v4 offset:55296
    ds_read_b64_tr_b16 v[40:41], v228 offset:63488
    ds_read_b64_tr_b16 v[42:43], v228 offset:64000
    s_add_u32 m0, s23, 45056
    s_add_u32 s25, s21, 40960
    buffer_load_dwordx4 v3, s[8:11], s25 offen lds
    s_add_u32 s21, s21, 81920
    s_cmp_eq_u32 s21, s39
    s_cselect_b32 s21, s38, s21
    s_waitcnt lgkmcnt(3)
    v_mfma_f32_32x32x16_bf16 v[64:79], v[248:251], v[240:243], v[64:79]
    s_waitcnt vmcnt(8) lgkmcnt(0)
    s_barrier
    ds_read_b128 v[48:51], v4 offset:0
    ds_read_b64_tr_b16 v[56:57], v228 offset:8192
    ds_read_b64_tr_b16 v[58:59], v228 offset:8704
    s_add_u32 m0, s23, 49152
    s_add_u32 s25, s20, 0
    buffer_load_dwordx4 v2, s[4:7], s25 offen sc1 lds
    s_waitcnt lgkmcnt(3)
    v_mfma_f32_32x32x16_bf16 v[64:79], v[40:43], v[32:35], v[64:79]
    ds_read_b128 v[240:243], v4 offset:2048
    ds_read_b64_tr_b16 v[248:249], v228 offset:10240
    ds_read_b64_tr_b16 v[250:251], v228 offset:10752
    s_add_u32 m0, s23, 53248
    s_add_u32 s25, s20, 131072
    buffer_load_dwordx4 v2, s[4:7], s25 offen sc1 lds
    s_add_u32 s20, s20, 262144
    s_cmp_eq_u32 s20, s37
    s_cselect_b32 s20, s36, s20
    s_waitcnt lgkmcnt(3)
    v_mfma_f32_32x32x16_bf16 v[64:79], v[56:59], v[48:51], v[64:79]
    ds_read_b128 v[32:35], v4 offset:4096
    ds_read_b64_tr_b16 v[40:41], v228 offset:12288
    ds_read_b64_tr_b16 v[42:43], v228 offset:12800
    s_add_u32 m0, s23, 57344
    s_add_u32 s25, s21, 0
    buffer_load_dwordx4 v3, s[8:11], s25 offen lds
    s_waitcnt lgkmcnt(3)
    v_mfma_f32_32x32x16_bf16 v[64:79], v[248:251], v[240:243], v[64:79]
    ds_read_b128 v[48:51], v4 offset:6144
    ds_read_b64_tr_b16 v[56:57], v228 offset:14336
    ds_read_b64_tr_b16 v[58:59], v228 offset:14848
    s_add_u32 m0, s23, 61440
    s_add_u32 s25, s21, 40960
    buffer_load_dwordx4 v3, s[8:11], s25 offen lds
    s_add_u32 s21, s21, 81920
    s_cmp_eq_u32 s21, s39
    s_cselect_b32 s21, s38, s21
    s_waitcnt lgkmcnt(3)
    v_mfma_f32_32x32x16_bf16 v[64:79], v[40:43], v[32:35], v[64:79]
    s_waitcnt vmcnt(8) lgkmcnt(0)
    s_barrier
    ds_read_b128 v[240:243], v4 offset:16384
    ds_read_b64_tr_b16 v[248:249], v228 offset:24576
    ds_read_b64_tr_b16 v[250:251], v228 offset:25088
    s_add_u32 m0, s23, 0
    s_add_u32 s25, s20, 0
    buffer_load_dwordx4 v2, s[4:7], s25 offen sc1 lds
    s_waitcnt lgkmcnt(3)
    v_mfma_f32_32x32x16_bf16 v[64:79], v[56:59], v[48:51], v[64:79]
    ds_read_b128 v[32:35], v4 offset:18432
    ds_read_b64_tr_b16 v[40:41], v228 offset:26624
    ds_read_b64_tr_b16 v[42:43], v228 offset:27136
    s_add_u32 m0, s23, 4096
    s_add_u32 s25, s20, 131072
    buffer_load_dwordx4 v2, s[4:7], s25 offen sc1 lds
    s_add_u32 s20, s20, 262144
    s_cmp_eq_u32 s20, s37
    s_cselect_b32 s20, s36, s20
    s_waitcnt lgkmcnt(3)
    v_mfma_f32_32x32x16_bf16 v[64:79], v[248:251], v[240:243], v[64:79]
    ds_read_b128 v[48:51], v4 offset:20480
    ds_read_b64_tr_b16 v[56:57], v228 offset:28672
    ds_read_b64_tr_b16 v[58:59], v228 offset:29184
    s_add_u32 m0, s23, 8192
    s_add_u32 s25, s21, 0
    buffer_load_dwordx4 v3, s[8:11], s25 offen lds
    s_waitcnt lgkmcnt(3)
    v_mfma_f32_32x32x16_bf16 v[64:79], v[40:43], v[32:35], v[64:79]
    ds_read_b128 v[240:243], v4 offset:22528
    ds_read_b64_tr_b16 v[248:249], v228 offset:30720
    ds_read_b64_tr_b16 v[250:251], v228 offset:31232
    s_add_u32 m0, s23, 12288
    s_add_u32 s25, s21, 40960
    buffer_load_dwordx4 v3, s[8:11], s25 offen lds
    s_add_u32 s21, s21, 81920
    s_cmp_eq_u32 s21, s39
    s_cselect_b32 s21, s38, s21
    s_waitcnt lgkmcnt(3)
    v_mfma_f32_32x32x16_bf16 v[64:79], v[56:59], v[48:51], v[64:79]
    s_waitcnt vmcnt(8) lgkmcnt(0)
    s_barrier
    ds_read_b128 v[32:35], v4 offset:32768
    ds_read_b64_tr_b16 v[40:41], v228 offset:40960
    ds_read_b64_tr_b16 v[42:43], v228 offset:41472
    s_add_u32 m0, s23, 16384
    s_add_u32 s25, s20, 0
    buffer_load_dwordx4 v2, s[4:7], s25 offen sc1 lds
    s_waitcnt lgkmcnt(3)
    v_mfma_f32_32x32x16_bf16 v[64:79], v[248:251], v[240:243], v[64:79]
    ds_read_b128 v[48:51], v4 offset:34816
    ds_read_b64_tr_b16 v[56:57], v228 offset:43008
    ds_read_b64_tr_b16 v[58:59], v228 offset:43520
    s_add_u32 m0, s23, 20480
    s_add_u32 s25, s20, 131072
    buffer_load_dwordx4 v2, s[4:7], s25 offen sc1 lds
    s_add_u32 s20, s20, 262144
    s_cmp_eq_u32 s20, s37
    s_cselect_b32 s20, s36, s20
    s_waitcnt lgkmcnt(3)
    v_mfma_f32_32x32x16_bf16 v[64:79], v[40:43], v[32:35], v[64:79]
    ds_read_b128 v[240:243], v4 offset:36864
    ds_read_b64_tr_b16 v[248:249], v228 offset:45056
    ds_read_b64_tr_b16 v[250:251], v228 offset:45568
    s_add_u32 m0, s23, 24576
    s_add_u32 s25, s21, 0
    buffer_load_dwordx4 v3, s[8:11], s25 offen lds
    s_waitcnt lgkmcnt(3)
    v_mfma_f32_32x32x16_bf16 v[64:79], v[56:59], v[48:51], v[64:79]
    ds_read_b128 v[32:35], v4 offset:38912
    ds_read_b64_tr_b16 v[40:41], v228 offset:47104
    ds_read_b64_tr_b16 v[42:43], v228 offset:47616
    s_add_u32 m0, s23, 28672
    s_add_u32 s25, s21, 40960
    buffer_load_dwordx4 v3, s[8:11], s25 offen lds
    s_add_u32 s21, s21, 81920
    s_cmp_eq_u32 s21, s39
    s_cselect_b32 s21, s38, s21
    s_waitcnt lgkmcnt(3)
    v_mfma_f32_32x32x16_bf16 v[64:79], v[248:251], v[240:243], v[64:79]
    s_waitcnt vmcnt(8) lgkmcnt(0)
    s_barrier
    ds_read_b128 v[48:51], v4 offset:49152
    ds_read_b64_tr_b16 v[56:57], v228 offset:57344
    ds_read_b64_tr_b16 v[58:59], v228 offset:57856
    s_add_u32 m0, s23, 32768
    s_add_u32 s25, s20, 0
    buffer_load_dwordx4 v2, s[4:7], s25 offen sc1 lds
    s_waitcnt lgkmcnt(3)
    v_mfma_f32_32x32x16_bf16 v[64:79], v[40:43], v[32:35], v[64:79]
    ds_read_b128 v[240:243], v4 offset:51200
    ds_read_b64_tr_b16 v[248:249], v228 offset:59392
    ds_read_b64_tr_b16 v[250:251], v228 offset:59904
    s_add_u32 m0, s23, 36864
    s_add_u32 s25, s20, 131072
    buffer_load_dwordx4 v2, s[4:7], s25 offen sc1 lds
    s_add_u32 s20, s20, 262144
    s_cmp_eq_u32 s20, s37
    s_cselect_b32 s20, s36, s20
    s_waitcnt lgkmcnt(3)
    v_mfma_f32_32x32x16_bf16 v[64:79], v[56:59], v[48:51], v[64:79]
    ds_read_b128 v[32:35], v4 offset:53248
    ds_read_b64_tr_b16 v[40:41], v228 offset:61440
    ds_read_b64_tr_b16 v[42:43], v228 offset:61952
    s_add_u32 m0, s23, 40960
    s_add_u32 s25, s21, 0
    buffer_load_dwordx4 v3, s[8:11], s25 offen lds
    s_waitcnt lgkmcnt(3)
    v_mfma_f32_32x32x16_bf16 v[64:79], v[248:251], v[240:243], v[64:79]
    ds_read_b128 v[48:51], v4 offset:55296
    ds_read_b64_tr_b16 v[56:57], v228 offset:63488
    ds_read_b64_tr_b16 v[58:59], v228 offset:64000
    s_add_u32 m0, s23, 45056
    s_add_u32 s25, s21, 40960
    buffer_load_dwordx4 v3, s[8:11], s25 offen lds
    s_add_u32 s21, s21, 81920
    s_cmp_eq_u32 s21, s39
    s_cselect_b32 s21, s38, s21
    s_waitcnt lgkmcnt(3)
    v_mfma_f32_32x32x16_bf16 v[64:79], v[40:43], v[32:35], v[64:79]
    s_waitcnt vmcnt(8) lgkmcnt(0)
    s_barrier
    ds_read_b128 v[240:243], v4 offset:0
    ds_read_b64_tr_b16 v[248:249], v228 offset:8192
    ds_read_b64_tr_b16 v[250:251], v228 offset:8704
    s_add_u32 m0, s23, 49152
    s_add_u32 s25, s20, 0
    buffer_load_dwordx4 v2, s[4:7], s25 offen sc1 lds
    s_waitcnt lgkmcnt(3)
    v_mfma_f32_32x32x16_bf16 v[64:79], v[56:59], v[48:51], v[64:79]
    ds_read_b128 v[32:35], v4 offset:2048
    ds_read_b64_tr_b16 v[40:41], v228 offset:10240
    ds_read_b64_tr_b16 v[42:43], v228 offset:10752
    s_add_u32 m0, s23, 53248
    s_add_u32 s25, s20, 131072
    buffer_load_dwordx4 v2, s[4:7], s25 offen sc1 lds
    s_add_u32 s20, s20, 262144
    s_cmp_eq_u32 s20, s37
    s_cselect_b32 s20, s36, s20
    s_waitcnt lgkmcnt(3)
    v_mfma_f32_32x32x16_bf16 v[64:79], v[248:251], v[240:243], v[64:79]
    ds_read_b128 v[48:51], v4 offset:4096
    ds_read_b64_tr_b16 v[56:57], v228 offset:12288
    ds_read_b64_tr_b16 v[58:59], v228 offset:12800
    s_add_u32 m0, s23, 57344
    s_add_u32 s25, s21, 0
    buffer_load_dwordx4 v3, s[8:11], s25 offen lds
    s_waitcnt lgkmcnt(3)
    v_mfma_f32_32x32x16_bf16 v[64:79], v[40:43], v[32:35], v[64:79]
    ds_read_b128 v[240:243], v4 offset:6144
    ds_read_b64_tr_b16 v[248:249], v228 offset:14336
    ds_read_b64_tr_b16 v[250:251], v228 offset:14848
    s_add_u32 m0, s23, 61440
    s_add_u32 s25, s21, 40960
    buffer_load_dwordx4 v3, s[8:11], s25 offen lds
    s_add_u32 s21, s21, 81920
    s_cmp_eq_u32 s21, s39
    s_cselect_b32 s21, s38, s21
    s_waitcnt lgkmcnt(3)
    v_mfma_f32_32x32x16_bf16 v[64:79], v[56:59], v[48:51], v[64:79]
    s_waitcnt vmcnt(8) lgkmcnt(0)
    s_barrier
    ds_read_b128 v[32:35], v4 offset:16384
    ds_read_b64_tr_b16 v[40:41], v228 offset:24576
    ds_read_b64_tr_b16 v[42:43], v228 offset:25088
    s_add_u32 m0, s23, 0
    s_add_u32 s25, s20, 0
    buffer_load_dwordx4 v2, s[4:7], s25 offen sc1 lds
    s_waitcnt lgkmcnt(3)
    v_mfma_f32_32x32x16_bf16 v[64:79], v[248:251], v[240:243], v[64:79]
    ds_read_b128 v[48:51], v4 offset:18432
    ds_read_b64_tr_b16 v[56:57], v228 offset:26624
    ds_read_b64_tr_b16 v[58:59], v228 offset:27136
    s_add_u32 m0, s23, 4096
    s_add_u32 s25, s20, 131072
    buffer_load_dwordx4 v2, s[4:7], s25 offen sc1 lds
    s_add_u32 s20, s20, 262144
    s_cmp_eq_u32 s20, s37
    s_cselect_b32 s20, s36, s20
    s_waitcnt lgkmcnt(3)
    v_mfma_f32_32x32x16_bf16 v[64:79], v[40:43], v[32:35], v[64:79]
    ds_read_b128 v[240:243], v4 offset:20480
    ds_read_b64_tr_b16 v[248:249], v228 offset:28672
    ds_read_b64_tr_b16 v[250:251], v228 offset:29184
    s_add_u32 m0, s23, 8192
    s_add_u32 s25, s21, 0
    buffer_load_dwordx4 v3, s[8:11], s25 offen lds
    s_waitcnt lgkmcnt(3)
    v_mfma_f32_32x32x16_bf16 v[64:79], v[56:59], v[48:51], v[64:79]
    ds_read_b128 v[32:35], v4 offset:22528
    ds_read_b64_tr_b16 v[40:41], v228 offset:30720
    ds_read_b64_tr_b16 v[42:43], v228 offset:31232
    s_add_u32 m0, s23, 12288
    s_add_u32 s25, s21, 40960
    buffer_load_dwordx4 v3, s[8:11], s25 offen lds
    s_add_u32 s21, s21, 81920
    s_cmp_eq_u32 s21, s39
    s_cselect_b32 s21, s38, s21
    s_waitcnt lgkmcnt(3)
    v_mfma_f32_32x32x16_bf16 v[64:79], v[248:251], v[240:243], v[64:79]
    s_waitcnt vmcnt(8) lgkmcnt(0)
    s_barrier
    ds_read_b128 v[48:51], v4 offset:32768
    ds_read_b64_tr_b16 v[56:57], v228 offset:40960
    ds_read_b64_tr_b16 v[58:59], v228 offset:41472
    s_add_u32 m0, s23, 16384
    s_add_u32 s25, s20, 0
    buffer_load_dwordx4 v2, s[4:7], s25 offen sc1 lds
    s_waitcnt lgkmcnt(3)
    v_mfma_f32_32x32x16_bf16 v[64:79], v[40:43], v[32:35], v[64:79]
    ds_read_b128 v[240:243], v4 offset:34816
    ds_read_b64_tr_b16 v[248:249], v228 offset:43008
    ds_read_b64_tr_b16 v[250:251], v228 offset:43520
    s_add_u32 m0, s23, 20480
    s_add_u32 s25, s20, 131072
    buffer_load_dwordx4 v2, s[4:7], s25 offen sc1 lds
    s_add_u32 s20, s20, 262144
    s_cmp_eq_u32 s20, s37
    s_cselect_b32 s20, s36, s20
    s_waitcnt lgkmcnt(3)
    v_mfma_f32_32x32x16_bf16 v[64:79], v[56:59], v[48:51], v[64:79]
    ds_read_b128 v[32:35], v4 offset:36864
    ds_read_b64_tr_b16 v[40:41], v228 offset:45056
    ds_read_b64_tr_b16 v[42:43], v228 offset:45568
    s_add_u32 m0, s23, 24576
    s_add_u32 s25, s21, 0
    buffer_load_dwordx4 v3, s[8:11], s25 offen lds
    s_waitcnt lgkmcnt(3)
    v_mfma_f32_32x32x16_bf16 v[64:79], v[248:251], v[240:243], v[64:79]
    ds_read_b128 v[48:51], v4 offset:38912
    ds_read_b64_tr_b16 v[56:57], v228 offset:47104
    ds_read_b64_tr_b16 v[58:59], v228 offset:47616
    s_add_u32 m0, s23, 28672
    s_add_u32 s25, s21, 40960
    buffer_load_dwordx4 v3, s[8:11], s25 offen lds
    s_add_u32 s21, s21, 81920
    s_cmp_eq_u32 s21, s39
    s_cselect_b32 s21, s38, s21
    s_waitcnt lgkmcnt(3)
    v_mfma_f32_32x32x16_bf16 v[64:79], v[40:43], v[32:35], v[64:79]
    s_waitcnt vmcnt(8) lgkmcnt(0)
    s_barrier
    ds_read_b128 v[240:243], v4 offset:49152
    ds_read_b64_tr_b16 v[248:249], v228 offset:57344
    ds_read_b64_tr_b16 v[250:251], v228 offset:57856
    s_add_u32 m0, s23, 32768
    s_add_u32 s25, s20, 0
    buffer_load_dwordx4 v2, s[4:7], s25 offen sc1 lds
    s_waitcnt lgkmcnt(3)
    v_mfma_f32_32x32x16_bf16 v[64:79], v[56:59], v[48:51], v[64:79]
    ds_read_b128 v[32:35], v4 offset:51200
    ds_read_b64_tr_b16 v[40:41], v228 offset:59392
    ds_read_b64_tr_b16 v[42:43], v228 offset:59904
    s_add_u32 m0, s23, 36864
    s_add_u32 s25, s20, 131072
    buffer_load_dwordx4 v2, s[4:7], s25 offen sc1 lds
    s_add_u32 s20, s20, 262144
    s_cmp_eq_u32 s20, s37
    s_cselect_b32 s20, s36, s20
    s_waitcnt lgkmcnt(3)
    v_mfma_f32_32x32x16_bf16 v[64:79], v[248:251], v[240:243], v[64:79]
    ds_read_b128 v[48:51], v4 offset:53248
    ds_read_b64_tr_b16 v[56:57], v228 offset:61440
    ds_read_b64_tr_b16 v[58:59], v228 offset:61952
    s_add_u32 m0, s23, 40960
    s_add_u32 s25, s21, 0
    buffer_load_dwordx4 v3, s[8:11], s25 offen lds
    s_waitcnt lgkmcnt(3)
    v_mfma_f32_32x32x16_bf16 v[64:79], v[40:43], v[32:35], v[64:79]
    ds_read_b128 v[240:243], v4 offset:55296
    ds_read_b64_tr_b16 v[248:249], v228 offset:63488
    ds_read_b64_tr_b16 v[250:251], v228 offset:64000
    s_add_u32 m0, s23, 45056
    s_add_u32 s25, s21, 40960
    buffer_load_dwordx4 v3, s[8:11], s25 offen lds
    s_add_u32 s21, s21, 81920
    s_cmp_eq_u32 s21, s39
    s_cselect_b32 s21, s38, s21
    s_waitcnt lgkmcnt(3)
    v_mfma_f32_32x32x16_bf16 v[64:79], v[56:59], v[48:51], v[64:79]
    s_waitcnt vmcnt(8) lgkmcnt(0)
    s_barrier
    ds_read_b128 v[32:35], v4 offset:0
    ds_read_b64_tr_b16 v[40:41], v228 offset:8192
    ds_read_b64_tr_b16 v[42:43], v228 offset:8704
    s_waitcnt lgkmcnt(3)
    v_mfma_f32_32x32x16_bf16 v[64:79], v[248:251], v[240:243], v[64:79]
    ds_read_b128 v[48:51], v4 offset:2048
    ds_read_b64_tr_b16 v[56:57], v228 offset:10240
    ds_read_b64_tr_b16 v[58:59], v228 offset:10752
    s_waitcnt lgkmcnt(3)
    v_mfma_f32_32x32x16_bf16 v[64:79], v[40:43], v[32:35], v[64:79]
    ds_read_b128 v[240:243], v4 offset:4096
    ds_read_b64_tr_b16 v[248:249], v228 offset:12288
    ds_read_b64_tr_b16 v[250:251], v228 offset:12800
    s_waitcnt lgkmcnt(3)
    v_mfma_f32_32x32x16_bf16 v[64:79], v[56:59], v[48:51], v[64:79]
    ds_read_b128 v[32:35], v4 offset:6144
    ds_read_b64_tr_b16 v[40:41], v228 offset:14336
    ds_read_b64_tr_b16 v[42:43], v228 offset:14848
    s_waitcnt lgkmcnt(3)
    v_mfma_f32_32x32x16_bf16 v[64:79], v[248:251], v[240:243], v[64:79]
    s_waitcnt vmcnt(4) lgkmcnt(0)
    s_barrier
    ds_read_b128 v[48:51], v4 offset:16384
    ds_read_b64_tr_b16 v[56:57], v228 offset:24576
    ds_read_b64_tr_b16 v[58:59], v228 offset:25088
    s_waitcnt lgkmcnt(3)
    v_mfma_f32_32x32x16_bf16 v[64:79], v[40:43], v[32:35], v[64:79]
    ds_read_b128 v[240:243], v4 offset:18432
    ds_read_b64_tr_b16 v[248:249], v228 offset:26624
    ds_read_b64_tr_b16 v[250:251], v228 offset:27136
    s_waitcnt lgkmcnt(3)
    v_mfma_f32_32x32x16_bf16 v[64:79], v[56:59], v[48:51], v[64:79]
    ds_read_b128 v[32:35], v4 offset:20480
    ds_read_b64_tr_b16 v[40:41], v228 offset:28672
    ds_read_b64_tr_b16 v[42:43], v228 offset:29184
    s_waitcnt lgkmcnt(3)
    v_mfma_f32_32x32x16_bf16 v[64:79], v[248:251], v[240:243], v[64:79]
    ds_read_b128 v[48:51], v4 offset:22528
    ds_read_b64_tr_b16 v[56:57], v228 offset:30720
    ds_read_b64_tr_b16 v[58:59], v228 offset:31232
    s_waitcnt lgkmcnt(3)
    v_mfma_f32_32x32x16_bf16 v[64:79], v[40:43], v[32:35], v[64:79]
    s_waitcnt vmcnt(0) lgkmcnt(0)
    s_barrier
    ds_read_b128 v[240:243], v4 offset:32768
    ds_read_b64_tr_b16 v[248:249], v228 offset:40960
    ds_read_b64_tr_b16 v[250:251], v228 offset:41472
    s_waitcnt lgkmcnt(3)
    v_mfma_f32_32x32x16_bf16 v[64:79], v[56:59], v[48:51], v[64:79]
    ds_read_b128 v[32:35], v4 offset:34816
    ds_read_b64_tr_b16 v[40:41], v228 offset:43008
    ds_read_b64_tr_b16 v[42:43], v228 offset:43520
    s_waitcnt lgkmcnt(3)
    v_mfma_f32_32x32x16_bf16 v[64:79], v[248:251], v[240:243], v[64:79]
    ds_read_b128 v[48:51], v4 offset:36864
    ds_read_b64_tr_b16 v[56:57], v228 offset:45056
    ds_read_b64_tr_b16 v[58:59], v228 offset:45568
    s_waitcnt lgkmcnt(3)
    v_mfma_f32_32x32x16_bf16 v[64:79], v[40:43], v[32:35], v[64:79]
    ds_read_b128 v[240:243], v4 offset:38912
    ds_read_b64_tr_b16 v[248:249], v228 offset:47104
    ds_read_b64_tr_b16 v[250:251], v228 offset:47616
    s_waitcnt lgkmcnt(3)
    v_mfma_f32_32x32x16_bf16 v[64:79], v[56:59], v[48:51], v[64:79]
    s_waitcnt lgkmcnt(0)
    v_mfma_f32_32x32x16_bf16 v[64:79], v[248:251], v[240:243], v[64:79]
    s_nop 15
    s_setprio 2
    v_mul_f32 v14, 0xbfb8aa3b, v64
    v_mul_f32 v15, 0xbfb8aa3b, v65
    v_mul_f32 v16, 0xbfb8aa3b, v66
    v_mul_f32 v17, 0xbfb8aa3b, v67
    v_exp_f32 v14, v14
    v_exp_f32 v15, v15
    v_exp_f32 v16, v16
    v_exp_f32 v17, v17
    v_add_f32 v14, 1.0, v14
    v_add_f32 v15, 1.0, v15
    v_add_f32 v16, 1.0, v16
    v_add_f32 v17, 1.0, v17
    v_rcp_f32 v14, v14
    v_rcp_f32 v15, v15
    v_rcp_f32 v16, v16
    v_rcp_f32 v17, v17
    s_nop 0
    v_mul_f32 v128, v64, v14
    v_mul_f32 v129, v65, v15
    v_mul_f32 v130, v66, v16
    v_mul_f32 v131, v67, v17
    v_mul_f32 v14, 0xbfb8aa3b, v68
    v_mul_f32 v15, 0xbfb8aa3b, v69
    v_mul_f32 v16, 0xbfb8aa3b, v70
    v_mul_f32 v17, 0xbfb8aa3b, v71
    v_exp_f32 v14, v14
    v_exp_f32 v15, v15
    v_exp_f32 v16, v16
    v_exp_f32 v17, v17
    v_add_f32 v14, 1.0, v14
    v_add_f32 v15, 1.0, v15
    v_add_f32 v16, 1.0, v16
    v_add_f32 v17, 1.0, v17
    v_rcp_f32 v14, v14
    v_rcp_f32 v15, v15
    v_rcp_f32 v16, v16
    v_rcp_f32 v17, v17
    s_nop 0
    v_mul_f32 v132, v68, v14
    v_mul_f32 v133, v69, v15
    v_mul_f32 v134, v70, v16
    v_mul_f32 v135, v71, v17
    v_mul_f32 v14, 0xbfb8aa3b, v72
    v_mul_f32 v15, 0xbfb8aa3b, v73
    v_mul_f32 v16, 0xbfb8aa3b, v74
    v_mul_f32 v17, 0xbfb8aa3b, v75
    v_exp_f32 v14, v14
    v_exp_f32 v15, v15
    v_exp_f32 v16, v16
    v_exp_f32 v17, v17
    v_add_f32 v14, 1.0, v14
    v_add_f32 v15, 1.0, v15
    v_add_f32 v16, 1.0, v16
    v_add_f32 v17, 1.0, v17
    v_rcp_f32 v14, v14
    v_rcp_f32 v15, v15
    v_rcp_f32 v16, v16
    v_rcp_f32 v17, v17
    s_nop 0
    v_mul_f32 v136, v72, v14
    v_mul_f32 v137, v73, v15
    v_mul_f32 v138, v74, v16
    v_mul_f32 v139, v75, v17
    v_mul_f32 v14, 0xbfb8aa3b, v76
    v_mul_f32 v15, 0xbfb8aa3b, v77
    v_mul_f32 v16, 0xbfb8aa3b, v78
    v_mul_f32 v17, 0xbfb8aa3b, v79
    v_exp_f32 v14, v14
    v_exp_f32 v15, v15
    v_exp_f32 v16, v16
    v_exp_f32 v17, v17
    v_add_f32 v14, 1.0, v14
    v_add_f32 v15, 1.0, v15
    v_add_f32 v16, 1.0, v16
    v_add_f32 v17, 1.0, v17
    v_rcp_f32 v14, v14
    v_rcp_f32 v15, v15
    v_rcp_f32 v16, v16
    v_rcp_f32 v17, v17
    s_nop 0
    v_mul_f32 v140, v76, v14
    v_mul_f32 v141, v77, v15
    v_mul_f32 v142, v78, v16
    v_mul_f32 v143, v79, v17
    s_barrier
    v_lshrrev_b32 v14, 5, v1
    s_lshl_b32 s25, s26, 1
    v_add_u32 v14, s25, v14
    v_lshlrev_b32 v14, 14, v14
    v_and_b32 v15, 31, v1
    v_lshl_add_u32 v2, v15, 4, v14
    v_lshrrev_b32 v14, 5, v1
    v_lshlrev_b32 v14, 10, v14
    s_lshl_b32 s25, s27, 5
    v_add_u32 v15, s25, v15
    v_lshl_add_u32 v4, v15, 3, v14
    s_add_u32 s4, s76, 15990784
    s_addc_u32 s5, s77, 0
    s_and_b32 s5, s5, 0xffff
    s_mov_b32 s6, 2621440
    s_mov_b32 s7, 0x00020000
    s_mov_b32 s8, s64
    s_mov_b32 s9, s65
    s_and_b32 s9, s9, 0xffff
    s_mov_b32 s10, 819200
    s_mov_b32 s11, 0x00020000
    s_mov_b32 s12, s64
    s_mov_b32 s13, s65
    s_and_b32 s13, s13, 0xffff
    s_mov_b32 s14, 819200
    s_mov_b32 s15, 0x00020000
    s_lshl_b32 s20, s44, 9
    s_lshl_b32 s21, s45, 7
    s_lshr_b32 s46, s41, 2
    s_mul_i32 s46, s46, 2
    s_and_b32 s25, s41, 3
    s_mul_i32 s25, s25, 3
    s_add_u32 s46, s46, s25
    s_mul_i32 s25, s46, 6554
    s_lshr_b32 s25, s25, 16
    s_mul_i32 s25, s25, 10
    s_sub_u32 s46, s46, s25
    s_mov_b32 s36, s20
    s_add_u32 s37, s20, 2621440
    s_mul_i32 s25, s46, 262144
    s_add_u32 s20, s20, s25
    s_mov_b32 s38, s21
    s_add_u32 s39, s21, 819200
    s_mul_i32 s25, s46, 81920
    s_add_u32 s21, s21, s25
    s_mov_b32 s16, s60
    s_mov_b32 s17, s61
    s_and_b32 s17, s17, 0xffff
    s_mov_b32 s18, 2621440
    s_mov_b32 s19, 0x00020000
    s_lshl_b32 s51, s44, 6
    s_lshl_b32 s52, s27, 5
    s_add_u32 s51, s51, s52
    v_and_b32 v160, 31, v1
    v_add_u32 v160, s51, v160
    v_mul_u32_u24 v160, 1280, v160
    s_lshl_b32 s52, s45, 7
    s_lshl_b32 s53, s28, 6
    s_add_u32 s52, s52, s53
    v_lshrrev_b32 v161, 5, v1
    v_lshlrev_b32 v161, 4, v161
    v_add3_u32 v160, v160, v161, s52
    buffer_load_dwordx4 v[164:167], v160, s[16:19], 0 offen offset:0
    buffer_load_dwordx4 v[168:171], v160, s[16:19], 0 offen offset:32
    s_add_u32 m0, s23, 8192
    s_add_u32 s25, s21, 0
    buffer_load_dwordx4 v3, s[8:11], s25 offen lds
    s_add_u32 m0, s23, 12288
    s_add_u32 s25, s21, 40960
    buffer_load_dwordx4 v3, s[8:11], s25 offen lds
    s_add_u32 s21, s21, 81920
    s_cmp_eq_u32 s21, s39
    s_cselect_b32 s21, s38, s21
    s_add_u32 m0, s23, 24576
    s_add_u32 s25, s21, 0
    buffer_load_dwordx4 v3, s[8:11], s25 offen lds
    s_add_u32 m0, s23, 28672
    s_add_u32 s25, s21, 40960
    buffer_load_dwordx4 v3, s[8:11], s25 offen lds
    s_add_u32 s21, s21, 81920
    s_cmp_eq_u32 s21, s39
    s_cselect_b32 s21, s38, s21
    s_add_u32 m0, s23, 40960
    s_add_u32 s25, s21, 0
    buffer_load_dwordx4 v3, s[8:11], s25 offen lds
    s_add_u32 m0, s23, 45056
    s_add_u32 s25, s21, 40960
    buffer_load_dwordx4 v3, s[8:11], s25 offen lds
    s_add_u32 s21, s21, 81920
    s_cmp_eq_u32 s21, s39
    s_cselect_b32 s21, s38, s21
    s_add_u32 m0, s23, 57344
    s_add_u32 s25, s21, 0
    buffer_load_dwordx4 v3, s[8:11], s25 offen lds
    s_add_u32 m0, s23, 61440
    s_add_u32 s25, s21, 40960
    buffer_load_dwordx4 v3, s[8:11], s25 offen lds
    s_add_u32 s21, s21, 81920
    s_cmp_eq_u32 s21, s39
    s_cselect_b32 s21, s38, s21
    s_add_u32 s50, s40, 184
    s_cmp_lg_u32 s26, 0
    s_cbranch_scc1 L_wcd_51
    s_lshl_b32 s31, s50, 7
    v_mov_b32 v238, s31
    s_mov_b32 exec_lo, 1
    s_mov_b32 exec_hi, 0
    s_mov_b32 s30, 0x40000
L_wc_50:
    buffer_load_dword v239, v238, s[56:59], 0 offen sc1
    s_waitcnt vmcnt(0)
    v_cmp_gt_u32 vcc, 32, v239
    s_nop 4
    s_cbranch_vccz L_wcd_51_x
    s_sleep 4
    s_sub_u32 s30, s30, 1
    s_cmp_lg_u32 s30, 0
    s_cbranch_scc1 L_wc_50
L_wcd_51_x:
    s_mov_b64 exec, -1
L_wcd_51:
    s_waitcnt vmcnt(0)
    s_barrier
    s_add_u32 m0, s23, 0
    s_add_u32 s25, s20, 0
    buffer_load_dwordx4 v2, s[4:7], s25 offen sc1 lds
    s_add_u32 m0, s23, 4096
    s_add_u32 s25, s20, 131072
    buffer_load_dwordx4 v2, s[4:7], s25 offen sc1 lds
    s_add_u32 s20, s20, 262144
    s_cmp_eq_u32 s20, s37
    s_cselect_b32 s20, s36, s20
    s_add_u32 m0, s23, 16384
    s_add_u32 s25, s20, 0
    buffer_load_dwordx4 v2, s[4:7], s25 offen sc1 lds
    s_add_u32 m0, s23, 20480
    s_add_u32 s25, s20, 131072
    buffer_load_dwordx4 v2, s[4:7], s25 offen sc1 lds
    s_add_u32 s20, s20, 262144
    s_cmp_eq_u32 s20, s37
    s_cselect_b32 s20, s36, s20
    s_add_u32 m0, s23, 32768
    s_add_u32 s25, s20, 0
    buffer_load_dwordx4 v2, s[4:7], s25 offen sc1 lds
    s_add_u32 m0, s23, 36864
    s_add_u32 s25, s20, 131072
    buffer_load_dwordx4 v2, s[4:7], s25 offen sc1 lds
    s_add_u32 s20, s20, 262144
    s_cmp_eq_u32 s20, s37
    s_cselect_b32 s20, s36, s20
    s_add_u32 m0, s23, 49152
    s_add_u32 s25, s20, 0
    buffer_load_dwordx4 v2, s[4:7], s25 offen sc1 lds
    s_add_u32 m0, s23, 53248
    s_add_u32 s25, s20, 131072
    buffer_load_dwordx4 v2, s[4:7], s25 offen sc1 lds
    s_add_u32 s20, s20, 262144
    s_cmp_eq_u32 s20, s37
    s_cselect_b32 s20, s36, s20
    s_waitcnt vmcnt(6)
    s_barrier
    ds_read_b64 v[32:33], v4 offset:0
    ds_read_b64 v[34:35], v4 offset:512
    ds_read_b64_tr_b16 v[40:41], v228 offset:8192
    ds_read_b64_tr_b16 v[42:43], v228 offset:8704
    ds_read_b64 v[48:49], v4 offset:2048
    ds_read_b64 v[50:51], v4 offset:2560
    ds_read_b64_tr_b16 v[56:57], v228 offset:10240
    ds_read_b64_tr_b16 v[58:59], v228 offset:10752
    s_waitcnt lgkmcnt(4)
    v_mfma_f32_32x32x16_bf16 v[64:79], v[40:43], v[32:35], 0
    ds_read_b64 v[240:241], v4 offset:4096
    ds_read_b64 v[242:243], v4 offset:4608
    ds_read_b64_tr_b16 v[248:249], v228 offset:12288
    ds_read_b64_tr_b16 v[250:251], v228 offset:12800
    s_waitcnt lgkmcnt(4)
    v_mfma_f32_32x32x16_bf16 v[64:79], v[56:59], v[48:51], v[64:79]
    ds_read_b64 v[32:33], v4 offset:6144
    ds_read_b64 v[34:35], v4 offset:6656
    ds_read_b64_tr_b16 v[40:41], v228 offset:14336
    ds_read_b64_tr_b16 v[42:43], v228 offset:14848
    s_waitcnt lgkmcnt(4)
    v_mfma_f32_32x32x16_bf16 v[64:79], v[248:251], v[240:243], v[64:79]
    s_waitcnt vmcnt(4) lgkmcnt(0)
    s_barrier
    ds_read_b64 v[48:49], v4 offset:16384
    ds_read_b64 v[50:51], v4 offset:16896
    ds_read_b64_tr_b16 v[56:57], v228 offset:24576
    ds_read_b64_tr_b16 v[58:59], v228 offset:25088
    s_add_u32 m0, s23, 0
    s_add_u32 s25, s20, 0
    buffer_load_dwordx4 v2, s[4:7], s25 offen sc1 lds
    s_waitcnt lgkmcnt(4)
    v_mfma_f32_32x32x16_bf16 v[64:79], v[40:43], v[32:35], v[64:79]
    ds_read_b64 v[240:241], v4 offset:18432
    ds_read_b64 v[242:243], v4 offset:18944
    ds_read_b64_tr_b16 v[248:249], v228 offset:26624
    ds_read_b64_tr_b16 v[250:251], v228 offset:27136
    s_add_u32 m0, s23, 4096
    s_add_u32 s25, s20, 131072
    buffer_load_dwordx4 v2, s[4:7], s25 offen sc1 lds
    s_add_u32 s20, s20, 262144
    s_cmp_eq_u32 s20, s37
    s_cselect_b32 s20, s36, s20
    s_waitcnt lgkmcnt(4)
    v_mfma_f32_32x32x16_bf16 v[64:79], v[56:59], v[48:51], v[64:79]
    ds_read_b64 v[32:33], v4 offset:20480
    ds_read_b64 v[34:35], v4 offset:20992
    ds_read_b64_tr_b16 v[40:41], v228 offset:28672
    ds_read_b64_tr_b16 v[42:43], v228 offset:29184
    s_add_u32 m0, s23, 8192
    s_add_u32 s25, s21, 0
    buffer_load_dwordx4 v3, s[8:11], s25 offen lds
    s_waitcnt lgkmcnt(4)
    v_mfma_f32_32x32x16_bf16 v[64:79], v[248:251], v[240:243], v[64:79]
    ds_read_b64 v[48:49], v4 offset:22528
    ds_read_b64 v[50:51], v4 offset:23040
    ds_read_b64_tr_b16 v[56:57], v228 offset:30720
    ds_read_b64_tr_b16 v[58:59], v228 offset:31232
    s_add_u32 m0, s23, 12288
    s_add_u32 s25, s21, 40960
    buffer_load_dwordx4 v3, s[8:11], s25 offen lds
    s_add_u32 s21, s21, 81920
    s_cmp_eq_u32 s21, s39
    s_cselect_b32 s21, s38, s21
    s_waitcnt lgkmcnt(4)
    v_mfma_f32_32x32x16_bf16 v[64:79], v[40:43], v[32:35], v[64:79]
    s_waitcnt vmcnt(6) lgkmcnt(0)
    s_barrier
    ds_read_b64 v[240:241], v4 offset:32768
    ds_read_b64 v[242:243], v4 offset:33280
    ds_read_b64_tr_b16 v[248:249], v228 offset:40960
    ds_read_b64_tr_b16 v[250:251], v228 offset:41472
    s_add_u32 m0, s23, 16384
    s_add_u32 s25, s20, 0
    buffer_load_dwordx4 v2, s[4:7], s25 offen sc1 lds
    s_waitcnt lgkmcnt(4)
    v_mfma_f32_32x32x16_bf16 v[64:79], v[56:59], v[48:51], v[64:79]
    ds_read_b64 v[32:33], v4 offset:34816
    ds_read_b64 v[34:35], v4 offset:35328
    ds_read_b64_tr_b16 v[40:41], v228 offset:43008
    ds_read_b64_tr_b16 v[42:43], v228 offset:43520
    s_add_u32 m0, s23, 20480
    s_add_u32 s25, s20, 131072
    buffer_load_dwordx4 v2, s[4:7], s25 offen sc1 lds
    s_add_u32 s20, s20, 262144
    s_cmp_eq_u32 s20, s37
    s_cselect_b32 s20, s36, s20
    s_waitcnt lgkmcnt(4)
    v_mfma_f32_32x32x16_bf16 v[64:79], v[248:251], v[240:243], v[64:79]
    ds_read_b64 v[48:49], v4 offset:36864
    ds_read_b64 v[50:51], v4 offset:37376
    ds_read_b64_tr_b16 v[56:57], v228 offset:45056
    ds_read_b64_tr_b16 v[58:59], v228 offset:45568
    s_add_u32 m0, s23, 24576
    s_add_u32 s25, s21, 0
    buffer_load_dwordx4 v3, s[8:11], s25 offen lds
    s_waitcnt lgkmcnt(4)
    v_mfma_f32_32x32x16_bf16 v[64:79], v[40:43], v[32:35], v[64:79]
    ds_read_b64 v[240:241], v4 offset:38912
    ds_read_b64 v[242:243], v4 offset:39424
    ds_read_b64_tr_b16 v[248:249], v228 offset:47104
    ds_read_b64_tr_b16 v[250:251], v228 offset:47616
    s_add_u32 m0, s23, 28672
    s_add_u32 s25, s21, 40960
    buffer_load_dwordx4 v3, s[8:11], s25 offen lds
    s_add_u32 s21, s21, 81920
    s_cmp_eq_u32 s21, s39
    s_cselect_b32 s21, s38, s21
    s_waitcnt lgkmcnt(4)
    v_mfma_f32_32x32x16_bf16 v[64:79], v[56:59], v[48:51], v[64:79]
    s_waitcnt vmcnt(8) lgkmcnt(0)
    s_barrier
    ds_read_b64 v[32:33], v4 offset:49152
    ds_read_b64 v[34:35], v4 offset:49664
    ds_read_b64_tr_b16 v[40:41], v228 offset:57344
    ds_read_b64_tr_b16 v[42:43], v228 offset:57856
    s_add_u32 m0, s23, 32768
    s_add_u32 s25, s20, 0
    buffer_load_dwordx4 v2, s[4:7], s25 offen sc1 lds
    s_waitcnt lgkmcnt(4)
    v_mfma_f32_32x32x16_bf16 v[64:79], v[248:251], v[240:243], v[64:79]
    ds_read_b64 v[48:49], v4 offset:51200
    ds_read_b64 v[50:51], v4 offset:51712
    ds_read_b64_tr_b16 v[56:57], v228 offset:59392
    ds_read_b64_tr_b16 v[58:59], v228 offset:59904
    s_add_u32 m0, s23, 36864
    s_add_u32 s25, s20, 131072
    buffer_load_dwordx4 v2, s[4:7], s25 offen sc1 lds
    s_add_u32 s20, s20, 262144
    s_cmp_eq_u32 s20, s37
    s_cselect_b32 s20, s36, s20
    s_waitcnt lgkmcnt(4)
    v_mfma_f32_32x32x16_bf16 v[64:79], v[40:43], v[32:35], v[64:79]
    ds_read_b64 v[240:241], v4 offset:53248
    ds_read_b64 v[242:243], v4 offset:53760
    ds_read_b64_tr_b16 v[248:249], v228 offset:61440
    ds_read_b64_tr_b16 v[250:251], v228 offset:61952
    s_add_u32 m0, s23, 40960
    s_add_u32 s25, s21, 0
    buffer_load_dwordx4 v3, s[8:11], s25 offen lds
    s_waitcnt lgkmcnt(4)
    v_mfma_f32_32x32x16_bf16 v[64:79], v[56:59], v[48:51], v[64:79]
    ds_read_b64 v[32:33], v4 offset:55296
    ds_read_b64 v[34:35], v4 offset:55808
    ds_read_b64_tr_b16 v[40:41], v228 offset:63488
    ds_read_b64_tr_b16 v[42:43], v228 offset:64000
    s_add_u32 m0, s23, 45056
    s_add_u32 s25, s21, 40960
    buffer_load_dwordx4 v3, s[8:11], s25 offen lds
    s_add_u32 s21, s21, 81920
    s_cmp_eq_u32 s21, s39
    s_cselect_b32 s21, s38, s21
    s_waitcnt lgkmcnt(4)
    v_mfma_f32_32x32x16_bf16 v[64:79], v[248:251], v[240:243], v[64:79]
    s_waitcnt vmcnt(8) lgkmcnt(0)
    s_barrier
    ds_read_b64 v[48:49], v4 offset:0
    ds_read_b64 v[50:51], v4 offset:512
    ds_read_b64_tr_b16 v[56:57], v228 offset:8192
    ds_read_b64_tr_b16 v[58:59], v228 offset:8704
    s_add_u32 m0, s23, 49152
    s_add_u32 s25, s20, 0
    buffer_load_dwordx4 v2, s[4:7], s25 offen sc1 lds
    s_waitcnt lgkmcnt(4)
    v_mfma_f32_32x32x16_bf16 v[64:79], v[40:43], v[32:35], v[64:79]
    ds_read_b64 v[240:241], v4 offset:2048
    ds_read_b64 v[242:243], v4 offset:2560
    ds_read_b64_tr_b16 v[248:249], v228 offset:10240
    ds_read_b64_tr_b16 v[250:251], v228 offset:10752
    s_add_u32 m0, s23, 53248
    s_add_u32 s25, s20, 131072
    buffer_load_dwordx4 v2, s[4:7], s25 offen sc1 lds
    s_add_u32 s20, s20, 262144
    s_cmp_eq_u32 s20, s37
    s_cselect_b32 s20, s36, s20
    s_waitcnt lgkmcnt(4)
    v_mfma_f32_32x32x16_bf16 v[64:79], v[56:59], v[48:51], v[64:79]
    ds_read_b64 v[32:33], v4 offset:4096
    ds_read_b64 v[34:35], v4 offset:4608
    ds_read_b64_tr_b16 v[40:41], v228 offset:12288
    ds_read_b64_tr_b16 v[42:43], v228 offset:12800
    s_add_u32 m0, s23, 57344
    s_add_u32 s25, s21, 0
    buffer_load_dwordx4 v3, s[8:11], s25 offen lds
    s_waitcnt lgkmcnt(4)
    v_mfma_f32_32x32x16_bf16 v[64:79], v[248:251], v[240:243], v[64:79]
    ds_read_b64 v[48:49], v4 offset:6144
    ds_read_b64 v[50:51], v4 offset:6656
    ds_read_b64_tr_b16 v[56:57], v228 offset:14336
    ds_read_b64_tr_b16 v[58:59], v228 offset:14848
    s_add_u32 m0, s23, 61440
    s_add_u32 s25, s21, 40960
    buffer_load_dwordx4 v3, s[8:11], s25 offen lds
    s_add_u32 s21, s21, 81920
    s_cmp_eq_u32 s21, s39
    s_cselect_b32 s21, s38, s21
    s_waitcnt lgkmcnt(4)
    v_mfma_f32_32x32x16_bf16 v[64:79], v[40:43], v[32:35], v[64:79]
    s_waitcnt vmcnt(8) lgkmcnt(0)
    s_barrier
    ds_read_b64 v[240:241], v4 offset:16384
    ds_read_b64 v[242:243], v4 offset:16896
    ds_read_b64_tr_b16 v[248:249], v228 offset:24576
    ds_read_b64_tr_b16 v[250:251], v228 offset:25088
    s_add_u32 m0, s23, 0
    s_add_u32 s25, s20, 0
    buffer_load_dwordx4 v2, s[4:7], s25 offen sc1 lds
    s_waitcnt lgkmcnt(4)
    v_mfma_f32_32x32x16_bf16 v[64:79], v[56:59], v[48:51], v[64:79]
    ds_read_b64 v[32:33], v4 offset:18432
    ds_read_b64 v[34:35], v4 offset:18944
    ds_read_b64_tr_b16 v[40:41], v228 offset:26624
    ds_read_b64_tr_b16 v[42:43], v228 offset:27136
    s_add_u32 m0, s23, 4096
    s_add_u32 s25, s20, 131072
    buffer_load_dwordx4 v2, s[4:7], s25 offen sc1 lds
    s_add_u32 s20, s20, 262144
    s_cmp_eq_u32 s20, s37
    s_cselect_b32 s20, s36, s20
    s_waitcnt lgkmcnt(4)
    v_mfma_f32_32x32x16_bf16 v[64:79], v[248:251], v[240:243], v[64:79]
    ds_read_b64 v[48:49], v4 offset:20480
    ds_read_b64 v[50:51], v4 offset:20992
    ds_read_b64_tr_b16 v[56:57], v228 offset:28672
    ds_read_b64_tr_b16 v[58:59], v228 offset:29184
    s_add_u32 m0, s23, 8192
    s_add_u32 s25, s21, 0
    buffer_load_dwordx4 v3, s[8:11], s25 offen lds
    s_waitcnt lgkmcnt(4)
    v_mfma_f32_32x32x16_bf16 v[64:79], v[40:43], v[32:35], v[64:79]
    ds_read_b64 v[240:241], v4 offset:22528
    ds_read_b64 v[242:243], v4 offset:23040
    ds_read_b64_tr_b16 v[248:249], v228 offset:30720
    ds_read_b64_tr_b16 v[250:251], v228 offset:31232
    s_add_u32 m0, s23, 12288
    s_add_u32 s25, s21, 40960
    buffer_load_dwordx4 v3, s[8:11], s25 offen lds
    s_add_u32 s21, s21, 81920
    s_cmp_eq_u32 s21, s39
    s_cselect_b32 s21, s38, s21
    s_waitcnt lgkmcnt(4)
    v_mfma_f32_32x32x16_bf16 v[64:79], v[56:59], v[48:51], v[64:79]
    s_waitcnt vmcnt(8) lgkmcnt(0)
    s_barrier
    ds_read_b64 v[32:33], v4 offset:32768
    ds_read_b64 v[34:35], v4 offset:33280
    ds_read_b64_tr_b16 v[40:41], v228 offset:40960
    ds_read_b64_tr_b16 v[42:43], v228 offset:41472
    s_add_u32 m0, s23, 16384
    s_add_u32 s25, s20, 0
    buffer_load_dwordx4 v2, s[4:7], s25 offen sc1 lds
    s_waitcnt lgkmcnt(4)
    v_mfma_f32_32x32x16_bf16 v[64:79], v[248:251], v[240:243], v[64:79]
    ds_read_b64 v[48:49], v4 offset:34816
    ds_read_b64 v[50:51], v4 offset:35328
    ds_read_b64_tr_b16 v[56:57], v228 offset:43008
    ds_read_b64_tr_b16 v[58:59], v228 offset:43520
    s_add_u32 m0, s23, 20480
    s_add_u32 s25, s20, 131072
    buffer_load_dwordx4 v2, s[4:7], s25 offen sc1 lds
    s_add_u32 s20, s20, 262144
    s_cmp_eq_u32 s20, s37
    s_cselect_b32 s20, s36, s20
    s_waitcnt lgkmcnt(4)
    v_mfma_f32_32x32x16_bf16 v[64:79], v[40:43], v[32:35], v[64:79]
    ds_read_b64 v[240:241], v4 offset:36864
    ds_read_b64 v[242:243], v4 offset:37376
    ds_read_b64_tr_b16 v[248:249], v228 offset:45056
    ds_read_b64_tr_b16 v[250:251], v228 offset:45568
    s_add_u32 m0, s23, 24576
    s_add_u32 s25, s21, 0
    buffer_load_dwordx4 v3, s[8:11], s25 offen lds
    s_waitcnt lgkmcnt(4)
    v_mfma_f32_32x32x16_bf16 v[64:79], v[56:59], v[48:51], v[64:79]
    ds_read_b64 v[32:33], v4 offset:38912
    ds_read_b64 v[34:35], v4 offset:39424
    ds_read_b64_tr_b16 v[40:41], v228 offset:47104
    ds_read_b64_tr_b16 v[42:43], v228 offset:47616
    s_add_u32 m0, s23, 28672
    s_add_u32 s25, s21, 40960
    buffer_load_dwordx4 v3, s[8:11], s25 offen lds
    s_add_u32 s21, s21, 81920
    s_cmp_eq_u32 s21, s39
    s_cselect_b32 s21, s38, s21
    s_waitcnt lgkmcnt(4)
    v_mfma_f32_32x32x16_bf16 v[64:79], v[248:251], v[240:243], v[64:79]
    s_waitcnt vmcnt(8) lgkmcnt(0)
    s_barrier
    ds_read_b64 v[48:49], v4 offset:49152
    ds_read_b64 v[50:51], v4 offset:49664
    ds_read_b64_tr_b16 v[56:57], v228 offset:57344
    ds_read_b64_tr_b16 v[58:59], v228 offset:57856
    s_waitcnt lgkmcnt(4)
    v_mfma_f32_32x32x16_bf16 v[64:79], v[40:43], v[32:35], v[64:79]
    ds_read_b64 v[240:241], v4 offset:51200
    ds_read_b64 v[242:243], v4 offset:51712
    ds_read_b64_tr_b16 v[248:249], v228 offset:59392
    ds_read_b64_tr_b16 v[250:251], v228 offset:59904
    s_waitcnt lgkmcnt(4)
    v_mfma_f32_32x32x16_bf16 v[64:79], v[56:59], v[48:51], v[64:79]
    ds_read_b64 v[32:33], v4 offset:53248
    ds_read_b64 v[34:35], v4 offset:53760
    ds_read_b64_tr_b16 v[40:41], v228 offset:61440
    ds_read_b64_tr_b16 v[42:43], v228 offset:61952
    s_waitcnt lgkmcnt(4)
    v_mfma_f32_32x32x16_bf16 v[64:79], v[248:251], v[240:243], v[64:79]
    ds_read_b64 v[48:49], v4 offset:55296
    ds_read_b64 v[50:51], v4 offset:55808
    ds_read_b64_tr_b16 v[56:57], v228 offset:63488
    ds_read_b64_tr_b16 v[58:59], v228 offset:64000
    s_waitcnt lgkmcnt(4)
    v_mfma_f32_32x32x16_bf16 v[64:79], v[40:43], v[32:35], v[64:79]
    s_waitcnt vmcnt(4) lgkmcnt(0)
    s_barrier
    ds_read_b64 v[240:241], v4 offset:0
    ds_read_b64 v[242:243], v4 offset:512
    ds_read_b64_tr_b16 v[248:249], v228 offset:8192
    ds_read_b64_tr_b16 v[250:251], v228 offset:8704
    s_waitcnt lgkmcnt(4)
    v_mfma_f32_32x32x16_bf16 v[64:79], v[56:59], v[48:51], v[64:79]
    ds_read_b64 v[32:33], v4 offset:2048
    ds_read_b64 v[34:35], v4 offset:2560
    ds_read_b64_tr_b16 v[40:41], v228 offset:10240
    ds_read_b64_tr_b16 v[42:43], v228 offset:10752
    s_waitcnt lgkmcnt(4)
    v_mfma_f32_32x32x16_bf16 v[64:79], v[248:251], v[240:243], v[64:79]
    ds_read_b64 v[48:49], v4 offset:4096
    ds_read_b64 v[50:51], v4 offset:4608
    ds_read_b64_tr_b16 v[56:57], v228 offset:12288
    ds_read_b64_tr_b16 v[58:59], v228 offset:12800
    s_waitcnt lgkmcnt(4)
    v_mfma_f32_32x32x16_bf16 v[64:79], v[40:43], v[32:35], v[64:79]
    ds_read_b64 v[240:241], v4 offset:6144
    ds_read_b64 v[242:243], v4 offset:6656
    ds_read_b64_tr_b16 v[248:249], v228 offset:14336
    ds_read_b64_tr_b16 v[250:251], v228 offset:14848
    s_waitcnt lgkmcnt(4)
    v_mfma_f32_32x32x16_bf16 v[64:79], v[56:59], v[48:51], v[64:79]
    s_waitcnt vmcnt(0) lgkmcnt(0)
    s_barrier
    ds_read_b64 v[32:33], v4 offset:16384
    ds_read_b64 v[34:35], v4 offset:16896
    ds_read_b64_tr_b16 v[40:41], v228 offset:24576
    ds_read_b64_tr_b16 v[42:43], v228 offset:25088
    s_waitcnt lgkmcnt(4)
    v_mfma_f32_32x32x16_bf16 v[64:79], v[248:251], v[240:243], v[64:79]
    ds_read_b64 v[48:49], v4 offset:18432
    ds_read_b64 v[50:51], v4 offset:18944
    ds_read_b64_tr_b16 v[56:57], v228 offset:26624
    ds_read_b64_tr_b16 v[58:59], v228 offset:27136
    s_waitcnt lgkmcnt(4)
    v_mfma_f32_32x32x16_bf16 v[64:79], v[40:43], v[32:35], v[64:79]
    ds_read_b64 v[240:241], v4 offset:20480
    ds_read_b64 v[242:243], v4 offset:20992
    ds_read_b64_tr_b16 v[248:249], v228 offset:28672
    ds_read_b64_tr_b16 v[250:251], v228 offset:29184
    s_waitcnt lgkmcnt(4)
    v_mfma_f32_32x32x16_bf16 v[64:79], v[56:59], v[48:51], v[64:79]
    ds_read_b64 v[32:33], v4 offset:22528
    ds_read_b64 v[34:35], v4 offset:23040
    ds_read_b64_tr_b16 v[40:41], v228 offset:30720
    ds_read_b64_tr_b16 v[42:43], v228 offset:31232
    s_waitcnt lgkmcnt(4)
    v_mfma_f32_32x32x16_bf16 v[64:79], v[248:251], v[240:243], v[64:79]
    s_waitcnt lgkmcnt(0)
    v_mfma_f32_32x32x16_bf16 v[64:79], v[40:43], v[32:35], v[64:79]
    s_nop 15
    s_mov_b32 s16, s72
    s_mov_b32 s17, s73
    s_and_b32 s17, s17, 0xffff
    s_mov_b32 s18, 2621440
    s_mov_b32 s19, 0x00020000
    v_permlane32_swap_b32 v164, v166
    v_permlane32_swap_b32 v165, v167
    s_nop 0
    v_lshlrev_b32 v14, 16, v164
    v_and_b32 v15, 0xffff0000, v164
    v_lshlrev_b32 v16, 16, v165
    v_and_b32 v17, 0xffff0000, v165
    v_fmac_f32 v14, v64, v128
    v_fmac_f32 v15, v65, v129
    v_fmac_f32 v16, v66, v130
    v_fmac_f32 v17, v67, v131
    v_lshlrev_b32 v18, 16, v166
    v_and_b32 v19, 0xffff0000, v166
    v_lshlrev_b32 v20, 16, v167
    v_and_b32 v21, 0xffff0000, v167
    v_fmac_f32 v18, v68, v132
    v_fmac_f32 v19, v69, v133
    v_fmac_f32 v20, v70, v134
    v_fmac_f32 v21, v71, v135
    v_cvt_pk_bf16_f32 v22, v14, v15
    v_cvt_pk_bf16_f32 v23, v16, v17
    v_cvt_pk_bf16_f32 v24, v18, v19
    v_cvt_pk_bf16_f32 v25, v20, v21
    s_nop 1
    v_permlane32_swap_b32 v22, v24
    v_permlane32_swap_b32 v23, v25
    buffer_store_dwordx4 v[22:25], v160, s[16:19], 0 offen offset:0
    v_permlane32_swap_b32 v168, v170
    v_permlane32_swap_b32 v169, v171
    s_nop 0
    v_lshlrev_b32 v26, 16, v168
    v_and_b32 v27, 0xffff0000, v168
    v_lshlrev_b32 v28, 16, v169
    v_and_b32 v29, 0xffff0000, v169
    v_fmac_f32 v26, v72, v136
    v_fmac_f32 v27, v73, v137
    v_fmac_f32 v28, v74, v138
    v_fmac_f32 v29, v75, v139
    v_lshlrev_b32 v30, 16, v170
    v_and_b32 v31, 0xffff0000, v170
    v_lshlrev_b32 v32, 16, v171
    v_and_b32 v33, 0xffff0000, v171
    v_fmac_f32 v30, v76, v140
    v_fmac_f32 v31, v77, v141
    v_fmac_f32 v32, v78, v142
    v_fmac_f32 v33, v79, v143
    v_cvt_pk_bf16_f32 v34, v26, v27
    v_cvt_pk_bf16_f32 v35, v28, v29
    v_cvt_pk_bf16_f32 v36, v30, v31
    v_cvt_pk_bf16_f32 v37, v32, v33
    s_nop 1
    v_permlane32_swap_b32 v34, v36
    v_permlane32_swap_b32 v35, v37
    buffer_store_dwordx4 v[34:37], v160, s[16:19], 0 offen offset:32
L_b23_done:
L_exit:
    s_endpgm
L_code_end:
.section .rodata,"a"
.p2align 6
.amdhsa_kernel recurrent_scan__softmax_full_mha__glu_gated_glu__prompt_kernel
  .amdhsa_next_free_vgpr 256
  .amdhsa_next_free_sgpr 102
  .amdhsa_accum_offset 256
  .amdhsa_group_segment_fixed_size 0
  .amdhsa_kernarg_size 80
  .amdhsa_user_sgpr_count 2
  .amdhsa_user_sgpr_kernarg_segment_ptr 1
  .amdhsa_system_sgpr_workgroup_id_x 1
  .amdhsa_float_denorm_mode_32 3
  .amdhsa_float_denorm_mode_16_64 3
.end_amdhsa_kernel
```
